```python
import torch

def _softmax(x, axis=-1):
    return torch.softmax(x, dim=axis)

def _gelu(x):
    return torch.nn.functional.gelu(x, approximate='tanh')

def _silu(x):
    return torch.nn.functional.silu(x)

def _sigmoid(x):
    return torch.sigmoid(x)

def _layernorm(x, axis=-1, eps=1e-05):
    m = x.mean(dim=axis, keepdim=True)
    v = x.var(dim=axis, keepdim=True, unbiased=False)
    return (x - m) / torch.sqrt(v + eps)

def _scatter_add(tgt, idx, src, axis=0):
    return tgt.clone().index_add_(axis, idx, src)

def _segment_sum(src, seg, n):
    out = torch.zeros((n,) + src.shape[1:], dtype=src.dtype)
    return out.index_add_(0, seg, src)

def _pad(x, pw):
    flat = tuple((v for pair in reversed(pw) for v in pair))
    return torch.nn.functional.pad(x, flat)
kernel_name = 'standalone__conformer_family_branchformer__speech'

def setup_inputs():

    _w = lambda a: (lambda t: t.to(torch.bfloat16) if t.is_floating_point() else t)(torch.as_tensor(a))
    B, T, D, K = (2, 4000, 256, 15)
    s = float(D) ** (-0.5)
    return {'x': _w((lambda *s: torch.randn(*s, dtype=torch.bfloat16) * 0.05)(B, T, D)), 'w_q': _w((lambda *s: torch.randn(*s, dtype=torch.bfloat16) * 1.6)(D, D) * s), 'w_k': _w((lambda *s: torch.randn(*s, dtype=torch.bfloat16) * 1.6)(D, D) * s), 'w_v': _w((lambda *s: torch.randn(*s, dtype=torch.bfloat16) * 0.4)(D, D) * s), 'w_ao': _w((lambda *s: torch.randn(*s, dtype=torch.bfloat16) * 0.4)(D, D) * s), 'w_up': _w((lambda *s: torch.randn(*s, dtype=torch.bfloat16) * 0.8)(D, 2 * D) * s), 'dw': _w((lambda *s: torch.randn(*s, dtype=torch.bfloat16) * 0.8)(K, D) * (1.0 / K)), 'w_dn': _w((lambda *s: torch.randn(*s, dtype=torch.bfloat16) * 0.4)(D, D) * s), 'w_merge': _w((lambda *s: torch.randn(*s, dtype=torch.bfloat16) * 0.4)(2 * D, D) * s)}

def reference(x, w_q, w_k, w_v, w_ao, w_up, dw, w_dn, w_merge):
    B, T, D = x.shape
    K = dw.shape[0]
    xa = _layernorm(x, axis=-1)
    q = torch.einsum('btd,de->bte', xa, w_q)
    k = torch.einsum('btd,de->bte', xa, w_k)
    v = torch.einsum('btd,de->bte', xa, w_v)
    logits = torch.einsum('btd,bsd->bts', q, k) * float(D) ** (-0.5)
    attn = _softmax(logits, axis=-1)
    ya = torch.einsum('bts,bsd->btd', attn, v)
    ya = torch.einsum('btd,de->bte', ya, w_ao)
    xc = _layernorm(x, axis=-1)
    h = _gelu(torch.einsum('btd,de->bte', xc, w_up))
    u = h[..., :D].clone()
    g = _layernorm(h[..., D:], axis=-1)
    pad = K // 2
    gp = _pad(g, ((0, 0), (pad, pad), (0, 0)))
    conv = torch.zeros_like(g)
    for i in range(K):
        conv = conv + gp[:, i:i + T, :] * dw[i][None, None, :]
    yc = torch.einsum('btd,de->bte', u * conv, w_dn)
    merged = torch.concatenate([ya, yc], axis=-1)
    out = torch.einsum('btf,fd->btd', merged, w_merge)
    return x + out
```

```asm
; @launch grid=(256,1,1) block=(256,1,1) lds=163840
.amdgcn_target "amdgcn-amd-amdhsa--gfx950"
.text
.globl standalone__conformer_family_branchformer__speech_kernel
.p2align 12
.p2align 8
.type standalone__conformer_family_branchformer__speech_kernel,@function
standalone__conformer_family_branchformer__speech_kernel:
    s_cmp_ge_u32 s2, 256
    s_cbranch_scc1 L_end
    s_load_dwordx16 s[4:19], s[0:1], 0
    s_load_dwordx8 s[20:27], s[0:1], 64
    s_getpc_b64 s[70:71]
L_pc:
    s_bfe_u32 s72, s2, 0x30003
    s_lshl_b32 s72, s72, 13
    v_lshrrev_b32 v19, 2, v0
    v_lshlrev_b32 v19, 7, v19
    v_add_u32 v17, s72, v19
    v_min_u32 v17, L_end-L_pc, v17
    global_load_dword v128, v17, s[70:71]
    v_lshrrev_b32 v2, 6, v0
    v_and_b32 v1, 63, v0
    v_readfirstlane_b32 s52, v2
    s_mov_b32 s3, s2
    s_and_b32 s2, s3, 0xf2
    s_and_b32 s72, s3, 1
    s_lshl_b32 s72, s72, 3
    s_or_b32 s2, s2, s72
    s_bfe_u32 s72, s3, 0x10002
    s_bfe_u32 s73, s3, 0x10003
    s_cmp_ge_u32 s2, 248
    s_cselect_b32 s74, s73, s72
    s_cselect_b32 s73, s72, s73
    s_lshl_b32 s74, s74, 2
    s_or_b32 s2, s2, s74
    s_or_b32 s2, s2, s73
    v_and_b32 v8, 15, v1
    v_lshrrev_b32 v9, 4, v1
    v_bfe_u32 v10, v1, 4, 1
    v_lshrrev_b32 v11, 5, v1
    v_lshl_add_u32 v10, v10, 1, v11
    s_mul_i32 s57, s52, 40960
    s_mov_b32 s67, 0xffff0000
    s_movk_i32 s68, 4096
    s_movk_i32 s69, 16384
    s_and_b32 s54, s2, 1
    s_bfe_u32 s53, s2, 0x10001
    s_lshr_b32 s70, s2, 2
    s_lshl_b32 s70, s70, 1
    s_add_u32 s55, s70, s54
    s_lshr_b32 s71, s52, 1
    s_xor_b32 s71, s71, 1
    s_xor_b32 s65, s55, s71
    s_and_b32 s71, s52, 1
    s_lshl_b32 s72, s65, 1
    s_add_u32 s72, s72, s71
    s_lshl_b32 s72, s72, 13
    v_xor_b32 v16, v1, v11
    v_lshlrev_b32 v13, 4, v16
    v_add_u32 v144, s72, v13
    v_xor_b32 v145, 32, v144
    v_xor_b32 v146, 64, v144
    v_xor_b32 v147, 96, v144
    v_xor_b32 v148, 128, v144
    v_xor_b32 v149, 160, v144
    v_xor_b32 v150, 192, v144
    v_xor_b32 v151, 224, v144
    v_lshrrev_b32 v16, 3, v1
    v_and_b32 v17, 7, v1
    v_and_b32 v18, 2, v16
    v_xor_b32 v17, v17, v18
    v_lshlrev_b32 v16, 10, v16
    v_lshl_add_u32 v14, v17, 4, v16
    s_lshl_b32 s73, s52, 7
    s_add_u32 s73, s73, 512
    v_add_u32 v137, s73, v14
    s_lshr_b32 s79, s2, 7
    s_mul_i32 s79, s79, 6
    s_xor_b32 s79, s79, s2
    s_lshl_b32 s73, s52, 6
    v_xor_b32 v16, s73, v13
    s_lshl_b32 s73, s52, 12
    v_add_u32 v16, s73, v16
    s_and_b32 s73, s79, 7
    s_lshl_b32 s73, s73, 14
    v_add_u32 v164, s73, v16
    v_xor_b32 v165, 32, v164
    s_bfe_u32 s73, s79, 0x30004
    s_lshl_b32 s73, s73, 14
    s_bfe_u32 s72, s79, 0x10003
    s_lshl_b32 s72, s72, 11
    s_add_u32 s73, s73, s72
    v_add_u32 v188, s73, v16
    v_xor_b32 v189, 32, v188
    s_waitcnt lgkmcnt(0)
    s_load_dword s56, s[26:27], 0
    s_mov_b32 s40, s26
    s_mov_b32 s41, s27
    s_mov_b32 s42, 16777216
    s_mov_b32 s43, 0x20000
    s_cmp_ge_u32 s2, 252
    s_cbranch_scc1 L_fold
    s_mov_b32 s32, s14
    s_mov_b32 s33, s15
    s_mov_b32 s34, 262144
    s_mov_b32 s35, 0x20000
    s_bfe_u32 s73, s3, 0x40003
    s_lshl_b32 s73, s73, 14
    v_lshrrev_b32 v139, 9, v19
    v_lshl_add_u32 v139, v139, 9, v19
    buffer_load_dword v130, v139, s[32:35], s73 offen offset:512
    v_add_u32 v132, 7168, v137
    v_xor_b32 v139, 64, v137
    v_add_u32 v133, 14336, v139
    v_add_u32 v134, 21504, v139
    s_add_u32 m0, s57, 26624
    s_nop 0
    global_load_lds_dwordx4 v164, s[6:7] offset:0
    global_load_lds_dwordx4 v165, s[6:7] offset:1024
    v_lshlrev_b32 v30, 4, v1
    v_lshlrev_b32 v173, 2, v1
    v_bfe_u32 v16, v8, 2, 1
    v_bfe_u32 v17, v8, 3, 1
    v_lshl_add_u32 v16, v16, 1, v17
    v_and_b32 v17, 3, v8
    v_lshl_add_u32 v18, v16, 2, v17
    v_xor_b32 v18, v18, v9
    v_lshlrev_b32 v18, 4, v18
    v_lshl_add_u32 v18, v17, 9, v18
    global_load_lds_dwordx4 v164, s[6:7] offset:2048
    v_mul_u32_u24 v16, 40960, v16
    v_add_u32 v160, v16, v18
    v_xor_b32 v161, 64, v160
    v_xor_b32 v162, 128, v160
    v_xor_b32 v163, 192, v160
    s_bfe_u32 s70, s79, 0x20005
    s_lshl_b32 s70, s70, 3
    s_and_b32 s71, s79, 7
    s_add_u32 s70, s70, s71
    s_bfe_u32 s71, s79, 0x20003
    global_load_lds_dwordx4 v165, s[6:7] offset:3072
    s_and_b32 s74, s79, 0x70
    s_and_b32 s72, s79, 7
    s_lshl_b32 s72, s72, 1
    s_or_b32 s74, s74, s72
    s_and_b32 s72, s71, 1
    s_or_b32 s74, s74, s72
    s_lshl_b32 s74, s74, 10
    s_add_u32 s74, s74, 6291456
    s_lshl_b32 s72, s70, 5
    s_add_u32 s72, s72, s71
    s_add_u32 m0, s57, 30720
    s_nop 0
    global_load_lds_dwordx4 v188, s[8:9] offset:0
    s_lshl_b32 s72, s72, 2
    s_add_u32 s75, s72, 40960
    s_lshl_b32 s72, s52, 28
    s_add_u32 s74, s74, s72
    s_add_u32 s75, s75, s72
    s_mul_i32 s70, s53, 2048000
    s_add_u32 s48, s22, s70
    s_addc_u32 s49, s23, 0
    s_mov_b32 s50, 2048000
    s_mov_b32 s51, 0x20000
    global_load_lds_dwordx4 v189, s[8:9] offset:1024
    s_add_u32 s70, s70, 1048576
    s_add_u32 s44, s26, s70
    s_addc_u32 s45, s27, 0
    s_mov_b32 s46, 2048000
    s_mov_b32 s47, 0x20000
    s_mul_i32 s66, s54, 63
    s_lshl_b32 s70, s52, 4
    s_add_u32 s66, s66, s70
    s_add_u32 s70, s52, s54
    s_cmp_ge_u32 s70, 3
    s_cselect_b32 s64, 1, 0
    s_mul_i32 s73, s53, 2048000
    s_add_u32 s28, s4, s73
    s_addc_u32 s29, s5, 0
    s_mov_b32 s30, 2048000
    s_mov_b32 s31, 0x20000
    s_add_u32 m0, s57, 32768
    s_nop 0
    buffer_load_dwordx4 v144, s[28:31], 0 offen offset:0 lds
    s_cmp_eq_u32 s70, 4
    s_cselect_b32 s70, 1, 0
    s_sub_u32 s66, s66, s70
    s_lshl_b32 s70, s66, 14
    s_lshr_b32 s71, s52, 1
    s_lshl_b32 s71, s71, 13
    s_add_u32 s72, s70, s71
    s_add_u32 s58, s44, s72
    s_addc_u32 s59, s45, 0
    s_xor_b32 s72, s72, 8192
    buffer_load_dwordx4 v145, s[28:31], 0 offen offset:1024 lds
    s_add_u32 s60, s44, s72
    s_addc_u32 s61, s45, 0
    s_mov_b32 s62, 0x5d800000
    s_mov_b32 s63, 0x21800000
    s_mov_b32 s77, 0
    s_mov_b32 s12, 0x100001
    s_mov_b32 s13, 0x10000100
    s_mov_b32 s14, 0x200002
    s_mov_b32 s15, 0x20000200
    s_mov_b32 s16, 0x400004
    buffer_load_dwordx4 v146, s[28:31], 0 offen offset:2048 lds
    s_mov_b32 s17, 0x40000400
    s_mov_b32 s18, 0x800008
    s_mov_b32 s19, 0x80000800
    v_lshlrev_b32 v16, 3, v11
    v_xor_b32 v16, v8, v16
    v_lshlrev_b32 v16, 4, v16
    v_lshl_add_u32 v29, v10, 9, v16
    s_and_b32 s71, s52, 1
    s_lshl_b32 s71, s71, 8
    s_lshl_b32 s72, s65, 14
    buffer_load_dwordx4 v147, s[28:31], 0 offen offset:3072 lds
    s_add_u32 s71, s71, s72
    s_lshl_b32 s72, s54, 13
    s_add_u32 s71, s71, s72
    v_add_u32 v26, s71, v29
    s_lshl_b32 s72, s54, 12
    s_add_u32 s72, s72, s57
    s_add_u32 s72, s72, 32768
    v_add_u32 v27, s72, v30
    v_xor_b32 v28, 4096, v27
    v_xor_b32 v16, v10, v8
    s_add_u32 m0, s57, 36864
    s_nop 0
    buffer_load_dwordx4 v148, s[28:31], s68 offen offset:0 lds
    v_lshlrev_b32 v16, 4, v16
    v_lshl_add_u32 v16, v8, 9, v16
    s_lshl_b32 s72, s54, 8
    s_add_u32 s72, s72, s57
    v_add_u32 v152, s72, v16
    v_xor_b32 v153, 64, v152
    v_xor_b32 v154, 128, v152
    v_xor_b32 v155, 192, v152
    v_xor_b32 v156, 256, v152
    v_xor_b32 v157, 320, v152
    buffer_load_dwordx4 v149, s[28:31], s68 offen offset:1024 lds
    v_xor_b32 v158, 384, v152
    v_xor_b32 v159, 448, v152
    v_lshrrev_b32 v16, 3, v8
    v_and_b32 v18, 2, v10
    v_or_b32 v16, v16, v18
    v_lshlrev_b32 v16, 5, v16
    v_bfe_u32 v18, v8, 1, 1
    v_lshl_add_u32 v16, v18, 4, v16
    v_and_b32 v18, 1, v8
    v_lshl_add_u32 v16, v18, 3, v16
    buffer_load_dwordx4 v150, s[28:31], s68 offen offset:2048 lds
    v_lshrrev_b32 v18, 2, v8
    v_lshl_add_u32 v16, v18, 7, v16
    v_lshl_add_u32 v16, v10, 10, v16
    v_add_u32 v2, s57, v16
    v_xor_b32 v3, 32, v2
    v_xor_b32 v4, 64, v2
    v_xor_b32 v5, 96, v2
    v_bfe_u32 v16, v1, 2, 3
    v_and_b32 v17, 3, v1
    v_lshl_add_u32 v16, v16, 5, v17
    buffer_load_dwordx4 v151, s[28:31], s68 offen offset:3072 lds
    v_lshlrev_b32 v16, 2, v16
    s_lshl_b32 s72, s52, 10
    s_add_u32 s72, s72, 40960
    v_add_u32 v166, s72, v16
    s_mul_i32 s70, s53, 2048000
    s_add_u32 s70, s70, 16777216
    s_add_u32 s36, s26, s70
    s_addc_u32 s37, s27, 0
    s_mov_b32 s38, 2048000
    s_mov_b32 s39, 0x20000
    s_add_u32 m0, s57, 0
    s_mov_b32 s81, 0
    buffer_load_dwordx4 v137, s[32:35], s81 offen offset:0 lds
    s_mul_i32 s70, s52, 512000
    s_lshl_b32 s71, s55, 8
    s_add_u32 s70, s70, s71
    s_cmp_gt_u32 s55, 124
    s_cselect_b32 s70, 0x40000000, s70
    v_mul_u32_u24 v16, 32000, v9
    v_lshl_add_u32 v16, v8, 4, v16
    v_add_u32 v167, s70, v16
    v_lshrrev_b32 v16, 3, v8
    v_mul_u32_u24 v16, 40704, v16
    buffer_load_dwordx4 v132, s[32:35], s81 offen offset:1024 lds
    v_lshl_add_u32 v16, v8, 5, v16
    v_lshl_add_u32 v16, v9, 8, v16
    v_add_u32 v172, 81920, v16
    s_lshl_b32 s72, s53, 7
    s_add_u32 s72, s72, s55
    s_lshl_b32 s72, s72, 5
    s_add_u32 s72, s72, s52
    s_lshl_b32 s72, s72, 2
    s_add_u32 s83, s72, 4112
    v_lshrrev_b32 v16, 2, v1
    s_sub_u32 s72, 15, s64
    v_min_u32 v16, s72, v16
    s_lshl_b32 s72, s53, 7
    s_add_u32 s72, s72, s66
    v_add_u32 v16, s72, v16
    v_and_b32 v18, 3, v1
    v_lshl_add_u32 v16, v16, 5, v18
    v_lshlrev_b32 v16, 2, v16
    v_add_u32 v6, 4096, v16
    s_lshl_b32 s72, s53, 7
    s_add_u32 s72, s72, s65
    s_lshl_b32 s72, s72, 5
    s_and_b32 s71, s52, 1
    s_lshl_b32 s71, s71, 1
    s_add_u32 s72, s72, s71
    s_add_u32 s72, s72, s54
    s_lshl_b32 s72, s72, 2
    s_add_u32 s82, s72, 4096
    v_add_u32 v8, 0, v30
    v_add_u32 v9, 40960, v30
    v_add_u32 v10, 81920, v30
    v_add_u32 v11, 122880, v30
    v_mov_b32 v20, 0x3f803f80
    v_mov_b32 v21, 0x3f803f80
    v_mov_b32 v22, 0x3f803f80
    v_mov_b32 v23, 0x3f803f80
    s_xor_b32 s71, s52, 0
    s_mul_i32 s71, s71, 40960
    v_add_u32 v12, s71, v30
    s_xor_b32 s71, s52, 1
    s_mul_i32 s71, s71, 40960
    v_add_u32 v13, s71, v30
    s_xor_b32 s71, s52, 2
    s_mul_i32 s71, s71, 40960
    v_add_u32 v14, s71, v30
    s_xor_b32 s71, s52, 3
    s_mul_i32 s71, s71, 40960
    v_add_u32 v15, s71, v30
    v_lshlrev_b32 v16, 3, v1
    v_sub_u32 v168, v12, v16
    v_sub_u32 v169, v13, v16
    v_sub_u32 v170, v14, v16
    v_sub_u32 v171, v15, v16
    s_waitcnt lgkmcnt(0)
    s_mul_i32 s56, s56, 1664525
    s_add_u32 s56, s56, 1013904223
    v_mov_b32 v7, s56
    s_mov_b32 vcc_lo, 0xf0000f
    s_mov_b32 vcc_hi, 0xf0000f00
    s_waitcnt vmcnt(10)
    s_barrier
    s_cmp_eq_u32 s52, 0
    s_cbranch_scc1 L_mtile
    s_mov_b64 exec, 0
    s_cmp_eq_u32 s52, 1
    s_cbranch_scc1 L_pk0
    s_cmp_eq_u32 s52, 2
    s_cbranch_scc1 L_pk1
    s_branch L_pk2
L_mtile:
    ds_read_b128 a[0:3], v160 offset:26624
    ds_read_b128 a[4:7], v160 offset:28672
    ds_read_b128 a[8:11], v160 offset:30720
    ds_read_b128 a[12:15], v161 offset:26624
    ds_read_b128 a[16:19], v161 offset:28672
    ds_read_b128 a[20:23], v161 offset:30720
    ds_read_b128 a[24:27], v162 offset:26624
    ds_read_b128 a[28:31], v162 offset:28672
    ds_read_b128 a[32:35], v162 offset:30720
    ds_read_b128 a[36:39], v163 offset:26624
    ds_read_b128 a[40:43], v163 offset:28672
    ds_read_b128 a[44:47], v163 offset:30720
    s_waitcnt lgkmcnt(9)
    v_mfma_f32_16x16x32_bf16 v[248:251], a[0:3], a[8:11], 0
    v_mfma_f32_16x16x32_bf16 v[252:255], a[4:7], a[8:11], 0
    ds_read_b128 a[48:51], v160 offset:26880
    ds_read_b128 a[52:55], v160 offset:28928
    ds_read_b128 a[56:59], v160 offset:30976
    s_waitcnt lgkmcnt(9)
    v_mfma_f32_16x16x32_bf16 v[248:251], a[12:15], a[20:23], v[248:251]
    v_mfma_f32_16x16x32_bf16 v[252:255], a[16:19], a[20:23], v[252:255]
    ds_read_b128 a[60:63], v161 offset:26880
    ds_read_b128 a[64:67], v161 offset:28928
    ds_read_b128 a[68:71], v161 offset:30976
    s_waitcnt lgkmcnt(9)
    v_mfma_f32_16x16x32_bf16 v[248:251], a[24:27], a[32:35], v[248:251]
    v_mfma_f32_16x16x32_bf16 v[252:255], a[28:31], a[32:35], v[252:255]
    ds_read_b128 a[72:75], v162 offset:26880
    ds_read_b128 a[76:79], v162 offset:28928
    ds_read_b128 a[80:83], v162 offset:30976
    s_waitcnt lgkmcnt(9)
    v_mfma_f32_16x16x32_bf16 v[248:251], a[36:39], a[44:47], v[248:251]
    v_mfma_f32_16x16x32_bf16 v[252:255], a[40:43], a[44:47], v[252:255]
    ds_read_b128 a[84:87], v163 offset:26880
    ds_read_b128 a[88:91], v163 offset:28928
    ds_read_b128 a[92:95], v163 offset:30976
    s_waitcnt lgkmcnt(9)
    v_mfma_f32_16x16x32_bf16 v[248:251], a[48:51], a[56:59], v[248:251]
    v_mfma_f32_16x16x32_bf16 v[252:255], a[52:55], a[56:59], v[252:255]
    s_waitcnt lgkmcnt(6)
    v_mfma_f32_16x16x32_bf16 v[248:251], a[60:63], a[68:71], v[248:251]
    v_mfma_f32_16x16x32_bf16 v[252:255], a[64:67], a[68:71], v[252:255]
    s_waitcnt lgkmcnt(3)
    v_mfma_f32_16x16x32_bf16 v[248:251], a[72:75], a[80:83], v[248:251]
    v_mfma_f32_16x16x32_bf16 v[252:255], a[76:79], a[80:83], v[252:255]
    s_waitcnt lgkmcnt(0)
    v_mfma_f32_16x16x32_bf16 v[248:251], a[84:87], a[92:95], v[248:251]
    v_mfma_f32_16x16x32_bf16 v[252:255], a[88:91], a[92:95], v[252:255]
L_pkdone:
    s_mov_b64 exec, -1
    s_nop 7
    v_cvt_pk_bf16_f32 v176, v248, v249
    v_cvt_pk_bf16_f32 v177, v250, v251
    v_cvt_pk_bf16_f32 v178, v252, v253
    v_cvt_pk_bf16_f32 v179, v254, v255
    buffer_store_dwordx4 v[176:179], v30, s[40:43], s74 offen sc1
    buffer_load_dwordx4 v133, s[32:35], s81 offen offset:2048 lds
    buffer_load_dwordx4 v134, s[32:35], s81 offen offset:3072 lds
    s_add_u32 m0, s57, 4096
    s_mov_b32 s81, 32768
    buffer_load_dwordx4 v137, s[32:35], s81 offen offset:0 lds
    buffer_load_dwordx4 v132, s[32:35], s81 offen offset:1024 lds
    buffer_load_dwordx4 v133, s[32:35], s81 offen offset:2048 lds
    buffer_load_dwordx4 v134, s[32:35], s81 offen offset:3072 lds
    s_add_u32 m0, s57, 8192
    s_mov_b32 s81, 65536
    buffer_load_dwordx4 v137, s[32:35], s81 offen offset:0 lds
    buffer_load_dwordx4 v132, s[32:35], s81 offen offset:1024 lds
    buffer_load_dwordx4 v133, s[32:35], s81 offen offset:2048 lds
    buffer_load_dwordx4 v134, s[32:35], s81 offen offset:3072 lds
    s_waitcnt vmcnt(13)
    ds_read_b128 v[32:35], v152 offset:32768
    ds_read_b128 v[36:39], v153 offset:32768
    ds_read_b128 v[40:43], v154 offset:32768
    ds_read_b128 v[44:47], v155 offset:32768
    ds_read_b128 v[48:51], v156 offset:32768
    ds_read_b128 v[52:55], v157 offset:32768
    ds_read_b128 v[56:59], v158 offset:32768
    ds_read_b128 v[60:63], v159 offset:32768
    s_waitcnt lgkmcnt(7)
    v_mfma_f32_16x16x32_bf16 v[140:143], v[32:35], v[32:35], 0
    v_lshlrev_b32 v64, 16, v32
    v_and_b32 v65, s67, v32
    v_lshlrev_b32 v66, 16, v33
    v_and_b32 v67, s67, v33
    v_mfma_f32_16x16x32_bf16 v[16:19], v[20:23], v[32:35], 0
    v_lshlrev_b32 v68, 16, v34
    v_and_b32 v69, s67, v34
    s_add_u32 m0, s57, 12288
    s_mov_b32 s81, 98304
    buffer_load_dwordx4 v137, s[32:35], s81 offen offset:0 lds
    v_lshlrev_b32 v70, 16, v35
    v_and_b32 v71, s67, v35
    s_waitcnt lgkmcnt(6)
    v_mfma_f32_16x16x32_bf16 v[140:143], v[36:39], v[36:39], v[140:143]
    v_lshlrev_b32 v72, 16, v36
    v_and_b32 v73, s67, v36
    v_lshlrev_b32 v74, 16, v37
    v_and_b32 v75, s67, v37
    v_mfma_f32_16x16x32_bf16 v[16:19], v[20:23], v[36:39], v[16:19]
    v_lshlrev_b32 v76, 16, v38
    buffer_load_dwordx4 v132, s[32:35], s81 offen offset:1024 lds
    v_and_b32 v77, s67, v38
    v_lshlrev_b32 v78, 16, v39
    v_and_b32 v79, s67, v39
    s_waitcnt lgkmcnt(5)
    v_mfma_f32_16x16x32_bf16 v[140:143], v[40:43], v[40:43], v[140:143]
    v_lshlrev_b32 v80, 16, v40
    v_and_b32 v81, s67, v40
    v_lshlrev_b32 v82, 16, v41
    v_and_b32 v83, s67, v41
    buffer_load_dwordx4 v133, s[32:35], s81 offen offset:2048 lds
    v_mfma_f32_16x16x32_bf16 v[16:19], v[20:23], v[40:43], v[16:19]
    v_lshlrev_b32 v84, 16, v42
    v_and_b32 v85, s67, v42
    v_lshlrev_b32 v86, 16, v43
    v_and_b32 v87, s67, v43
    s_waitcnt lgkmcnt(4)
    v_mfma_f32_16x16x32_bf16 v[140:143], v[44:47], v[44:47], v[140:143]
    v_lshlrev_b32 v88, 16, v44
    v_and_b32 v89, s67, v44
    buffer_load_dwordx4 v134, s[32:35], s81 offen offset:3072 lds
    v_lshlrev_b32 v90, 16, v45
    v_and_b32 v91, s67, v45
    v_mfma_f32_16x16x32_bf16 v[16:19], v[20:23], v[44:47], v[16:19]
    v_lshlrev_b32 v92, 16, v46
    v_and_b32 v93, s67, v46
    v_lshlrev_b32 v94, 16, v47
    v_and_b32 v95, s67, v47
    s_waitcnt lgkmcnt(3)
    v_mfma_f32_16x16x32_bf16 v[140:143], v[48:51], v[48:51], v[140:143]
    v_lshlrev_b32 v96, 16, v48
    s_add_u32 m0, s57, 16384
    s_mov_b32 s81, 131072
    buffer_load_dwordx4 v137, s[32:35], s81 offen offset:0 lds
    v_and_b32 v97, s67, v48
    v_lshlrev_b32 v98, 16, v49
    v_and_b32 v99, s67, v49
    v_mfma_f32_16x16x32_bf16 v[16:19], v[20:23], v[48:51], v[16:19]
    v_lshlrev_b32 v100, 16, v50
    v_and_b32 v101, s67, v50
    v_lshlrev_b32 v102, 16, v51
    v_and_b32 v103, s67, v51
    buffer_load_dwordx4 v132, s[32:35], s81 offen offset:1024 lds
    s_waitcnt lgkmcnt(2)
    v_mfma_f32_16x16x32_bf16 v[140:143], v[52:55], v[52:55], v[140:143]
    v_lshlrev_b32 v104, 16, v52
    v_and_b32 v105, s67, v52
    v_lshlrev_b32 v106, 16, v53
    v_and_b32 v107, s67, v53
    v_mfma_f32_16x16x32_bf16 v[16:19], v[20:23], v[52:55], v[16:19]
    v_lshlrev_b32 v108, 16, v54
    v_and_b32 v109, s67, v54
    buffer_load_dwordx4 v133, s[32:35], s81 offen offset:2048 lds
    v_lshlrev_b32 v110, 16, v55
    v_and_b32 v111, s67, v55
    s_waitcnt lgkmcnt(1)
    v_mfma_f32_16x16x32_bf16 v[140:143], v[56:59], v[56:59], v[140:143]
    s_waitcnt vmcnt(17)
    s_mov_b64 exec, 1
    buffer_store_dword v7, off, s[40:43], s75 sc1
    s_mov_b64 exec, -1
    v_lshlrev_b32 v112, 16, v56
    v_and_b32 v113, s67, v56
    v_lshlrev_b32 v114, 16, v57
    v_and_b32 v115, s67, v57
    v_mfma_f32_16x16x32_bf16 v[16:19], v[20:23], v[56:59], v[16:19]
    v_lshlrev_b32 v116, 16, v58
    buffer_load_dwordx4 v134, s[32:35], s81 offen offset:3072 lds
    v_and_b32 v117, s67, v58
    v_lshlrev_b32 v118, 16, v59
    v_and_b32 v119, s67, v59
    s_waitcnt lgkmcnt(0)
    v_mfma_f32_16x16x32_bf16 v[140:143], v[60:63], v[60:63], v[140:143]
    v_mfma_f32_16x16x32_bf16 v[16:19], v[20:23], v[60:63], v[16:19]
    v_lshlrev_b32 v120, 16, v60
    v_and_b32 v121, s67, v60
    v_lshlrev_b32 v122, 16, v61
    s_add_u32 m0, s57, 20480
    s_mov_b32 s81, 163840
    buffer_load_dwordx4 v137, s[32:35], s81 offen offset:0 lds
    v_and_b32 v123, s67, v61
    v_lshlrev_b32 v124, 16, v62
    v_and_b32 v125, s67, v62
    v_lshlrev_b32 v126, 16, v63
    v_and_b32 v127, s67, v63
    v_cndmask_b32 v18, v141, v140, s[12:13]
    v_cndmask_b32 v18, v18, v142, s[16:17]
    v_cndmask_b32 v18, v18, v143, s[18:19]
    buffer_load_dwordx4 v132, s[32:35], s81 offen offset:1024 lds
    v_cndmask_b32 v18, 0, v18, vcc
    v_mul_f32 v16, 0xbb800000, v16
    v_mov_b32 v19, v18
    v_mul_f32 v17, 0x41800000, v16
    v_mul_f32 v17, v17, v17
    v_permlane32_swap_b32 v19, v18
    v_add_f32 v18, v18, v19
    v_mov_b32 v19, v18
    buffer_load_dwordx4 v133, s[32:35], s81 offen offset:2048 lds
    v_mov_b32 v20, 0x38e894e4
    s_nop 0
    v_permlane16_swap_b32 v19, v18
    v_add_f32 v18, v18, v19
    v_sub_f32 v18, v18, v17
    v_max_f32 v18, 0, v18
    v_fmamk_f32 v18, v18, 0x3d317218, v20
    v_rsq_f32 v18, v18
    s_nop 0
    v_mul_f32 v19, v16, v18
    buffer_load_dwordx4 v134, s[32:35], s81 offen offset:3072 lds
    s_barrier
    v_pk_fma_f32 v[64:65], v[64:65], v[18:19], v[18:19] op_sel:[0,0,1] op_sel_hi:[1,0,1]
    v_pk_fma_f32 v[66:67], v[66:67], v[18:19], v[18:19] op_sel:[0,0,1] op_sel_hi:[1,0,1]
    v_pk_fma_f32 v[68:69], v[68:69], v[18:19], v[18:19] op_sel:[0,0,1] op_sel_hi:[1,0,1]
    v_pk_fma_f32 v[70:71], v[70:71], v[18:19], v[18:19] op_sel:[0,0,1] op_sel_hi:[1,0,1]
    v_cvt_pk_bf16_f32 v32, v64, v65
    v_cvt_pk_bf16_f32 v33, v66, v67
    v_cvt_pk_bf16_f32 v34, v68, v69
    v_cvt_pk_bf16_f32 v35, v70, v71
    ds_write_b128 v27, v[32:35] offset:0
    buffer_store_dwordx4 v[32:35], v26, s[44:47], 0 offen offset:0 sc1
    v_pk_fma_f32 v[72:73], v[72:73], v[18:19], v[18:19] op_sel:[0,0,1] op_sel_hi:[1,0,1]
    v_pk_fma_f32 v[74:75], v[74:75], v[18:19], v[18:19] op_sel:[0,0,1] op_sel_hi:[1,0,1]
    v_pk_fma_f32 v[76:77], v[76:77], v[18:19], v[18:19] op_sel:[0,0,1] op_sel_hi:[1,0,1]
L_pk0:
    s_cbranch_execz L_pk3
    v_pk_fma_f32 v[78:79], v[78:79], v[18:19], v[18:19] op_sel:[0,0,1] op_sel_hi:[1,0,1]
    v_cvt_pk_bf16_f32 v36, v72, v73
    v_cvt_pk_bf16_f32 v37, v74, v75
    v_cvt_pk_bf16_f32 v38, v76, v77
    v_cvt_pk_bf16_f32 v39, v78, v79
    ds_write_b128 v27, v[36:39] offset:1024
    buffer_store_dwordx4 v[36:39], v26, s[44:47], 0 offen offset:2048 sc1
    v_pk_fma_f32 v[80:81], v[80:81], v[18:19], v[18:19] op_sel:[0,0,1] op_sel_hi:[1,0,1]
    v_pk_fma_f32 v[82:83], v[82:83], v[18:19], v[18:19] op_sel:[0,0,1] op_sel_hi:[1,0,1]
    v_pk_fma_f32 v[84:85], v[84:85], v[18:19], v[18:19] op_sel:[0,0,1] op_sel_hi:[1,0,1]
    v_pk_fma_f32 v[86:87], v[86:87], v[18:19], v[18:19] op_sel:[0,0,1] op_sel_hi:[1,0,1]
    v_cvt_pk_bf16_f32 v40, v80, v81
    v_cvt_pk_bf16_f32 v41, v82, v83
    v_cvt_pk_bf16_f32 v42, v84, v85
    v_cvt_pk_bf16_f32 v43, v86, v87
    ds_write_b128 v27, v[40:43] offset:2048
    buffer_store_dwordx4 v[40:43], v26, s[44:47], s68 offen offset:0 sc1
    v_pk_fma_f32 v[88:89], v[88:89], v[18:19], v[18:19] op_sel:[0,0,1] op_sel_hi:[1,0,1]
    v_pk_fma_f32 v[90:91], v[90:91], v[18:19], v[18:19] op_sel:[0,0,1] op_sel_hi:[1,0,1]
    v_pk_fma_f32 v[92:93], v[92:93], v[18:19], v[18:19] op_sel:[0,0,1] op_sel_hi:[1,0,1]
    v_pk_fma_f32 v[94:95], v[94:95], v[18:19], v[18:19] op_sel:[0,0,1] op_sel_hi:[1,0,1]
    v_cvt_pk_bf16_f32 v44, v88, v89
    v_cvt_pk_bf16_f32 v45, v90, v91
    v_cvt_pk_bf16_f32 v46, v92, v93
    v_cvt_pk_bf16_f32 v47, v94, v95
    ds_write_b128 v27, v[44:47] offset:3072
    buffer_store_dwordx4 v[44:47], v26, s[44:47], s68 offen offset:2048 sc1
    v_pk_fma_f32 v[96:97], v[96:97], v[18:19], v[18:19] op_sel:[0,0,1] op_sel_hi:[1,0,1]
    v_pk_fma_f32 v[98:99], v[98:99], v[18:19], v[18:19] op_sel:[0,0,1] op_sel_hi:[1,0,1]
    v_pk_fma_f32 v[100:101], v[100:101], v[18:19], v[18:19] op_sel:[0,0,1] op_sel_hi:[1,0,1]
    v_pk_fma_f32 v[102:103], v[102:103], v[18:19], v[18:19] op_sel:[0,0,1] op_sel_hi:[1,0,1]
    v_cvt_pk_bf16_f32 v48, v96, v97
    v_cvt_pk_bf16_f32 v49, v98, v99
    v_cvt_pk_bf16_f32 v50, v100, v101
    v_cvt_pk_bf16_f32 v51, v102, v103
    ds_write_b128 v28, v[48:51] offset:0
    v_pk_fma_f32 v[104:105], v[104:105], v[18:19], v[18:19] op_sel:[0,0,1] op_sel_hi:[1,0,1]
    v_pk_fma_f32 v[106:107], v[106:107], v[18:19], v[18:19] op_sel:[0,0,1] op_sel_hi:[1,0,1]
    v_pk_fma_f32 v[108:109], v[108:109], v[18:19], v[18:19] op_sel:[0,0,1] op_sel_hi:[1,0,1]
    v_pk_fma_f32 v[110:111], v[110:111], v[18:19], v[18:19] op_sel:[0,0,1] op_sel_hi:[1,0,1]
    v_cvt_pk_bf16_f32 v52, v104, v105
    v_cvt_pk_bf16_f32 v53, v106, v107
    v_cvt_pk_bf16_f32 v54, v108, v109
    v_cvt_pk_bf16_f32 v55, v110, v111
    ds_write_b128 v28, v[52:55] offset:1024
    v_pk_fma_f32 v[112:113], v[112:113], v[18:19], v[18:19] op_sel:[0,0,1] op_sel_hi:[1,0,1]
    v_pk_fma_f32 v[114:115], v[114:115], v[18:19], v[18:19] op_sel:[0,0,1] op_sel_hi:[1,0,1]
    v_pk_fma_f32 v[116:117], v[116:117], v[18:19], v[18:19] op_sel:[0,0,1] op_sel_hi:[1,0,1]
    v_pk_fma_f32 v[118:119], v[118:119], v[18:19], v[18:19] op_sel:[0,0,1] op_sel_hi:[1,0,1]
    v_cvt_pk_bf16_f32 v56, v112, v113
    v_cvt_pk_bf16_f32 v57, v114, v115
    v_cvt_pk_bf16_f32 v58, v116, v117
    v_cvt_pk_bf16_f32 v59, v118, v119
    ds_write_b128 v28, v[56:59] offset:2048
    v_pk_fma_f32 v[120:121], v[120:121], v[18:19], v[18:19] op_sel:[0,0,1] op_sel_hi:[1,0,1]
    v_pk_fma_f32 v[122:123], v[122:123], v[18:19], v[18:19] op_sel:[0,0,1] op_sel_hi:[1,0,1]
    v_pk_fma_f32 v[124:125], v[124:125], v[18:19], v[18:19] op_sel:[0,0,1] op_sel_hi:[1,0,1]
    v_pk_fma_f32 v[126:127], v[126:127], v[18:19], v[18:19] op_sel:[0,0,1] op_sel_hi:[1,0,1]
    v_cvt_pk_bf16_f32 v60, v120, v121
    v_cvt_pk_bf16_f32 v61, v122, v123
    v_cvt_pk_bf16_f32 v62, v124, v125
    v_cvt_pk_bf16_f32 v63, v126, v127
    ds_write_b128 v28, v[60:63] offset:3072
    s_add_u32 m0, s57, 24576
    s_mov_b32 s81, 196608
    buffer_load_dwordx4 v137, s[32:35], s81 offen offset:0 lds
    buffer_load_dwordx4 v132, s[32:35], s81 offen offset:1024 lds
    buffer_load_dwordx4 v133, s[32:35], s81 offen offset:2048 lds
    buffer_load_dwordx4 v134, s[32:35], s81 offen offset:3072 lds
    s_waitcnt vmcnt(25)
    ds_read_b64_tr_b16 v[64:65], v2 offset:0
    ds_read_b64_tr_b16 v[66:67], v2 offset:512
    ds_read_b64_tr_b16 v[68:69], v3 offset:0
    ds_read_b64_tr_b16 v[70:71], v3 offset:512
    ds_read_b64_tr_b16 v[72:73], v4 offset:0
    ds_read_b64_tr_b16 v[74:75], v4 offset:512
    ds_read_b64_tr_b16 v[76:77], v5 offset:0
    ds_read_b64_tr_b16 v[78:79], v5 offset:512
    ds_read_b64_tr_b16 v[80:81], v2 offset:4096
    ds_read_b64_tr_b16 v[82:83], v2 offset:4608
    ds_read_b64_tr_b16 v[84:85], v3 offset:4096
    ds_read_b64_tr_b16 v[86:87], v3 offset:4608
    ds_read_b64_tr_b16 v[88:89], v4 offset:4096
    ds_read_b64_tr_b16 v[90:91], v4 offset:4608
    ds_read_b64_tr_b16 v[92:93], v5 offset:4096
    ds_read_b64_tr_b16 v[94:95], v5 offset:4608
    s_waitcnt lgkmcnt(0)
    s_barrier
    ds_read_b128 v[48:51], v172 offset:32768
    ds_read_b128 v[52:55], v172 offset:32784
    ds_read_b128 v[56:59], v172 offset:33792
    ds_read_b128 v[60:63], v172 offset:33808
    s_add_u32 m0, s57, 28672
    s_mov_b32 s81, 229376
    buffer_load_dwordx4 v137, s[32:35], s81 offen offset:0 lds
    buffer_load_dwordx4 v132, s[32:35], s81 offen offset:1024 lds
    buffer_load_dwordx4 v133, s[32:35], s81 offen offset:2048 lds
    buffer_load_dwordx4 v134, s[32:35], s81 offen offset:3072 lds
    s_waitcnt lgkmcnt(3)
    v_mfma_f32_16x16x32_bf16 v[192:195], v[64:67], v[48:51], 0
    s_waitcnt vmcnt(25)
    ds_read_b64_tr_b16 v[96:97], v2 offset:8192
    ds_read_b64_tr_b16 v[98:99], v2 offset:8704
    s_waitcnt lgkmcnt(4)
    v_mfma_f32_16x16x32_bf16 v[208:211], v[64:67], v[52:55], 0
    ds_read_b128 v[112:115], v172 offset:34816
    ds_read_b128 v[116:119], v172 offset:34832
    v_mfma_f32_16x16x32_bf16 v[196:199], v[68:71], v[48:51], 0
    v_mfma_f32_16x16x32_bf16 v[212:215], v[68:71], v[52:55], 0
    ds_read_b64_tr_b16 v[100:101], v3 offset:8192
    ds_read_b64_tr_b16 v[102:103], v3 offset:8704
    v_mfma_f32_16x16x32_bf16 v[200:203], v[72:75], v[48:51], 0
    ds_read_b64_tr_b16 v[104:105], v4 offset:8192
    ds_read_b64_tr_b16 v[106:107], v4 offset:8704
    v_mfma_f32_16x16x32_bf16 v[216:219], v[72:75], v[52:55], 0
    ds_read_b64_tr_b16 v[108:109], v5 offset:8192
    ds_read_b64_tr_b16 v[110:111], v5 offset:8704
    v_mfma_f32_16x16x32_bf16 v[204:207], v[76:79], v[48:51], 0
    v_mfma_f32_16x16x32_bf16 v[220:223], v[76:79], v[52:55], 0
    s_waitcnt lgkmcnt(10)
    v_mfma_f32_16x16x32_bf16 v[192:195], v[80:83], v[56:59], v[192:195]
    s_waitcnt vmcnt(21)
    ds_read_b64_tr_b16 v[64:65], v2 offset:12288
    ds_read_b64_tr_b16 v[66:67], v2 offset:12800
    v_mfma_f32_16x16x32_bf16 v[208:211], v[80:83], v[60:63], v[208:211]
    ds_read_b128 v[48:51], v172 offset:35840
    ds_read_b128 v[52:55], v172 offset:35856
    v_mfma_f32_16x16x32_bf16 v[196:199], v[84:87], v[56:59], v[196:199]
    v_mfma_f32_16x16x32_bf16 v[212:215], v[84:87], v[60:63], v[212:215]
    ds_read_b64_tr_b16 v[68:69], v3 offset:12288
    ds_read_b64_tr_b16 v[70:71], v3 offset:12800
    v_mfma_f32_16x16x32_bf16 v[200:203], v[88:91], v[56:59], v[200:203]
    ds_read_b64_tr_b16 v[72:73], v4 offset:12288
    ds_read_b64_tr_b16 v[74:75], v4 offset:12800
    v_mfma_f32_16x16x32_bf16 v[216:219], v[88:91], v[60:63], v[216:219]
    ds_read_b64_tr_b16 v[76:77], v5 offset:12288
    ds_read_b64_tr_b16 v[78:79], v5 offset:12800
    v_mfma_f32_16x16x32_bf16 v[204:207], v[92:95], v[56:59], v[204:207]
    v_mfma_f32_16x16x32_bf16 v[220:223], v[92:95], v[60:63], v[220:223]
    s_waitcnt lgkmcnt(10)
    v_mfma_f32_16x16x32_bf16 v[192:195], v[96:99], v[112:115], v[192:195]
    s_waitcnt vmcnt(16)
    ds_read_b64_tr_b16 v[80:81], v2 offset:16384
    ds_read_b64_tr_b16 v[82:83], v2 offset:16896
    v_mfma_f32_16x16x32_bf16 v[208:211], v[96:99], v[116:119], v[208:211]
    ds_read_b128 v[56:59], v172 offset:36864
    ds_read_b128 v[60:63], v172 offset:36880
    v_mfma_f32_16x16x32_bf16 v[196:199], v[100:103], v[112:115], v[196:199]
    v_mfma_f32_16x16x32_bf16 v[212:215], v[100:103], v[116:119], v[212:215]
    ds_read_b64_tr_b16 v[84:85], v3 offset:16384
    ds_read_b64_tr_b16 v[86:87], v3 offset:16896
    v_mfma_f32_16x16x32_bf16 v[200:203], v[104:107], v[112:115], v[200:203]
    ds_read_b64_tr_b16 v[88:89], v4 offset:16384
    ds_read_b64_tr_b16 v[90:91], v4 offset:16896
    v_mfma_f32_16x16x32_bf16 v[216:219], v[104:107], v[116:119], v[216:219]
    ds_read_b64_tr_b16 v[92:93], v5 offset:16384
    ds_read_b64_tr_b16 v[94:95], v5 offset:16896
    v_mfma_f32_16x16x32_bf16 v[204:207], v[108:111], v[112:115], v[204:207]
    v_mfma_f32_16x16x32_bf16 v[220:223], v[108:111], v[116:119], v[220:223]
    s_waitcnt lgkmcnt(10)
    v_mfma_f32_16x16x32_bf16 v[192:195], v[64:67], v[48:51], v[192:195]
    s_waitcnt vmcnt(12)
    ds_read_b64_tr_b16 v[96:97], v2 offset:20480
    ds_read_b64_tr_b16 v[98:99], v2 offset:20992
    v_mfma_f32_16x16x32_bf16 v[208:211], v[64:67], v[52:55], v[208:211]
    ds_read_b128 v[112:115], v172 offset:37888
    ds_read_b128 v[116:119], v172 offset:37904
    v_mfma_f32_16x16x32_bf16 v[196:199], v[68:71], v[48:51], v[196:199]
    v_mfma_f32_16x16x32_bf16 v[212:215], v[68:71], v[52:55], v[212:215]
    ds_read_b64_tr_b16 v[100:101], v3 offset:20480
    ds_read_b64_tr_b16 v[102:103], v3 offset:20992
    v_mfma_f32_16x16x32_bf16 v[200:203], v[72:75], v[48:51], v[200:203]
    ds_read_b64_tr_b16 v[104:105], v4 offset:20480
    ds_read_b64_tr_b16 v[106:107], v4 offset:20992
    v_mfma_f32_16x16x32_bf16 v[216:219], v[72:75], v[52:55], v[216:219]
    ds_read_b64_tr_b16 v[108:109], v5 offset:20480
    ds_read_b64_tr_b16 v[110:111], v5 offset:20992
    v_mfma_f32_16x16x32_bf16 v[204:207], v[76:79], v[48:51], v[204:207]
    v_mfma_f32_16x16x32_bf16 v[220:223], v[76:79], v[52:55], v[220:223]
    s_waitcnt lgkmcnt(10)
    v_mfma_f32_16x16x32_bf16 v[192:195], v[80:83], v[56:59], v[192:195]
    s_waitcnt vmcnt(4)
    ds_read_b64_tr_b16 v[64:65], v2 offset:24576
    ds_read_b64_tr_b16 v[66:67], v2 offset:25088
    v_mfma_f32_16x16x32_bf16 v[208:211], v[80:83], v[60:63], v[208:211]
    ds_read_b128 v[48:51], v172 offset:38912
    ds_read_b128 v[52:55], v172 offset:38928
    v_mfma_f32_16x16x32_bf16 v[196:199], v[84:87], v[56:59], v[196:199]
    buffer_load_dword v25, v166, s[40:43], 0 offen sc1
    v_mfma_f32_16x16x32_bf16 v[212:215], v[84:87], v[60:63], v[212:215]
    ds_read_b64_tr_b16 v[68:69], v3 offset:24576
    ds_read_b64_tr_b16 v[70:71], v3 offset:25088
    v_mfma_f32_16x16x32_bf16 v[200:203], v[88:91], v[56:59], v[200:203]
    ds_read_b64_tr_b16 v[72:73], v4 offset:24576
    ds_read_b64_tr_b16 v[74:75], v4 offset:25088
    v_mfma_f32_16x16x32_bf16 v[216:219], v[88:91], v[60:63], v[216:219]
    ds_read_b64_tr_b16 v[76:77], v5 offset:24576
    ds_read_b64_tr_b16 v[78:79], v5 offset:25088
    v_mfma_f32_16x16x32_bf16 v[204:207], v[92:95], v[56:59], v[204:207]
    v_mfma_f32_16x16x32_bf16 v[220:223], v[92:95], v[60:63], v[220:223]
    s_waitcnt lgkmcnt(10)
    v_mfma_f32_16x16x32_bf16 v[192:195], v[96:99], v[112:115], v[192:195]
    s_waitcnt vmcnt(1)
    ds_read_b64_tr_b16 v[80:81], v2 offset:28672
    ds_read_b64_tr_b16 v[82:83], v2 offset:29184
    v_mfma_f32_16x16x32_bf16 v[208:211], v[96:99], v[116:119], v[208:211]
    ds_read_b128 v[56:59], v172 offset:39936
    ds_read_b128 v[60:63], v172 offset:39952
    v_mfma_f32_16x16x32_bf16 v[196:199], v[100:103], v[112:115], v[196:199]
    v_mfma_f32_16x16x32_bf16 v[212:215], v[100:103], v[116:119], v[212:215]
    ds_read_b64_tr_b16 v[84:85], v3 offset:28672
    ds_read_b64_tr_b16 v[86:87], v3 offset:29184
    v_mfma_f32_16x16x32_bf16 v[200:203], v[104:107], v[112:115], v[200:203]
    ds_read_b64_tr_b16 v[88:89], v4 offset:28672
    ds_read_b64_tr_b16 v[90:91], v4 offset:29184
    v_mfma_f32_16x16x32_bf16 v[216:219], v[104:107], v[116:119], v[216:219]
    ds_read_b64_tr_b16 v[92:93], v5 offset:28672
    ds_read_b64_tr_b16 v[94:95], v5 offset:29184
    v_mfma_f32_16x16x32_bf16 v[204:207], v[108:111], v[112:115], v[204:207]
    s_mov_b64 exec, 1
    buffer_store_dword v7, off, s[40:43], s82 sc1
    s_mov_b64 exec, -1
    v_mfma_f32_16x16x32_bf16 v[220:223], v[108:111], v[116:119], v[220:223]
    s_waitcnt lgkmcnt(10)
    v_mfma_f32_16x16x32_bf16 v[192:195], v[64:67], v[48:51], v[192:195]
    ds_read_b128 a[128:131], v8 offset:32768
    ds_read_b128 a[132:135], v9 offset:32768
    v_mfma_f32_16x16x32_bf16 v[208:211], v[64:67], v[52:55], v[208:211]
    ds_read_b128 a[136:139], v10 offset:32768
    ds_read_b128 a[140:143], v11 offset:32768
    v_mfma_f32_16x16x32_bf16 v[196:199], v[68:71], v[48:51], v[196:199]
    v_mfma_f32_16x16x32_bf16 v[212:215], v[68:71], v[52:55], v[212:215]
    ds_read_b128 a[144:147], v8 offset:33792
    ds_read_b128 a[148:151], v9 offset:33792
    v_mfma_f32_16x16x32_bf16 v[200:203], v[72:75], v[48:51], v[200:203]
    ds_read_b128 a[152:155], v10 offset:33792
    ds_read_b128 a[156:159], v11 offset:33792
    v_mfma_f32_16x16x32_bf16 v[216:219], v[72:75], v[52:55], v[216:219]
    v_mfma_f32_16x16x32_bf16 v[204:207], v[76:79], v[48:51], v[204:207]
    v_mfma_f32_16x16x32_bf16 v[220:223], v[76:79], v[52:55], v[220:223]
    s_waitcnt lgkmcnt(8)
    s_lshl_b32 s81, s52, 15
    s_add_u32 s81, s81, 6291456
    v_mfma_f32_16x16x32_bf16 v[192:195], v[80:83], v[56:59], v[192:195]
    v_mov_b32 v16, 0xc0f556e3
    v_mov_b32 v17, 0xc0735486
    v_mfma_f32_16x16x32_bf16 v[208:211], v[80:83], v[60:63], v[208:211]
    ds_read_b128 a[160:163], v8 offset:34816
    ds_read_b128 a[164:167], v9 offset:34816
    v_mfma_f32_16x16x32_bf16 v[196:199], v[84:87], v[56:59], v[196:199]
    v_mfma_f32_16x16x32_bf16 v[212:215], v[84:87], v[60:63], v[212:215]
    ds_read_b128 a[168:171], v10 offset:34816
    ds_read_b128 a[172:175], v11 offset:34816
    v_mfma_f32_16x16x32_bf16 v[200:203], v[88:91], v[56:59], v[200:203]
    ds_read_b128 a[176:179], v8 offset:35840
    ds_read_b128 a[180:183], v9 offset:35840
    v_mfma_f32_16x16x32_bf16 v[216:219], v[88:91], v[60:63], v[216:219]
    ds_read_b128 a[184:187], v10 offset:35840
    ds_read_b128 a[188:191], v11 offset:35840
    v_mfma_f32_16x16x32_bf16 v[204:207], v[92:95], v[56:59], v[204:207]
    v_mfma_f32_16x16x32_bf16 v[220:223], v[92:95], v[60:63], v[220:223]
    v_pk_mul_f32 v[224:225], v[192:193], v[192:193]
    v_pk_mul_f32 v[226:227], v[194:195], v[194:195]
    v_pk_mul_f32 v[228:229], v[196:197], v[196:197]
    v_pk_mul_f32 v[230:231], v[198:199], v[198:199]
    v_pk_fma_f32 v[224:225], v[224:225], v[16:17], v[16:17] op_sel:[0,1,0] op_sel_hi:[1,1,0]
    v_pk_fma_f32 v[226:227], v[226:227], v[16:17], v[16:17] op_sel:[0,1,0] op_sel_hi:[1,1,0]
    v_pk_fma_f32 v[228:229], v[228:229], v[16:17], v[16:17] op_sel:[0,1,0] op_sel_hi:[1,1,0]
    v_pk_fma_f32 v[230:231], v[230:231], v[16:17], v[16:17] op_sel:[0,1,0] op_sel_hi:[1,1,0]
    v_pk_mul_f32 v[224:225], v[224:225], v[192:193]
    v_pk_mul_f32 v[226:227], v[226:227], v[194:195]
    v_pk_mul_f32 v[228:229], v[228:229], v[196:197]
    v_pk_mul_f32 v[230:231], v[230:231], v[198:199]
    s_waitcnt vmcnt(1)
    v_cmp_ne_u32 vcc, s56, v25
    s_cbranch_vccnz L_spin_m
L_back_m:
    buffer_load_dwordx4 a[0:3], v30, s[40:43], s81 offen offset:0 sc1
    buffer_load_dwordx4 a[4:7], v30, s[40:43], s81 offen offset:1024 sc1
    buffer_load_dwordx4 a[8:11], v30, s[40:43], s81 offen offset:2048 sc1
    ds_read_b128 a[192:195], v8 offset:36864
    ds_read_b128 a[196:199], v9 offset:36864
    v_exp_f32 v224, v224
    v_exp_f32 v225, v225
    v_exp_f32 v226, v226
    v_exp_f32 v227, v227
    v_exp_f32 v228, v228
    v_exp_f32 v229, v229
    v_exp_f32 v230, v230
    v_exp_f32 v231, v231
    v_pk_add_f32 v[224:225], v[224:225], 1.0 op_sel_hi:[1,0]
    v_pk_add_f32 v[226:227], v[226:227], 1.0 op_sel_hi:[1,0]
    v_pk_add_f32 v[228:229], v[228:229], 1.0 op_sel_hi:[1,0]
    v_pk_add_f32 v[230:231], v[230:231], 1.0 op_sel_hi:[1,0]
    buffer_load_dwordx4 a[12:15], v30, s[40:43], s81 offen offset:3072 sc1
    s_add_u32 s81, s81, 4096
    ds_read_b128 a[200:203], v10 offset:36864
    ds_read_b128 a[204:207], v11 offset:36864
    v_rcp_f32 v224, v224
    v_rcp_f32 v225, v225
    v_rcp_f32 v226, v226
    v_rcp_f32 v227, v227
    v_rcp_f32 v228, v228
    v_rcp_f32 v229, v229
    v_rcp_f32 v230, v230
    v_rcp_f32 v231, v231
    v_pk_mul_f32 v[192:193], v[192:193], v[224:225]
    v_pk_mul_f32 v[194:195], v[194:195], v[226:227]
    v_pk_mul_f32 v[196:197], v[196:197], v[228:229]
    v_pk_mul_f32 v[198:199], v[198:199], v[230:231]
    v_pk_add_f32 v[232:233], v[192:193], v[194:195]
    v_pk_mul_f32 v[236:237], v[192:193], v[192:193]
    v_pk_add_f32 v[240:241], v[196:197], v[198:199]
    v_pk_mul_f32 v[242:243], v[194:195], v[194:195]
    v_pk_fma_f32 v[236:237], v[196:197], v[196:197], v[236:237]
    v_pk_fma_f32 v[242:243], v[198:199], v[198:199], v[242:243]
    buffer_load_dwordx4 a[16:19], v30, s[40:43], s81 offen offset:0 sc1
    buffer_load_dwordx4 a[20:23], v30, s[40:43], s81 offen offset:1024 sc1
    ds_read_b128 a[208:211], v8 offset:37888
    ds_read_b128 a[212:215], v9 offset:37888
    v_pk_mul_f32 v[224:225], v[200:201], v[200:201]
    v_pk_mul_f32 v[226:227], v[202:203], v[202:203]
    v_pk_mul_f32 v[228:229], v[204:205], v[204:205]
    v_pk_mul_f32 v[230:231], v[206:207], v[206:207]
    v_pk_fma_f32 v[224:225], v[224:225], v[16:17], v[16:17] op_sel:[0,1,0] op_sel_hi:[1,1,0]
    v_pk_fma_f32 v[226:227], v[226:227], v[16:17], v[16:17] op_sel:[0,1,0] op_sel_hi:[1,1,0]
    v_pk_fma_f32 v[228:229], v[228:229], v[16:17], v[16:17] op_sel:[0,1,0] op_sel_hi:[1,1,0]
    v_pk_fma_f32 v[230:231], v[230:231], v[16:17], v[16:17] op_sel:[0,1,0] op_sel_hi:[1,1,0]
    v_pk_mul_f32 v[224:225], v[224:225], v[200:201]
    v_pk_mul_f32 v[226:227], v[226:227], v[202:203]
    v_pk_mul_f32 v[228:229], v[228:229], v[204:205]
    v_pk_mul_f32 v[230:231], v[230:231], v[206:207]
    buffer_load_dwordx4 a[24:27], v30, s[40:43], s81 offen offset:2048 sc1
    ds_read_b128 a[216:219], v10 offset:37888
    ds_read_b128 a[220:223], v11 offset:37888
    v_exp_f32 v224, v224
    v_exp_f32 v225, v225
    v_exp_f32 v226, v226
    v_exp_f32 v227, v227
    v_exp_f32 v228, v228
    v_exp_f32 v229, v229
    v_exp_f32 v230, v230
    v_exp_f32 v231, v231
    v_pk_add_f32 v[224:225], v[224:225], 1.0 op_sel_hi:[1,0]
    v_pk_add_f32 v[226:227], v[226:227], 1.0 op_sel_hi:[1,0]
    v_pk_add_f32 v[228:229], v[228:229], 1.0 op_sel_hi:[1,0]
    v_pk_add_f32 v[230:231], v[230:231], 1.0 op_sel_hi:[1,0]
    buffer_load_dwordx4 a[28:31], v30, s[40:43], s81 offen offset:3072 sc1
    s_add_u32 s81, s81, 4096
    ds_read_b128 a[224:227], v8 offset:38912
    ds_read_b128 a[228:231], v9 offset:38912
    v_rcp_f32 v224, v224
    v_rcp_f32 v225, v225
    v_rcp_f32 v226, v226
    v_rcp_f32 v227, v227
    v_rcp_f32 v228, v228
    v_rcp_f32 v229, v229
    v_rcp_f32 v230, v230
    v_rcp_f32 v231, v231
    v_pk_mul_f32 v[200:201], v[200:201], v[224:225]
    v_pk_mul_f32 v[202:203], v[202:203], v[226:227]
    v_pk_mul_f32 v[204:205], v[204:205], v[228:229]
    v_pk_mul_f32 v[206:207], v[206:207], v[230:231]
    v_pk_add_f32 v[232:233], v[232:233], v[200:201]
    v_pk_fma_f32 v[236:237], v[200:201], v[200:201], v[236:237]
    v_pk_add_f32 v[240:241], v[240:241], v[202:203]
    v_pk_fma_f32 v[242:243], v[202:203], v[202:203], v[242:243]
    v_pk_add_f32 v[232:233], v[232:233], v[204:205]
    v_pk_fma_f32 v[236:237], v[204:205], v[204:205], v[236:237]
    v_pk_add_f32 v[240:241], v[240:241], v[206:207]
    v_pk_fma_f32 v[242:243], v[206:207], v[206:207], v[242:243]
    v_pk_add_f32 v[232:233], v[232:233], v[240:241]
    v_pk_add_f32 v[236:237], v[236:237], v[242:243]
    buffer_load_dwordx4 a[32:35], v30, s[40:43], s81 offen offset:0 sc1
    buffer_load_dwordx4 a[36:39], v30, s[40:43], s81 offen offset:1024 sc1
    ds_read_b128 a[232:235], v10 offset:38912
    ds_read_b128 a[236:239], v11 offset:38912
    v_pk_mul_f32 v[224:225], v[208:209], v[208:209]
    v_pk_mul_f32 v[226:227], v[210:211], v[210:211]
    v_pk_mul_f32 v[228:229], v[212:213], v[212:213]
    v_pk_mul_f32 v[230:231], v[214:215], v[214:215]
    v_pk_fma_f32 v[224:225], v[224:225], v[16:17], v[16:17] op_sel:[0,1,0] op_sel_hi:[1,1,0]
    v_pk_fma_f32 v[226:227], v[226:227], v[16:17], v[16:17] op_sel:[0,1,0] op_sel_hi:[1,1,0]
    v_pk_fma_f32 v[228:229], v[228:229], v[16:17], v[16:17] op_sel:[0,1,0] op_sel_hi:[1,1,0]
    v_pk_fma_f32 v[230:231], v[230:231], v[16:17], v[16:17] op_sel:[0,1,0] op_sel_hi:[1,1,0]
    v_pk_mul_f32 v[224:225], v[224:225], v[208:209]
    v_pk_mul_f32 v[226:227], v[226:227], v[210:211]
    v_pk_mul_f32 v[228:229], v[228:229], v[212:213]
    v_pk_mul_f32 v[230:231], v[230:231], v[214:215]
    buffer_load_dwordx4 a[40:43], v30, s[40:43], s81 offen offset:2048 sc1
    ds_read_b128 a[240:243], v8 offset:39936
    ds_read_b128 a[244:247], v9 offset:39936
    v_exp_f32 v224, v224
    v_exp_f32 v225, v225
    v_exp_f32 v226, v226
    v_exp_f32 v227, v227
    v_exp_f32 v228, v228
    v_exp_f32 v229, v229
    v_exp_f32 v230, v230
    v_exp_f32 v231, v231
    v_pk_add_f32 v[224:225], v[224:225], 1.0 op_sel_hi:[1,0]
    v_pk_add_f32 v[226:227], v[226:227], 1.0 op_sel_hi:[1,0]
    v_pk_add_f32 v[228:229], v[228:229], 1.0 op_sel_hi:[1,0]
    v_pk_add_f32 v[230:231], v[230:231], 1.0 op_sel_hi:[1,0]
    buffer_load_dwordx4 a[44:47], v30, s[40:43], s81 offen offset:3072 sc1
    s_add_u32 s81, s81, 4096
    ds_read_b128 a[248:251], v10 offset:39936
    ds_read_b128 a[252:255], v11 offset:39936
    v_rcp_f32 v224, v224
    v_rcp_f32 v225, v225
    v_rcp_f32 v226, v226
    v_rcp_f32 v227, v227
    v_rcp_f32 v228, v228
    v_rcp_f32 v229, v229
    v_rcp_f32 v230, v230
    v_rcp_f32 v231, v231
    v_pk_mul_f32 v[208:209], v[208:209], v[224:225]
    v_pk_mul_f32 v[210:211], v[210:211], v[226:227]
    v_pk_mul_f32 v[212:213], v[212:213], v[228:229]
    v_pk_mul_f32 v[214:215], v[214:215], v[230:231]
    v_pk_add_f32 v[234:235], v[208:209], v[210:211]
    v_pk_mul_f32 v[238:239], v[208:209], v[208:209]
    v_pk_add_f32 v[240:241], v[212:213], v[214:215]
    v_pk_mul_f32 v[242:243], v[210:211], v[210:211]
    v_pk_fma_f32 v[238:239], v[212:213], v[212:213], v[238:239]
    v_pk_fma_f32 v[242:243], v[214:215], v[214:215], v[242:243]
    buffer_load_dwordx4 a[48:51], v30, s[40:43], s81 offen offset:0 sc1
    buffer_load_dwordx4 a[52:55], v30, s[40:43], s81 offen offset:1024 sc1
    v_pk_mul_f32 v[224:225], v[216:217], v[216:217]
    v_pk_mul_f32 v[226:227], v[218:219], v[218:219]
    v_pk_mul_f32 v[228:229], v[220:221], v[220:221]
    v_pk_mul_f32 v[230:231], v[222:223], v[222:223]
    v_pk_fma_f32 v[224:225], v[224:225], v[16:17], v[16:17] op_sel:[0,1,0] op_sel_hi:[1,1,0]
    v_pk_fma_f32 v[226:227], v[226:227], v[16:17], v[16:17] op_sel:[0,1,0] op_sel_hi:[1,1,0]
    v_pk_fma_f32 v[228:229], v[228:229], v[16:17], v[16:17] op_sel:[0,1,0] op_sel_hi:[1,1,0]
    v_pk_fma_f32 v[230:231], v[230:231], v[16:17], v[16:17] op_sel:[0,1,0] op_sel_hi:[1,1,0]
    v_pk_mul_f32 v[224:225], v[224:225], v[216:217]
    v_pk_mul_f32 v[226:227], v[226:227], v[218:219]
    v_pk_mul_f32 v[228:229], v[228:229], v[220:221]
    v_pk_mul_f32 v[230:231], v[230:231], v[222:223]
    buffer_load_dwordx4 a[56:59], v30, s[40:43], s81 offen offset:2048 sc1
    v_exp_f32 v224, v224
    v_exp_f32 v225, v225
    v_exp_f32 v226, v226
    v_exp_f32 v227, v227
    v_exp_f32 v228, v228
    v_exp_f32 v229, v229
    v_exp_f32 v230, v230
    v_exp_f32 v231, v231
    v_pk_add_f32 v[224:225], v[224:225], 1.0 op_sel_hi:[1,0]
    v_pk_add_f32 v[226:227], v[226:227], 1.0 op_sel_hi:[1,0]
    v_pk_add_f32 v[228:229], v[228:229], 1.0 op_sel_hi:[1,0]
    v_pk_add_f32 v[230:231], v[230:231], 1.0 op_sel_hi:[1,0]
    buffer_load_dwordx4 a[60:63], v30, s[40:43], s81 offen offset:3072 sc1
    s_add_u32 s81, s81, 4096
    v_rcp_f32 v224, v224
    v_rcp_f32 v225, v225
    v_rcp_f32 v226, v226
    v_rcp_f32 v227, v227
    v_rcp_f32 v228, v228
    v_rcp_f32 v229, v229
    v_rcp_f32 v230, v230
    v_rcp_f32 v231, v231
    v_pk_mul_f32 v[216:217], v[216:217], v[224:225]
    v_pk_mul_f32 v[218:219], v[218:219], v[226:227]
    v_pk_mul_f32 v[220:221], v[220:221], v[228:229]
    v_pk_mul_f32 v[222:223], v[222:223], v[230:231]
    v_pk_add_f32 v[234:235], v[234:235], v[216:217]
    v_pk_fma_f32 v[238:239], v[216:217], v[216:217], v[238:239]
    v_pk_add_f32 v[240:241], v[240:241], v[218:219]
    v_pk_fma_f32 v[242:243], v[218:219], v[218:219], v[242:243]
    v_pk_add_f32 v[234:235], v[234:235], v[220:221]
    v_pk_fma_f32 v[238:239], v[220:221], v[220:221], v[238:239]
    v_pk_add_f32 v[240:241], v[240:241], v[222:223]
    v_pk_fma_f32 v[242:243], v[222:223], v[222:223], v[242:243]
    v_pk_add_f32 v[234:235], v[234:235], v[240:241]
    v_pk_add_f32 v[238:239], v[238:239], v[242:243]
    buffer_load_dwordx4 a[64:67], v30, s[40:43], s81 offen offset:0 sc1
    buffer_load_dwordx4 a[68:71], v30, s[40:43], s81 offen offset:1024 sc1
    s_mov_b32 s12, 128000
    s_mov_b32 s13, 256000
    s_mov_b32 s14, 384000
    s_and_b32 s73, s52, 1
    s_lshl_b32 s73, s73, 12
    s_add_u32 s72, s73, 4096
    s_xor_b32 s73, s73, 4096
    s_waitcnt vmcnt(17) lgkmcnt(15)
    v_mfma_f32_16x16x32_bf16 v[64:67], a[0:3], a[128:131], 0
    v_add_f32 v232, v232, v233
    v_add_f32 v236, v236, v237
    s_waitcnt vmcnt(15)
    v_mfma_f32_16x16x32_bf16 v[64:67], a[8:11], a[144:147], v[64:67]
    v_add_f32 v234, v234, v235
    v_add_f32 v238, v238, v239
    s_waitcnt vmcnt(14)
    v_mfma_f32_16x16x32_bf16 v[80:83], a[12:15], a[144:147], 0
    buffer_load_dwordx4 a[72:75], v30, s[40:43], s81 offen offset:2048 sc1
    v_mfma_f32_16x16x32_bf16 v[80:83], a[4:7], a[128:131], v[80:83]
    v_permlane32_swap_b32 v232, v236
    v_mfma_f32_16x16x32_bf16 v[84:87], a[4:7], a[132:135], 0
    v_permlane32_swap_b32 v234, v238
    v_mfma_f32_16x16x32_bf16 v[84:87], a[12:15], a[148:151], v[84:87]
    v_mfma_f32_16x16x32_bf16 v[68:71], a[8:11], a[148:151], 0
    buffer_load_dwordx4 a[76:79], v30, s[40:43], s81 offen offset:3072 sc1
    v_mfma_f32_16x16x32_bf16 v[68:71], a[0:3], a[132:135], v[68:71]
    s_add_u32 s81, s81, 4096
    v_add_f32 v232, v232, v236
    v_add_f32 v234, v234, v238
    v_mfma_f32_16x16x32_bf16 v[72:75], a[0:3], a[136:139], 0
    s_nop 0
    v_mfma_f32_16x16x32_bf16 v[72:75], a[8:11], a[152:155], v[72:75]
    v_permlane16_swap_b32 v232, v234
    v_mfma_f32_16x16x32_bf16 v[88:91], a[12:15], a[152:155], 0
    buffer_load_dword v24, v6, s[40:43], 0 offen sc1
    v_mfma_f32_16x16x32_bf16 v[88:91], a[4:7], a[136:139], v[88:91]
    v_add_f32 v232, v232, v234
    v_mfma_f32_16x16x32_bf16 v[92:95], a[4:7], a[140:143], 0
    ds_write_b32 v168, v232 offset:31744
    v_mfma_f32_16x16x32_bf16 v[92:95], a[12:15], a[156:159], v[92:95]
    v_mfma_f32_16x16x32_bf16 v[76:79], a[8:11], a[156:159], 0
    buffer_load_dwordx4 a[80:83], v30, s[40:43], s81 offen offset:0 sc1
    v_mfma_f32_16x16x32_bf16 v[76:79], a[0:3], a[140:143], v[76:79]
    s_waitcnt vmcnt(14)
    v_mfma_f32_16x16x32_bf16 v[64:67], a[16:19], a[160:163], v[64:67]
    s_waitcnt lgkmcnt(0)
    s_barrier
    v_mfma_f32_16x16x32_bf16 v[64:67], a[24:27], a[176:179], v[64:67]
    ds_read_b32 v233, v169 offset:31744
    ds_read_b32 v234, v170 offset:31744
    v_mfma_f32_16x16x32_bf16 v[80:83], a[28:31], a[176:179], v[80:83]
    buffer_load_dwordx4 a[84:87], v30, s[40:43], s81 offen offset:1024 sc1
    v_mfma_f32_16x16x32_bf16 v[80:83], a[20:23], a[160:163], v[80:83]
    ds_read_b32 v235, v171 offset:31744
    v_add_u32 v2, s57, v29
    v_mfma_f32_16x16x32_bf16 v[84:87], a[20:23], a[164:167], v[84:87]
    v_lshrrev_b32 v16, 2, v1
    v_bfe_u32 v17, v1, 1, 1
    v_mfma_f32_16x16x32_bf16 v[84:87], a[28:31], a[180:183], v[84:87]
    v_lshlrev_b32 v18, 3, v17
    v_mfma_f32_16x16x32_bf16 v[68:71], a[24:27], a[180:183], v[68:71]
    buffer_load_dwordx4 a[88:91], v30, s[40:43], s81 offen offset:2048 sc1
    v_mfma_f32_16x16x32_bf16 v[68:71], a[16:19], a[164:167], v[68:71]
    v_xor_b32 v16, v16, v18
    v_lshlrev_b32 v16, 4, v16
    v_mfma_f32_16x16x32_bf16 v[72:75], a[16:19], a[168:171], v[72:75]
    v_lshl_add_u32 v16, v17, 9, v16
    v_and_b32 v17, 1, v1
    v_mfma_f32_16x16x32_bf16 v[72:75], a[24:27], a[184:187], v[72:75]
    v_lshl_add_u32 v16, v17, 3, v16
    v_mfma_f32_16x16x32_bf16 v[88:91], a[28:31], a[184:187], v[88:91]
    buffer_load_dwordx4 a[92:95], v30, s[40:43], s81 offen offset:3072 sc1
    v_mfma_f32_16x16x32_bf16 v[88:91], a[20:23], a[168:171], v[88:91]
    s_add_u32 s81, s81, 4096
    v_add_u32 v3, s57, v16
    v_add_u32 v4, s72, v30
    v_mfma_f32_16x16x32_bf16 v[92:95], a[20:23], a[172:175], v[92:95]
    v_add_u32 v5, s73, v30
    v_mfma_f32_16x16x32_bf16 v[92:95], a[28:31], a[188:191], v[92:95]
    s_waitcnt lgkmcnt(0)
    v_add_f32 v232, v232, v233
    v_add_f32 v234, v234, v235
    v_mfma_f32_16x16x32_bf16 v[76:79], a[24:27], a[188:191], v[76:79]
    buffer_load_dwordx4 a[96:99], v30, s[40:43], s81 offen offset:0 sc1
    v_mfma_f32_16x16x32_bf16 v[76:79], a[16:19], a[172:175], v[76:79]
    s_waitcnt vmcnt(14)
    v_add_f32 v232, v232, v234
    v_mul_f32 v232, 0x3b800000, v232
    v_mfma_f32_16x16x32_bf16 v[64:67], a[32:35], a[192:195], v[64:67]
    v_mov_b32 v233, v232
    v_mfma_f32_16x16x32_bf16 v[64:67], a[40:43], a[208:211], v[64:67]
    s_nop 0
    v_mfma_f32_16x16x32_bf16 v[80:83], a[44:47], a[208:211], v[80:83]
    buffer_load_dwordx4 a[100:103], v30, s[40:43], s81 offen offset:1024 sc1
    v_mfma_f32_16x16x32_bf16 v[80:83], a[36:39], a[192:195], v[80:83]
    v_permlane32_swap_b32 v232, v233
    v_mfma_f32_16x16x32_bf16 v[84:87], a[36:39], a[196:199], v[84:87]
    v_fma_f32 v233, -v232, v232, v233
    v_max_f32 v233, 0, v233
    v_mfma_f32_16x16x32_bf16 v[84:87], a[44:47], a[212:215], v[84:87]
    v_add_f32 v233, 0x35720b48, v233
L_pk1:
    s_cbranch_execz L_pk4
    v_mfma_f32_16x16x32_bf16 v[68:71], a[40:43], a[212:215], v[68:71]
    buffer_load_dwordx4 a[104:107], v30, s[40:43], s81 offen offset:2048 sc1
    v_mfma_f32_16x16x32_bf16 v[68:71], a[32:35], a[196:199], v[68:71]
    v_rsq_f32 v233, v233
    v_mfma_f32_16x16x32_bf16 v[72:75], a[32:35], a[200:203], v[72:75]
    v_mul_f32 v232, v232, v233
    v_mov_b32 v235, v233
    v_mfma_f32_16x16x32_bf16 v[72:75], a[40:43], a[216:219], v[72:75]
    v_mov_b32 v234, v232
    s_nop 0
    v_mfma_f32_16x16x32_bf16 v[88:91], a[44:47], a[216:219], v[88:91]
    buffer_load_dwordx4 a[108:111], v30, s[40:43], s81 offen offset:3072 sc1
    v_mfma_f32_16x16x32_bf16 v[88:91], a[36:39], a[200:203], v[88:91]
    s_add_u32 s81, s81, 4096
    v_permlane16_swap_b32 v233, v235
    v_mfma_f32_16x16x32_bf16 v[92:95], a[36:39], a[204:207], v[92:95]
    v_permlane16_swap_b32 v232, v234
    v_mfma_f32_16x16x32_bf16 v[92:95], a[44:47], a[220:223], v[92:95]
    v_fma_f32 v192, v192, v233, -v232
    v_mfma_f32_16x16x32_bf16 v[76:79], a[40:43], a[220:223], v[76:79]
    buffer_load_dwordx4 a[112:115], v30, s[40:43], s81 offen offset:0 sc1
    v_mfma_f32_16x16x32_bf16 v[76:79], a[32:35], a[204:207], v[76:79]
    s_waitcnt vmcnt(14)
    v_fma_f32 v193, v193, v233, -v232
    v_mfma_f32_16x16x32_bf16 v[64:67], a[48:51], a[224:227], v[64:67]
    v_fma_f32 v194, v194, v233, -v232
    v_fma_f32 v195, v195, v233, -v232
    v_mfma_f32_16x16x32_bf16 v[64:67], a[56:59], a[240:243], v[64:67]
    v_fma_f32 v196, v196, v233, -v232
    v_mfma_f32_16x16x32_bf16 v[80:83], a[60:63], a[240:243], v[80:83]
    buffer_load_dwordx4 a[116:119], v30, s[40:43], s81 offen offset:1024 sc1
    v_mfma_f32_16x16x32_bf16 v[80:83], a[52:55], a[224:227], v[80:83]
    v_fma_f32 v197, v197, v233, -v232
    v_fma_f32 v198, v198, v233, -v232
    v_mfma_f32_16x16x32_bf16 v[84:87], a[52:55], a[228:231], v[84:87]
    v_fma_f32 v199, v199, v233, -v232
    v_fma_f32 v200, v200, v233, -v232
    v_mfma_f32_16x16x32_bf16 v[84:87], a[60:63], a[244:247], v[84:87]
    v_fma_f32 v201, v201, v233, -v232
    v_mfma_f32_16x16x32_bf16 v[68:71], a[56:59], a[244:247], v[68:71]
    buffer_load_dwordx4 a[120:123], v30, s[40:43], s81 offen offset:2048 sc1
    v_mfma_f32_16x16x32_bf16 v[68:71], a[48:51], a[228:231], v[68:71]
    v_cvt_pk_bf16_f32 v32, v64, v65
    v_cvt_pk_bf16_f32 v33, v66, v67
    v_mfma_f32_16x16x32_bf16 v[72:75], a[48:51], a[232:235], v[72:75]
    v_cvt_pk_bf16_f32 v34, v80, v81
    v_cvt_pk_bf16_f32 v35, v82, v83
    v_mfma_f32_16x16x32_bf16 v[72:75], a[56:59], a[248:251], v[72:75]
    s_waitcnt vmcnt(11)
    ds_write_b128 v12, v[32:35] offset:32768
    v_cmp_ne_u32 vcc, s56, v24
    v_mfma_f32_16x16x32_bf16 v[88:91], a[60:63], a[248:251], v[88:91]
    buffer_load_dwordx4 a[124:127], v30, s[40:43], s81 offen offset:3072 sc1
    v_mfma_f32_16x16x32_bf16 v[88:91], a[52:55], a[232:235], v[88:91]
    s_add_u32 s81, s81, 102400
    v_cvt_pk_bf16_f32 v38, v84, v85
    v_cvt_pk_bf16_f32 v39, v86, v87
    s_cbranch_vccnz L_spin_xa
L_back_xa:
    v_mfma_f32_16x16x32_bf16 v[92:95], a[52:55], a[236:239], v[92:95]
    v_cvt_pk_bf16_f32 v36, v68, v69
    v_cvt_pk_bf16_f32 v37, v70, v71
    v_mfma_f32_16x16x32_bf16 v[92:95], a[60:63], a[252:255], v[92:95]
    s_add_u32 m0, s57, 4096
    ds_write_b128 v12, v[36:39] offset:34816
    v_mfma_f32_16x16x32_bf16 v[76:79], a[56:59], a[252:255], v[76:79]
    global_load_lds_dwordx4 v4, s[58:59] offset:-4096 sc1
    v_mfma_f32_16x16x32_bf16 v[76:79], a[48:51], a[236:239], v[76:79]
    v_cvt_pk_bf16_f32 v40, v72, v73
    v_cvt_pk_bf16_f32 v41, v74, v75
    v_mfma_f32_16x16x32_bf16 v[96:99], a[64:67], a[128:131], 0
    v_cvt_pk_bf16_f32 v42, v88, v89
    v_cvt_pk_bf16_f32 v43, v90, v91
    v_mfma_f32_16x16x32_bf16 v[96:99], a[72:75], a[144:147], v[96:99]
    ds_write_b128 v12, v[40:43] offset:36864
    v_mfma_f32_16x16x32_bf16 v[112:115], a[76:79], a[144:147], 0
    global_load_lds_dwordx4 v4, s[58:59] offset:-3072 sc1
    v_mfma_f32_16x16x32_bf16 v[112:115], a[68:71], a[128:131], v[112:115]
    v_cvt_pk_bf16_f32 v46, v92, v93
    v_cvt_pk_bf16_f32 v47, v94, v95
    v_mfma_f32_16x16x32_bf16 v[116:119], a[68:71], a[132:135], 0
    v_cvt_pk_bf16_f32 v44, v76, v77
    v_cvt_pk_bf16_f32 v45, v78, v79
    v_mfma_f32_16x16x32_bf16 v[116:119], a[76:79], a[148:151], v[116:119]
    ds_write_b128 v12, v[44:47] offset:38912
    v_mfma_f32_16x16x32_bf16 v[100:103], a[72:75], a[148:151], 0
    global_load_lds_dwordx4 v4, s[58:59] offset:-2048 sc1
    v_mfma_f32_16x16x32_bf16 v[100:103], a[64:67], a[132:135], v[100:103]
    v_fma_f32 v202, v202, v233, -v232
    v_fma_f32 v203, v203, v233, -v232
    v_mfma_f32_16x16x32_bf16 v[104:107], a[64:67], a[136:139], 0
    v_fma_f32 v204, v204, v233, -v232
    v_fma_f32 v205, v205, v233, -v232
    v_mfma_f32_16x16x32_bf16 v[104:107], a[72:75], a[152:155], v[104:107]
    v_fma_f32 v206, v206, v233, -v232
    v_mfma_f32_16x16x32_bf16 v[120:123], a[76:79], a[152:155], 0
    global_load_lds_dwordx4 v4, s[58:59] offset:-1024 sc1
    v_mfma_f32_16x16x32_bf16 v[120:123], a[68:71], a[136:139], v[120:123]
    v_fma_f32 v207, v207, v233, -v232
    v_fma_f32 v208, v208, v235, -v234
    v_mfma_f32_16x16x32_bf16 v[124:127], a[68:71], a[140:143], 0
    v_fma_f32 v209, v209, v235, -v234
    v_mfma_f32_16x16x32_bf16 v[124:127], a[76:79], a[156:159], v[124:127]
    v_fma_f32 v210, v210, v235, -v234
    v_fma_f32 v211, v211, v235, -v234
    v_mfma_f32_16x16x32_bf16 v[108:111], a[72:75], a[156:159], 0
    global_load_lds_dwordx4 v5, s[58:59] offset:0 sc1
    v_mfma_f32_16x16x32_bf16 v[108:111], a[64:67], a[140:143], v[108:111]
    s_waitcnt vmcnt(13)
    v_fma_f32 v212, v212, v235, -v234
    v_fma_f32 v213, v213, v235, -v234
    v_mfma_f32_16x16x32_bf16 v[96:99], a[80:83], a[160:163], v[96:99]
    v_fma_f32 v214, v214, v235, -v234
    v_mfma_f32_16x16x32_bf16 v[96:99], a[88:91], a[176:179], v[96:99]
    v_fma_f32 v215, v215, v235, -v234
    v_fma_f32 v216, v216, v235, -v234
    v_mfma_f32_16x16x32_bf16 v[112:115], a[92:95], a[176:179], v[112:115]
    global_load_lds_dwordx4 v5, s[58:59] offset:1024 sc1
    v_mfma_f32_16x16x32_bf16 v[112:115], a[84:87], a[160:163], v[112:115]
    v_fma_f32 v217, v217, v235, -v234
    v_mfma_f32_16x16x32_bf16 v[116:119], a[84:87], a[164:167], v[116:119]
    v_fma_f32 v218, v218, v235, -v234
    v_fma_f32 v219, v219, v235, -v234
    v_mfma_f32_16x16x32_bf16 v[116:119], a[92:95], a[180:183], v[116:119]
    v_fma_f32 v220, v220, v235, -v234
    v_fma_f32 v221, v221, v235, -v234
    v_mfma_f32_16x16x32_bf16 v[100:103], a[88:91], a[180:183], v[100:103]
    global_load_lds_dwordx4 v5, s[58:59] offset:2048 sc1
    v_mfma_f32_16x16x32_bf16 v[100:103], a[80:83], a[164:167], v[100:103]
    v_fma_f32 v222, v222, v235, -v234
    v_mfma_f32_16x16x32_bf16 v[104:107], a[80:83], a[168:171], v[104:107]
    v_fma_f32 v223, v223, v235, -v234
    v_cvt_pk_bf16_f32 v240, v192, v208
    v_mfma_f32_16x16x32_bf16 v[104:107], a[88:91], a[184:187], v[104:107]
    v_cvt_pk_bf16_f32 v241, v193, v209
    v_cvt_pk_bf16_f32 v242, v194, v210
    v_mfma_f32_16x16x32_bf16 v[120:123], a[92:95], a[184:187], v[120:123]
    global_load_lds_dwordx4 v5, s[58:59] offset:3072 sc1
    v_mfma_f32_16x16x32_bf16 v[120:123], a[84:87], a[168:171], v[120:123]
    s_add_u32 s58, s58, 16384
    s_addc_u32 s59, s59, 0
    v_cvt_pk_bf16_f32 v243, v195, v211
    v_mfma_f32_16x16x32_bf16 v[124:127], a[84:87], a[172:175], v[124:127]
    v_cvt_pk_bf16_f32 v244, v196, v212
    v_cvt_pk_bf16_f32 v245, v197, v213
    v_mfma_f32_16x16x32_bf16 v[124:127], a[92:95], a[188:191], v[124:127]
    s_add_u32 m0, s57, 12288
    v_cvt_pk_bf16_f32 v246, v198, v214
    v_mfma_f32_16x16x32_bf16 v[108:111], a[88:91], a[188:191], v[108:111]
    global_load_lds_dwordx4 v4, s[60:61] offset:-4096 sc1
    v_mfma_f32_16x16x32_bf16 v[108:111], a[80:83], a[172:175], v[108:111]
    s_waitcnt vmcnt(13)
    v_cvt_pk_bf16_f32 v247, v199, v215
    v_cvt_pk_bf16_f32 v248, v200, v216
    v_mfma_f32_16x16x32_bf16 v[96:99], a[96:99], a[192:195], v[96:99]
    v_cvt_pk_bf16_f32 v249, v201, v217
    v_cvt_pk_bf16_f32 v250, v202, v218
    v_mfma_f32_16x16x32_bf16 v[96:99], a[104:107], a[208:211], v[96:99]
    v_cvt_pk_bf16_f32 v251, v203, v219
    v_mfma_f32_16x16x32_bf16 v[112:115], a[108:111], a[208:211], v[112:115]
    global_load_lds_dwordx4 v4, s[60:61] offset:-3072 sc1
    v_mfma_f32_16x16x32_bf16 v[112:115], a[100:103], a[192:195], v[112:115]
    v_cvt_pk_bf16_f32 v252, v204, v220
    v_cvt_pk_bf16_f32 v253, v205, v221
    v_mfma_f32_16x16x32_bf16 v[116:119], a[100:103], a[196:199], v[116:119]
    v_cvt_pk_bf16_f32 v254, v206, v222
    v_cvt_pk_bf16_f32 v255, v207, v223
    v_mfma_f32_16x16x32_bf16 v[116:119], a[108:111], a[212:215], v[116:119]
    v_mov_b32 v16, 0
    v_mfma_f32_16x16x32_bf16 v[100:103], a[104:107], a[212:215], v[100:103]
    global_load_lds_dwordx4 v4, s[60:61] offset:-2048 sc1
    v_mfma_f32_16x16x32_bf16 v[100:103], a[96:99], a[196:199], v[100:103]
    v_mov_b32 v17, 0
    v_mov_b32 v18, 0
    v_mfma_f32_16x16x32_bf16 v[104:107], a[96:99], a[200:203], v[104:107]
    v_mov_b32 v19, 0
    v_mfma_f32_16x16x32_bf16 v[104:107], a[104:107], a[216:219], v[104:107]
    v_mov_b32 v20, 0
    v_mov_b32 v21, 0
    v_mfma_f32_16x16x32_bf16 v[120:123], a[108:111], a[216:219], v[120:123]
    global_load_lds_dwordx4 v4, s[60:61] offset:-1024 sc1
    v_mfma_f32_16x16x32_bf16 v[120:123], a[100:103], a[200:203], v[120:123]
    v_mov_b32 v22, 0
    v_mov_b32 v23, 0
    v_mfma_f32_16x16x32_bf16 v[124:127], a[100:103], a[204:207], v[124:127]
    v_mov_b32 v24, 0
    v_mfma_f32_16x16x32_bf16 v[124:127], a[108:111], a[220:223], v[124:127]
    v_mov_b32 v25, 0
    v_mov_b32 v26, 0
    v_mfma_f32_16x16x32_bf16 v[108:111], a[104:107], a[220:223], v[108:111]
    global_load_lds_dwordx4 v5, s[60:61] offset:0 sc1
    v_mfma_f32_16x16x32_bf16 v[108:111], a[96:99], a[204:207], v[108:111]
    s_waitcnt vmcnt(13)
    v_mov_b32 v27, 0
    v_mov_b32 v28, 0
    v_mfma_f32_16x16x32_bf16 v[96:99], a[112:115], a[224:227], v[96:99]
    v_mov_b32 v29, 0
    v_mfma_f32_16x16x32_bf16 v[96:99], a[120:123], a[240:243], v[96:99]
    v_mov_b32 v31, 0
    v_mov_b32 v8, 0
    v_mfma_f32_16x16x32_bf16 v[112:115], a[124:127], a[240:243], v[112:115]
    s_waitcnt vmcnt(9)
    ds_read_b128 v[32:35], v2 offset:0
    ds_read_b128 v[36:39], v2 offset:256
    v_mov_b32 v9, 0
    v_mfma_f32_16x16x32_bf16 v[112:115], a[116:119], a[224:227], v[112:115]
    v_mov_b32 v10, 0
    v_mov_b32 v11, 0
    v_mfma_f32_16x16x32_bf16 v[116:119], a[116:119], a[228:231], v[116:119]
    s_nop 1
    v_mfma_f32_16x16x32_bf16 v[116:119], a[124:127], a[244:247], v[116:119]
    s_nop 1
    v_mfma_f32_16x16x32_bf16 v[100:103], a[120:123], a[244:247], v[100:103]
    ds_read_b128 v[40:43], v2 offset:2048
    ds_read_b128 v[44:47], v2 offset:2304
    v_mfma_f32_16x16x32_bf16 v[100:103], a[112:115], a[228:231], v[100:103]
    v_cvt_pk_bf16_f32 v48, v96, v97
    v_cvt_pk_bf16_f32 v49, v98, v99
    v_mfma_f32_16x16x32_bf16 v[104:107], a[112:115], a[232:235], v[104:107]
    v_cvt_pk_bf16_f32 v50, v112, v113
    v_cvt_pk_bf16_f32 v51, v114, v115
    v_mfma_f32_16x16x32_bf16 v[104:107], a[120:123], a[248:251], v[104:107]
    ds_write_b128 v12, v[48:51] offset:33792
    v_mfma_f32_16x16x32_bf16 v[120:123], a[124:127], a[248:251], v[120:123]
    v_mov_b32 v30, 0
    v_mov_b32 v0, v167
    v_mfma_f32_16x16x32_bf16 v[120:123], a[116:119], a[232:235], v[120:123]
    v_cvt_pk_bf16_f32 v54, v116, v117
    v_cvt_pk_bf16_f32 v55, v118, v119
    v_mfma_f32_16x16x32_bf16 v[124:127], a[116:119], a[236:239], v[124:127]
    v_cvt_pk_bf16_f32 v52, v100, v101
    v_cvt_pk_bf16_f32 v53, v102, v103
    v_mfma_f32_16x16x32_bf16 v[124:127], a[124:127], a[252:255], v[124:127]
    ds_write_b128 v12, v[52:55] offset:35840
    v_mfma_f32_16x16x32_bf16 v[108:111], a[120:123], a[252:255], v[108:111]
    v_mfma_f32_16x16x32_bf16 v[108:111], a[112:115], a[236:239], v[108:111]
    v_cvt_pk_bf16_f32 v56, v104, v105
    v_cvt_pk_bf16_f32 v57, v106, v107
    ds_read_b128 a[0:3], v12 offset:32768
    ds_read_b128 a[32:35], v12 offset:34816
    ds_read_b128 a[64:67], v12 offset:36864
    ds_read_b128 a[96:99], v12 offset:38912
    v_cvt_pk_bf16_f32 v58, v120, v121
    v_cvt_pk_bf16_f32 v59, v122, v123
    ds_write_b128 v12, v[56:59] offset:37888
    v_cvt_pk_bf16_f32 v62, v124, v125
    v_cvt_pk_bf16_f32 v63, v126, v127
    v_cvt_pk_bf16_f32 v60, v108, v109
    v_cvt_pk_bf16_f32 v61, v110, v111
    ds_write_b128 v12, v[60:63] offset:39936
    ds_read_b128 a[4:7], v12 offset:33792
    ds_read_b128 a[36:39], v12 offset:35840
    ds_read_b128 a[68:71], v12 offset:37888
    ds_read_b128 a[100:103], v12 offset:39936
    global_load_lds_dwordx4 v5, s[60:61] offset:1024 sc1
    s_waitcnt lgkmcnt(9)
    v_mfma_f32_16x16x32_bf16 v[64:67], v[32:35], a[0:3], v[16:19]
    s_waitcnt vmcnt(8)
    ds_read_b128 v[48:51], v2 offset:4096
    v_mfma_f32_16x16x32_bf16 v[68:71], v[36:39], a[0:3], v[16:19]
    s_waitcnt lgkmcnt(9)
    v_mfma_f32_16x16x32_bf16 v[72:75], v[32:35], a[32:35], v[20:23]
    global_load_lds_dwordx4 v5, s[60:61] offset:2048 sc1
    v_mfma_f32_16x16x32_bf16 v[76:79], v[36:39], a[32:35], v[20:23]
    s_waitcnt lgkmcnt(5)
    s_barrier
    v_mfma_f32_16x16x32_bf16 v[80:83], v[32:35], a[64:67], v[24:27]
    ds_read_b128 v[52:55], v2 offset:4352
    v_mfma_f32_16x16x32_bf16 v[84:87], v[36:39], a[64:67], v[24:27]
    ds_read_b128 a[8:11], v13 offset:32768
    ds_read_b128 a[40:43], v13 offset:34816
    v_mfma_f32_16x16x32_bf16 v[88:91], v[32:35], a[96:99], v[28:31]
    global_load_lds_dwordx4 v5, s[60:61] offset:3072 sc1
    v_mfma_f32_16x16x32_bf16 v[92:95], v[36:39], a[96:99], v[28:31]
    s_waitcnt lgkmcnt(4)
    s_add_u32 s60, s60, 16384
    s_addc_u32 s61, s61, 0
    ds_read_b128 a[72:75], v13 offset:36864
    ds_read_b128 a[104:107], v13 offset:38912
    v_mfma_f32_16x16x32_bf16 v[64:67], v[40:43], a[4:7], v[64:67]
    s_waitcnt vmcnt(8)
    ds_read_b128 v[56:59], v2 offset:6144
    v_mfma_f32_16x16x32_bf16 v[68:71], v[44:47], a[4:7], v[68:71]
    s_add_u32 m0, s57, 20480
    ds_read_b128 a[12:15], v13 offset:33792
    ds_read_b128 a[44:47], v13 offset:35840
    v_mfma_f32_16x16x32_bf16 v[72:75], v[40:43], a[36:39], v[72:75]
    global_load_lds_dwordx4 v4, s[58:59] offset:-4096 sc1
    v_mfma_f32_16x16x32_bf16 v[76:79], v[44:47], a[36:39], v[76:79]
    v_mfma_f32_16x16x32_bf16 v[80:83], v[40:43], a[68:71], v[80:83]
    ds_read_b128 v[60:63], v2 offset:6400
    v_mfma_f32_16x16x32_bf16 v[84:87], v[44:47], a[68:71], v[84:87]
    ds_read_b128 a[76:79], v13 offset:37888
    ds_read_b128 a[108:111], v13 offset:39936
    v_mfma_f32_16x16x32_bf16 v[88:91], v[40:43], a[100:103], v[88:91]
    global_load_lds_dwordx4 v4, s[58:59] offset:-3072 sc1
    v_mfma_f32_16x16x32_bf16 v[92:95], v[44:47], a[100:103], v[92:95]
    s_waitcnt lgkmcnt(6)
    v_mfma_f32_16x16x32_bf16 v[64:67], v[48:51], a[8:11], v[64:67]
    s_waitcnt vmcnt(8)
    ds_read_b128 v[32:35], v2 offset:8192
    v_mfma_f32_16x16x32_bf16 v[68:71], v[52:55], a[8:11], v[68:71]
    ds_read_b128 a[16:19], v14 offset:32768
    ds_read_b128 a[48:51], v14 offset:34816
    v_mfma_f32_16x16x32_bf16 v[72:75], v[48:51], a[40:43], v[72:75]
    global_load_lds_dwordx4 v4, s[58:59] offset:-2048 sc1
    v_mfma_f32_16x16x32_bf16 v[76:79], v[52:55], a[40:43], v[76:79]
    v_mfma_f32_16x16x32_bf16 v[80:83], v[48:51], a[72:75], v[80:83]
    ds_read_b128 v[36:39], v2 offset:8448
    v_mfma_f32_16x16x32_bf16 v[84:87], v[52:55], a[72:75], v[84:87]
    ds_read_b128 a[80:83], v14 offset:36864
    ds_read_b128 a[112:115], v14 offset:38912
    v_mfma_f32_16x16x32_bf16 v[88:91], v[48:51], a[104:107], v[88:91]
    global_load_lds_dwordx4 v4, s[58:59] offset:-1024 sc1
    v_mfma_f32_16x16x32_bf16 v[92:95], v[52:55], a[104:107], v[92:95]
    s_waitcnt lgkmcnt(6)
    v_mfma_f32_16x16x32_bf16 v[64:67], v[56:59], a[12:15], v[64:67]
    s_waitcnt vmcnt(8)
    ds_read_b128 v[40:43], v2 offset:10240
    v_mfma_f32_16x16x32_bf16 v[68:71], v[60:63], a[12:15], v[68:71]
    ds_read_b128 a[20:23], v14 offset:33792
    ds_read_b128 a[52:55], v14 offset:35840
    v_mfma_f32_16x16x32_bf16 v[72:75], v[56:59], a[44:47], v[72:75]
    global_load_lds_dwordx4 v5, s[58:59] offset:0 sc1
    v_mfma_f32_16x16x32_bf16 v[76:79], v[60:63], a[44:47], v[76:79]
    v_mfma_f32_16x16x32_bf16 v[80:83], v[56:59], a[76:79], v[80:83]
    ds_read_b128 v[44:47], v2 offset:10496
    v_mfma_f32_16x16x32_bf16 v[84:87], v[60:63], a[76:79], v[84:87]
    ds_read_b128 a[84:87], v14 offset:37888
    ds_read_b128 a[116:119], v14 offset:39936
    v_mfma_f32_16x16x32_bf16 v[88:91], v[56:59], a[108:111], v[88:91]
    global_load_lds_dwordx4 v5, s[58:59] offset:1024 sc1
    v_mfma_f32_16x16x32_bf16 v[92:95], v[60:63], a[108:111], v[92:95]
    s_waitcnt lgkmcnt(6)
    v_mfma_f32_16x16x32_bf16 v[64:67], v[32:35], a[16:19], v[64:67]
    s_waitcnt vmcnt(8)
    ds_read_b128 v[48:51], v2 offset:12288
    v_mfma_f32_16x16x32_bf16 v[68:71], v[36:39], a[16:19], v[68:71]
    ds_read_b128 a[24:27], v15 offset:32768
    ds_read_b128 a[56:59], v15 offset:34816
    v_mfma_f32_16x16x32_bf16 v[72:75], v[32:35], a[48:51], v[72:75]
    global_load_lds_dwordx4 v5, s[58:59] offset:2048 sc1
    v_mfma_f32_16x16x32_bf16 v[76:79], v[36:39], a[48:51], v[76:79]
    v_mfma_f32_16x16x32_bf16 v[80:83], v[32:35], a[80:83], v[80:83]
    ds_read_b128 v[52:55], v2 offset:12544
    v_mfma_f32_16x16x32_bf16 v[84:87], v[36:39], a[80:83], v[84:87]
    ds_read_b128 a[88:91], v15 offset:36864
    ds_read_b128 a[120:123], v15 offset:38912
    v_mfma_f32_16x16x32_bf16 v[88:91], v[32:35], a[112:115], v[88:91]
    global_load_lds_dwordx4 v5, s[58:59] offset:3072 sc1
    v_mfma_f32_16x16x32_bf16 v[92:95], v[36:39], a[112:115], v[92:95]
    s_waitcnt lgkmcnt(6)
    s_add_u32 s58, s58, 16384
    s_addc_u32 s59, s59, 0
    v_mfma_f32_16x16x32_bf16 v[64:67], v[40:43], a[20:23], v[64:67]
    s_waitcnt vmcnt(8)
    ds_read_b128 v[56:59], v2 offset:14336
    v_mfma_f32_16x16x32_bf16 v[68:71], v[44:47], a[20:23], v[68:71]
    s_add_u32 m0, s57, 28672
    ds_read_b128 a[28:31], v15 offset:33792
    ds_read_b128 a[60:63], v15 offset:35840
    v_mfma_f32_16x16x32_bf16 v[72:75], v[40:43], a[52:55], v[72:75]
    global_load_lds_dwordx4 v4, s[60:61] offset:-4096 sc1
    v_mfma_f32_16x16x32_bf16 v[76:79], v[44:47], a[52:55], v[76:79]
    v_mfma_f32_16x16x32_bf16 v[80:83], v[40:43], a[84:87], v[80:83]
    ds_read_b128 v[60:63], v2 offset:14592
    v_mfma_f32_16x16x32_bf16 v[84:87], v[44:47], a[84:87], v[84:87]
    ds_read_b128 a[92:95], v15 offset:37888
    ds_read_b128 a[124:127], v15 offset:39936
    v_mfma_f32_16x16x32_bf16 v[88:91], v[40:43], a[116:119], v[88:91]
    global_load_lds_dwordx4 v4, s[60:61] offset:-3072 sc1
    v_mfma_f32_16x16x32_bf16 v[92:95], v[44:47], a[116:119], v[92:95]
    s_waitcnt lgkmcnt(6)
    v_mfma_f32_16x16x32_bf16 v[64:67], v[48:51], a[24:27], v[64:67]
    s_waitcnt vmcnt(8)
    ds_read_b128 v[32:35], v2 offset:16384
    v_mfma_f32_16x16x32_bf16 v[68:71], v[52:55], a[24:27], v[68:71]
    v_mfma_f32_16x16x32_bf16 v[72:75], v[48:51], a[56:59], v[72:75]
    global_load_lds_dwordx4 v4, s[60:61] offset:-2048 sc1
    v_mfma_f32_16x16x32_bf16 v[76:79], v[52:55], a[56:59], v[76:79]
    v_mfma_f32_16x16x32_bf16 v[80:83], v[48:51], a[88:91], v[80:83]
    ds_read_b128 v[36:39], v2 offset:16640
    v_mfma_f32_16x16x32_bf16 v[84:87], v[52:55], a[88:91], v[84:87]
    v_mfma_f32_16x16x32_bf16 v[88:91], v[48:51], a[120:123], v[88:91]
    global_load_lds_dwordx4 v4, s[60:61] offset:-1024 sc1
    v_mfma_f32_16x16x32_bf16 v[92:95], v[52:55], a[120:123], v[92:95]
    s_waitcnt lgkmcnt(2)
    v_mfma_f32_16x16x32_bf16 v[64:67], v[56:59], a[28:31], v[64:67]
    s_waitcnt vmcnt(8)
    ds_read_b128 v[40:43], v2 offset:18432
    v_mfma_f32_16x16x32_bf16 v[68:71], v[60:63], a[28:31], v[68:71]
    v_mfma_f32_16x16x32_bf16 v[72:75], v[56:59], a[60:63], v[72:75]
    global_load_lds_dwordx4 v5, s[60:61] offset:0 sc1
    v_mfma_f32_16x16x32_bf16 v[76:79], v[60:63], a[60:63], v[76:79]
    v_mfma_f32_16x16x32_bf16 v[80:83], v[56:59], a[92:95], v[80:83]
    ds_read_b128 v[44:47], v2 offset:18688
    v_mfma_f32_16x16x32_bf16 v[84:87], v[60:63], a[92:95], v[84:87]
    v_mfma_f32_16x16x32_bf16 v[88:91], v[56:59], a[124:127], v[88:91]
    global_load_lds_dwordx4 v5, s[60:61] offset:1024 sc1
    s_barrier
    v_mfma_f32_16x16x32_bf16 v[92:95], v[60:63], a[124:127], v[92:95]
    s_waitcnt lgkmcnt(2)
    v_mfma_f32_16x16x32_bf16 v[96:99], v[32:35], a[0:3], v[16:19]
    s_waitcnt vmcnt(8)
    ds_read_b128 v[48:51], v2 offset:20480
    v_mfma_f32_16x16x32_bf16 v[100:103], v[36:39], a[0:3], v[16:19]
    v_mfma_f32_16x16x32_bf16 v[104:107], v[32:35], a[32:35], v[20:23]
    global_load_lds_dwordx4 v5, s[60:61] offset:2048 sc1
    v_mfma_f32_16x16x32_bf16 v[108:111], v[36:39], a[32:35], v[20:23]
    v_mfma_f32_16x16x32_bf16 v[112:115], v[32:35], a[64:67], v[24:27]
    ds_read_b128 v[52:55], v2 offset:20736
    v_mfma_f32_16x16x32_bf16 v[116:119], v[36:39], a[64:67], v[24:27]
    v_exp_f32 v64, v64
    v_mfma_f32_16x16x32_bf16 v[120:123], v[32:35], a[96:99], v[28:31]
    global_load_lds_dwordx4 v5, s[60:61] offset:3072 sc1
    v_mfma_f32_16x16x32_bf16 v[124:127], v[36:39], a[96:99], v[28:31]
    s_waitcnt vmcnt(8) lgkmcnt(2)
    s_add_u32 s60, s60, 16384
    s_addc_u32 s61, s61, 0
    v_exp_f32 v65, v65
    v_mfma_f32_16x16x32_bf16 v[120:123], v[40:43], a[100:103], v[120:123]
    ds_read_b128 v[56:59], v2 offset:22528
    v_mfma_f32_16x16x32_bf16 v[124:127], v[44:47], a[100:103], v[124:127]
    s_add_u32 m0, s57, 36864
    v_exp_f32 v66, v66
    v_mfma_f32_16x16x32_bf16 v[112:115], v[40:43], a[68:71], v[112:115]
    global_load_lds_dwordx4 v4, s[58:59] offset:-4096 sc1
    v_mfma_f32_16x16x32_bf16 v[116:119], v[44:47], a[68:71], v[116:119]
    v_add_f32 v12, v64, v65
    v_cvt_pk_bf16_f32 v64, v64, v65
    v_mfma_f32_16x16x32_bf16 v[104:107], v[40:43], a[36:39], v[104:107]
    ds_read_b128 v[60:63], v2 offset:22784
    v_mfma_f32_16x16x32_bf16 v[108:111], v[44:47], a[36:39], v[108:111]
    v_exp_f32 v67, v67
    v_mfma_f32_16x16x32_bf16 v[96:99], v[40:43], a[4:7], v[96:99]
    global_load_lds_dwordx4 v4, s[58:59] offset:-3072 sc1
    v_mfma_f32_16x16x32_bf16 v[100:103], v[44:47], a[4:7], v[100:103]
    s_waitcnt vmcnt(8) lgkmcnt(2)
    v_add_f32 v12, v12, v66
    v_mfma_f32_16x16x32_bf16 v[96:99], v[48:51], a[8:11], v[96:99]
    ds_read_b128 v[32:35], v2 offset:24576
    v_mfma_f32_16x16x32_bf16 v[100:103], v[52:55], a[8:11], v[100:103]
    v_exp_f32 v68, v68
    v_mfma_f32_16x16x32_bf16 v[104:107], v[48:51], a[40:43], v[104:107]
    global_load_lds_dwordx4 v4, s[58:59] offset:-2048 sc1
    v_mfma_f32_16x16x32_bf16 v[108:111], v[52:55], a[40:43], v[108:111]
    v_add_f32 v12, v12, v67
    v_cvt_pk_bf16_f32 v65, v66, v67
    v_mfma_f32_16x16x32_bf16 v[112:115], v[48:51], a[72:75], v[112:115]
    ds_read_b128 v[36:39], v2 offset:24832
    v_mfma_f32_16x16x32_bf16 v[116:119], v[52:55], a[72:75], v[116:119]
    v_exp_f32 v69, v69
    v_mfma_f32_16x16x32_bf16 v[120:123], v[48:51], a[104:107], v[120:123]
    global_load_lds_dwordx4 v4, s[58:59] offset:-1024 sc1
    v_mfma_f32_16x16x32_bf16 v[124:127], v[52:55], a[104:107], v[124:127]
    s_waitcnt vmcnt(8) lgkmcnt(2)
    v_add_f32 v12, v12, v68
    v_mfma_f32_16x16x32_bf16 v[120:123], v[56:59], a[108:111], v[120:123]
    ds_read_b128 v[40:43], v2 offset:26624
    v_mfma_f32_16x16x32_bf16 v[124:127], v[60:63], a[108:111], v[124:127]
    v_exp_f32 v70, v70
    v_mfma_f32_16x16x32_bf16 v[112:115], v[56:59], a[76:79], v[112:115]
    global_load_lds_dwordx4 v5, s[58:59] offset:0 sc1
    v_mfma_f32_16x16x32_bf16 v[116:119], v[60:63], a[76:79], v[116:119]
    v_add_f32 v12, v12, v69
    v_cvt_pk_bf16_f32 v66, v68, v69
    v_mfma_f32_16x16x32_bf16 v[104:107], v[56:59], a[44:47], v[104:107]
    ds_read_b128 v[44:47], v2 offset:26880
    v_mfma_f32_16x16x32_bf16 v[108:111], v[60:63], a[44:47], v[108:111]
    v_exp_f32 v71, v71
    v_mfma_f32_16x16x32_bf16 v[96:99], v[56:59], a[12:15], v[96:99]
    global_load_lds_dwordx4 v5, s[58:59] offset:1024 sc1
    v_mfma_f32_16x16x32_bf16 v[100:103], v[60:63], a[12:15], v[100:103]
    s_waitcnt vmcnt(8) lgkmcnt(2)
    v_add_f32 v12, v12, v70
    v_mfma_f32_16x16x32_bf16 v[96:99], v[32:35], a[16:19], v[96:99]
    ds_read_b128 v[48:51], v2 offset:28672
    v_mfma_f32_16x16x32_bf16 v[100:103], v[36:39], a[16:19], v[100:103]
    v_exp_f32 v72, v72
    v_mfma_f32_16x16x32_bf16 v[104:107], v[32:35], a[48:51], v[104:107]
    global_load_lds_dwordx4 v5, s[58:59] offset:2048 sc1
    v_mfma_f32_16x16x32_bf16 v[108:111], v[36:39], a[48:51], v[108:111]
    v_add_f32 v12, v12, v71
    v_cvt_pk_bf16_f32 v67, v70, v71
    v_mfma_f32_16x16x32_bf16 v[112:115], v[32:35], a[80:83], v[112:115]
    ds_read_b128 v[52:55], v2 offset:28928
    v_mfma_f32_16x16x32_bf16 v[116:119], v[36:39], a[80:83], v[116:119]
    v_exp_f32 v73, v73
    v_mfma_f32_16x16x32_bf16 v[120:123], v[32:35], a[112:115], v[120:123]
    global_load_lds_dwordx4 v5, s[58:59] offset:3072 sc1
    v_mfma_f32_16x16x32_bf16 v[124:127], v[36:39], a[112:115], v[124:127]
    s_waitcnt vmcnt(8) lgkmcnt(2)
    s_add_u32 s58, s58, 16384
    s_addc_u32 s59, s59, 0
    v_exp_f32 v74, v74
    v_mfma_f32_16x16x32_bf16 v[120:123], v[40:43], a[116:119], v[120:123]
    ds_read_b128 v[56:59], v2 offset:30720
    v_add_f32 v13, v72, v73
    v_mfma_f32_16x16x32_bf16 v[124:127], v[44:47], a[116:119], v[124:127]
    v_cvt_pk_bf16_f32 v72, v72, v73
    v_mfma_f32_16x16x32_bf16 v[112:115], v[40:43], a[84:87], v[112:115]
    v_exp_f32 v75, v75
    v_mfma_f32_16x16x32_bf16 v[116:119], v[44:47], a[84:87], v[116:119]
    v_add_f32 v13, v13, v74
    v_mfma_f32_16x16x32_bf16 v[104:107], v[40:43], a[52:55], v[104:107]
    ds_read_b128 v[60:63], v2 offset:30976
    v_mfma_f32_16x16x32_bf16 v[108:111], v[44:47], a[52:55], v[108:111]
    v_exp_f32 v76, v76
    v_mfma_f32_16x16x32_bf16 v[96:99], v[40:43], a[20:23], v[96:99]
    v_add_f32 v13, v13, v75
    v_cvt_pk_bf16_f32 v73, v74, v75
    v_mfma_f32_16x16x32_bf16 v[100:103], v[44:47], a[20:23], v[100:103]
    s_waitcnt lgkmcnt(2)
    v_exp_f32 v77, v77
    v_mfma_f32_16x16x32_bf16 v[96:99], v[48:51], a[24:27], v[96:99]
    ds_read_b64_tr_b16 v[32:33], v3 offset:0
    ds_read_b64_tr_b16 v[34:35], v3 offset:256
    v_mfma_f32_16x16x32_bf16 v[100:103], v[52:55], a[24:27], v[100:103]
    v_add_f32 v13, v13, v76
    v_mfma_f32_16x16x32_bf16 v[104:107], v[48:51], a[56:59], v[104:107]
    v_exp_f32 v78, v78
    v_mfma_f32_16x16x32_bf16 v[108:111], v[52:55], a[56:59], v[108:111]
    v_add_f32 v13, v13, v77
    v_cvt_pk_bf16_f32 v74, v76, v77
    v_mfma_f32_16x16x32_bf16 v[112:115], v[48:51], a[88:91], v[112:115]
    ds_read_b64_tr_b16 v[36:37], v3 offset:1024
    ds_read_b64_tr_b16 v[38:39], v3 offset:1280
    v_mfma_f32_16x16x32_bf16 v[116:119], v[52:55], a[88:91], v[116:119]
    v_exp_f32 v79, v79
    v_mfma_f32_16x16x32_bf16 v[120:123], v[48:51], a[120:123], v[120:123]
    v_add_f32 v13, v13, v78
    v_mfma_f32_16x16x32_bf16 v[124:127], v[52:55], a[120:123], v[124:127]
    s_waitcnt lgkmcnt(4)
    v_exp_f32 v80, v80
    v_mfma_f32_16x16x32_bf16 v[120:123], v[56:59], a[124:127], v[120:123]
    ds_read_b64_tr_b16 v[40:41], v3 offset:2048
    ds_read_b64_tr_b16 v[42:43], v3 offset:2304
    v_mfma_f32_16x16x32_bf16 v[124:127], v[60:63], a[124:127], v[124:127]
    v_add_f32 v13, v13, v79
    v_cvt_pk_bf16_f32 v75, v78, v79
    v_mfma_f32_16x16x32_bf16 v[112:115], v[56:59], a[92:95], v[112:115]
    v_exp_f32 v81, v81
    v_mfma_f32_16x16x32_bf16 v[116:119], v[60:63], a[92:95], v[116:119]
    v_exp_f32 v82, v82
    v_mfma_f32_16x16x32_bf16 v[104:107], v[56:59], a[60:63], v[104:107]
    ds_read_b64_tr_b16 v[44:45], v3 offset:3072
    ds_read_b64_tr_b16 v[46:47], v3 offset:3328
    v_mfma_f32_16x16x32_bf16 v[108:111], v[60:63], a[60:63], v[108:111]
    v_add_f32 v14, v80, v81
    v_cvt_pk_bf16_f32 v80, v80, v81
    v_exp_f32 v83, v83
    v_add_f32 v14, v14, v82
    v_exp_f32 v84, v84
    v_add_f32 v14, v14, v83
    v_cvt_pk_bf16_f32 v81, v82, v83
    v_exp_f32 v85, v85
    v_add_f32 v14, v14, v84
    v_exp_f32 v86, v86
    v_add_f32 v14, v14, v85
    v_cvt_pk_bf16_f32 v82, v84, v85
    v_exp_f32 v87, v87
    v_add_f32 v14, v14, v86
    v_exp_f32 v88, v88
    v_add_f32 v14, v14, v87
    v_cvt_pk_bf16_f32 v83, v86, v87
    v_exp_f32 v89, v89
    v_exp_f32 v90, v90
    v_add_f32 v15, v88, v89
L_pk2:
    s_cbranch_execz L_pk5
    v_cvt_pk_bf16_f32 v88, v88, v89
    v_exp_f32 v91, v91
    v_add_f32 v15, v15, v90
    v_exp_f32 v92, v92
    v_add_f32 v15, v15, v91
    v_cvt_pk_bf16_f32 v89, v90, v91
    v_exp_f32 v93, v93
    v_add_f32 v15, v15, v92
    v_exp_f32 v94, v94
    v_add_f32 v15, v15, v93
    v_cvt_pk_bf16_f32 v90, v92, v93
    v_exp_f32 v95, v95
    v_add_f32 v15, v15, v94
    v_max3_f32 v7, v12, v13, v14
    v_add_f32 v15, v15, v95
    v_cvt_pk_bf16_f32 v91, v94, v95
    v_add_f32 v7, v7, v15
    v_cmp_nge_f32 vcc, s62, v7
    v_mfma_f32_16x16x32_bf16 v[96:99], v[56:59], a[28:31], v[96:99]
    v_mfma_f32_16x16x32_bf16 v[100:103], v[60:63], a[28:31], v[100:103]
    s_waitcnt lgkmcnt(4)
    s_cbranch_vccnz L_stub_i0
    v_min3_f32 v7, v12, v13, v14
    v_min_f32 v7, v7, v15
    v_cmp_nle_f32 vcc, s63, v7
    s_cbranch_vccnz L_stub_i0
L_back_i0:
    v_mfma_f32_16x16x32_bf16 v[128:131], v[32:35], v[64:67], 0
    ds_read_b64_tr_b16 v[48:49], v3 offset:4096
    ds_read_b64_tr_b16 v[50:51], v3 offset:4352
    v_mfma_f32_16x16x32_bf16 v[132:135], v[36:39], v[64:67], 0
    s_add_u32 m0, s57, 4096
    v_add_f32 v8, v8, v12
    v_add_f32 v9, v9, v13
    v_mfma_f32_16x16x32_bf16 v[196:199], v[36:39], v[72:75], 0
    global_load_lds_dwordx4 v4, s[60:61] offset:-4096 sc1
    v_mfma_f32_16x16x32_bf16 v[192:195], v[32:35], v[72:75], 0
    v_add_f32 v10, v10, v14
    v_add_f32 v11, v11, v15
    v_mfma_f32_16x16x32_bf16 a[128:131], v[32:35], v[80:83], 0
    ds_read_b64_tr_b16 v[52:53], v3 offset:5120
    ds_read_b64_tr_b16 v[54:55], v3 offset:5376
    v_mfma_f32_16x16x32_bf16 a[132:135], v[36:39], v[80:83], 0
    v_mfma_f32_16x16x32_bf16 a[196:199], v[36:39], v[88:91], 0
    global_load_lds_dwordx4 v4, s[60:61] offset:-3072 sc1
    v_mfma_f32_16x16x32_bf16 a[192:195], v[32:35], v[88:91], 0
    s_waitcnt lgkmcnt(4)
    v_exp_f32 v96, v96
    v_mfma_f32_16x16x32_bf16 a[200:203], v[40:43], v[88:91], 0
    ds_read_b64_tr_b16 v[56:57], v3 offset:6144
    ds_read_b64_tr_b16 v[58:59], v3 offset:6400
    v_mfma_f32_16x16x32_bf16 a[204:207], v[44:47], v[88:91], 0
    v_exp_f32 v97, v97
    v_mfma_f32_16x16x32_bf16 a[140:143], v[44:47], v[80:83], 0
    global_load_lds_dwordx4 v4, s[60:61] offset:-2048 sc1
    v_mfma_f32_16x16x32_bf16 a[136:139], v[40:43], v[80:83], 0
    v_mfma_f32_16x16x32_bf16 v[200:203], v[40:43], v[72:75], 0
    ds_read_b64_tr_b16 v[60:61], v3 offset:7168
    ds_read_b64_tr_b16 v[62:63], v3 offset:7424
    v_mfma_f32_16x16x32_bf16 v[204:207], v[44:47], v[72:75], 0
    v_exp_f32 v98, v98
    v_mfma_f32_16x16x32_bf16 v[140:143], v[44:47], v[64:67], 0
    global_load_lds_dwordx4 v4, s[60:61] offset:-1024 sc1
    v_mfma_f32_16x16x32_bf16 v[136:139], v[40:43], v[64:67], 0
    s_waitcnt lgkmcnt(4)
    v_mfma_f32_16x16x32_bf16 v[144:147], v[48:51], v[64:67], 0
    ds_read_b64_tr_b16 v[32:33], v3 offset:8192
    ds_read_b64_tr_b16 v[34:35], v3 offset:8448
    v_mfma_f32_16x16x32_bf16 v[148:151], v[52:55], v[64:67], 0
    v_add_f32 v12, v96, v97
    v_mfma_f32_16x16x32_bf16 v[212:215], v[52:55], v[72:75], 0
    global_load_lds_dwordx4 v5, s[60:61] offset:0 sc1
    v_mfma_f32_16x16x32_bf16 v[208:211], v[48:51], v[72:75], 0
    v_cvt_pk_bf16_f32 v96, v96, v97
    v_mfma_f32_16x16x32_bf16 a[144:147], v[48:51], v[80:83], 0
    ds_read_b64_tr_b16 v[36:37], v3 offset:9216
    ds_read_b64_tr_b16 v[38:39], v3 offset:9472
    v_mfma_f32_16x16x32_bf16 a[148:151], v[52:55], v[80:83], 0
    v_exp_f32 v99, v99
    v_mfma_f32_16x16x32_bf16 a[212:215], v[52:55], v[88:91], 0
    global_load_lds_dwordx4 v5, s[60:61] offset:1024 sc1
    v_mfma_f32_16x16x32_bf16 a[208:211], v[48:51], v[88:91], 0
    s_waitcnt lgkmcnt(4)
    v_add_f32 v12, v12, v98
    v_mfma_f32_16x16x32_bf16 a[216:219], v[56:59], v[88:91], 0
    ds_read_b64_tr_b16 v[40:41], v3 offset:10240
    ds_read_b64_tr_b16 v[42:43], v3 offset:10496
    v_mfma_f32_16x16x32_bf16 a[220:223], v[60:63], v[88:91], 0
    v_exp_f32 v100, v100
    v_mfma_f32_16x16x32_bf16 a[156:159], v[60:63], v[80:83], 0
    global_load_lds_dwordx4 v5, s[60:61] offset:2048 sc1
    v_mfma_f32_16x16x32_bf16 a[152:155], v[56:59], v[80:83], 0
    v_mfma_f32_16x16x32_bf16 v[216:219], v[56:59], v[72:75], 0
    ds_read_b64_tr_b16 v[44:45], v3 offset:11264
    ds_read_b64_tr_b16 v[46:47], v3 offset:11520
    v_mfma_f32_16x16x32_bf16 v[220:223], v[60:63], v[72:75], 0
    v_add_f32 v12, v12, v99
    v_mfma_f32_16x16x32_bf16 v[156:159], v[60:63], v[64:67], 0
    global_load_lds_dwordx4 v5, s[60:61] offset:3072 sc1
    v_mfma_f32_16x16x32_bf16 v[152:155], v[56:59], v[64:67], 0
    s_waitcnt lgkmcnt(4)
    s_add_u32 s60, s60, 16384
    s_addc_u32 s61, s61, 0
    v_cvt_pk_bf16_f32 v97, v98, v99
    v_mfma_f32_16x16x32_bf16 v[160:163], v[32:35], v[64:67], 0
    ds_read_b64_tr_b16 v[48:49], v3 offset:12288
    ds_read_b64_tr_b16 v[50:51], v3 offset:12544
    v_mfma_f32_16x16x32_bf16 v[164:167], v[36:39], v[64:67], 0
    v_exp_f32 v101, v101
    v_mfma_f32_16x16x32_bf16 v[228:231], v[36:39], v[72:75], 0
    buffer_store_dwordx4 v[240:243], v0, s[36:39], 0 offen sc1
    v_mfma_f32_16x16x32_bf16 v[224:227], v[32:35], v[72:75], 0
    v_add_f32 v12, v12, v100
    v_mfma_f32_16x16x32_bf16 a[160:163], v[32:35], v[80:83], 0
    ds_read_b64_tr_b16 v[52:53], v3 offset:13312
    ds_read_b64_tr_b16 v[54:55], v3 offset:13568
    v_mfma_f32_16x16x32_bf16 a[164:167], v[36:39], v[80:83], 0
    v_exp_f32 v102, v102
    v_mfma_f32_16x16x32_bf16 a[228:231], v[36:39], v[88:91], 0
    buffer_store_dwordx4 v[244:247], v0, s[36:39], s12 offen sc1
    v_mfma_f32_16x16x32_bf16 a[224:227], v[32:35], v[88:91], 0
    s_waitcnt lgkmcnt(4)
    v_mfma_f32_16x16x32_bf16 a[232:235], v[40:43], v[88:91], 0
    ds_read_b64_tr_b16 v[56:57], v3 offset:14336
    ds_read_b64_tr_b16 v[58:59], v3 offset:14592
    v_mfma_f32_16x16x32_bf16 a[236:239], v[44:47], v[88:91], 0
    v_add_f32 v12, v12, v101
    v_mfma_f32_16x16x32_bf16 a[172:175], v[44:47], v[80:83], 0
    buffer_store_dwordx4 v[248:251], v0, s[36:39], s14 offen sc1
    v_mfma_f32_16x16x32_bf16 a[168:171], v[40:43], v[80:83], 0
    v_cvt_pk_bf16_f32 v98, v100, v101
    v_mfma_f32_16x16x32_bf16 v[232:235], v[40:43], v[72:75], 0
    ds_read_b64_tr_b16 v[60:61], v3 offset:15360
    ds_read_b64_tr_b16 v[62:63], v3 offset:15616
    v_mfma_f32_16x16x32_bf16 v[236:239], v[44:47], v[72:75], 0
    v_exp_f32 v103, v103
    v_mfma_f32_16x16x32_bf16 v[172:175], v[44:47], v[64:67], 0
    buffer_store_dwordx4 v[252:255], v0, s[36:39], s13 offen sc1
    v_mfma_f32_16x16x32_bf16 v[168:171], v[40:43], v[64:67], 0
    s_waitcnt vmcnt(12) lgkmcnt(4)
    v_add_f32 v12, v12, v102
    v_mfma_f32_16x16x32_bf16 v[176:179], v[48:51], v[64:67], 0
    ds_read_b128 v[32:35], v2 offset:32768
    v_mfma_f32_16x16x32_bf16 v[180:183], v[52:55], v[64:67], 0
    ds_read_b128 v[36:39], v2 offset:34816
    v_mfma_f32_16x16x32_bf16 v[244:247], v[52:55], v[72:75], 0
    v_exp_f32 v104, v104
    v_mfma_f32_16x16x32_bf16 v[240:243], v[48:51], v[72:75], 0
    v_add_f32 v12, v12, v103
    v_mfma_f32_16x16x32_bf16 a[176:179], v[48:51], v[80:83], 0
    ds_read_b128 v[40:43], v2 offset:36864
    v_cvt_pk_bf16_f32 v99, v102, v103
    v_mfma_f32_16x16x32_bf16 a[180:183], v[52:55], v[80:83], 0
    ds_read_b128 v[44:47], v2 offset:38912
    v_mfma_f32_16x16x32_bf16 a[244:247], v[52:55], v[88:91], 0
    v_exp_f32 v105, v105
    v_mfma_f32_16x16x32_bf16 a[240:243], v[48:51], v[88:91], 0
    s_waitcnt lgkmcnt(4)
    v_exp_f32 v106, v106
    v_mfma_f32_16x16x32_bf16 a[248:251], v[56:59], v[88:91], 0
    v_mfma_f32_16x16x32_bf16 a[252:255], v[60:63], v[88:91], 0
    v_add_f32 v13, v104, v105
    v_mfma_f32_16x16x32_bf16 a[188:191], v[60:63], v[80:83], 0
    v_cvt_pk_bf16_f32 v104, v104, v105
    v_mfma_f32_16x16x32_bf16 a[184:187], v[56:59], v[80:83], 0
    v_exp_f32 v107, v107
    v_mfma_f32_16x16x32_bf16 v[248:251], v[56:59], v[72:75], 0
    v_add_f32 v13, v13, v106
    v_mfma_f32_16x16x32_bf16 v[252:255], v[60:63], v[72:75], 0
    v_exp_f32 v108, v108
    v_mfma_f32_16x16x32_bf16 v[188:191], v[60:63], v[64:67], 0
    v_mfma_f32_16x16x32_bf16 v[184:187], v[56:59], v[64:67], 0
    s_waitcnt lgkmcnt(0)
    v_add_f32 v13, v13, v107
    v_mfma_f32_16x16x32_bf16 v[64:67], v[32:35], a[0:3], v[16:19]
    ds_read_b128 v[48:51], v2 offset:33024
    v_cvt_pk_bf16_f32 v105, v106, v107
    v_mfma_f32_16x16x32_bf16 v[64:67], v[36:39], a[4:7], v[64:67]
    ds_read_b128 v[52:55], v2 offset:35072
    v_mfma_f32_16x16x32_bf16 v[64:67], v[40:43], a[8:11], v[64:67]
    v_exp_f32 v109, v109
    v_mfma_f32_16x16x32_bf16 v[64:67], v[44:47], a[12:15], v[64:67]
    v_add_f32 v13, v13, v108
    v_mfma_f32_16x16x32_bf16 v[72:75], v[44:47], a[44:47], v[20:23]
    ds_read_b128 v[56:59], v2 offset:37120
    v_mfma_f32_16x16x32_bf16 v[72:75], v[40:43], a[40:43], v[72:75]
    ds_read_b128 v[60:63], v2 offset:39168
    v_mfma_f32_16x16x32_bf16 v[72:75], v[36:39], a[36:39], v[72:75]
    v_exp_f32 v110, v110
    v_mfma_f32_16x16x32_bf16 v[72:75], v[32:35], a[32:35], v[72:75]
    v_add_f32 v13, v13, v109
    v_cvt_pk_bf16_f32 v106, v108, v109
    v_mfma_f32_16x16x32_bf16 v[80:83], v[32:35], a[64:67], v[24:27]
    v_exp_f32 v111, v111
    v_mfma_f32_16x16x32_bf16 v[80:83], v[36:39], a[68:71], v[80:83]
    v_add_f32 v13, v13, v110
    v_mfma_f32_16x16x32_bf16 v[80:83], v[40:43], a[72:75], v[80:83]
    v_exp_f32 v112, v112
    v_mfma_f32_16x16x32_bf16 v[80:83], v[44:47], a[76:79], v[80:83]
    v_add_f32 v13, v13, v111
    v_cvt_pk_bf16_f32 v107, v110, v111
    v_mfma_f32_16x16x32_bf16 v[88:91], v[44:47], a[108:111], v[28:31]
    v_exp_f32 v113, v113
    v_mfma_f32_16x16x32_bf16 v[88:91], v[40:43], a[104:107], v[88:91]
    v_exp_f32 v114, v114
    v_mfma_f32_16x16x32_bf16 v[88:91], v[36:39], a[100:103], v[88:91]
    v_add_f32 v14, v112, v113
    v_cvt_pk_bf16_f32 v112, v112, v113
    v_mfma_f32_16x16x32_bf16 v[88:91], v[32:35], a[96:99], v[88:91]
    s_waitcnt vmcnt(8) lgkmcnt(0)
    v_exp_f32 v115, v115
    v_mfma_f32_16x16x32_bf16 v[92:95], v[48:51], a[96:99], v[28:31]
    ds_read_b128 v[32:35], v2 offset:256
    v_add_f32 v14, v14, v114
    v_mfma_f32_16x16x32_bf16 v[92:95], v[52:55], a[100:103], v[92:95]
    s_add_u32 m0, s57, 12288
    ds_read_b128 v[36:39], v2 offset:2304
    v_mfma_f32_16x16x32_bf16 v[92:95], v[56:59], a[104:107], v[92:95]
    global_load_lds_dwordx4 v4, s[58:59] offset:-4096 sc1
    v_mfma_f32_16x16x32_bf16 v[92:95], v[60:63], a[108:111], v[92:95]
    s_waitcnt vmcnt(5)
    v_exp_f32 v116, v116
    v_mfma_f32_16x16x32_bf16 v[84:87], v[60:63], a[76:79], v[24:27]
    ds_read_b128 v[40:43], v2 offset:4352
    v_add_f32 v14, v14, v115
    v_mfma_f32_16x16x32_bf16 v[84:87], v[56:59], a[72:75], v[84:87]
    ds_read_b128 v[44:47], v2 offset:6400
    v_cvt_pk_bf16_f32 v113, v114, v115
    v_mfma_f32_16x16x32_bf16 v[84:87], v[52:55], a[68:71], v[84:87]
    global_load_lds_dwordx4 v4, s[58:59] offset:-3072 sc1
    v_mfma_f32_16x16x32_bf16 v[84:87], v[48:51], a[64:67], v[84:87]
    v_exp_f32 v117, v117
    v_mfma_f32_16x16x32_bf16 v[76:79], v[48:51], a[32:35], v[20:23]
    v_add_f32 v14, v14, v116
    v_mfma_f32_16x16x32_bf16 v[76:79], v[52:55], a[36:39], v[76:79]
    v_exp_f32 v118, v118
    v_mfma_f32_16x16x32_bf16 v[76:79], v[56:59], a[40:43], v[76:79]
    global_load_lds_dwordx4 v4, s[58:59] offset:-2048 sc1
    v_mfma_f32_16x16x32_bf16 v[76:79], v[60:63], a[44:47], v[76:79]
    v_add_f32 v14, v14, v117
    v_cvt_pk_bf16_f32 v114, v116, v117
    v_mfma_f32_16x16x32_bf16 v[68:71], v[60:63], a[12:15], v[16:19]
    v_exp_f32 v119, v119
    v_mfma_f32_16x16x32_bf16 v[68:71], v[56:59], a[8:11], v[68:71]
    v_add_f32 v14, v14, v118
    v_mfma_f32_16x16x32_bf16 v[68:71], v[52:55], a[4:7], v[68:71]
    global_load_lds_dwordx4 v4, s[58:59] offset:-1024 sc1
    v_mfma_f32_16x16x32_bf16 v[68:71], v[48:51], a[0:3], v[68:71]
    s_waitcnt lgkmcnt(0)
    v_exp_f32 v120, v120
    v_mfma_f32_16x16x32_bf16 v[68:71], v[32:35], a[16:19], v[68:71]
    ds_read_b128 v[48:51], v2 offset:0
    v_mfma_f32_16x16x32_bf16 v[68:71], v[36:39], a[20:23], v[68:71]
    ds_read_b128 v[52:55], v2 offset:2048
    v_add_f32 v14, v14, v119
    v_mfma_f32_16x16x32_bf16 v[68:71], v[40:43], a[24:27], v[68:71]
    global_load_lds_dwordx4 v5, s[58:59] offset:0 sc1
    v_mfma_f32_16x16x32_bf16 v[68:71], v[44:47], a[28:31], v[68:71]
    v_cvt_pk_bf16_f32 v115, v118, v119
    v_mfma_f32_16x16x32_bf16 v[76:79], v[44:47], a[60:63], v[76:79]
    ds_read_b128 v[56:59], v2 offset:4096
    v_mfma_f32_16x16x32_bf16 v[76:79], v[40:43], a[56:59], v[76:79]
    ds_read_b128 v[60:63], v2 offset:6144
    v_mfma_f32_16x16x32_bf16 v[76:79], v[36:39], a[52:55], v[76:79]
    global_load_lds_dwordx4 v5, s[58:59] offset:1024 sc1
    v_mfma_f32_16x16x32_bf16 v[76:79], v[32:35], a[48:51], v[76:79]
    v_exp_f32 v121, v121
    v_mfma_f32_16x16x32_bf16 v[84:87], v[32:35], a[80:83], v[84:87]
    v_exp_f32 v122, v122
    v_mfma_f32_16x16x32_bf16 v[84:87], v[36:39], a[84:87], v[84:87]
    v_add_f32 v15, v120, v121
    v_cvt_pk_bf16_f32 v120, v120, v121
    v_mfma_f32_16x16x32_bf16 v[84:87], v[40:43], a[88:91], v[84:87]
    global_load_lds_dwordx4 v5, s[58:59] offset:2048 sc1
    v_mfma_f32_16x16x32_bf16 v[84:87], v[44:47], a[92:95], v[84:87]
    v_exp_f32 v123, v123
    v_mfma_f32_16x16x32_bf16 v[92:95], v[44:47], a[124:127], v[92:95]
    v_add_f32 v15, v15, v122
    v_mfma_f32_16x16x32_bf16 v[92:95], v[40:43], a[120:123], v[92:95]
    v_exp_f32 v124, v124
    v_mfma_f32_16x16x32_bf16 v[92:95], v[36:39], a[116:119], v[92:95]
    global_load_lds_dwordx4 v5, s[58:59] offset:3072 sc1
    v_mfma_f32_16x16x32_bf16 v[92:95], v[32:35], a[112:115], v[92:95]
    s_waitcnt lgkmcnt(0)
    s_add_u32 s58, s58, 16384
    s_addc_u32 s59, s59, 0
    v_add_f32 v15, v15, v123
    v_cvt_pk_bf16_f32 v121, v122, v123
    v_mfma_f32_16x16x32_bf16 v[88:91], v[48:51], a[112:115], v[88:91]
    ds_read_b64_tr_b16 v[32:33], v3 offset:16384
    ds_read_b64_tr_b16 v[34:35], v3 offset:16640
    v_mfma_f32_16x16x32_bf16 v[88:91], v[52:55], a[116:119], v[88:91]
    v_exp_f32 v125, v125
    v_mfma_f32_16x16x32_bf16 v[88:91], v[56:59], a[120:123], v[88:91]
    v_add_f32 v15, v15, v124
    v_mfma_f32_16x16x32_bf16 v[88:91], v[60:63], a[124:127], v[88:91]
    v_exp_f32 v126, v126
    v_mfma_f32_16x16x32_bf16 v[80:83], v[60:63], a[92:95], v[80:83]
    ds_read_b64_tr_b16 v[36:37], v3 offset:17408
    ds_read_b64_tr_b16 v[38:39], v3 offset:17664
    v_mfma_f32_16x16x32_bf16 v[80:83], v[56:59], a[88:91], v[80:83]
    v_add_f32 v15, v15, v125
    v_cvt_pk_bf16_f32 v122, v124, v125
    v_mfma_f32_16x16x32_bf16 v[80:83], v[52:55], a[84:87], v[80:83]
    v_exp_f32 v127, v127
    v_mfma_f32_16x16x32_bf16 v[80:83], v[48:51], a[80:83], v[80:83]
    v_add_f32 v15, v15, v126
    v_mfma_f32_16x16x32_bf16 v[72:75], v[48:51], a[48:51], v[72:75]
    ds_read_b64_tr_b16 v[40:41], v3 offset:18432
    ds_read_b64_tr_b16 v[42:43], v3 offset:18688
    v_mfma_f32_16x16x32_bf16 v[72:75], v[52:55], a[52:55], v[72:75]
    v_max3_f32 v7, v12, v13, v14
    v_add_f32 v15, v15, v127
    v_mfma_f32_16x16x32_bf16 v[72:75], v[56:59], a[56:59], v[72:75]
    v_cvt_pk_bf16_f32 v123, v126, v127
    v_add_f32 v7, v7, v15
    v_mfma_f32_16x16x32_bf16 v[72:75], v[60:63], a[60:63], v[72:75]
    v_cmp_nge_f32 vcc, s62, v7
    v_mfma_f32_16x16x32_bf16 v[64:67], v[60:63], a[28:31], v[64:67]
    ds_read_b64_tr_b16 v[44:45], v3 offset:19456
    ds_read_b64_tr_b16 v[46:47], v3 offset:19712
    v_mfma_f32_16x16x32_bf16 v[64:67], v[56:59], a[24:27], v[64:67]
    v_mfma_f32_16x16x32_bf16 v[64:67], v[52:55], a[20:23], v[64:67]
    s_cmp_eq_u32 s52, 3
    s_cselect_b64 exec, 0, -1
    s_cbranch_execz L_pk9
L_pkdone2:
    s_mov_b64 exec, -1
    v_mfma_f32_16x16x32_bf16 v[64:67], v[48:51], a[16:19], v[64:67]
    s_waitcnt lgkmcnt(4)
    s_cbranch_vccnz L_stub_i1
L_back_i1:
    v_mfma_f32_16x16x32_bf16 v[128:131], v[32:35], v[96:99], v[128:131]
    ds_read_b64_tr_b16 v[48:49], v3 offset:20480
    ds_read_b64_tr_b16 v[50:51], v3 offset:20736
    v_mfma_f32_16x16x32_bf16 v[132:135], v[36:39], v[96:99], v[132:135]
    s_add_u32 m0, s57, 20480
    v_add_f32 v8, v8, v12
    v_add_f32 v9, v9, v13
    v_mfma_f32_16x16x32_bf16 v[196:199], v[36:39], v[104:107], v[196:199]
    global_load_lds_dwordx4 v4, s[60:61] offset:-4096 sc1
    v_mfma_f32_16x16x32_bf16 v[192:195], v[32:35], v[104:107], v[192:195]
    v_add_f32 v10, v10, v14
    v_add_f32 v11, v11, v15
    v_mfma_f32_16x16x32_bf16 a[128:131], v[32:35], v[112:115], a[128:131]
    ds_read_b64_tr_b16 v[52:53], v3 offset:21504
    ds_read_b64_tr_b16 v[54:55], v3 offset:21760
    v_mfma_f32_16x16x32_bf16 a[132:135], v[36:39], v[112:115], a[132:135]
    v_mfma_f32_16x16x32_bf16 a[196:199], v[36:39], v[120:123], a[196:199]
    global_load_lds_dwordx4 v4, s[60:61] offset:-3072 sc1
    v_mfma_f32_16x16x32_bf16 a[192:195], v[32:35], v[120:123], a[192:195]
    s_waitcnt lgkmcnt(4)
    v_exp_f32 v64, v64
    v_mfma_f32_16x16x32_bf16 a[200:203], v[40:43], v[120:123], a[200:203]
    ds_read_b64_tr_b16 v[56:57], v3 offset:22528
    ds_read_b64_tr_b16 v[58:59], v3 offset:22784
    v_mfma_f32_16x16x32_bf16 a[204:207], v[44:47], v[120:123], a[204:207]
    v_exp_f32 v65, v65
    v_mfma_f32_16x16x32_bf16 a[140:143], v[44:47], v[112:115], a[140:143]
    global_load_lds_dwordx4 v4, s[60:61] offset:-2048 sc1
    v_mfma_f32_16x16x32_bf16 a[136:139], v[40:43], v[112:115], a[136:139]
    v_mfma_f32_16x16x32_bf16 v[200:203], v[40:43], v[104:107], v[200:203]
    ds_read_b64_tr_b16 v[60:61], v3 offset:23552
    ds_read_b64_tr_b16 v[62:63], v3 offset:23808
    v_mfma_f32_16x16x32_bf16 v[204:207], v[44:47], v[104:107], v[204:207]
    v_exp_f32 v66, v66
    v_mfma_f32_16x16x32_bf16 v[140:143], v[44:47], v[96:99], v[140:143]
    global_load_lds_dwordx4 v4, s[60:61] offset:-1024 sc1
    v_mfma_f32_16x16x32_bf16 v[136:139], v[40:43], v[96:99], v[136:139]
    s_waitcnt lgkmcnt(4)
    v_add_f32 v12, v64, v65
    v_mfma_f32_16x16x32_bf16 v[144:147], v[48:51], v[96:99], v[144:147]
    ds_read_b64_tr_b16 v[32:33], v3 offset:24576
    ds_read_b64_tr_b16 v[34:35], v3 offset:24832
    v_mfma_f32_16x16x32_bf16 v[148:151], v[52:55], v[96:99], v[148:151]
    v_cvt_pk_bf16_f32 v64, v64, v65
    v_mfma_f32_16x16x32_bf16 v[212:215], v[52:55], v[104:107], v[212:215]
    global_load_lds_dwordx4 v5, s[60:61] offset:0 sc1
    v_mfma_f32_16x16x32_bf16 v[208:211], v[48:51], v[104:107], v[208:211]
    v_exp_f32 v67, v67
    v_mfma_f32_16x16x32_bf16 a[144:147], v[48:51], v[112:115], a[144:147]
    ds_read_b64_tr_b16 v[36:37], v3 offset:25600
    ds_read_b64_tr_b16 v[38:39], v3 offset:25856
    v_mfma_f32_16x16x32_bf16 a[148:151], v[52:55], v[112:115], a[148:151]
    v_add_f32 v12, v12, v66
    v_mfma_f32_16x16x32_bf16 a[212:215], v[52:55], v[120:123], a[212:215]
    global_load_lds_dwordx4 v5, s[60:61] offset:1024 sc1
    v_mfma_f32_16x16x32_bf16 a[208:211], v[48:51], v[120:123], a[208:211]
    s_waitcnt lgkmcnt(4)
    v_exp_f32 v68, v68
    v_mfma_f32_16x16x32_bf16 a[216:219], v[56:59], v[120:123], a[216:219]
    ds_read_b64_tr_b16 v[40:41], v3 offset:26624
    ds_read_b64_tr_b16 v[42:43], v3 offset:26880
    v_mfma_f32_16x16x32_bf16 a[220:223], v[60:63], v[120:123], a[220:223]
    v_add_f32 v12, v12, v67
    v_mfma_f32_16x16x32_bf16 a[156:159], v[60:63], v[112:115], a[156:159]
    global_load_lds_dwordx4 v5, s[60:61] offset:2048 sc1
    v_mfma_f32_16x16x32_bf16 a[152:155], v[56:59], v[112:115], a[152:155]
    v_cvt_pk_bf16_f32 v65, v66, v67
    v_mfma_f32_16x16x32_bf16 v[216:219], v[56:59], v[104:107], v[216:219]
    ds_read_b64_tr_b16 v[44:45], v3 offset:27648
    ds_read_b64_tr_b16 v[46:47], v3 offset:27904
    v_mfma_f32_16x16x32_bf16 v[220:223], v[60:63], v[104:107], v[220:223]
    v_exp_f32 v69, v69
    v_mfma_f32_16x16x32_bf16 v[156:159], v[60:63], v[96:99], v[156:159]
    global_load_lds_dwordx4 v5, s[60:61] offset:3072 sc1
    v_mfma_f32_16x16x32_bf16 v[152:155], v[56:59], v[96:99], v[152:155]
    s_waitcnt lgkmcnt(4)
    s_add_u32 s60, s60, 16384
    s_addc_u32 s61, s61, 0
    v_add_f32 v12, v12, v68
    v_mfma_f32_16x16x32_bf16 v[160:163], v[32:35], v[96:99], v[160:163]
    ds_read_b64_tr_b16 v[48:49], v3 offset:28672
    ds_read_b64_tr_b16 v[50:51], v3 offset:28928
    v_mfma_f32_16x16x32_bf16 v[164:167], v[36:39], v[96:99], v[164:167]
    s_add_u32 m0, s57, 28672
    v_exp_f32 v70, v70
    v_mfma_f32_16x16x32_bf16 v[228:231], v[36:39], v[104:107], v[228:231]
    global_load_lds_dwordx4 v4, s[58:59] offset:-4096 sc1
    v_mfma_f32_16x16x32_bf16 v[224:227], v[32:35], v[104:107], v[224:227]
    v_mfma_f32_16x16x32_bf16 a[160:163], v[32:35], v[112:115], a[160:163]
    ds_read_b64_tr_b16 v[52:53], v3 offset:29696
    ds_read_b64_tr_b16 v[54:55], v3 offset:29952
    v_mfma_f32_16x16x32_bf16 a[164:167], v[36:39], v[112:115], a[164:167]
    v_add_f32 v12, v12, v69
    v_cvt_pk_bf16_f32 v66, v68, v69
    v_mfma_f32_16x16x32_bf16 a[228:231], v[36:39], v[120:123], a[228:231]
    global_load_lds_dwordx4 v4, s[58:59] offset:-3072 sc1
    v_mfma_f32_16x16x32_bf16 a[224:227], v[32:35], v[120:123], a[224:227]
    s_waitcnt lgkmcnt(4)
    v_exp_f32 v71, v71
    v_mfma_f32_16x16x32_bf16 a[232:235], v[40:43], v[120:123], a[232:235]
    ds_read_b64_tr_b16 v[56:57], v3 offset:30720
    ds_read_b64_tr_b16 v[58:59], v3 offset:30976
    v_mfma_f32_16x16x32_bf16 a[236:239], v[44:47], v[120:123], a[236:239]
    v_mfma_f32_16x16x32_bf16 a[172:175], v[44:47], v[112:115], a[172:175]
    global_load_lds_dwordx4 v4, s[58:59] offset:-2048 sc1
    v_mfma_f32_16x16x32_bf16 a[168:171], v[40:43], v[112:115], a[168:171]
    v_add_f32 v12, v12, v70
    v_mfma_f32_16x16x32_bf16 v[232:235], v[40:43], v[104:107], v[232:235]
    ds_read_b64_tr_b16 v[60:61], v3 offset:31744
    ds_read_b64_tr_b16 v[62:63], v3 offset:32000
    v_mfma_f32_16x16x32_bf16 v[236:239], v[44:47], v[104:107], v[236:239]
    v_exp_f32 v72, v72
    v_mfma_f32_16x16x32_bf16 v[172:175], v[44:47], v[96:99], v[172:175]
    global_load_lds_dwordx4 v4, s[58:59] offset:-1024 sc1
    v_mfma_f32_16x16x32_bf16 v[168:171], v[40:43], v[96:99], v[168:171]
    s_waitcnt vmcnt(12) lgkmcnt(4)
    v_add_f32 v12, v12, v71
    v_mfma_f32_16x16x32_bf16 v[176:179], v[48:51], v[96:99], v[176:179]
    ds_read_b128 v[32:35], v2 offset:8192
    v_cvt_pk_bf16_f32 v67, v70, v71
    v_mfma_f32_16x16x32_bf16 v[180:183], v[52:55], v[96:99], v[180:183]
    ds_read_b128 v[36:39], v2 offset:10240
    v_mfma_f32_16x16x32_bf16 v[244:247], v[52:55], v[104:107], v[244:247]
    global_load_lds_dwordx4 v5, s[58:59] offset:0 sc1
    v_mfma_f32_16x16x32_bf16 v[240:243], v[48:51], v[104:107], v[240:243]
    v_exp_f32 v73, v73
    v_mfma_f32_16x16x32_bf16 a[176:179], v[48:51], v[112:115], a[176:179]
    ds_read_b128 v[40:43], v2 offset:12288
    v_mfma_f32_16x16x32_bf16 a[180:183], v[52:55], v[112:115], a[180:183]
    ds_read_b128 v[44:47], v2 offset:14336
    v_mfma_f32_16x16x32_bf16 a[244:247], v[52:55], v[120:123], a[244:247]
    global_load_lds_dwordx4 v5, s[58:59] offset:1024 sc1
    v_mfma_f32_16x16x32_bf16 a[240:243], v[48:51], v[120:123], a[240:243]
    s_waitcnt lgkmcnt(4)
    v_exp_f32 v74, v74
    v_mfma_f32_16x16x32_bf16 a[248:251], v[56:59], v[120:123], a[248:251]
    v_add_f32 v13, v72, v73
    v_cvt_pk_bf16_f32 v72, v72, v73
    v_mfma_f32_16x16x32_bf16 a[252:255], v[60:63], v[120:123], a[252:255]
    v_exp_f32 v75, v75
    v_mfma_f32_16x16x32_bf16 a[188:191], v[60:63], v[112:115], a[188:191]
    global_load_lds_dwordx4 v5, s[58:59] offset:2048 sc1
    v_mfma_f32_16x16x32_bf16 a[184:187], v[56:59], v[112:115], a[184:187]
    v_mfma_f32_16x16x32_bf16 v[248:251], v[56:59], v[104:107], v[248:251]
    v_add_f32 v13, v13, v74
    v_mfma_f32_16x16x32_bf16 v[252:255], v[60:63], v[104:107], v[252:255]
    v_exp_f32 v76, v76
    v_mfma_f32_16x16x32_bf16 v[188:191], v[60:63], v[96:99], v[188:191]
    global_load_lds_dwordx4 v5, s[58:59] offset:3072 sc1
    v_mfma_f32_16x16x32_bf16 v[184:187], v[56:59], v[96:99], v[184:187]
    s_waitcnt lgkmcnt(0)
    s_add_u32 s58, s58, 16384
    s_addc_u32 s59, s59, 0
    v_add_f32 v13, v13, v75
    v_mfma_f32_16x16x32_bf16 v[96:99], v[32:35], a[0:3], v[16:19]
    ds_read_b128 v[48:51], v2 offset:8448
    v_cvt_pk_bf16_f32 v73, v74, v75
    v_mfma_f32_16x16x32_bf16 v[96:99], v[36:39], a[4:7], v[96:99]
    ds_read_b128 v[52:55], v2 offset:10496
    v_mfma_f32_16x16x32_bf16 v[96:99], v[40:43], a[8:11], v[96:99]
    v_mov_b32 v0, s56
    v_mfma_f32_16x16x32_bf16 v[96:99], v[44:47], a[12:15], v[96:99]
    v_exp_f32 v77, v77
    v_mfma_f32_16x16x32_bf16 v[104:107], v[44:47], a[44:47], v[20:23]
    ds_read_b128 v[56:59], v2 offset:12544
    v_add_f32 v13, v13, v76
    v_mfma_f32_16x16x32_bf16 v[104:107], v[40:43], a[40:43], v[104:107]
    ds_read_b128 v[60:63], v2 offset:14592
    v_mfma_f32_16x16x32_bf16 v[104:107], v[36:39], a[36:39], v[104:107]
    s_mov_b64 exec, 1
    buffer_store_dword v0, off, s[40:43], s83 sc1
    s_mov_b64 exec, -1
    v_mfma_f32_16x16x32_bf16 v[104:107], v[32:35], a[32:35], v[104:107]
    v_exp_f32 v78, v78
    v_mfma_f32_16x16x32_bf16 v[112:115], v[32:35], a[64:67], v[24:27]
    v_add_f32 v13, v13, v77
    v_cvt_pk_bf16_f32 v74, v76, v77
    v_mfma_f32_16x16x32_bf16 v[112:115], v[36:39], a[68:71], v[112:115]
    v_exp_f32 v79, v79
    v_mfma_f32_16x16x32_bf16 v[112:115], v[40:43], a[72:75], v[112:115]
    v_add_f32 v13, v13, v78
    v_mfma_f32_16x16x32_bf16 v[112:115], v[44:47], a[76:79], v[112:115]
    v_exp_f32 v80, v80
    v_mfma_f32_16x16x32_bf16 v[120:123], v[44:47], a[108:111], v[28:31]
    v_add_f32 v13, v13, v79
    v_mfma_f32_16x16x32_bf16 v[120:123], v[40:43], a[104:107], v[120:123]
    v_cvt_pk_bf16_f32 v75, v78, v79
    v_mfma_f32_16x16x32_bf16 v[120:123], v[36:39], a[100:103], v[120:123]
    v_exp_f32 v81, v81
    v_mfma_f32_16x16x32_bf16 v[120:123], v[32:35], a[96:99], v[120:123]
    s_waitcnt vmcnt(13) lgkmcnt(0)
    v_exp_f32 v82, v82
    v_mfma_f32_16x16x32_bf16 v[124:127], v[48:51], a[96:99], v[28:31]
    ds_read_b128 v[32:35], v2 offset:16640
    v_mfma_f32_16x16x32_bf16 v[124:127], v[52:55], a[100:103], v[124:127]
    ds_read_b128 v[36:39], v2 offset:18688
    v_mfma_f32_16x16x32_bf16 v[124:127], v[56:59], a[104:107], v[124:127]
    v_add_f32 v14, v80, v81
    v_cvt_pk_bf16_f32 v80, v80, v81
    v_mfma_f32_16x16x32_bf16 v[124:127], v[60:63], a[108:111], v[124:127]
    s_waitcnt vmcnt(9)
    v_exp_f32 v83, v83
    v_mfma_f32_16x16x32_bf16 v[116:119], v[60:63], a[76:79], v[24:27]
    ds_read_b128 v[40:43], v2 offset:20736
    v_mfma_f32_16x16x32_bf16 v[116:119], v[56:59], a[72:75], v[116:119]
    ds_read_b128 v[44:47], v2 offset:22784
    v_add_f32 v14, v14, v82
    v_mfma_f32_16x16x32_bf16 v[116:119], v[52:55], a[68:71], v[116:119]
    v_exp_f32 v84, v84
    v_mfma_f32_16x16x32_bf16 v[116:119], v[48:51], a[64:67], v[116:119]
    v_mfma_f32_16x16x32_bf16 v[108:111], v[48:51], a[32:35], v[20:23]
    v_add_f32 v14, v14, v83
    v_cvt_pk_bf16_f32 v81, v82, v83
    v_mfma_f32_16x16x32_bf16 v[108:111], v[52:55], a[36:39], v[108:111]
    v_exp_f32 v85, v85
    v_mfma_f32_16x16x32_bf16 v[108:111], v[56:59], a[40:43], v[108:111]
    v_add_f32 v14, v14, v84
    v_mfma_f32_16x16x32_bf16 v[108:111], v[60:63], a[44:47], v[108:111]
    v_exp_f32 v86, v86
    v_mfma_f32_16x16x32_bf16 v[100:103], v[60:63], a[12:15], v[16:19]
    v_mfma_f32_16x16x32_bf16 v[100:103], v[56:59], a[8:11], v[100:103]
    v_add_f32 v14, v14, v85
    v_cvt_pk_bf16_f32 v82, v84, v85
    v_mfma_f32_16x16x32_bf16 v[100:103], v[52:55], a[4:7], v[100:103]
    v_exp_f32 v87, v87
    v_mfma_f32_16x16x32_bf16 v[100:103], v[48:51], a[0:3], v[100:103]
    s_waitcnt lgkmcnt(0)
    v_add_f32 v14, v14, v86
    v_mfma_f32_16x16x32_bf16 v[100:103], v[32:35], a[16:19], v[100:103]
    ds_read_b128 v[48:51], v2 offset:16384
    v_mfma_f32_16x16x32_bf16 v[100:103], v[36:39], a[20:23], v[100:103]
    ds_read_b128 v[52:55], v2 offset:18432
    v_mfma_f32_16x16x32_bf16 v[100:103], v[40:43], a[24:27], v[100:103]
    v_exp_f32 v88, v88
    v_mfma_f32_16x16x32_bf16 v[100:103], v[44:47], a[28:31], v[100:103]
    v_add_f32 v14, v14, v87
    v_cvt_pk_bf16_f32 v83, v86, v87
    v_mfma_f32_16x16x32_bf16 v[108:111], v[44:47], a[60:63], v[108:111]
    ds_read_b128 v[56:59], v2 offset:20480
    v_mfma_f32_16x16x32_bf16 v[108:111], v[40:43], a[56:59], v[108:111]
    ds_read_b128 v[60:63], v2 offset:22528
    v_mfma_f32_16x16x32_bf16 v[108:111], v[36:39], a[52:55], v[108:111]
    v_exp_f32 v89, v89
    v_mfma_f32_16x16x32_bf16 v[108:111], v[32:35], a[48:51], v[108:111]
    v_exp_f32 v90, v90
    v_mfma_f32_16x16x32_bf16 v[116:119], v[32:35], a[80:83], v[116:119]
    v_add_f32 v15, v88, v89
    v_mfma_f32_16x16x32_bf16 v[116:119], v[36:39], a[84:87], v[116:119]
    v_cvt_pk_bf16_f32 v88, v88, v89
    v_mfma_f32_16x16x32_bf16 v[116:119], v[40:43], a[88:91], v[116:119]
    v_exp_f32 v91, v91
    v_mfma_f32_16x16x32_bf16 v[116:119], v[44:47], a[92:95], v[116:119]
    v_add_f32 v15, v15, v90
    v_mfma_f32_16x16x32_bf16 v[124:127], v[44:47], a[124:127], v[124:127]
    v_exp_f32 v92, v92
    v_mfma_f32_16x16x32_bf16 v[124:127], v[40:43], a[120:123], v[124:127]
    v_add_f32 v15, v15, v91
    v_mfma_f32_16x16x32_bf16 v[124:127], v[36:39], a[116:119], v[124:127]
    v_cvt_pk_bf16_f32 v89, v90, v91
    v_mfma_f32_16x16x32_bf16 v[124:127], v[32:35], a[112:115], v[124:127]
    s_waitcnt lgkmcnt(0)
    v_exp_f32 v93, v93
    v_mfma_f32_16x16x32_bf16 v[120:123], v[48:51], a[112:115], v[120:123]
    ds_read_b64_tr_b16 v[32:33], v3 offset:32768
    ds_read_b64_tr_b16 v[34:35], v3 offset:33024
    v_mfma_f32_16x16x32_bf16 v[120:123], v[52:55], a[116:119], v[120:123]
    v_add_f32 v15, v15, v92
    v_mfma_f32_16x16x32_bf16 v[120:123], v[56:59], a[120:123], v[120:123]
    v_exp_f32 v94, v94
    v_mfma_f32_16x16x32_bf16 v[120:123], v[60:63], a[124:127], v[120:123]
    v_add_f32 v15, v15, v93
    v_mfma_f32_16x16x32_bf16 v[112:115], v[60:63], a[92:95], v[112:115]
    ds_read_b64_tr_b16 v[36:37], v3 offset:33792
    ds_read_b64_tr_b16 v[38:39], v3 offset:34048
    v_mfma_f32_16x16x32_bf16 v[112:115], v[56:59], a[88:91], v[112:115]
    v_cvt_pk_bf16_f32 v90, v92, v93
L_pk3:
    s_cbranch_execz L_pk6
    v_mfma_f32_16x16x32_bf16 v[112:115], v[52:55], a[84:87], v[112:115]
    v_exp_f32 v95, v95
    v_mfma_f32_16x16x32_bf16 v[112:115], v[48:51], a[80:83], v[112:115]
    v_add_f32 v15, v15, v94
    v_max3_f32 v7, v12, v13, v14
    v_mfma_f32_16x16x32_bf16 v[104:107], v[48:51], a[48:51], v[104:107]
    ds_read_b64_tr_b16 v[40:41], v3 offset:34816
    ds_read_b64_tr_b16 v[42:43], v3 offset:35072
    v_mfma_f32_16x16x32_bf16 v[104:107], v[52:55], a[52:55], v[104:107]
    v_add_f32 v15, v15, v95
    v_mfma_f32_16x16x32_bf16 v[104:107], v[56:59], a[56:59], v[104:107]
    v_cvt_pk_bf16_f32 v91, v94, v95
    v_mfma_f32_16x16x32_bf16 v[104:107], v[60:63], a[60:63], v[104:107]
    v_add_f32 v7, v7, v15
    v_cmp_nge_f32 vcc, s62, v7
    v_mfma_f32_16x16x32_bf16 v[96:99], v[60:63], a[28:31], v[96:99]
    ds_read_b64_tr_b16 v[44:45], v3 offset:35840
    ds_read_b64_tr_b16 v[46:47], v3 offset:36096
    v_mfma_f32_16x16x32_bf16 v[96:99], v[56:59], a[24:27], v[96:99]
    v_mfma_f32_16x16x32_bf16 v[96:99], v[52:55], a[20:23], v[96:99]
    v_mfma_f32_16x16x32_bf16 v[96:99], v[48:51], a[16:19], v[96:99]
    s_waitcnt lgkmcnt(4)
    s_cbranch_vccnz L_stub_i2
L_back_i2:
    v_mfma_f32_16x16x32_bf16 v[128:131], v[32:35], v[64:67], v[128:131]
    ds_read_b64_tr_b16 v[48:49], v3 offset:36864
    ds_read_b64_tr_b16 v[50:51], v3 offset:37120
    v_mfma_f32_16x16x32_bf16 v[132:135], v[36:39], v[64:67], v[132:135]
    s_add_u32 m0, s57, 36864
    v_add_f32 v8, v8, v12
    v_add_f32 v9, v9, v13
    v_mfma_f32_16x16x32_bf16 v[196:199], v[36:39], v[72:75], v[196:199]
    global_load_lds_dwordx4 v4, s[60:61] offset:-4096 sc1
    v_mfma_f32_16x16x32_bf16 v[192:195], v[32:35], v[72:75], v[192:195]
    v_add_f32 v10, v10, v14
    v_add_f32 v11, v11, v15
    v_mfma_f32_16x16x32_bf16 a[128:131], v[32:35], v[80:83], a[128:131]
    ds_read_b64_tr_b16 v[52:53], v3 offset:37888
    ds_read_b64_tr_b16 v[54:55], v3 offset:38144
    v_mfma_f32_16x16x32_bf16 a[132:135], v[36:39], v[80:83], a[132:135]
    v_mfma_f32_16x16x32_bf16 a[196:199], v[36:39], v[88:91], a[196:199]
    global_load_lds_dwordx4 v4, s[60:61] offset:-3072 sc1
    v_mfma_f32_16x16x32_bf16 a[192:195], v[32:35], v[88:91], a[192:195]
    s_waitcnt lgkmcnt(4)
    v_exp_f32 v96, v96
    v_mfma_f32_16x16x32_bf16 a[200:203], v[40:43], v[88:91], a[200:203]
    ds_read_b64_tr_b16 v[56:57], v3 offset:38912
    ds_read_b64_tr_b16 v[58:59], v3 offset:39168
    v_mfma_f32_16x16x32_bf16 a[204:207], v[44:47], v[88:91], a[204:207]
    v_exp_f32 v97, v97
    v_mfma_f32_16x16x32_bf16 a[140:143], v[44:47], v[80:83], a[140:143]
    global_load_lds_dwordx4 v4, s[60:61] offset:-2048 sc1
    v_mfma_f32_16x16x32_bf16 a[136:139], v[40:43], v[80:83], a[136:139]
    v_mfma_f32_16x16x32_bf16 v[200:203], v[40:43], v[72:75], v[200:203]
    ds_read_b64_tr_b16 v[60:61], v3 offset:39936
    ds_read_b64_tr_b16 v[62:63], v3 offset:40192
    v_mfma_f32_16x16x32_bf16 v[204:207], v[44:47], v[72:75], v[204:207]
    v_exp_f32 v98, v98
    v_mfma_f32_16x16x32_bf16 v[140:143], v[44:47], v[64:67], v[140:143]
    global_load_lds_dwordx4 v4, s[60:61] offset:-1024 sc1
    v_mfma_f32_16x16x32_bf16 v[136:139], v[40:43], v[64:67], v[136:139]
    s_waitcnt lgkmcnt(4)
    v_add_f32 v12, v96, v97
    v_mfma_f32_16x16x32_bf16 v[144:147], v[48:51], v[64:67], v[144:147]
    ds_read_b64_tr_b16 v[32:33], v3 offset:0
    ds_read_b64_tr_b16 v[34:35], v3 offset:256
    v_mfma_f32_16x16x32_bf16 v[148:151], v[52:55], v[64:67], v[148:151]
    v_cvt_pk_bf16_f32 v96, v96, v97
    v_mfma_f32_16x16x32_bf16 v[212:215], v[52:55], v[72:75], v[212:215]
    global_load_lds_dwordx4 v5, s[60:61] offset:0 sc1
    v_mfma_f32_16x16x32_bf16 v[208:211], v[48:51], v[72:75], v[208:211]
    v_exp_f32 v99, v99
    v_mfma_f32_16x16x32_bf16 a[144:147], v[48:51], v[80:83], a[144:147]
    ds_read_b64_tr_b16 v[36:37], v3 offset:1024
    ds_read_b64_tr_b16 v[38:39], v3 offset:1280
    v_mfma_f32_16x16x32_bf16 a[148:151], v[52:55], v[80:83], a[148:151]
    v_add_f32 v12, v12, v98
    v_mfma_f32_16x16x32_bf16 a[212:215], v[52:55], v[88:91], a[212:215]
    global_load_lds_dwordx4 v5, s[60:61] offset:1024 sc1
    v_mfma_f32_16x16x32_bf16 a[208:211], v[48:51], v[88:91], a[208:211]
    s_waitcnt lgkmcnt(4)
    v_exp_f32 v100, v100
    v_mfma_f32_16x16x32_bf16 a[216:219], v[56:59], v[88:91], a[216:219]
    ds_read_b64_tr_b16 v[40:41], v3 offset:2048
    ds_read_b64_tr_b16 v[42:43], v3 offset:2304
    v_mfma_f32_16x16x32_bf16 a[220:223], v[60:63], v[88:91], a[220:223]
    v_add_f32 v12, v12, v99
    v_mfma_f32_16x16x32_bf16 a[156:159], v[60:63], v[80:83], a[156:159]
    global_load_lds_dwordx4 v5, s[60:61] offset:2048 sc1
    v_mfma_f32_16x16x32_bf16 a[152:155], v[56:59], v[80:83], a[152:155]
    v_cvt_pk_bf16_f32 v97, v98, v99
    v_mfma_f32_16x16x32_bf16 v[216:219], v[56:59], v[72:75], v[216:219]
    ds_read_b64_tr_b16 v[44:45], v3 offset:3072
    ds_read_b64_tr_b16 v[46:47], v3 offset:3328
    v_mfma_f32_16x16x32_bf16 v[220:223], v[60:63], v[72:75], v[220:223]
    v_exp_f32 v101, v101
    v_mfma_f32_16x16x32_bf16 v[156:159], v[60:63], v[64:67], v[156:159]
    global_load_lds_dwordx4 v5, s[60:61] offset:3072 sc1
    v_mfma_f32_16x16x32_bf16 v[152:155], v[56:59], v[64:67], v[152:155]
    s_waitcnt lgkmcnt(4)
    s_add_u32 s60, s60, 16384
    s_addc_u32 s61, s61, 0
    v_add_f32 v12, v12, v100
    v_mfma_f32_16x16x32_bf16 v[160:163], v[32:35], v[64:67], v[160:163]
    ds_read_b64_tr_b16 v[48:49], v3 offset:4096
    ds_read_b64_tr_b16 v[50:51], v3 offset:4352
    v_mfma_f32_16x16x32_bf16 v[164:167], v[36:39], v[64:67], v[164:167]
    s_add_u32 m0, s57, 4096
    v_exp_f32 v102, v102
    v_mfma_f32_16x16x32_bf16 v[228:231], v[36:39], v[72:75], v[228:231]
    global_load_lds_dwordx4 v4, s[58:59] offset:-4096 sc1
    v_mfma_f32_16x16x32_bf16 v[224:227], v[32:35], v[72:75], v[224:227]
    v_mfma_f32_16x16x32_bf16 a[160:163], v[32:35], v[80:83], a[160:163]
    ds_read_b64_tr_b16 v[52:53], v3 offset:5120
    ds_read_b64_tr_b16 v[54:55], v3 offset:5376
    v_mfma_f32_16x16x32_bf16 a[164:167], v[36:39], v[80:83], a[164:167]
    v_add_f32 v12, v12, v101
    v_cvt_pk_bf16_f32 v98, v100, v101
    v_mfma_f32_16x16x32_bf16 a[228:231], v[36:39], v[88:91], a[228:231]
    global_load_lds_dwordx4 v4, s[58:59] offset:-3072 sc1
    v_mfma_f32_16x16x32_bf16 a[224:227], v[32:35], v[88:91], a[224:227]
    s_waitcnt lgkmcnt(4)
    v_exp_f32 v103, v103
    v_mfma_f32_16x16x32_bf16 a[232:235], v[40:43], v[88:91], a[232:235]
    ds_read_b64_tr_b16 v[56:57], v3 offset:6144
    ds_read_b64_tr_b16 v[58:59], v3 offset:6400
    v_mfma_f32_16x16x32_bf16 a[236:239], v[44:47], v[88:91], a[236:239]
    v_mfma_f32_16x16x32_bf16 a[172:175], v[44:47], v[80:83], a[172:175]
    global_load_lds_dwordx4 v4, s[58:59] offset:-2048 sc1
    v_mfma_f32_16x16x32_bf16 a[168:171], v[40:43], v[80:83], a[168:171]
    v_add_f32 v12, v12, v102
    v_mfma_f32_16x16x32_bf16 v[232:235], v[40:43], v[72:75], v[232:235]
    ds_read_b64_tr_b16 v[60:61], v3 offset:7168
    ds_read_b64_tr_b16 v[62:63], v3 offset:7424
    v_mfma_f32_16x16x32_bf16 v[236:239], v[44:47], v[72:75], v[236:239]
    v_exp_f32 v104, v104
    v_mfma_f32_16x16x32_bf16 v[172:175], v[44:47], v[64:67], v[172:175]
    global_load_lds_dwordx4 v4, s[58:59] offset:-1024 sc1
    v_mfma_f32_16x16x32_bf16 v[168:171], v[40:43], v[64:67], v[168:171]
    s_waitcnt vmcnt(13) lgkmcnt(4)
    v_add_f32 v12, v12, v103
    v_mfma_f32_16x16x32_bf16 v[176:179], v[48:51], v[64:67], v[176:179]
    ds_read_b128 v[32:35], v2 offset:24576
    v_cvt_pk_bf16_f32 v99, v102, v103
    v_mfma_f32_16x16x32_bf16 v[180:183], v[52:55], v[64:67], v[180:183]
    ds_read_b128 v[36:39], v2 offset:26624
    v_mfma_f32_16x16x32_bf16 v[244:247], v[52:55], v[72:75], v[244:247]
    global_load_lds_dwordx4 v5, s[58:59] offset:0 sc1
    v_mfma_f32_16x16x32_bf16 v[240:243], v[48:51], v[72:75], v[240:243]
    v_exp_f32 v105, v105
    v_mfma_f32_16x16x32_bf16 a[176:179], v[48:51], v[80:83], a[176:179]
    ds_read_b128 v[40:43], v2 offset:28672
    v_mfma_f32_16x16x32_bf16 a[180:183], v[52:55], v[80:83], a[180:183]
    ds_read_b128 v[44:47], v2 offset:30720
    v_mfma_f32_16x16x32_bf16 a[244:247], v[52:55], v[88:91], a[244:247]
    global_load_lds_dwordx4 v5, s[58:59] offset:1024 sc1
    v_mfma_f32_16x16x32_bf16 a[240:243], v[48:51], v[88:91], a[240:243]
    s_waitcnt lgkmcnt(4)
    v_exp_f32 v106, v106
    v_mfma_f32_16x16x32_bf16 a[248:251], v[56:59], v[88:91], a[248:251]
    v_add_f32 v13, v104, v105
    v_cvt_pk_bf16_f32 v104, v104, v105
    v_mfma_f32_16x16x32_bf16 a[252:255], v[60:63], v[88:91], a[252:255]
    v_exp_f32 v107, v107
    v_mfma_f32_16x16x32_bf16 a[188:191], v[60:63], v[80:83], a[188:191]
    global_load_lds_dwordx4 v5, s[58:59] offset:2048 sc1
    v_mfma_f32_16x16x32_bf16 a[184:187], v[56:59], v[80:83], a[184:187]
    v_mfma_f32_16x16x32_bf16 v[248:251], v[56:59], v[72:75], v[248:251]
    v_add_f32 v13, v13, v106
    v_mfma_f32_16x16x32_bf16 v[252:255], v[60:63], v[72:75], v[252:255]
    v_exp_f32 v108, v108
    v_mfma_f32_16x16x32_bf16 v[188:191], v[60:63], v[64:67], v[188:191]
    global_load_lds_dwordx4 v5, s[58:59] offset:3072 sc1
    v_mfma_f32_16x16x32_bf16 v[184:187], v[56:59], v[64:67], v[184:187]
    s_waitcnt lgkmcnt(0)
    s_add_u32 s58, s58, 16384
    s_addc_u32 s59, s59, 0
    v_add_f32 v13, v13, v107
    v_mfma_f32_16x16x32_bf16 v[64:67], v[32:35], a[0:3], v[16:19]
    ds_read_b128 v[48:51], v2 offset:24832
    v_cvt_pk_bf16_f32 v105, v106, v107
    v_mfma_f32_16x16x32_bf16 v[64:67], v[36:39], a[4:7], v[64:67]
    ds_read_b128 v[52:55], v2 offset:26880
    v_mfma_f32_16x16x32_bf16 v[64:67], v[40:43], a[8:11], v[64:67]
    v_exp_f32 v109, v109
    v_mfma_f32_16x16x32_bf16 v[64:67], v[44:47], a[12:15], v[64:67]
    v_add_f32 v13, v13, v108
    v_mfma_f32_16x16x32_bf16 v[72:75], v[44:47], a[44:47], v[20:23]
    ds_read_b128 v[56:59], v2 offset:28928
    v_mfma_f32_16x16x32_bf16 v[72:75], v[40:43], a[40:43], v[72:75]
    ds_read_b128 v[60:63], v2 offset:30976
    v_mfma_f32_16x16x32_bf16 v[72:75], v[36:39], a[36:39], v[72:75]
    v_exp_f32 v110, v110
    v_mfma_f32_16x16x32_bf16 v[72:75], v[32:35], a[32:35], v[72:75]
    v_add_f32 v13, v13, v109
    v_cvt_pk_bf16_f32 v106, v108, v109
    v_mfma_f32_16x16x32_bf16 v[80:83], v[32:35], a[64:67], v[24:27]
    v_exp_f32 v111, v111
    v_mfma_f32_16x16x32_bf16 v[80:83], v[36:39], a[68:71], v[80:83]
    v_add_f32 v13, v13, v110
    v_mfma_f32_16x16x32_bf16 v[80:83], v[40:43], a[72:75], v[80:83]
    v_exp_f32 v112, v112
    v_mfma_f32_16x16x32_bf16 v[80:83], v[44:47], a[76:79], v[80:83]
    v_add_f32 v13, v13, v111
    v_mfma_f32_16x16x32_bf16 v[88:91], v[44:47], a[108:111], v[28:31]
    v_cvt_pk_bf16_f32 v107, v110, v111
    v_mfma_f32_16x16x32_bf16 v[88:91], v[40:43], a[104:107], v[88:91]
    v_exp_f32 v113, v113
    v_mfma_f32_16x16x32_bf16 v[88:91], v[36:39], a[100:103], v[88:91]
    v_exp_f32 v114, v114
    v_mfma_f32_16x16x32_bf16 v[88:91], v[32:35], a[96:99], v[88:91]
    s_waitcnt vmcnt(12) lgkmcnt(0)
    v_add_f32 v14, v112, v113
    v_mfma_f32_16x16x32_bf16 v[92:95], v[48:51], a[96:99], v[28:31]
    ds_read_b128 v[32:35], v2 offset:33024
    v_mfma_f32_16x16x32_bf16 v[92:95], v[52:55], a[100:103], v[92:95]
    ds_read_b128 v[36:39], v2 offset:35072
    v_cvt_pk_bf16_f32 v112, v112, v113
    v_mfma_f32_16x16x32_bf16 v[92:95], v[56:59], a[104:107], v[92:95]
    v_exp_f32 v115, v115
    v_mfma_f32_16x16x32_bf16 v[92:95], v[60:63], a[108:111], v[92:95]
    s_waitcnt vmcnt(8)
    v_add_f32 v14, v14, v114
    v_mfma_f32_16x16x32_bf16 v[84:87], v[60:63], a[76:79], v[24:27]
    ds_read_b128 v[40:43], v2 offset:37120
    v_mfma_f32_16x16x32_bf16 v[84:87], v[56:59], a[72:75], v[84:87]
    ds_read_b128 v[44:47], v2 offset:39168
    v_mfma_f32_16x16x32_bf16 v[84:87], v[52:55], a[68:71], v[84:87]
    v_exp_f32 v116, v116
    v_mfma_f32_16x16x32_bf16 v[84:87], v[48:51], a[64:67], v[84:87]
    v_add_f32 v14, v14, v115
    v_cvt_pk_bf16_f32 v113, v114, v115
    v_mfma_f32_16x16x32_bf16 v[76:79], v[48:51], a[32:35], v[20:23]
    v_exp_f32 v117, v117
    v_mfma_f32_16x16x32_bf16 v[76:79], v[52:55], a[36:39], v[76:79]
    v_mfma_f32_16x16x32_bf16 v[76:79], v[56:59], a[40:43], v[76:79]
    v_add_f32 v14, v14, v116
    v_mfma_f32_16x16x32_bf16 v[76:79], v[60:63], a[44:47], v[76:79]
    v_exp_f32 v118, v118
    v_mfma_f32_16x16x32_bf16 v[68:71], v[60:63], a[12:15], v[16:19]
    v_add_f32 v14, v14, v117
    v_mfma_f32_16x16x32_bf16 v[68:71], v[56:59], a[8:11], v[68:71]
    v_cvt_pk_bf16_f32 v114, v116, v117
    v_mfma_f32_16x16x32_bf16 v[68:71], v[52:55], a[4:7], v[68:71]
    v_exp_f32 v119, v119
    v_mfma_f32_16x16x32_bf16 v[68:71], v[48:51], a[0:3], v[68:71]
    s_waitcnt lgkmcnt(0)
    v_add_f32 v14, v14, v118
    v_mfma_f32_16x16x32_bf16 v[68:71], v[32:35], a[16:19], v[68:71]
    ds_read_b128 v[48:51], v2 offset:32768
    v_mfma_f32_16x16x32_bf16 v[68:71], v[36:39], a[20:23], v[68:71]
    ds_read_b128 v[52:55], v2 offset:34816
    v_mfma_f32_16x16x32_bf16 v[68:71], v[40:43], a[24:27], v[68:71]
    v_exp_f32 v120, v120
    v_mfma_f32_16x16x32_bf16 v[68:71], v[44:47], a[28:31], v[68:71]
    v_add_f32 v14, v14, v119
    v_cvt_pk_bf16_f32 v115, v118, v119
    v_mfma_f32_16x16x32_bf16 v[76:79], v[44:47], a[60:63], v[76:79]
    ds_read_b128 v[56:59], v2 offset:36864
    v_mfma_f32_16x16x32_bf16 v[76:79], v[40:43], a[56:59], v[76:79]
    ds_read_b128 v[60:63], v2 offset:38912
    v_mfma_f32_16x16x32_bf16 v[76:79], v[36:39], a[52:55], v[76:79]
    v_exp_f32 v121, v121
    v_mfma_f32_16x16x32_bf16 v[76:79], v[32:35], a[48:51], v[76:79]
    v_exp_f32 v122, v122
    v_mfma_f32_16x16x32_bf16 v[84:87], v[32:35], a[80:83], v[84:87]
    v_add_f32 v15, v120, v121
    v_cvt_pk_bf16_f32 v120, v120, v121
    v_mfma_f32_16x16x32_bf16 v[84:87], v[36:39], a[84:87], v[84:87]
    v_exp_f32 v123, v123
    v_mfma_f32_16x16x32_bf16 v[84:87], v[40:43], a[88:91], v[84:87]
    v_add_f32 v15, v15, v122
    v_mfma_f32_16x16x32_bf16 v[84:87], v[44:47], a[92:95], v[84:87]
    v_exp_f32 v124, v124
    v_mfma_f32_16x16x32_bf16 v[92:95], v[44:47], a[124:127], v[92:95]
    v_add_f32 v15, v15, v123
    v_mfma_f32_16x16x32_bf16 v[92:95], v[40:43], a[120:123], v[92:95]
    v_cvt_pk_bf16_f32 v121, v122, v123
    v_mfma_f32_16x16x32_bf16 v[92:95], v[36:39], a[116:119], v[92:95]
    v_exp_f32 v125, v125
    v_mfma_f32_16x16x32_bf16 v[92:95], v[32:35], a[112:115], v[92:95]
    s_waitcnt lgkmcnt(0)
    v_add_f32 v15, v15, v124
    v_mfma_f32_16x16x32_bf16 v[88:91], v[48:51], a[112:115], v[88:91]
    ds_read_b64_tr_b16 v[32:33], v3 offset:8192
    ds_read_b64_tr_b16 v[34:35], v3 offset:8448
    v_mfma_f32_16x16x32_bf16 v[88:91], v[52:55], a[116:119], v[88:91]
    v_exp_f32 v126, v126
    v_mfma_f32_16x16x32_bf16 v[88:91], v[56:59], a[120:123], v[88:91]
    v_mfma_f32_16x16x32_bf16 v[88:91], v[60:63], a[124:127], v[88:91]
    v_add_f32 v15, v15, v125
    v_cvt_pk_bf16_f32 v122, v124, v125
    v_mfma_f32_16x16x32_bf16 v[80:83], v[60:63], a[92:95], v[80:83]
    ds_read_b64_tr_b16 v[36:37], v3 offset:9216
    ds_read_b64_tr_b16 v[38:39], v3 offset:9472
    v_mfma_f32_16x16x32_bf16 v[80:83], v[56:59], a[88:91], v[80:83]
    v_exp_f32 v127, v127
    v_mfma_f32_16x16x32_bf16 v[80:83], v[52:55], a[84:87], v[80:83]
    v_mfma_f32_16x16x32_bf16 v[80:83], v[48:51], a[80:83], v[80:83]
    v_add_f32 v15, v15, v126
    v_max3_f32 v7, v12, v13, v14
    v_mfma_f32_16x16x32_bf16 v[72:75], v[48:51], a[48:51], v[72:75]
    ds_read_b64_tr_b16 v[40:41], v3 offset:10240
    ds_read_b64_tr_b16 v[42:43], v3 offset:10496
    v_mfma_f32_16x16x32_bf16 v[72:75], v[52:55], a[52:55], v[72:75]
    v_add_f32 v15, v15, v127
    v_mfma_f32_16x16x32_bf16 v[72:75], v[56:59], a[56:59], v[72:75]
    v_cvt_pk_bf16_f32 v123, v126, v127
    v_mfma_f32_16x16x32_bf16 v[72:75], v[60:63], a[60:63], v[72:75]
    v_add_f32 v7, v7, v15
    v_cmp_nge_f32 vcc, s62, v7
    v_mfma_f32_16x16x32_bf16 v[64:67], v[60:63], a[28:31], v[64:67]
    ds_read_b64_tr_b16 v[44:45], v3 offset:11264
    ds_read_b64_tr_b16 v[46:47], v3 offset:11520
    v_mfma_f32_16x16x32_bf16 v[64:67], v[56:59], a[24:27], v[64:67]
    v_mfma_f32_16x16x32_bf16 v[64:67], v[52:55], a[20:23], v[64:67]
    v_mfma_f32_16x16x32_bf16 v[64:67], v[48:51], a[16:19], v[64:67]
    s_waitcnt lgkmcnt(4)
    s_cbranch_vccnz L_stub_i3
L_back_i3:
    v_mfma_f32_16x16x32_bf16 v[128:131], v[32:35], v[96:99], v[128:131]
    ds_read_b64_tr_b16 v[48:49], v3 offset:12288
    ds_read_b64_tr_b16 v[50:51], v3 offset:12544
    v_mfma_f32_16x16x32_bf16 v[132:135], v[36:39], v[96:99], v[132:135]
    s_add_u32 m0, s57, 12288
    v_add_f32 v8, v8, v12
    v_add_f32 v9, v9, v13
    v_mfma_f32_16x16x32_bf16 v[196:199], v[36:39], v[104:107], v[196:199]
    global_load_lds_dwordx4 v4, s[60:61] offset:-4096 sc1
    v_mfma_f32_16x16x32_bf16 v[192:195], v[32:35], v[104:107], v[192:195]
    v_add_f32 v10, v10, v14
    v_add_f32 v11, v11, v15
    v_mfma_f32_16x16x32_bf16 a[128:131], v[32:35], v[112:115], a[128:131]
    ds_read_b64_tr_b16 v[52:53], v3 offset:13312
    ds_read_b64_tr_b16 v[54:55], v3 offset:13568
    v_mfma_f32_16x16x32_bf16 a[132:135], v[36:39], v[112:115], a[132:135]
    v_mfma_f32_16x16x32_bf16 a[196:199], v[36:39], v[120:123], a[196:199]
    global_load_lds_dwordx4 v4, s[60:61] offset:-3072 sc1
    v_mfma_f32_16x16x32_bf16 a[192:195], v[32:35], v[120:123], a[192:195]
    s_waitcnt lgkmcnt(4)
    v_exp_f32 v64, v64
    v_mfma_f32_16x16x32_bf16 a[200:203], v[40:43], v[120:123], a[200:203]
    ds_read_b64_tr_b16 v[56:57], v3 offset:14336
    ds_read_b64_tr_b16 v[58:59], v3 offset:14592
    v_mfma_f32_16x16x32_bf16 a[204:207], v[44:47], v[120:123], a[204:207]
    v_exp_f32 v65, v65
    v_mfma_f32_16x16x32_bf16 a[140:143], v[44:47], v[112:115], a[140:143]
    global_load_lds_dwordx4 v4, s[60:61] offset:-2048 sc1
    v_mfma_f32_16x16x32_bf16 a[136:139], v[40:43], v[112:115], a[136:139]
    v_mfma_f32_16x16x32_bf16 v[200:203], v[40:43], v[104:107], v[200:203]
    ds_read_b64_tr_b16 v[60:61], v3 offset:15360
    ds_read_b64_tr_b16 v[62:63], v3 offset:15616
    v_mfma_f32_16x16x32_bf16 v[204:207], v[44:47], v[104:107], v[204:207]
    v_exp_f32 v66, v66
    v_mfma_f32_16x16x32_bf16 v[140:143], v[44:47], v[96:99], v[140:143]
    global_load_lds_dwordx4 v4, s[60:61] offset:-1024 sc1
    v_mfma_f32_16x16x32_bf16 v[136:139], v[40:43], v[96:99], v[136:139]
    s_waitcnt lgkmcnt(4)
    v_add_f32 v12, v64, v65
    v_mfma_f32_16x16x32_bf16 v[144:147], v[48:51], v[96:99], v[144:147]
    ds_read_b64_tr_b16 v[32:33], v3 offset:16384
    ds_read_b64_tr_b16 v[34:35], v3 offset:16640
    v_mfma_f32_16x16x32_bf16 v[148:151], v[52:55], v[96:99], v[148:151]
    v_cvt_pk_bf16_f32 v64, v64, v65
    v_mfma_f32_16x16x32_bf16 v[212:215], v[52:55], v[104:107], v[212:215]
    global_load_lds_dwordx4 v5, s[60:61] offset:0 sc1
    v_mfma_f32_16x16x32_bf16 v[208:211], v[48:51], v[104:107], v[208:211]
    v_exp_f32 v67, v67
    v_mfma_f32_16x16x32_bf16 a[144:147], v[48:51], v[112:115], a[144:147]
    ds_read_b64_tr_b16 v[36:37], v3 offset:17408
    ds_read_b64_tr_b16 v[38:39], v3 offset:17664
    v_mfma_f32_16x16x32_bf16 a[148:151], v[52:55], v[112:115], a[148:151]
    v_add_f32 v12, v12, v66
    v_mfma_f32_16x16x32_bf16 a[212:215], v[52:55], v[120:123], a[212:215]
    global_load_lds_dwordx4 v5, s[60:61] offset:1024 sc1
    v_mfma_f32_16x16x32_bf16 a[208:211], v[48:51], v[120:123], a[208:211]
    s_waitcnt lgkmcnt(4)
    v_exp_f32 v68, v68
    v_mfma_f32_16x16x32_bf16 a[216:219], v[56:59], v[120:123], a[216:219]
    ds_read_b64_tr_b16 v[40:41], v3 offset:18432
    ds_read_b64_tr_b16 v[42:43], v3 offset:18688
    v_mfma_f32_16x16x32_bf16 a[220:223], v[60:63], v[120:123], a[220:223]
    v_add_f32 v12, v12, v67
    v_mfma_f32_16x16x32_bf16 a[156:159], v[60:63], v[112:115], a[156:159]
    global_load_lds_dwordx4 v5, s[60:61] offset:2048 sc1
    v_mfma_f32_16x16x32_bf16 a[152:155], v[56:59], v[112:115], a[152:155]
    v_cvt_pk_bf16_f32 v65, v66, v67
    v_mfma_f32_16x16x32_bf16 v[216:219], v[56:59], v[104:107], v[216:219]
    ds_read_b64_tr_b16 v[44:45], v3 offset:19456
    ds_read_b64_tr_b16 v[46:47], v3 offset:19712
    v_mfma_f32_16x16x32_bf16 v[220:223], v[60:63], v[104:107], v[220:223]
    v_exp_f32 v69, v69
    v_mfma_f32_16x16x32_bf16 v[156:159], v[60:63], v[96:99], v[156:159]
    global_load_lds_dwordx4 v5, s[60:61] offset:3072 sc1
    v_mfma_f32_16x16x32_bf16 v[152:155], v[56:59], v[96:99], v[152:155]
    s_waitcnt lgkmcnt(4)
    s_add_u32 s60, s60, 16384
    s_addc_u32 s61, s61, 0
    v_add_f32 v12, v12, v68
    v_mfma_f32_16x16x32_bf16 v[160:163], v[32:35], v[96:99], v[160:163]
    ds_read_b64_tr_b16 v[48:49], v3 offset:20480
    ds_read_b64_tr_b16 v[50:51], v3 offset:20736
    v_mfma_f32_16x16x32_bf16 v[164:167], v[36:39], v[96:99], v[164:167]
    s_add_u32 m0, s57, 20480
    v_exp_f32 v70, v70
    v_mfma_f32_16x16x32_bf16 v[228:231], v[36:39], v[104:107], v[228:231]
    global_load_lds_dwordx4 v4, s[58:59] offset:-4096 sc1
    v_mfma_f32_16x16x32_bf16 v[224:227], v[32:35], v[104:107], v[224:227]
    v_mfma_f32_16x16x32_bf16 a[160:163], v[32:35], v[112:115], a[160:163]
    ds_read_b64_tr_b16 v[52:53], v3 offset:21504
    ds_read_b64_tr_b16 v[54:55], v3 offset:21760
    v_mfma_f32_16x16x32_bf16 a[164:167], v[36:39], v[112:115], a[164:167]
    v_add_f32 v12, v12, v69
    v_cvt_pk_bf16_f32 v66, v68, v69
    v_mfma_f32_16x16x32_bf16 a[228:231], v[36:39], v[120:123], a[228:231]
    global_load_lds_dwordx4 v4, s[58:59] offset:-3072 sc1
    v_mfma_f32_16x16x32_bf16 a[224:227], v[32:35], v[120:123], a[224:227]
    s_waitcnt lgkmcnt(4)
    v_exp_f32 v71, v71
    v_mfma_f32_16x16x32_bf16 a[232:235], v[40:43], v[120:123], a[232:235]
    ds_read_b64_tr_b16 v[56:57], v3 offset:22528
    ds_read_b64_tr_b16 v[58:59], v3 offset:22784
    v_mfma_f32_16x16x32_bf16 a[236:239], v[44:47], v[120:123], a[236:239]
    v_mfma_f32_16x16x32_bf16 a[172:175], v[44:47], v[112:115], a[172:175]
    global_load_lds_dwordx4 v4, s[58:59] offset:-2048 sc1
    v_mfma_f32_16x16x32_bf16 a[168:171], v[40:43], v[112:115], a[168:171]
    v_add_f32 v12, v12, v70
    v_mfma_f32_16x16x32_bf16 v[232:235], v[40:43], v[104:107], v[232:235]
    ds_read_b64_tr_b16 v[60:61], v3 offset:23552
    ds_read_b64_tr_b16 v[62:63], v3 offset:23808
    v_mfma_f32_16x16x32_bf16 v[236:239], v[44:47], v[104:107], v[236:239]
    v_exp_f32 v72, v72
    v_mfma_f32_16x16x32_bf16 v[172:175], v[44:47], v[96:99], v[172:175]
    global_load_lds_dwordx4 v4, s[58:59] offset:-1024 sc1
    v_mfma_f32_16x16x32_bf16 v[168:171], v[40:43], v[96:99], v[168:171]
    s_waitcnt vmcnt(12) lgkmcnt(4)
    v_add_f32 v12, v12, v71
    v_mfma_f32_16x16x32_bf16 v[176:179], v[48:51], v[96:99], v[176:179]
    ds_read_b128 v[32:35], v2 offset:0
    v_cvt_pk_bf16_f32 v67, v70, v71
    v_mfma_f32_16x16x32_bf16 v[180:183], v[52:55], v[96:99], v[180:183]
    ds_read_b128 v[36:39], v2 offset:2048
    v_mfma_f32_16x16x32_bf16 v[244:247], v[52:55], v[104:107], v[244:247]
    global_load_lds_dwordx4 v5, s[58:59] offset:0 sc1
    v_mfma_f32_16x16x32_bf16 v[240:243], v[48:51], v[104:107], v[240:243]
    v_exp_f32 v73, v73
    v_mfma_f32_16x16x32_bf16 a[176:179], v[48:51], v[112:115], a[176:179]
    ds_read_b128 v[40:43], v2 offset:4096
    v_mfma_f32_16x16x32_bf16 a[180:183], v[52:55], v[112:115], a[180:183]
    ds_read_b128 v[44:47], v2 offset:6144
    v_mfma_f32_16x16x32_bf16 a[244:247], v[52:55], v[120:123], a[244:247]
    global_load_lds_dwordx4 v5, s[58:59] offset:1024 sc1
    v_mfma_f32_16x16x32_bf16 a[240:243], v[48:51], v[120:123], a[240:243]
    s_waitcnt lgkmcnt(4)
    v_exp_f32 v74, v74
    v_mfma_f32_16x16x32_bf16 a[248:251], v[56:59], v[120:123], a[248:251]
    v_add_f32 v13, v72, v73
    v_cvt_pk_bf16_f32 v72, v72, v73
    v_mfma_f32_16x16x32_bf16 a[252:255], v[60:63], v[120:123], a[252:255]
    v_exp_f32 v75, v75
    v_mfma_f32_16x16x32_bf16 a[188:191], v[60:63], v[112:115], a[188:191]
    global_load_lds_dwordx4 v5, s[58:59] offset:2048 sc1
    v_mfma_f32_16x16x32_bf16 a[184:187], v[56:59], v[112:115], a[184:187]
    v_mfma_f32_16x16x32_bf16 v[248:251], v[56:59], v[104:107], v[248:251]
    v_add_f32 v13, v13, v74
    v_mfma_f32_16x16x32_bf16 v[252:255], v[60:63], v[104:107], v[252:255]
    v_exp_f32 v76, v76
    v_mfma_f32_16x16x32_bf16 v[188:191], v[60:63], v[96:99], v[188:191]
    global_load_lds_dwordx4 v5, s[58:59] offset:3072 sc1
    v_mfma_f32_16x16x32_bf16 v[184:187], v[56:59], v[96:99], v[184:187]
    s_waitcnt lgkmcnt(0)
    s_add_u32 s58, s58, 16384
    s_addc_u32 s59, s59, 0
    v_add_f32 v13, v13, v75
    v_mfma_f32_16x16x32_bf16 v[96:99], v[32:35], a[0:3], v[16:19]
    ds_read_b128 v[48:51], v2 offset:256
    v_cvt_pk_bf16_f32 v73, v74, v75
    v_mfma_f32_16x16x32_bf16 v[96:99], v[36:39], a[4:7], v[96:99]
    ds_read_b128 v[52:55], v2 offset:2304
    v_mfma_f32_16x16x32_bf16 v[96:99], v[40:43], a[8:11], v[96:99]
    v_exp_f32 v77, v77
    v_mfma_f32_16x16x32_bf16 v[96:99], v[44:47], a[12:15], v[96:99]
    v_add_f32 v13, v13, v76
    v_mfma_f32_16x16x32_bf16 v[104:107], v[44:47], a[44:47], v[20:23]
    ds_read_b128 v[56:59], v2 offset:4352
    v_mfma_f32_16x16x32_bf16 v[104:107], v[40:43], a[40:43], v[104:107]
    ds_read_b128 v[60:63], v2 offset:6400
    v_mfma_f32_16x16x32_bf16 v[104:107], v[36:39], a[36:39], v[104:107]
    v_exp_f32 v78, v78
    v_mfma_f32_16x16x32_bf16 v[104:107], v[32:35], a[32:35], v[104:107]
    v_add_f32 v13, v13, v77
    v_cvt_pk_bf16_f32 v74, v76, v77
    v_mfma_f32_16x16x32_bf16 v[112:115], v[32:35], a[64:67], v[24:27]
    v_exp_f32 v79, v79
    v_mfma_f32_16x16x32_bf16 v[112:115], v[36:39], a[68:71], v[112:115]
    v_add_f32 v13, v13, v78
    v_mfma_f32_16x16x32_bf16 v[112:115], v[40:43], a[72:75], v[112:115]
    v_exp_f32 v80, v80
    v_mfma_f32_16x16x32_bf16 v[112:115], v[44:47], a[76:79], v[112:115]
    v_add_f32 v13, v13, v79
    v_mfma_f32_16x16x32_bf16 v[120:123], v[44:47], a[108:111], v[28:31]
    v_cvt_pk_bf16_f32 v75, v78, v79
    v_mfma_f32_16x16x32_bf16 v[120:123], v[40:43], a[104:107], v[120:123]
    v_exp_f32 v81, v81
    v_mfma_f32_16x16x32_bf16 v[120:123], v[36:39], a[100:103], v[120:123]
    v_exp_f32 v82, v82
    v_mfma_f32_16x16x32_bf16 v[120:123], v[32:35], a[96:99], v[120:123]
    s_waitcnt vmcnt(12) lgkmcnt(0)
    v_add_f32 v14, v80, v81
    v_mfma_f32_16x16x32_bf16 v[124:127], v[48:51], a[96:99], v[28:31]
    ds_read_b128 v[32:35], v2 offset:8448
    v_mfma_f32_16x16x32_bf16 v[124:127], v[52:55], a[100:103], v[124:127]
    ds_read_b128 v[36:39], v2 offset:10496
    v_cvt_pk_bf16_f32 v80, v80, v81
    v_mfma_f32_16x16x32_bf16 v[124:127], v[56:59], a[104:107], v[124:127]
    v_exp_f32 v83, v83
    v_mfma_f32_16x16x32_bf16 v[124:127], v[60:63], a[108:111], v[124:127]
    s_waitcnt vmcnt(8)
    v_add_f32 v14, v14, v82
    v_mfma_f32_16x16x32_bf16 v[116:119], v[60:63], a[76:79], v[24:27]
    ds_read_b128 v[40:43], v2 offset:12544
    v_mfma_f32_16x16x32_bf16 v[116:119], v[56:59], a[72:75], v[116:119]
    ds_read_b128 v[44:47], v2 offset:14592
    v_mfma_f32_16x16x32_bf16 v[116:119], v[52:55], a[68:71], v[116:119]
    v_exp_f32 v84, v84
    v_mfma_f32_16x16x32_bf16 v[116:119], v[48:51], a[64:67], v[116:119]
    v_add_f32 v14, v14, v83
    v_cvt_pk_bf16_f32 v81, v82, v83
    v_mfma_f32_16x16x32_bf16 v[108:111], v[48:51], a[32:35], v[20:23]
    v_exp_f32 v85, v85
    v_mfma_f32_16x16x32_bf16 v[108:111], v[52:55], a[36:39], v[108:111]
    v_mfma_f32_16x16x32_bf16 v[108:111], v[56:59], a[40:43], v[108:111]
    v_add_f32 v14, v14, v84
    v_mfma_f32_16x16x32_bf16 v[108:111], v[60:63], a[44:47], v[108:111]
    v_exp_f32 v86, v86
    v_mfma_f32_16x16x32_bf16 v[100:103], v[60:63], a[12:15], v[16:19]
    v_add_f32 v14, v14, v85
    v_mfma_f32_16x16x32_bf16 v[100:103], v[56:59], a[8:11], v[100:103]
    v_cvt_pk_bf16_f32 v82, v84, v85
    v_mfma_f32_16x16x32_bf16 v[100:103], v[52:55], a[4:7], v[100:103]
    v_exp_f32 v87, v87
    v_mfma_f32_16x16x32_bf16 v[100:103], v[48:51], a[0:3], v[100:103]
    s_waitcnt lgkmcnt(0)
    v_add_f32 v14, v14, v86
    v_mfma_f32_16x16x32_bf16 v[100:103], v[32:35], a[16:19], v[100:103]
    ds_read_b128 v[48:51], v2 offset:8192
    v_mfma_f32_16x16x32_bf16 v[100:103], v[36:39], a[20:23], v[100:103]
    ds_read_b128 v[52:55], v2 offset:10240
    v_mfma_f32_16x16x32_bf16 v[100:103], v[40:43], a[24:27], v[100:103]
    v_exp_f32 v88, v88
    v_mfma_f32_16x16x32_bf16 v[100:103], v[44:47], a[28:31], v[100:103]
    v_add_f32 v14, v14, v87
    v_cvt_pk_bf16_f32 v83, v86, v87
    v_mfma_f32_16x16x32_bf16 v[108:111], v[44:47], a[60:63], v[108:111]
    ds_read_b128 v[56:59], v2 offset:12288
    v_mfma_f32_16x16x32_bf16 v[108:111], v[40:43], a[56:59], v[108:111]
    ds_read_b128 v[60:63], v2 offset:14336
    v_mfma_f32_16x16x32_bf16 v[108:111], v[36:39], a[52:55], v[108:111]
    v_exp_f32 v89, v89
    v_mfma_f32_16x16x32_bf16 v[108:111], v[32:35], a[48:51], v[108:111]
    v_exp_f32 v90, v90
    v_mfma_f32_16x16x32_bf16 v[116:119], v[32:35], a[80:83], v[116:119]
    v_add_f32 v15, v88, v89
    v_cvt_pk_bf16_f32 v88, v88, v89
    v_mfma_f32_16x16x32_bf16 v[116:119], v[36:39], a[84:87], v[116:119]
    v_exp_f32 v91, v91
    v_mfma_f32_16x16x32_bf16 v[116:119], v[40:43], a[88:91], v[116:119]
    v_add_f32 v15, v15, v90
    v_mfma_f32_16x16x32_bf16 v[116:119], v[44:47], a[92:95], v[116:119]
    v_exp_f32 v92, v92
    v_mfma_f32_16x16x32_bf16 v[124:127], v[44:47], a[124:127], v[124:127]
    v_add_f32 v15, v15, v91
    v_mfma_f32_16x16x32_bf16 v[124:127], v[40:43], a[120:123], v[124:127]
    v_cvt_pk_bf16_f32 v89, v90, v91
    v_mfma_f32_16x16x32_bf16 v[124:127], v[36:39], a[116:119], v[124:127]
    v_exp_f32 v93, v93
    v_mfma_f32_16x16x32_bf16 v[124:127], v[32:35], a[112:115], v[124:127]
    s_waitcnt lgkmcnt(0)
    v_add_f32 v15, v15, v92
    v_mfma_f32_16x16x32_bf16 v[120:123], v[48:51], a[112:115], v[120:123]
    ds_read_b64_tr_b16 v[32:33], v3 offset:24576
    ds_read_b64_tr_b16 v[34:35], v3 offset:24832
    v_mfma_f32_16x16x32_bf16 v[120:123], v[52:55], a[116:119], v[120:123]
    v_exp_f32 v94, v94
    v_mfma_f32_16x16x32_bf16 v[120:123], v[56:59], a[120:123], v[120:123]
    v_mfma_f32_16x16x32_bf16 v[120:123], v[60:63], a[124:127], v[120:123]
    v_add_f32 v15, v15, v93
    v_cvt_pk_bf16_f32 v90, v92, v93
    v_mfma_f32_16x16x32_bf16 v[112:115], v[60:63], a[92:95], v[112:115]
    ds_read_b64_tr_b16 v[36:37], v3 offset:25600
    ds_read_b64_tr_b16 v[38:39], v3 offset:25856
    v_mfma_f32_16x16x32_bf16 v[112:115], v[56:59], a[88:91], v[112:115]
    v_exp_f32 v95, v95
    v_mfma_f32_16x16x32_bf16 v[112:115], v[52:55], a[84:87], v[112:115]
L_pk4:
    s_cbranch_execz L_pk7
    v_mfma_f32_16x16x32_bf16 v[112:115], v[48:51], a[80:83], v[112:115]
    v_add_f32 v15, v15, v94
    v_max3_f32 v7, v12, v13, v14
    v_mfma_f32_16x16x32_bf16 v[104:107], v[48:51], a[48:51], v[104:107]
    ds_read_b64_tr_b16 v[40:41], v3 offset:26624
    ds_read_b64_tr_b16 v[42:43], v3 offset:26880
    v_mfma_f32_16x16x32_bf16 v[104:107], v[52:55], a[52:55], v[104:107]
    v_add_f32 v15, v15, v95
    v_mfma_f32_16x16x32_bf16 v[104:107], v[56:59], a[56:59], v[104:107]
    v_cvt_pk_bf16_f32 v91, v94, v95
    v_mfma_f32_16x16x32_bf16 v[104:107], v[60:63], a[60:63], v[104:107]
    v_add_f32 v7, v7, v15
    v_cmp_nge_f32 vcc, s62, v7
    v_mfma_f32_16x16x32_bf16 v[96:99], v[60:63], a[28:31], v[96:99]
    ds_read_b64_tr_b16 v[44:45], v3 offset:27648
    ds_read_b64_tr_b16 v[46:47], v3 offset:27904
    v_mfma_f32_16x16x32_bf16 v[96:99], v[56:59], a[24:27], v[96:99]
    v_mfma_f32_16x16x32_bf16 v[96:99], v[52:55], a[20:23], v[96:99]
    v_mfma_f32_16x16x32_bf16 v[96:99], v[48:51], a[16:19], v[96:99]
    s_waitcnt lgkmcnt(4)
    s_cbranch_vccnz L_stub_i4
L_back_i4:
    v_mfma_f32_16x16x32_bf16 v[128:131], v[32:35], v[64:67], v[128:131]
    ds_read_b64_tr_b16 v[48:49], v3 offset:28672
    ds_read_b64_tr_b16 v[50:51], v3 offset:28928
    v_mfma_f32_16x16x32_bf16 v[132:135], v[36:39], v[64:67], v[132:135]
    s_add_u32 m0, s57, 28672
    v_add_f32 v8, v8, v12
    v_add_f32 v9, v9, v13
    v_mfma_f32_16x16x32_bf16 v[196:199], v[36:39], v[72:75], v[196:199]
    global_load_lds_dwordx4 v4, s[60:61] offset:-4096 sc1
    v_mfma_f32_16x16x32_bf16 v[192:195], v[32:35], v[72:75], v[192:195]
    v_add_f32 v10, v10, v14
    v_add_f32 v11, v11, v15
    v_mfma_f32_16x16x32_bf16 a[128:131], v[32:35], v[80:83], a[128:131]
    ds_read_b64_tr_b16 v[52:53], v3 offset:29696
    ds_read_b64_tr_b16 v[54:55], v3 offset:29952
    v_mfma_f32_16x16x32_bf16 a[132:135], v[36:39], v[80:83], a[132:135]
    v_mfma_f32_16x16x32_bf16 a[196:199], v[36:39], v[88:91], a[196:199]
    global_load_lds_dwordx4 v4, s[60:61] offset:-3072 sc1
    v_mfma_f32_16x16x32_bf16 a[192:195], v[32:35], v[88:91], a[192:195]
    s_waitcnt lgkmcnt(4)
    v_exp_f32 v96, v96
    v_mfma_f32_16x16x32_bf16 a[200:203], v[40:43], v[88:91], a[200:203]
    ds_read_b64_tr_b16 v[56:57], v3 offset:30720
    ds_read_b64_tr_b16 v[58:59], v3 offset:30976
    v_mfma_f32_16x16x32_bf16 a[204:207], v[44:47], v[88:91], a[204:207]
    v_exp_f32 v97, v97
    v_mfma_f32_16x16x32_bf16 a[140:143], v[44:47], v[80:83], a[140:143]
    global_load_lds_dwordx4 v4, s[60:61] offset:-2048 sc1
    v_mfma_f32_16x16x32_bf16 a[136:139], v[40:43], v[80:83], a[136:139]
    v_mfma_f32_16x16x32_bf16 v[200:203], v[40:43], v[72:75], v[200:203]
    ds_read_b64_tr_b16 v[60:61], v3 offset:31744
    ds_read_b64_tr_b16 v[62:63], v3 offset:32000
    v_mfma_f32_16x16x32_bf16 v[204:207], v[44:47], v[72:75], v[204:207]
    v_exp_f32 v98, v98
    v_mfma_f32_16x16x32_bf16 v[140:143], v[44:47], v[64:67], v[140:143]
    global_load_lds_dwordx4 v4, s[60:61] offset:-1024 sc1
    v_mfma_f32_16x16x32_bf16 v[136:139], v[40:43], v[64:67], v[136:139]
    s_waitcnt lgkmcnt(4)
    v_add_f32 v12, v96, v97
    v_mfma_f32_16x16x32_bf16 v[144:147], v[48:51], v[64:67], v[144:147]
    ds_read_b64_tr_b16 v[32:33], v3 offset:32768
    ds_read_b64_tr_b16 v[34:35], v3 offset:33024
    v_mfma_f32_16x16x32_bf16 v[148:151], v[52:55], v[64:67], v[148:151]
    v_cvt_pk_bf16_f32 v96, v96, v97
    v_mfma_f32_16x16x32_bf16 v[212:215], v[52:55], v[72:75], v[212:215]
    global_load_lds_dwordx4 v5, s[60:61] offset:0 sc1
    v_mfma_f32_16x16x32_bf16 v[208:211], v[48:51], v[72:75], v[208:211]
    v_exp_f32 v99, v99
    v_mfma_f32_16x16x32_bf16 a[144:147], v[48:51], v[80:83], a[144:147]
    ds_read_b64_tr_b16 v[36:37], v3 offset:33792
    ds_read_b64_tr_b16 v[38:39], v3 offset:34048
    v_mfma_f32_16x16x32_bf16 a[148:151], v[52:55], v[80:83], a[148:151]
    v_add_f32 v12, v12, v98
    v_mfma_f32_16x16x32_bf16 a[212:215], v[52:55], v[88:91], a[212:215]
    global_load_lds_dwordx4 v5, s[60:61] offset:1024 sc1
    v_mfma_f32_16x16x32_bf16 a[208:211], v[48:51], v[88:91], a[208:211]
    s_waitcnt lgkmcnt(4)
    v_exp_f32 v100, v100
    v_mfma_f32_16x16x32_bf16 a[216:219], v[56:59], v[88:91], a[216:219]
    ds_read_b64_tr_b16 v[40:41], v3 offset:34816
    ds_read_b64_tr_b16 v[42:43], v3 offset:35072
    v_mfma_f32_16x16x32_bf16 a[220:223], v[60:63], v[88:91], a[220:223]
    v_add_f32 v12, v12, v99
    v_mfma_f32_16x16x32_bf16 a[156:159], v[60:63], v[80:83], a[156:159]
    global_load_lds_dwordx4 v5, s[60:61] offset:2048 sc1
    v_mfma_f32_16x16x32_bf16 a[152:155], v[56:59], v[80:83], a[152:155]
    v_cvt_pk_bf16_f32 v97, v98, v99
    v_mfma_f32_16x16x32_bf16 v[216:219], v[56:59], v[72:75], v[216:219]
    ds_read_b64_tr_b16 v[44:45], v3 offset:35840
    ds_read_b64_tr_b16 v[46:47], v3 offset:36096
    v_mfma_f32_16x16x32_bf16 v[220:223], v[60:63], v[72:75], v[220:223]
    v_exp_f32 v101, v101
    v_mfma_f32_16x16x32_bf16 v[156:159], v[60:63], v[64:67], v[156:159]
    global_load_lds_dwordx4 v5, s[60:61] offset:3072 sc1
    v_mfma_f32_16x16x32_bf16 v[152:155], v[56:59], v[64:67], v[152:155]
    s_waitcnt lgkmcnt(4)
    s_add_u32 s60, s60, 16384
    s_addc_u32 s61, s61, 0
    v_add_f32 v12, v12, v100
    v_mfma_f32_16x16x32_bf16 v[160:163], v[32:35], v[64:67], v[160:163]
    ds_read_b64_tr_b16 v[48:49], v3 offset:36864
    ds_read_b64_tr_b16 v[50:51], v3 offset:37120
    v_mfma_f32_16x16x32_bf16 v[164:167], v[36:39], v[64:67], v[164:167]
    s_add_u32 m0, s57, 36864
    v_exp_f32 v102, v102
    v_mfma_f32_16x16x32_bf16 v[228:231], v[36:39], v[72:75], v[228:231]
    global_load_lds_dwordx4 v4, s[58:59] offset:-4096 sc1
    v_mfma_f32_16x16x32_bf16 v[224:227], v[32:35], v[72:75], v[224:227]
    v_mfma_f32_16x16x32_bf16 a[160:163], v[32:35], v[80:83], a[160:163]
    ds_read_b64_tr_b16 v[52:53], v3 offset:37888
    ds_read_b64_tr_b16 v[54:55], v3 offset:38144
    v_mfma_f32_16x16x32_bf16 a[164:167], v[36:39], v[80:83], a[164:167]
    v_add_f32 v12, v12, v101
    v_cvt_pk_bf16_f32 v98, v100, v101
    v_mfma_f32_16x16x32_bf16 a[228:231], v[36:39], v[88:91], a[228:231]
    global_load_lds_dwordx4 v4, s[58:59] offset:-3072 sc1
    v_mfma_f32_16x16x32_bf16 a[224:227], v[32:35], v[88:91], a[224:227]
    s_waitcnt lgkmcnt(4)
    v_exp_f32 v103, v103
    v_mfma_f32_16x16x32_bf16 a[232:235], v[40:43], v[88:91], a[232:235]
    ds_read_b64_tr_b16 v[56:57], v3 offset:38912
    ds_read_b64_tr_b16 v[58:59], v3 offset:39168
    v_mfma_f32_16x16x32_bf16 a[236:239], v[44:47], v[88:91], a[236:239]
    v_mfma_f32_16x16x32_bf16 a[172:175], v[44:47], v[80:83], a[172:175]
    global_load_lds_dwordx4 v4, s[58:59] offset:-2048 sc1
    v_mfma_f32_16x16x32_bf16 a[168:171], v[40:43], v[80:83], a[168:171]
    v_add_f32 v12, v12, v102
    v_mfma_f32_16x16x32_bf16 v[232:235], v[40:43], v[72:75], v[232:235]
    ds_read_b64_tr_b16 v[60:61], v3 offset:39936
    ds_read_b64_tr_b16 v[62:63], v3 offset:40192
    v_mfma_f32_16x16x32_bf16 v[236:239], v[44:47], v[72:75], v[236:239]
    v_exp_f32 v104, v104
    v_mfma_f32_16x16x32_bf16 v[172:175], v[44:47], v[64:67], v[172:175]
    global_load_lds_dwordx4 v4, s[58:59] offset:-1024 sc1
    v_mfma_f32_16x16x32_bf16 v[168:171], v[40:43], v[64:67], v[168:171]
    s_waitcnt vmcnt(12) lgkmcnt(4)
    v_add_f32 v12, v12, v103
    v_mfma_f32_16x16x32_bf16 v[176:179], v[48:51], v[64:67], v[176:179]
    ds_read_b128 v[32:35], v2 offset:16384
    v_cvt_pk_bf16_f32 v99, v102, v103
    v_mfma_f32_16x16x32_bf16 v[180:183], v[52:55], v[64:67], v[180:183]
    ds_read_b128 v[36:39], v2 offset:18432
    v_mfma_f32_16x16x32_bf16 v[244:247], v[52:55], v[72:75], v[244:247]
    global_load_lds_dwordx4 v5, s[58:59] offset:0 sc1
    v_mfma_f32_16x16x32_bf16 v[240:243], v[48:51], v[72:75], v[240:243]
    v_exp_f32 v105, v105
    v_mfma_f32_16x16x32_bf16 a[176:179], v[48:51], v[80:83], a[176:179]
    ds_read_b128 v[40:43], v2 offset:20480
    v_mfma_f32_16x16x32_bf16 a[180:183], v[52:55], v[80:83], a[180:183]
    ds_read_b128 v[44:47], v2 offset:22528
    v_mfma_f32_16x16x32_bf16 a[244:247], v[52:55], v[88:91], a[244:247]
    global_load_lds_dwordx4 v5, s[58:59] offset:1024 sc1
    v_mfma_f32_16x16x32_bf16 a[240:243], v[48:51], v[88:91], a[240:243]
    s_waitcnt lgkmcnt(4)
    v_exp_f32 v106, v106
    v_mfma_f32_16x16x32_bf16 a[248:251], v[56:59], v[88:91], a[248:251]
    v_add_f32 v13, v104, v105
    v_cvt_pk_bf16_f32 v104, v104, v105
    v_mfma_f32_16x16x32_bf16 a[252:255], v[60:63], v[88:91], a[252:255]
    v_exp_f32 v107, v107
    v_mfma_f32_16x16x32_bf16 a[188:191], v[60:63], v[80:83], a[188:191]
    global_load_lds_dwordx4 v5, s[58:59] offset:2048 sc1
    v_mfma_f32_16x16x32_bf16 a[184:187], v[56:59], v[80:83], a[184:187]
    v_mfma_f32_16x16x32_bf16 v[248:251], v[56:59], v[72:75], v[248:251]
    v_add_f32 v13, v13, v106
    v_mfma_f32_16x16x32_bf16 v[252:255], v[60:63], v[72:75], v[252:255]
    v_exp_f32 v108, v108
    v_mfma_f32_16x16x32_bf16 v[188:191], v[60:63], v[64:67], v[188:191]
    global_load_lds_dwordx4 v5, s[58:59] offset:3072 sc1
    v_mfma_f32_16x16x32_bf16 v[184:187], v[56:59], v[64:67], v[184:187]
    s_waitcnt lgkmcnt(0)
    s_add_u32 s58, s58, 16384
    s_addc_u32 s59, s59, 0
    v_add_f32 v13, v13, v107
    v_mfma_f32_16x16x32_bf16 v[64:67], v[32:35], a[0:3], v[16:19]
    ds_read_b128 v[48:51], v2 offset:16640
    v_cvt_pk_bf16_f32 v105, v106, v107
    v_mfma_f32_16x16x32_bf16 v[64:67], v[36:39], a[4:7], v[64:67]
    ds_read_b128 v[52:55], v2 offset:18688
    v_mfma_f32_16x16x32_bf16 v[64:67], v[40:43], a[8:11], v[64:67]
    v_exp_f32 v109, v109
    v_mfma_f32_16x16x32_bf16 v[64:67], v[44:47], a[12:15], v[64:67]
    v_add_f32 v13, v13, v108
    v_mfma_f32_16x16x32_bf16 v[72:75], v[44:47], a[44:47], v[20:23]
    ds_read_b128 v[56:59], v2 offset:20736
    v_mfma_f32_16x16x32_bf16 v[72:75], v[40:43], a[40:43], v[72:75]
    ds_read_b128 v[60:63], v2 offset:22784
    v_mfma_f32_16x16x32_bf16 v[72:75], v[36:39], a[36:39], v[72:75]
    v_exp_f32 v110, v110
    v_mfma_f32_16x16x32_bf16 v[72:75], v[32:35], a[32:35], v[72:75]
    v_add_f32 v13, v13, v109
    v_cvt_pk_bf16_f32 v106, v108, v109
    v_mfma_f32_16x16x32_bf16 v[80:83], v[32:35], a[64:67], v[24:27]
    v_exp_f32 v111, v111
    v_mfma_f32_16x16x32_bf16 v[80:83], v[36:39], a[68:71], v[80:83]
    v_add_f32 v13, v13, v110
    v_mfma_f32_16x16x32_bf16 v[80:83], v[40:43], a[72:75], v[80:83]
    v_exp_f32 v112, v112
    v_mfma_f32_16x16x32_bf16 v[80:83], v[44:47], a[76:79], v[80:83]
    v_add_f32 v13, v13, v111
    v_mfma_f32_16x16x32_bf16 v[88:91], v[44:47], a[108:111], v[28:31]
    v_cvt_pk_bf16_f32 v107, v110, v111
    v_mfma_f32_16x16x32_bf16 v[88:91], v[40:43], a[104:107], v[88:91]
    v_exp_f32 v113, v113
    v_mfma_f32_16x16x32_bf16 v[88:91], v[36:39], a[100:103], v[88:91]
    v_exp_f32 v114, v114
    v_mfma_f32_16x16x32_bf16 v[88:91], v[32:35], a[96:99], v[88:91]
    s_waitcnt vmcnt(12) lgkmcnt(0)
    v_add_f32 v14, v112, v113
    v_mfma_f32_16x16x32_bf16 v[92:95], v[48:51], a[96:99], v[28:31]
    ds_read_b128 v[32:35], v2 offset:24832
    v_mfma_f32_16x16x32_bf16 v[92:95], v[52:55], a[100:103], v[92:95]
    ds_read_b128 v[36:39], v2 offset:26880
    v_cvt_pk_bf16_f32 v112, v112, v113
    v_mfma_f32_16x16x32_bf16 v[92:95], v[56:59], a[104:107], v[92:95]
    v_exp_f32 v115, v115
    v_mfma_f32_16x16x32_bf16 v[92:95], v[60:63], a[108:111], v[92:95]
    s_waitcnt vmcnt(8)
    v_add_f32 v14, v14, v114
    v_mfma_f32_16x16x32_bf16 v[84:87], v[60:63], a[76:79], v[24:27]
    ds_read_b128 v[40:43], v2 offset:28928
    v_mfma_f32_16x16x32_bf16 v[84:87], v[56:59], a[72:75], v[84:87]
    ds_read_b128 v[44:47], v2 offset:30976
    v_mfma_f32_16x16x32_bf16 v[84:87], v[52:55], a[68:71], v[84:87]
    v_exp_f32 v116, v116
    v_mfma_f32_16x16x32_bf16 v[84:87], v[48:51], a[64:67], v[84:87]
    v_add_f32 v14, v14, v115
    v_cvt_pk_bf16_f32 v113, v114, v115
    v_mfma_f32_16x16x32_bf16 v[76:79], v[48:51], a[32:35], v[20:23]
    v_exp_f32 v117, v117
    v_mfma_f32_16x16x32_bf16 v[76:79], v[52:55], a[36:39], v[76:79]
    v_mfma_f32_16x16x32_bf16 v[76:79], v[56:59], a[40:43], v[76:79]
    v_add_f32 v14, v14, v116
    v_mfma_f32_16x16x32_bf16 v[76:79], v[60:63], a[44:47], v[76:79]
    v_exp_f32 v118, v118
    v_mfma_f32_16x16x32_bf16 v[68:71], v[60:63], a[12:15], v[16:19]
    v_add_f32 v14, v14, v117
    v_mfma_f32_16x16x32_bf16 v[68:71], v[56:59], a[8:11], v[68:71]
    v_cvt_pk_bf16_f32 v114, v116, v117
    v_mfma_f32_16x16x32_bf16 v[68:71], v[52:55], a[4:7], v[68:71]
    v_exp_f32 v119, v119
    v_mfma_f32_16x16x32_bf16 v[68:71], v[48:51], a[0:3], v[68:71]
    s_waitcnt lgkmcnt(0)
    v_add_f32 v14, v14, v118
    v_mfma_f32_16x16x32_bf16 v[68:71], v[32:35], a[16:19], v[68:71]
    ds_read_b128 v[48:51], v2 offset:24576
    v_mfma_f32_16x16x32_bf16 v[68:71], v[36:39], a[20:23], v[68:71]
    ds_read_b128 v[52:55], v2 offset:26624
    v_mfma_f32_16x16x32_bf16 v[68:71], v[40:43], a[24:27], v[68:71]
    v_exp_f32 v120, v120
    v_mfma_f32_16x16x32_bf16 v[68:71], v[44:47], a[28:31], v[68:71]
    v_add_f32 v14, v14, v119
    v_cvt_pk_bf16_f32 v115, v118, v119
    v_mfma_f32_16x16x32_bf16 v[76:79], v[44:47], a[60:63], v[76:79]
    ds_read_b128 v[56:59], v2 offset:28672
    v_mfma_f32_16x16x32_bf16 v[76:79], v[40:43], a[56:59], v[76:79]
    ds_read_b128 v[60:63], v2 offset:30720
    v_mfma_f32_16x16x32_bf16 v[76:79], v[36:39], a[52:55], v[76:79]
    v_exp_f32 v121, v121
    v_mfma_f32_16x16x32_bf16 v[76:79], v[32:35], a[48:51], v[76:79]
    v_exp_f32 v122, v122
    v_mfma_f32_16x16x32_bf16 v[84:87], v[32:35], a[80:83], v[84:87]
    v_add_f32 v15, v120, v121
    v_cvt_pk_bf16_f32 v120, v120, v121
    v_mfma_f32_16x16x32_bf16 v[84:87], v[36:39], a[84:87], v[84:87]
    v_exp_f32 v123, v123
    v_mfma_f32_16x16x32_bf16 v[84:87], v[40:43], a[88:91], v[84:87]
    v_add_f32 v15, v15, v122
    v_mfma_f32_16x16x32_bf16 v[84:87], v[44:47], a[92:95], v[84:87]
    v_exp_f32 v124, v124
    v_mfma_f32_16x16x32_bf16 v[92:95], v[44:47], a[124:127], v[92:95]
    v_add_f32 v15, v15, v123
    v_mfma_f32_16x16x32_bf16 v[92:95], v[40:43], a[120:123], v[92:95]
    v_cvt_pk_bf16_f32 v121, v122, v123
    v_mfma_f32_16x16x32_bf16 v[92:95], v[36:39], a[116:119], v[92:95]
    v_exp_f32 v125, v125
    v_mfma_f32_16x16x32_bf16 v[92:95], v[32:35], a[112:115], v[92:95]
    s_waitcnt lgkmcnt(0)
    v_add_f32 v15, v15, v124
    v_mfma_f32_16x16x32_bf16 v[88:91], v[48:51], a[112:115], v[88:91]
    ds_read_b64_tr_b16 v[32:33], v3 offset:0
    ds_read_b64_tr_b16 v[34:35], v3 offset:256
    v_mfma_f32_16x16x32_bf16 v[88:91], v[52:55], a[116:119], v[88:91]
    v_exp_f32 v126, v126
    v_mfma_f32_16x16x32_bf16 v[88:91], v[56:59], a[120:123], v[88:91]
    v_mfma_f32_16x16x32_bf16 v[88:91], v[60:63], a[124:127], v[88:91]
    v_add_f32 v15, v15, v125
    v_cvt_pk_bf16_f32 v122, v124, v125
    v_mfma_f32_16x16x32_bf16 v[80:83], v[60:63], a[92:95], v[80:83]
    ds_read_b64_tr_b16 v[36:37], v3 offset:1024
    ds_read_b64_tr_b16 v[38:39], v3 offset:1280
    v_mfma_f32_16x16x32_bf16 v[80:83], v[56:59], a[88:91], v[80:83]
    v_exp_f32 v127, v127
    v_mfma_f32_16x16x32_bf16 v[80:83], v[52:55], a[84:87], v[80:83]
    v_mfma_f32_16x16x32_bf16 v[80:83], v[48:51], a[80:83], v[80:83]
    v_add_f32 v15, v15, v126
    v_max3_f32 v7, v12, v13, v14
    v_mfma_f32_16x16x32_bf16 v[72:75], v[48:51], a[48:51], v[72:75]
    ds_read_b64_tr_b16 v[40:41], v3 offset:2048
    ds_read_b64_tr_b16 v[42:43], v3 offset:2304
    v_mfma_f32_16x16x32_bf16 v[72:75], v[52:55], a[52:55], v[72:75]
    v_add_f32 v15, v15, v127
    v_mfma_f32_16x16x32_bf16 v[72:75], v[56:59], a[56:59], v[72:75]
    v_cvt_pk_bf16_f32 v123, v126, v127
    v_mfma_f32_16x16x32_bf16 v[72:75], v[60:63], a[60:63], v[72:75]
    v_add_f32 v7, v7, v15
    v_cmp_nge_f32 vcc, s62, v7
    v_mfma_f32_16x16x32_bf16 v[64:67], v[60:63], a[28:31], v[64:67]
    ds_read_b64_tr_b16 v[44:45], v3 offset:3072
    ds_read_b64_tr_b16 v[46:47], v3 offset:3328
    v_mfma_f32_16x16x32_bf16 v[64:67], v[56:59], a[24:27], v[64:67]
    v_mfma_f32_16x16x32_bf16 v[64:67], v[52:55], a[20:23], v[64:67]
    v_mfma_f32_16x16x32_bf16 v[64:67], v[48:51], a[16:19], v[64:67]
    s_waitcnt lgkmcnt(4)
    s_cbranch_vccnz L_stub_i5
L_back_i5:
    v_mfma_f32_16x16x32_bf16 v[128:131], v[32:35], v[96:99], v[128:131]
    ds_read_b64_tr_b16 v[48:49], v3 offset:4096
    ds_read_b64_tr_b16 v[50:51], v3 offset:4352
    v_mfma_f32_16x16x32_bf16 v[132:135], v[36:39], v[96:99], v[132:135]
    s_add_u32 m0, s57, 4096
    v_add_f32 v8, v8, v12
    v_add_f32 v9, v9, v13
    v_mfma_f32_16x16x32_bf16 v[196:199], v[36:39], v[104:107], v[196:199]
    global_load_lds_dwordx4 v4, s[60:61] offset:-4096 sc1
    v_mfma_f32_16x16x32_bf16 v[192:195], v[32:35], v[104:107], v[192:195]
    v_add_f32 v10, v10, v14
    v_add_f32 v11, v11, v15
    v_mfma_f32_16x16x32_bf16 a[128:131], v[32:35], v[112:115], a[128:131]
    ds_read_b64_tr_b16 v[52:53], v3 offset:5120
    ds_read_b64_tr_b16 v[54:55], v3 offset:5376
    v_mfma_f32_16x16x32_bf16 a[132:135], v[36:39], v[112:115], a[132:135]
    v_mfma_f32_16x16x32_bf16 a[196:199], v[36:39], v[120:123], a[196:199]
    global_load_lds_dwordx4 v4, s[60:61] offset:-3072 sc1
    v_mfma_f32_16x16x32_bf16 a[192:195], v[32:35], v[120:123], a[192:195]
    s_waitcnt lgkmcnt(4)
    v_exp_f32 v64, v64
    v_mfma_f32_16x16x32_bf16 a[200:203], v[40:43], v[120:123], a[200:203]
    ds_read_b64_tr_b16 v[56:57], v3 offset:6144
    ds_read_b64_tr_b16 v[58:59], v3 offset:6400
    v_mfma_f32_16x16x32_bf16 a[204:207], v[44:47], v[120:123], a[204:207]
    v_exp_f32 v65, v65
    v_mfma_f32_16x16x32_bf16 a[140:143], v[44:47], v[112:115], a[140:143]
    global_load_lds_dwordx4 v4, s[60:61] offset:-2048 sc1
    v_mfma_f32_16x16x32_bf16 a[136:139], v[40:43], v[112:115], a[136:139]
    v_mfma_f32_16x16x32_bf16 v[200:203], v[40:43], v[104:107], v[200:203]
    ds_read_b64_tr_b16 v[60:61], v3 offset:7168
    ds_read_b64_tr_b16 v[62:63], v3 offset:7424
    v_mfma_f32_16x16x32_bf16 v[204:207], v[44:47], v[104:107], v[204:207]
    v_exp_f32 v66, v66
    v_mfma_f32_16x16x32_bf16 v[140:143], v[44:47], v[96:99], v[140:143]
    global_load_lds_dwordx4 v4, s[60:61] offset:-1024 sc1
    v_mfma_f32_16x16x32_bf16 v[136:139], v[40:43], v[96:99], v[136:139]
    s_waitcnt lgkmcnt(4)
    v_add_f32 v12, v64, v65
    v_mfma_f32_16x16x32_bf16 v[144:147], v[48:51], v[96:99], v[144:147]
    ds_read_b64_tr_b16 v[32:33], v3 offset:8192
    ds_read_b64_tr_b16 v[34:35], v3 offset:8448
    v_mfma_f32_16x16x32_bf16 v[148:151], v[52:55], v[96:99], v[148:151]
    v_cvt_pk_bf16_f32 v64, v64, v65
    v_mfma_f32_16x16x32_bf16 v[212:215], v[52:55], v[104:107], v[212:215]
    global_load_lds_dwordx4 v5, s[60:61] offset:0 sc1
    v_mfma_f32_16x16x32_bf16 v[208:211], v[48:51], v[104:107], v[208:211]
    v_exp_f32 v67, v67
    v_mfma_f32_16x16x32_bf16 a[144:147], v[48:51], v[112:115], a[144:147]
    ds_read_b64_tr_b16 v[36:37], v3 offset:9216
    ds_read_b64_tr_b16 v[38:39], v3 offset:9472
    v_mfma_f32_16x16x32_bf16 a[148:151], v[52:55], v[112:115], a[148:151]
    v_add_f32 v12, v12, v66
    v_mfma_f32_16x16x32_bf16 a[212:215], v[52:55], v[120:123], a[212:215]
    global_load_lds_dwordx4 v5, s[60:61] offset:1024 sc1
    v_mfma_f32_16x16x32_bf16 a[208:211], v[48:51], v[120:123], a[208:211]
    s_waitcnt lgkmcnt(4)
    v_exp_f32 v68, v68
    v_mfma_f32_16x16x32_bf16 a[216:219], v[56:59], v[120:123], a[216:219]
    ds_read_b64_tr_b16 v[40:41], v3 offset:10240
    ds_read_b64_tr_b16 v[42:43], v3 offset:10496
    v_mfma_f32_16x16x32_bf16 a[220:223], v[60:63], v[120:123], a[220:223]
    v_add_f32 v12, v12, v67
    v_mfma_f32_16x16x32_bf16 a[156:159], v[60:63], v[112:115], a[156:159]
    global_load_lds_dwordx4 v5, s[60:61] offset:2048 sc1
    v_mfma_f32_16x16x32_bf16 a[152:155], v[56:59], v[112:115], a[152:155]
    v_cvt_pk_bf16_f32 v65, v66, v67
    v_mfma_f32_16x16x32_bf16 v[216:219], v[56:59], v[104:107], v[216:219]
    ds_read_b64_tr_b16 v[44:45], v3 offset:11264
    ds_read_b64_tr_b16 v[46:47], v3 offset:11520
    v_mfma_f32_16x16x32_bf16 v[220:223], v[60:63], v[104:107], v[220:223]
    v_exp_f32 v69, v69
    v_mfma_f32_16x16x32_bf16 v[156:159], v[60:63], v[96:99], v[156:159]
    global_load_lds_dwordx4 v5, s[60:61] offset:3072 sc1
    v_mfma_f32_16x16x32_bf16 v[152:155], v[56:59], v[96:99], v[152:155]
    s_waitcnt lgkmcnt(4)
    s_add_u32 s60, s60, 16384
    s_addc_u32 s61, s61, 0
    v_add_f32 v12, v12, v68
    v_mfma_f32_16x16x32_bf16 v[160:163], v[32:35], v[96:99], v[160:163]
    ds_read_b64_tr_b16 v[48:49], v3 offset:12288
    ds_read_b64_tr_b16 v[50:51], v3 offset:12544
    v_mfma_f32_16x16x32_bf16 v[164:167], v[36:39], v[96:99], v[164:167]
    s_add_u32 m0, s57, 12288
    v_exp_f32 v70, v70
    v_mfma_f32_16x16x32_bf16 v[228:231], v[36:39], v[104:107], v[228:231]
    global_load_lds_dwordx4 v4, s[58:59] offset:-4096 sc1
    v_mfma_f32_16x16x32_bf16 v[224:227], v[32:35], v[104:107], v[224:227]
    v_mfma_f32_16x16x32_bf16 a[160:163], v[32:35], v[112:115], a[160:163]
    ds_read_b64_tr_b16 v[52:53], v3 offset:13312
    ds_read_b64_tr_b16 v[54:55], v3 offset:13568
    v_mfma_f32_16x16x32_bf16 a[164:167], v[36:39], v[112:115], a[164:167]
    v_add_f32 v12, v12, v69
    v_cvt_pk_bf16_f32 v66, v68, v69
    v_mfma_f32_16x16x32_bf16 a[228:231], v[36:39], v[120:123], a[228:231]
    global_load_lds_dwordx4 v4, s[58:59] offset:-3072 sc1
    v_mfma_f32_16x16x32_bf16 a[224:227], v[32:35], v[120:123], a[224:227]
    s_waitcnt lgkmcnt(4)
    v_exp_f32 v71, v71
    v_mfma_f32_16x16x32_bf16 a[232:235], v[40:43], v[120:123], a[232:235]
    ds_read_b64_tr_b16 v[56:57], v3 offset:14336
    ds_read_b64_tr_b16 v[58:59], v3 offset:14592
    v_mfma_f32_16x16x32_bf16 a[236:239], v[44:47], v[120:123], a[236:239]
    v_mfma_f32_16x16x32_bf16 a[172:175], v[44:47], v[112:115], a[172:175]
    global_load_lds_dwordx4 v4, s[58:59] offset:-2048 sc1
    v_mfma_f32_16x16x32_bf16 a[168:171], v[40:43], v[112:115], a[168:171]
    v_add_f32 v12, v12, v70
    v_mfma_f32_16x16x32_bf16 v[232:235], v[40:43], v[104:107], v[232:235]
    ds_read_b64_tr_b16 v[60:61], v3 offset:15360
    ds_read_b64_tr_b16 v[62:63], v3 offset:15616
    v_mfma_f32_16x16x32_bf16 v[236:239], v[44:47], v[104:107], v[236:239]
    v_exp_f32 v72, v72
    v_mfma_f32_16x16x32_bf16 v[172:175], v[44:47], v[96:99], v[172:175]
    global_load_lds_dwordx4 v4, s[58:59] offset:-1024 sc1
    v_mfma_f32_16x16x32_bf16 v[168:171], v[40:43], v[96:99], v[168:171]
    s_waitcnt vmcnt(12) lgkmcnt(4)
    v_add_f32 v12, v12, v71
    v_mfma_f32_16x16x32_bf16 v[176:179], v[48:51], v[96:99], v[176:179]
    ds_read_b128 v[32:35], v2 offset:32768
    v_cvt_pk_bf16_f32 v67, v70, v71
    v_mfma_f32_16x16x32_bf16 v[180:183], v[52:55], v[96:99], v[180:183]
    ds_read_b128 v[36:39], v2 offset:34816
    v_mfma_f32_16x16x32_bf16 v[244:247], v[52:55], v[104:107], v[244:247]
    global_load_lds_dwordx4 v5, s[58:59] offset:0 sc1
    v_mfma_f32_16x16x32_bf16 v[240:243], v[48:51], v[104:107], v[240:243]
    v_exp_f32 v73, v73
    v_mfma_f32_16x16x32_bf16 a[176:179], v[48:51], v[112:115], a[176:179]
    ds_read_b128 v[40:43], v2 offset:36864
    v_mfma_f32_16x16x32_bf16 a[180:183], v[52:55], v[112:115], a[180:183]
    ds_read_b128 v[44:47], v2 offset:38912
    v_mfma_f32_16x16x32_bf16 a[244:247], v[52:55], v[120:123], a[244:247]
    global_load_lds_dwordx4 v5, s[58:59] offset:1024 sc1
    v_mfma_f32_16x16x32_bf16 a[240:243], v[48:51], v[120:123], a[240:243]
    s_waitcnt lgkmcnt(4)
    v_exp_f32 v74, v74
    v_mfma_f32_16x16x32_bf16 a[248:251], v[56:59], v[120:123], a[248:251]
    v_add_f32 v13, v72, v73
    v_cvt_pk_bf16_f32 v72, v72, v73
    v_mfma_f32_16x16x32_bf16 a[252:255], v[60:63], v[120:123], a[252:255]
    v_exp_f32 v75, v75
    v_mfma_f32_16x16x32_bf16 a[188:191], v[60:63], v[112:115], a[188:191]
    global_load_lds_dwordx4 v5, s[58:59] offset:2048 sc1
    v_mfma_f32_16x16x32_bf16 a[184:187], v[56:59], v[112:115], a[184:187]
    v_mfma_f32_16x16x32_bf16 v[248:251], v[56:59], v[104:107], v[248:251]
    v_add_f32 v13, v13, v74
    v_mfma_f32_16x16x32_bf16 v[252:255], v[60:63], v[104:107], v[252:255]
    v_exp_f32 v76, v76
    v_mfma_f32_16x16x32_bf16 v[188:191], v[60:63], v[96:99], v[188:191]
    global_load_lds_dwordx4 v5, s[58:59] offset:3072 sc1
    v_mfma_f32_16x16x32_bf16 v[184:187], v[56:59], v[96:99], v[184:187]
    s_waitcnt lgkmcnt(0)
    s_add_u32 s58, s58, 16384
    s_addc_u32 s59, s59, 0
    v_add_f32 v13, v13, v75
    v_mfma_f32_16x16x32_bf16 v[96:99], v[32:35], a[0:3], v[16:19]
    ds_read_b128 v[48:51], v2 offset:33024
    v_cvt_pk_bf16_f32 v73, v74, v75
    v_mfma_f32_16x16x32_bf16 v[96:99], v[36:39], a[4:7], v[96:99]
    ds_read_b128 v[52:55], v2 offset:35072
    v_mfma_f32_16x16x32_bf16 v[96:99], v[40:43], a[8:11], v[96:99]
    v_exp_f32 v77, v77
    v_mfma_f32_16x16x32_bf16 v[96:99], v[44:47], a[12:15], v[96:99]
    v_add_f32 v13, v13, v76
    v_mfma_f32_16x16x32_bf16 v[104:107], v[44:47], a[44:47], v[20:23]
    ds_read_b128 v[56:59], v2 offset:37120
    v_mfma_f32_16x16x32_bf16 v[104:107], v[40:43], a[40:43], v[104:107]
    ds_read_b128 v[60:63], v2 offset:39168
    v_mfma_f32_16x16x32_bf16 v[104:107], v[36:39], a[36:39], v[104:107]
    v_exp_f32 v78, v78
    v_mfma_f32_16x16x32_bf16 v[104:107], v[32:35], a[32:35], v[104:107]
    v_add_f32 v13, v13, v77
    v_cvt_pk_bf16_f32 v74, v76, v77
    v_mfma_f32_16x16x32_bf16 v[112:115], v[32:35], a[64:67], v[24:27]
    v_exp_f32 v79, v79
    v_mfma_f32_16x16x32_bf16 v[112:115], v[36:39], a[68:71], v[112:115]
    v_add_f32 v13, v13, v78
    v_mfma_f32_16x16x32_bf16 v[112:115], v[40:43], a[72:75], v[112:115]
    v_exp_f32 v80, v80
    v_mfma_f32_16x16x32_bf16 v[112:115], v[44:47], a[76:79], v[112:115]
    v_add_f32 v13, v13, v79
    v_mfma_f32_16x16x32_bf16 v[120:123], v[44:47], a[108:111], v[28:31]
    v_cvt_pk_bf16_f32 v75, v78, v79
    v_mfma_f32_16x16x32_bf16 v[120:123], v[40:43], a[104:107], v[120:123]
    v_exp_f32 v81, v81
    v_mfma_f32_16x16x32_bf16 v[120:123], v[36:39], a[100:103], v[120:123]
    v_exp_f32 v82, v82
    v_mfma_f32_16x16x32_bf16 v[120:123], v[32:35], a[96:99], v[120:123]
    s_waitcnt vmcnt(12) lgkmcnt(0)
    v_add_f32 v14, v80, v81
    v_mfma_f32_16x16x32_bf16 v[124:127], v[48:51], a[96:99], v[28:31]
    ds_read_b128 v[32:35], v2 offset:256
    v_mfma_f32_16x16x32_bf16 v[124:127], v[52:55], a[100:103], v[124:127]
    ds_read_b128 v[36:39], v2 offset:2304
    v_cvt_pk_bf16_f32 v80, v80, v81
    v_mfma_f32_16x16x32_bf16 v[124:127], v[56:59], a[104:107], v[124:127]
    v_exp_f32 v83, v83
    v_mfma_f32_16x16x32_bf16 v[124:127], v[60:63], a[108:111], v[124:127]
    s_waitcnt vmcnt(8)
    v_add_f32 v14, v14, v82
    v_mfma_f32_16x16x32_bf16 v[116:119], v[60:63], a[76:79], v[24:27]
    ds_read_b128 v[40:43], v2 offset:4352
    v_mfma_f32_16x16x32_bf16 v[116:119], v[56:59], a[72:75], v[116:119]
    ds_read_b128 v[44:47], v2 offset:6400
    v_mfma_f32_16x16x32_bf16 v[116:119], v[52:55], a[68:71], v[116:119]
    v_exp_f32 v84, v84
    v_mfma_f32_16x16x32_bf16 v[116:119], v[48:51], a[64:67], v[116:119]
    v_add_f32 v14, v14, v83
    v_cvt_pk_bf16_f32 v81, v82, v83
    v_mfma_f32_16x16x32_bf16 v[108:111], v[48:51], a[32:35], v[20:23]
    v_exp_f32 v85, v85
    v_mfma_f32_16x16x32_bf16 v[108:111], v[52:55], a[36:39], v[108:111]
    v_mfma_f32_16x16x32_bf16 v[108:111], v[56:59], a[40:43], v[108:111]
    v_add_f32 v14, v14, v84
    v_mfma_f32_16x16x32_bf16 v[108:111], v[60:63], a[44:47], v[108:111]
    v_exp_f32 v86, v86
    v_mfma_f32_16x16x32_bf16 v[100:103], v[60:63], a[12:15], v[16:19]
    v_add_f32 v14, v14, v85
    v_mfma_f32_16x16x32_bf16 v[100:103], v[56:59], a[8:11], v[100:103]
    v_cvt_pk_bf16_f32 v82, v84, v85
    v_mfma_f32_16x16x32_bf16 v[100:103], v[52:55], a[4:7], v[100:103]
    v_exp_f32 v87, v87
    v_mfma_f32_16x16x32_bf16 v[100:103], v[48:51], a[0:3], v[100:103]
    s_waitcnt lgkmcnt(0)
    v_add_f32 v14, v14, v86
    v_mfma_f32_16x16x32_bf16 v[100:103], v[32:35], a[16:19], v[100:103]
    ds_read_b128 v[48:51], v2 offset:0
    v_mfma_f32_16x16x32_bf16 v[100:103], v[36:39], a[20:23], v[100:103]
    ds_read_b128 v[52:55], v2 offset:2048
    v_mfma_f32_16x16x32_bf16 v[100:103], v[40:43], a[24:27], v[100:103]
    v_exp_f32 v88, v88
    v_mfma_f32_16x16x32_bf16 v[100:103], v[44:47], a[28:31], v[100:103]
    v_add_f32 v14, v14, v87
    v_cvt_pk_bf16_f32 v83, v86, v87
    v_mfma_f32_16x16x32_bf16 v[108:111], v[44:47], a[60:63], v[108:111]
    ds_read_b128 v[56:59], v2 offset:4096
    v_mfma_f32_16x16x32_bf16 v[108:111], v[40:43], a[56:59], v[108:111]
    ds_read_b128 v[60:63], v2 offset:6144
    v_mfma_f32_16x16x32_bf16 v[108:111], v[36:39], a[52:55], v[108:111]
    v_exp_f32 v89, v89
    v_mfma_f32_16x16x32_bf16 v[108:111], v[32:35], a[48:51], v[108:111]
    v_exp_f32 v90, v90
    v_mfma_f32_16x16x32_bf16 v[116:119], v[32:35], a[80:83], v[116:119]
    v_add_f32 v15, v88, v89
    v_cvt_pk_bf16_f32 v88, v88, v89
    v_mfma_f32_16x16x32_bf16 v[116:119], v[36:39], a[84:87], v[116:119]
    v_exp_f32 v91, v91
    v_mfma_f32_16x16x32_bf16 v[116:119], v[40:43], a[88:91], v[116:119]
    v_add_f32 v15, v15, v90
    v_mfma_f32_16x16x32_bf16 v[116:119], v[44:47], a[92:95], v[116:119]
    v_exp_f32 v92, v92
    v_mfma_f32_16x16x32_bf16 v[124:127], v[44:47], a[124:127], v[124:127]
    v_add_f32 v15, v15, v91
    v_mfma_f32_16x16x32_bf16 v[124:127], v[40:43], a[120:123], v[124:127]
    v_cvt_pk_bf16_f32 v89, v90, v91
    v_mfma_f32_16x16x32_bf16 v[124:127], v[36:39], a[116:119], v[124:127]
    v_exp_f32 v93, v93
    v_mfma_f32_16x16x32_bf16 v[124:127], v[32:35], a[112:115], v[124:127]
    s_waitcnt lgkmcnt(0)
    v_add_f32 v15, v15, v92
    v_mfma_f32_16x16x32_bf16 v[120:123], v[48:51], a[112:115], v[120:123]
    ds_read_b64_tr_b16 v[32:33], v3 offset:16384
    ds_read_b64_tr_b16 v[34:35], v3 offset:16640
    v_mfma_f32_16x16x32_bf16 v[120:123], v[52:55], a[116:119], v[120:123]
    v_exp_f32 v94, v94
    v_mfma_f32_16x16x32_bf16 v[120:123], v[56:59], a[120:123], v[120:123]
    v_mfma_f32_16x16x32_bf16 v[120:123], v[60:63], a[124:127], v[120:123]
    v_add_f32 v15, v15, v93
    v_cvt_pk_bf16_f32 v90, v92, v93
    v_mfma_f32_16x16x32_bf16 v[112:115], v[60:63], a[92:95], v[112:115]
    ds_read_b64_tr_b16 v[36:37], v3 offset:17408
    ds_read_b64_tr_b16 v[38:39], v3 offset:17664
    v_mfma_f32_16x16x32_bf16 v[112:115], v[56:59], a[88:91], v[112:115]
    v_exp_f32 v95, v95
    v_mfma_f32_16x16x32_bf16 v[112:115], v[52:55], a[84:87], v[112:115]
    v_mfma_f32_16x16x32_bf16 v[112:115], v[48:51], a[80:83], v[112:115]
    v_add_f32 v15, v15, v94
    v_max3_f32 v7, v12, v13, v14
    v_mfma_f32_16x16x32_bf16 v[104:107], v[48:51], a[48:51], v[104:107]
    ds_read_b64_tr_b16 v[40:41], v3 offset:18432
    ds_read_b64_tr_b16 v[42:43], v3 offset:18688
    v_mfma_f32_16x16x32_bf16 v[104:107], v[52:55], a[52:55], v[104:107]
    v_add_f32 v15, v15, v95
L_pk5:
    s_cbranch_execz L_pk8
    v_mfma_f32_16x16x32_bf16 v[104:107], v[56:59], a[56:59], v[104:107]
    v_cvt_pk_bf16_f32 v91, v94, v95
    v_mfma_f32_16x16x32_bf16 v[104:107], v[60:63], a[60:63], v[104:107]
    v_add_f32 v7, v7, v15
    v_cmp_nge_f32 vcc, s62, v7
    v_mfma_f32_16x16x32_bf16 v[96:99], v[60:63], a[28:31], v[96:99]
    ds_read_b64_tr_b16 v[44:45], v3 offset:19456
    ds_read_b64_tr_b16 v[46:47], v3 offset:19712
    v_mfma_f32_16x16x32_bf16 v[96:99], v[56:59], a[24:27], v[96:99]
    v_mfma_f32_16x16x32_bf16 v[96:99], v[52:55], a[20:23], v[96:99]
    v_mfma_f32_16x16x32_bf16 v[96:99], v[48:51], a[16:19], v[96:99]
    s_waitcnt lgkmcnt(4)
    s_cbranch_vccnz L_stub_i6
L_back_i6:
    v_mfma_f32_16x16x32_bf16 v[128:131], v[32:35], v[64:67], v[128:131]
    ds_read_b64_tr_b16 v[48:49], v3 offset:20480
    ds_read_b64_tr_b16 v[50:51], v3 offset:20736
    v_mfma_f32_16x16x32_bf16 v[132:135], v[36:39], v[64:67], v[132:135]
    s_add_u32 m0, s57, 20480
    v_add_f32 v8, v8, v12
    v_add_f32 v9, v9, v13
    v_mfma_f32_16x16x32_bf16 v[196:199], v[36:39], v[72:75], v[196:199]
    global_load_lds_dwordx4 v4, s[60:61] offset:-4096 sc1
    v_mfma_f32_16x16x32_bf16 v[192:195], v[32:35], v[72:75], v[192:195]
    v_add_f32 v10, v10, v14
    v_add_f32 v11, v11, v15
    v_mfma_f32_16x16x32_bf16 a[128:131], v[32:35], v[80:83], a[128:131]
    ds_read_b64_tr_b16 v[52:53], v3 offset:21504
    ds_read_b64_tr_b16 v[54:55], v3 offset:21760
    v_mfma_f32_16x16x32_bf16 a[132:135], v[36:39], v[80:83], a[132:135]
    v_mfma_f32_16x16x32_bf16 a[196:199], v[36:39], v[88:91], a[196:199]
    global_load_lds_dwordx4 v4, s[60:61] offset:-3072 sc1
    v_mfma_f32_16x16x32_bf16 a[192:195], v[32:35], v[88:91], a[192:195]
    s_waitcnt lgkmcnt(4)
    v_exp_f32 v96, v96
    v_mfma_f32_16x16x32_bf16 a[200:203], v[40:43], v[88:91], a[200:203]
    ds_read_b64_tr_b16 v[56:57], v3 offset:22528
    ds_read_b64_tr_b16 v[58:59], v3 offset:22784
    v_mfma_f32_16x16x32_bf16 a[204:207], v[44:47], v[88:91], a[204:207]
    v_exp_f32 v97, v97
    v_mfma_f32_16x16x32_bf16 a[140:143], v[44:47], v[80:83], a[140:143]
    global_load_lds_dwordx4 v4, s[60:61] offset:-2048 sc1
    v_mfma_f32_16x16x32_bf16 a[136:139], v[40:43], v[80:83], a[136:139]
    v_mfma_f32_16x16x32_bf16 v[200:203], v[40:43], v[72:75], v[200:203]
    ds_read_b64_tr_b16 v[60:61], v3 offset:23552
    ds_read_b64_tr_b16 v[62:63], v3 offset:23808
    v_mfma_f32_16x16x32_bf16 v[204:207], v[44:47], v[72:75], v[204:207]
    v_exp_f32 v98, v98
    v_mfma_f32_16x16x32_bf16 v[140:143], v[44:47], v[64:67], v[140:143]
    global_load_lds_dwordx4 v4, s[60:61] offset:-1024 sc1
    v_mfma_f32_16x16x32_bf16 v[136:139], v[40:43], v[64:67], v[136:139]
    s_waitcnt lgkmcnt(4)
    v_add_f32 v12, v96, v97
    v_mfma_f32_16x16x32_bf16 v[144:147], v[48:51], v[64:67], v[144:147]
    ds_read_b64_tr_b16 v[32:33], v3 offset:24576
    ds_read_b64_tr_b16 v[34:35], v3 offset:24832
    v_mfma_f32_16x16x32_bf16 v[148:151], v[52:55], v[64:67], v[148:151]
    v_cvt_pk_bf16_f32 v96, v96, v97
    v_mfma_f32_16x16x32_bf16 v[212:215], v[52:55], v[72:75], v[212:215]
    global_load_lds_dwordx4 v5, s[60:61] offset:0 sc1
    v_mfma_f32_16x16x32_bf16 v[208:211], v[48:51], v[72:75], v[208:211]
    v_exp_f32 v99, v99
    v_mfma_f32_16x16x32_bf16 a[144:147], v[48:51], v[80:83], a[144:147]
    ds_read_b64_tr_b16 v[36:37], v3 offset:25600
    ds_read_b64_tr_b16 v[38:39], v3 offset:25856
    v_mfma_f32_16x16x32_bf16 a[148:151], v[52:55], v[80:83], a[148:151]
    v_add_f32 v12, v12, v98
    v_mfma_f32_16x16x32_bf16 a[212:215], v[52:55], v[88:91], a[212:215]
    global_load_lds_dwordx4 v5, s[60:61] offset:1024 sc1
    v_mfma_f32_16x16x32_bf16 a[208:211], v[48:51], v[88:91], a[208:211]
    s_waitcnt lgkmcnt(4)
    v_exp_f32 v100, v100
    v_mfma_f32_16x16x32_bf16 a[216:219], v[56:59], v[88:91], a[216:219]
    ds_read_b64_tr_b16 v[40:41], v3 offset:26624
    ds_read_b64_tr_b16 v[42:43], v3 offset:26880
    v_mfma_f32_16x16x32_bf16 a[220:223], v[60:63], v[88:91], a[220:223]
    v_add_f32 v12, v12, v99
    v_mfma_f32_16x16x32_bf16 a[156:159], v[60:63], v[80:83], a[156:159]
    global_load_lds_dwordx4 v5, s[60:61] offset:2048 sc1
    v_mfma_f32_16x16x32_bf16 a[152:155], v[56:59], v[80:83], a[152:155]
    v_cvt_pk_bf16_f32 v97, v98, v99
    v_mfma_f32_16x16x32_bf16 v[216:219], v[56:59], v[72:75], v[216:219]
    ds_read_b64_tr_b16 v[44:45], v3 offset:27648
    ds_read_b64_tr_b16 v[46:47], v3 offset:27904
    v_mfma_f32_16x16x32_bf16 v[220:223], v[60:63], v[72:75], v[220:223]
    v_exp_f32 v101, v101
    v_mfma_f32_16x16x32_bf16 v[156:159], v[60:63], v[64:67], v[156:159]
    global_load_lds_dwordx4 v5, s[60:61] offset:3072 sc1
    v_mfma_f32_16x16x32_bf16 v[152:155], v[56:59], v[64:67], v[152:155]
    s_waitcnt lgkmcnt(4)
    s_add_u32 s60, s60, 16384
    s_addc_u32 s61, s61, 0
    v_add_f32 v12, v12, v100
    v_mfma_f32_16x16x32_bf16 v[160:163], v[32:35], v[64:67], v[160:163]
    ds_read_b64_tr_b16 v[48:49], v3 offset:28672
    ds_read_b64_tr_b16 v[50:51], v3 offset:28928
    v_mfma_f32_16x16x32_bf16 v[164:167], v[36:39], v[64:67], v[164:167]
    s_add_u32 m0, s57, 28672
    v_exp_f32 v102, v102
    v_mfma_f32_16x16x32_bf16 v[228:231], v[36:39], v[72:75], v[228:231]
    global_load_lds_dwordx4 v4, s[58:59] offset:-4096 sc1
    v_mfma_f32_16x16x32_bf16 v[224:227], v[32:35], v[72:75], v[224:227]
    v_mfma_f32_16x16x32_bf16 a[160:163], v[32:35], v[80:83], a[160:163]
    ds_read_b64_tr_b16 v[52:53], v3 offset:29696
    ds_read_b64_tr_b16 v[54:55], v3 offset:29952
    v_mfma_f32_16x16x32_bf16 a[164:167], v[36:39], v[80:83], a[164:167]
    v_add_f32 v12, v12, v101
    v_cvt_pk_bf16_f32 v98, v100, v101
    v_mfma_f32_16x16x32_bf16 a[228:231], v[36:39], v[88:91], a[228:231]
    global_load_lds_dwordx4 v4, s[58:59] offset:-3072 sc1
    v_mfma_f32_16x16x32_bf16 a[224:227], v[32:35], v[88:91], a[224:227]
    s_waitcnt lgkmcnt(4)
    v_exp_f32 v103, v103
    v_mfma_f32_16x16x32_bf16 a[232:235], v[40:43], v[88:91], a[232:235]
    ds_read_b64_tr_b16 v[56:57], v3 offset:30720
    ds_read_b64_tr_b16 v[58:59], v3 offset:30976
    v_mfma_f32_16x16x32_bf16 a[236:239], v[44:47], v[88:91], a[236:239]
    v_mfma_f32_16x16x32_bf16 a[172:175], v[44:47], v[80:83], a[172:175]
    global_load_lds_dwordx4 v4, s[58:59] offset:-2048 sc1
    v_mfma_f32_16x16x32_bf16 a[168:171], v[40:43], v[80:83], a[168:171]
    v_add_f32 v12, v12, v102
    v_mfma_f32_16x16x32_bf16 v[232:235], v[40:43], v[72:75], v[232:235]
    ds_read_b64_tr_b16 v[60:61], v3 offset:31744
    ds_read_b64_tr_b16 v[62:63], v3 offset:32000
    v_mfma_f32_16x16x32_bf16 v[236:239], v[44:47], v[72:75], v[236:239]
    v_exp_f32 v104, v104
    v_mfma_f32_16x16x32_bf16 v[172:175], v[44:47], v[64:67], v[172:175]
    global_load_lds_dwordx4 v4, s[58:59] offset:-1024 sc1
    v_mfma_f32_16x16x32_bf16 v[168:171], v[40:43], v[64:67], v[168:171]
    s_waitcnt vmcnt(12) lgkmcnt(4)
    v_add_f32 v12, v12, v103
    v_mfma_f32_16x16x32_bf16 v[176:179], v[48:51], v[64:67], v[176:179]
    ds_read_b128 v[32:35], v2 offset:8192
    v_cvt_pk_bf16_f32 v99, v102, v103
    v_mfma_f32_16x16x32_bf16 v[180:183], v[52:55], v[64:67], v[180:183]
    ds_read_b128 v[36:39], v2 offset:10240
    v_mfma_f32_16x16x32_bf16 v[244:247], v[52:55], v[72:75], v[244:247]
    global_load_lds_dwordx4 v5, s[58:59] offset:0 sc1
    v_mfma_f32_16x16x32_bf16 v[240:243], v[48:51], v[72:75], v[240:243]
    v_exp_f32 v105, v105
    v_mfma_f32_16x16x32_bf16 a[176:179], v[48:51], v[80:83], a[176:179]
    ds_read_b128 v[40:43], v2 offset:12288
    v_mfma_f32_16x16x32_bf16 a[180:183], v[52:55], v[80:83], a[180:183]
    ds_read_b128 v[44:47], v2 offset:14336
    v_mfma_f32_16x16x32_bf16 a[244:247], v[52:55], v[88:91], a[244:247]
    global_load_lds_dwordx4 v5, s[58:59] offset:1024 sc1
    v_mfma_f32_16x16x32_bf16 a[240:243], v[48:51], v[88:91], a[240:243]
    s_waitcnt lgkmcnt(4)
    v_exp_f32 v106, v106
    v_mfma_f32_16x16x32_bf16 a[248:251], v[56:59], v[88:91], a[248:251]
    v_add_f32 v13, v104, v105
    v_cvt_pk_bf16_f32 v104, v104, v105
    v_mfma_f32_16x16x32_bf16 a[252:255], v[60:63], v[88:91], a[252:255]
    v_exp_f32 v107, v107
    v_mfma_f32_16x16x32_bf16 a[188:191], v[60:63], v[80:83], a[188:191]
    global_load_lds_dwordx4 v5, s[58:59] offset:2048 sc1
    v_mfma_f32_16x16x32_bf16 a[184:187], v[56:59], v[80:83], a[184:187]
    v_mfma_f32_16x16x32_bf16 v[248:251], v[56:59], v[72:75], v[248:251]
    v_add_f32 v13, v13, v106
    v_mfma_f32_16x16x32_bf16 v[252:255], v[60:63], v[72:75], v[252:255]
    v_exp_f32 v108, v108
    v_mfma_f32_16x16x32_bf16 v[188:191], v[60:63], v[64:67], v[188:191]
    global_load_lds_dwordx4 v5, s[58:59] offset:3072 sc1
    v_mfma_f32_16x16x32_bf16 v[184:187], v[56:59], v[64:67], v[184:187]
    s_waitcnt lgkmcnt(0)
    s_add_u32 s58, s58, 16384
    s_addc_u32 s59, s59, 0
    v_add_f32 v13, v13, v107
    v_mfma_f32_16x16x32_bf16 v[64:67], v[32:35], a[0:3], v[16:19]
    ds_read_b128 v[48:51], v2 offset:8448
    v_cvt_pk_bf16_f32 v105, v106, v107
    v_mfma_f32_16x16x32_bf16 v[64:67], v[36:39], a[4:7], v[64:67]
    ds_read_b128 v[52:55], v2 offset:10496
    v_mfma_f32_16x16x32_bf16 v[64:67], v[40:43], a[8:11], v[64:67]
    v_exp_f32 v109, v109
    v_mfma_f32_16x16x32_bf16 v[64:67], v[44:47], a[12:15], v[64:67]
    v_add_f32 v13, v13, v108
    v_mfma_f32_16x16x32_bf16 v[72:75], v[44:47], a[44:47], v[20:23]
    ds_read_b128 v[56:59], v2 offset:12544
    v_mfma_f32_16x16x32_bf16 v[72:75], v[40:43], a[40:43], v[72:75]
    ds_read_b128 v[60:63], v2 offset:14592
    v_mfma_f32_16x16x32_bf16 v[72:75], v[36:39], a[36:39], v[72:75]
    v_exp_f32 v110, v110
    v_mfma_f32_16x16x32_bf16 v[72:75], v[32:35], a[32:35], v[72:75]
    v_add_f32 v13, v13, v109
    v_cvt_pk_bf16_f32 v106, v108, v109
    v_mfma_f32_16x16x32_bf16 v[80:83], v[32:35], a[64:67], v[24:27]
    v_exp_f32 v111, v111
    v_mfma_f32_16x16x32_bf16 v[80:83], v[36:39], a[68:71], v[80:83]
    v_add_f32 v13, v13, v110
    v_mfma_f32_16x16x32_bf16 v[80:83], v[40:43], a[72:75], v[80:83]
    v_exp_f32 v112, v112
    v_mfma_f32_16x16x32_bf16 v[80:83], v[44:47], a[76:79], v[80:83]
    v_add_f32 v13, v13, v111
    v_mfma_f32_16x16x32_bf16 v[88:91], v[44:47], a[108:111], v[28:31]
    v_cvt_pk_bf16_f32 v107, v110, v111
    v_mfma_f32_16x16x32_bf16 v[88:91], v[40:43], a[104:107], v[88:91]
    v_exp_f32 v113, v113
    v_mfma_f32_16x16x32_bf16 v[88:91], v[36:39], a[100:103], v[88:91]
    v_exp_f32 v114, v114
    v_mfma_f32_16x16x32_bf16 v[88:91], v[32:35], a[96:99], v[88:91]
    s_waitcnt vmcnt(12) lgkmcnt(0)
    v_add_f32 v14, v112, v113
    v_mfma_f32_16x16x32_bf16 v[92:95], v[48:51], a[96:99], v[28:31]
    ds_read_b128 v[32:35], v2 offset:16640
    v_mfma_f32_16x16x32_bf16 v[92:95], v[52:55], a[100:103], v[92:95]
    ds_read_b128 v[36:39], v2 offset:18688
    v_cvt_pk_bf16_f32 v112, v112, v113
    v_mfma_f32_16x16x32_bf16 v[92:95], v[56:59], a[104:107], v[92:95]
    v_exp_f32 v115, v115
    v_mfma_f32_16x16x32_bf16 v[92:95], v[60:63], a[108:111], v[92:95]
    s_waitcnt vmcnt(8)
    v_add_f32 v14, v14, v114
    v_mfma_f32_16x16x32_bf16 v[84:87], v[60:63], a[76:79], v[24:27]
    ds_read_b128 v[40:43], v2 offset:20736
    v_mfma_f32_16x16x32_bf16 v[84:87], v[56:59], a[72:75], v[84:87]
    ds_read_b128 v[44:47], v2 offset:22784
    v_mfma_f32_16x16x32_bf16 v[84:87], v[52:55], a[68:71], v[84:87]
    v_exp_f32 v116, v116
    v_mfma_f32_16x16x32_bf16 v[84:87], v[48:51], a[64:67], v[84:87]
    v_add_f32 v14, v14, v115
    v_cvt_pk_bf16_f32 v113, v114, v115
    v_mfma_f32_16x16x32_bf16 v[76:79], v[48:51], a[32:35], v[20:23]
    v_exp_f32 v117, v117
    v_mfma_f32_16x16x32_bf16 v[76:79], v[52:55], a[36:39], v[76:79]
    v_mfma_f32_16x16x32_bf16 v[76:79], v[56:59], a[40:43], v[76:79]
    v_add_f32 v14, v14, v116
    v_mfma_f32_16x16x32_bf16 v[76:79], v[60:63], a[44:47], v[76:79]
    v_exp_f32 v118, v118
    v_mfma_f32_16x16x32_bf16 v[68:71], v[60:63], a[12:15], v[16:19]
    v_add_f32 v14, v14, v117
    v_mfma_f32_16x16x32_bf16 v[68:71], v[56:59], a[8:11], v[68:71]
    v_cvt_pk_bf16_f32 v114, v116, v117
    v_mfma_f32_16x16x32_bf16 v[68:71], v[52:55], a[4:7], v[68:71]
    v_exp_f32 v119, v119
    v_mfma_f32_16x16x32_bf16 v[68:71], v[48:51], a[0:3], v[68:71]
    s_waitcnt lgkmcnt(0)
    v_add_f32 v14, v14, v118
    v_mfma_f32_16x16x32_bf16 v[68:71], v[32:35], a[16:19], v[68:71]
    ds_read_b128 v[48:51], v2 offset:16384
    v_mfma_f32_16x16x32_bf16 v[68:71], v[36:39], a[20:23], v[68:71]
    ds_read_b128 v[52:55], v2 offset:18432
    v_mfma_f32_16x16x32_bf16 v[68:71], v[40:43], a[24:27], v[68:71]
    v_exp_f32 v120, v120
    v_mfma_f32_16x16x32_bf16 v[68:71], v[44:47], a[28:31], v[68:71]
    v_add_f32 v14, v14, v119
    v_cvt_pk_bf16_f32 v115, v118, v119
    v_mfma_f32_16x16x32_bf16 v[76:79], v[44:47], a[60:63], v[76:79]
    ds_read_b128 v[56:59], v2 offset:20480
    v_mfma_f32_16x16x32_bf16 v[76:79], v[40:43], a[56:59], v[76:79]
    ds_read_b128 v[60:63], v2 offset:22528
    v_mfma_f32_16x16x32_bf16 v[76:79], v[36:39], a[52:55], v[76:79]
    v_exp_f32 v121, v121
    v_mfma_f32_16x16x32_bf16 v[76:79], v[32:35], a[48:51], v[76:79]
    v_exp_f32 v122, v122
    v_mfma_f32_16x16x32_bf16 v[84:87], v[32:35], a[80:83], v[84:87]
    v_add_f32 v15, v120, v121
    v_cvt_pk_bf16_f32 v120, v120, v121
    v_mfma_f32_16x16x32_bf16 v[84:87], v[36:39], a[84:87], v[84:87]
    v_exp_f32 v123, v123
    v_mfma_f32_16x16x32_bf16 v[84:87], v[40:43], a[88:91], v[84:87]
    v_add_f32 v15, v15, v122
    v_mfma_f32_16x16x32_bf16 v[84:87], v[44:47], a[92:95], v[84:87]
    v_exp_f32 v124, v124
    v_mfma_f32_16x16x32_bf16 v[92:95], v[44:47], a[124:127], v[92:95]
    v_add_f32 v15, v15, v123
    v_mfma_f32_16x16x32_bf16 v[92:95], v[40:43], a[120:123], v[92:95]
    v_cvt_pk_bf16_f32 v121, v122, v123
    v_mfma_f32_16x16x32_bf16 v[92:95], v[36:39], a[116:119], v[92:95]
    v_exp_f32 v125, v125
    v_mfma_f32_16x16x32_bf16 v[92:95], v[32:35], a[112:115], v[92:95]
    s_waitcnt lgkmcnt(0)
    v_add_f32 v15, v15, v124
    v_mfma_f32_16x16x32_bf16 v[88:91], v[48:51], a[112:115], v[88:91]
    ds_read_b64_tr_b16 v[32:33], v3 offset:32768
    ds_read_b64_tr_b16 v[34:35], v3 offset:33024
    v_mfma_f32_16x16x32_bf16 v[88:91], v[52:55], a[116:119], v[88:91]
    v_exp_f32 v126, v126
    v_mfma_f32_16x16x32_bf16 v[88:91], v[56:59], a[120:123], v[88:91]
    v_mfma_f32_16x16x32_bf16 v[88:91], v[60:63], a[124:127], v[88:91]
    v_add_f32 v15, v15, v125
    v_cvt_pk_bf16_f32 v122, v124, v125
    v_mfma_f32_16x16x32_bf16 v[80:83], v[60:63], a[92:95], v[80:83]
    ds_read_b64_tr_b16 v[36:37], v3 offset:33792
    ds_read_b64_tr_b16 v[38:39], v3 offset:34048
    v_mfma_f32_16x16x32_bf16 v[80:83], v[56:59], a[88:91], v[80:83]
    v_exp_f32 v127, v127
    v_mfma_f32_16x16x32_bf16 v[80:83], v[52:55], a[84:87], v[80:83]
    v_mfma_f32_16x16x32_bf16 v[80:83], v[48:51], a[80:83], v[80:83]
    v_add_f32 v15, v15, v126
    v_max3_f32 v7, v12, v13, v14
    v_mfma_f32_16x16x32_bf16 v[72:75], v[48:51], a[48:51], v[72:75]
    ds_read_b64_tr_b16 v[40:41], v3 offset:34816
    ds_read_b64_tr_b16 v[42:43], v3 offset:35072
    v_mfma_f32_16x16x32_bf16 v[72:75], v[52:55], a[52:55], v[72:75]
    v_add_f32 v15, v15, v127
    v_mfma_f32_16x16x32_bf16 v[72:75], v[56:59], a[56:59], v[72:75]
    v_cvt_pk_bf16_f32 v123, v126, v127
    v_mfma_f32_16x16x32_bf16 v[72:75], v[60:63], a[60:63], v[72:75]
    v_add_f32 v7, v7, v15
    v_cmp_nge_f32 vcc, s62, v7
    v_mfma_f32_16x16x32_bf16 v[64:67], v[60:63], a[28:31], v[64:67]
    ds_read_b64_tr_b16 v[44:45], v3 offset:35840
    ds_read_b64_tr_b16 v[46:47], v3 offset:36096
    v_mfma_f32_16x16x32_bf16 v[64:67], v[56:59], a[24:27], v[64:67]
    v_mfma_f32_16x16x32_bf16 v[64:67], v[52:55], a[20:23], v[64:67]
    v_mfma_f32_16x16x32_bf16 v[64:67], v[48:51], a[16:19], v[64:67]
    s_waitcnt lgkmcnt(4)
    s_cbranch_vccnz L_stub_i7
L_back_i7:
    v_mfma_f32_16x16x32_bf16 v[128:131], v[32:35], v[96:99], v[128:131]
    ds_read_b64_tr_b16 v[48:49], v3 offset:36864
    ds_read_b64_tr_b16 v[50:51], v3 offset:37120
    v_mfma_f32_16x16x32_bf16 v[132:135], v[36:39], v[96:99], v[132:135]
    s_add_u32 m0, s57, 36864
    v_add_f32 v8, v8, v12
    v_add_f32 v9, v9, v13
    v_mfma_f32_16x16x32_bf16 v[196:199], v[36:39], v[104:107], v[196:199]
    global_load_lds_dwordx4 v4, s[60:61] offset:-4096 sc1
    v_mfma_f32_16x16x32_bf16 v[192:195], v[32:35], v[104:107], v[192:195]
    v_add_f32 v10, v10, v14
    v_add_f32 v11, v11, v15
    v_mfma_f32_16x16x32_bf16 a[128:131], v[32:35], v[112:115], a[128:131]
    ds_read_b64_tr_b16 v[52:53], v3 offset:37888
    ds_read_b64_tr_b16 v[54:55], v3 offset:38144
    v_mfma_f32_16x16x32_bf16 a[132:135], v[36:39], v[112:115], a[132:135]
    v_mfma_f32_16x16x32_bf16 a[196:199], v[36:39], v[120:123], a[196:199]
    global_load_lds_dwordx4 v4, s[60:61] offset:-3072 sc1
    v_mfma_f32_16x16x32_bf16 a[192:195], v[32:35], v[120:123], a[192:195]
    s_waitcnt lgkmcnt(4)
    v_exp_f32 v64, v64
    v_mfma_f32_16x16x32_bf16 a[200:203], v[40:43], v[120:123], a[200:203]
    ds_read_b64_tr_b16 v[56:57], v3 offset:38912
    ds_read_b64_tr_b16 v[58:59], v3 offset:39168
    v_mfma_f32_16x16x32_bf16 a[204:207], v[44:47], v[120:123], a[204:207]
    v_exp_f32 v65, v65
    v_mfma_f32_16x16x32_bf16 a[140:143], v[44:47], v[112:115], a[140:143]
    global_load_lds_dwordx4 v4, s[60:61] offset:-2048 sc1
    v_mfma_f32_16x16x32_bf16 a[136:139], v[40:43], v[112:115], a[136:139]
    v_mfma_f32_16x16x32_bf16 v[200:203], v[40:43], v[104:107], v[200:203]
    ds_read_b64_tr_b16 v[60:61], v3 offset:39936
    ds_read_b64_tr_b16 v[62:63], v3 offset:40192
    v_mfma_f32_16x16x32_bf16 v[204:207], v[44:47], v[104:107], v[204:207]
    v_exp_f32 v66, v66
    v_mfma_f32_16x16x32_bf16 v[140:143], v[44:47], v[96:99], v[140:143]
    global_load_lds_dwordx4 v4, s[60:61] offset:-1024 sc1
    v_mfma_f32_16x16x32_bf16 v[136:139], v[40:43], v[96:99], v[136:139]
    s_waitcnt lgkmcnt(4)
    v_add_f32 v12, v64, v65
    v_mfma_f32_16x16x32_bf16 v[144:147], v[48:51], v[96:99], v[144:147]
    ds_read_b64_tr_b16 v[32:33], v3 offset:0
    ds_read_b64_tr_b16 v[34:35], v3 offset:256
    v_mfma_f32_16x16x32_bf16 v[148:151], v[52:55], v[96:99], v[148:151]
    v_cvt_pk_bf16_f32 v64, v64, v65
    v_mfma_f32_16x16x32_bf16 v[212:215], v[52:55], v[104:107], v[212:215]
    global_load_lds_dwordx4 v5, s[60:61] offset:0 sc1
    v_mfma_f32_16x16x32_bf16 v[208:211], v[48:51], v[104:107], v[208:211]
    v_exp_f32 v67, v67
    v_mfma_f32_16x16x32_bf16 a[144:147], v[48:51], v[112:115], a[144:147]
    ds_read_b64_tr_b16 v[36:37], v3 offset:1024
    ds_read_b64_tr_b16 v[38:39], v3 offset:1280
    v_mfma_f32_16x16x32_bf16 a[148:151], v[52:55], v[112:115], a[148:151]
    v_add_f32 v12, v12, v66
    v_mfma_f32_16x16x32_bf16 a[212:215], v[52:55], v[120:123], a[212:215]
    global_load_lds_dwordx4 v5, s[60:61] offset:1024 sc1
    v_mfma_f32_16x16x32_bf16 a[208:211], v[48:51], v[120:123], a[208:211]
    s_waitcnt lgkmcnt(4)
    v_exp_f32 v68, v68
    v_mfma_f32_16x16x32_bf16 a[216:219], v[56:59], v[120:123], a[216:219]
    ds_read_b64_tr_b16 v[40:41], v3 offset:2048
    ds_read_b64_tr_b16 v[42:43], v3 offset:2304
    v_mfma_f32_16x16x32_bf16 a[220:223], v[60:63], v[120:123], a[220:223]
    v_add_f32 v12, v12, v67
    v_mfma_f32_16x16x32_bf16 a[156:159], v[60:63], v[112:115], a[156:159]
    global_load_lds_dwordx4 v5, s[60:61] offset:2048 sc1
    v_mfma_f32_16x16x32_bf16 a[152:155], v[56:59], v[112:115], a[152:155]
    v_cvt_pk_bf16_f32 v65, v66, v67
    v_mfma_f32_16x16x32_bf16 v[216:219], v[56:59], v[104:107], v[216:219]
    ds_read_b64_tr_b16 v[44:45], v3 offset:3072
    ds_read_b64_tr_b16 v[46:47], v3 offset:3328
    v_mfma_f32_16x16x32_bf16 v[220:223], v[60:63], v[104:107], v[220:223]
    v_exp_f32 v69, v69
    v_mfma_f32_16x16x32_bf16 v[156:159], v[60:63], v[96:99], v[156:159]
    global_load_lds_dwordx4 v5, s[60:61] offset:3072 sc1
    v_mfma_f32_16x16x32_bf16 v[152:155], v[56:59], v[96:99], v[152:155]
    s_waitcnt lgkmcnt(4)
    s_add_u32 s60, s60, 16384
    s_addc_u32 s61, s61, 0
    v_add_f32 v12, v12, v68
    v_mfma_f32_16x16x32_bf16 v[160:163], v[32:35], v[96:99], v[160:163]
    ds_read_b64_tr_b16 v[48:49], v3 offset:4096
    ds_read_b64_tr_b16 v[50:51], v3 offset:4352
    v_mfma_f32_16x16x32_bf16 v[164:167], v[36:39], v[96:99], v[164:167]
    s_add_u32 m0, s57, 4096
    v_exp_f32 v70, v70
    v_mfma_f32_16x16x32_bf16 v[228:231], v[36:39], v[104:107], v[228:231]
    global_load_lds_dwordx4 v4, s[58:59] offset:-4096 sc1
    v_mfma_f32_16x16x32_bf16 v[224:227], v[32:35], v[104:107], v[224:227]
    v_mfma_f32_16x16x32_bf16 a[160:163], v[32:35], v[112:115], a[160:163]
    ds_read_b64_tr_b16 v[52:53], v3 offset:5120
    ds_read_b64_tr_b16 v[54:55], v3 offset:5376
    v_mfma_f32_16x16x32_bf16 a[164:167], v[36:39], v[112:115], a[164:167]
    v_add_f32 v12, v12, v69
    v_cvt_pk_bf16_f32 v66, v68, v69
    v_mfma_f32_16x16x32_bf16 a[228:231], v[36:39], v[120:123], a[228:231]
    global_load_lds_dwordx4 v4, s[58:59] offset:-3072 sc1
    v_mfma_f32_16x16x32_bf16 a[224:227], v[32:35], v[120:123], a[224:227]
    s_waitcnt lgkmcnt(4)
    v_exp_f32 v71, v71
    v_mfma_f32_16x16x32_bf16 a[232:235], v[40:43], v[120:123], a[232:235]
    ds_read_b64_tr_b16 v[56:57], v3 offset:6144
    ds_read_b64_tr_b16 v[58:59], v3 offset:6400
    v_mfma_f32_16x16x32_bf16 a[236:239], v[44:47], v[120:123], a[236:239]
    v_mfma_f32_16x16x32_bf16 a[172:175], v[44:47], v[112:115], a[172:175]
    global_load_lds_dwordx4 v4, s[58:59] offset:-2048 sc1
    v_mfma_f32_16x16x32_bf16 a[168:171], v[40:43], v[112:115], a[168:171]
    v_add_f32 v12, v12, v70
    v_mfma_f32_16x16x32_bf16 v[232:235], v[40:43], v[104:107], v[232:235]
    ds_read_b64_tr_b16 v[60:61], v3 offset:7168
    ds_read_b64_tr_b16 v[62:63], v3 offset:7424
    v_mfma_f32_16x16x32_bf16 v[236:239], v[44:47], v[104:107], v[236:239]
    v_exp_f32 v72, v72
    v_mfma_f32_16x16x32_bf16 v[172:175], v[44:47], v[96:99], v[172:175]
    global_load_lds_dwordx4 v4, s[58:59] offset:-1024 sc1
    v_mfma_f32_16x16x32_bf16 v[168:171], v[40:43], v[96:99], v[168:171]
    s_waitcnt vmcnt(12) lgkmcnt(4)
    v_add_f32 v12, v12, v71
    v_mfma_f32_16x16x32_bf16 v[176:179], v[48:51], v[96:99], v[176:179]
    ds_read_b128 v[32:35], v2 offset:24576
    v_cvt_pk_bf16_f32 v67, v70, v71
    v_mfma_f32_16x16x32_bf16 v[180:183], v[52:55], v[96:99], v[180:183]
    ds_read_b128 v[36:39], v2 offset:26624
    v_mfma_f32_16x16x32_bf16 v[244:247], v[52:55], v[104:107], v[244:247]
    global_load_lds_dwordx4 v5, s[58:59] offset:0 sc1
    v_mfma_f32_16x16x32_bf16 v[240:243], v[48:51], v[104:107], v[240:243]
    v_exp_f32 v73, v73
    v_mfma_f32_16x16x32_bf16 a[176:179], v[48:51], v[112:115], a[176:179]
    ds_read_b128 v[40:43], v2 offset:28672
    v_mfma_f32_16x16x32_bf16 a[180:183], v[52:55], v[112:115], a[180:183]
    ds_read_b128 v[44:47], v2 offset:30720
    v_mfma_f32_16x16x32_bf16 a[244:247], v[52:55], v[120:123], a[244:247]
    global_load_lds_dwordx4 v5, s[58:59] offset:1024 sc1
    v_mfma_f32_16x16x32_bf16 a[240:243], v[48:51], v[120:123], a[240:243]
    s_waitcnt lgkmcnt(4)
    v_exp_f32 v74, v74
    v_mfma_f32_16x16x32_bf16 a[248:251], v[56:59], v[120:123], a[248:251]
    v_add_f32 v13, v72, v73
    v_cvt_pk_bf16_f32 v72, v72, v73
    v_mfma_f32_16x16x32_bf16 a[252:255], v[60:63], v[120:123], a[252:255]
    v_exp_f32 v75, v75
    v_mfma_f32_16x16x32_bf16 a[188:191], v[60:63], v[112:115], a[188:191]
    global_load_lds_dwordx4 v5, s[58:59] offset:2048 sc1
    v_mfma_f32_16x16x32_bf16 a[184:187], v[56:59], v[112:115], a[184:187]
    v_mfma_f32_16x16x32_bf16 v[248:251], v[56:59], v[104:107], v[248:251]
    v_add_f32 v13, v13, v74
    v_mfma_f32_16x16x32_bf16 v[252:255], v[60:63], v[104:107], v[252:255]
    v_exp_f32 v76, v76
    v_mfma_f32_16x16x32_bf16 v[188:191], v[60:63], v[96:99], v[188:191]
    global_load_lds_dwordx4 v5, s[58:59] offset:3072 sc1
    v_mfma_f32_16x16x32_bf16 v[184:187], v[56:59], v[96:99], v[184:187]
    s_waitcnt lgkmcnt(0)
    s_add_u32 s58, s58, 16384
    s_addc_u32 s59, s59, 0
    v_add_f32 v13, v13, v75
    v_mfma_f32_16x16x32_bf16 v[96:99], v[32:35], a[0:3], v[16:19]
    ds_read_b128 v[48:51], v2 offset:24832
    v_cvt_pk_bf16_f32 v73, v74, v75
    v_mfma_f32_16x16x32_bf16 v[96:99], v[36:39], a[4:7], v[96:99]
    ds_read_b128 v[52:55], v2 offset:26880
    v_mfma_f32_16x16x32_bf16 v[96:99], v[40:43], a[8:11], v[96:99]
    v_exp_f32 v77, v77
    v_mfma_f32_16x16x32_bf16 v[96:99], v[44:47], a[12:15], v[96:99]
    v_add_f32 v13, v13, v76
    v_mfma_f32_16x16x32_bf16 v[104:107], v[44:47], a[44:47], v[20:23]
    ds_read_b128 v[56:59], v2 offset:28928
    v_mfma_f32_16x16x32_bf16 v[104:107], v[40:43], a[40:43], v[104:107]
    ds_read_b128 v[60:63], v2 offset:30976
    v_mfma_f32_16x16x32_bf16 v[104:107], v[36:39], a[36:39], v[104:107]
    v_exp_f32 v78, v78
    v_mfma_f32_16x16x32_bf16 v[104:107], v[32:35], a[32:35], v[104:107]
    v_add_f32 v13, v13, v77
    v_cvt_pk_bf16_f32 v74, v76, v77
    v_mfma_f32_16x16x32_bf16 v[112:115], v[32:35], a[64:67], v[24:27]
    v_exp_f32 v79, v79
    v_mfma_f32_16x16x32_bf16 v[112:115], v[36:39], a[68:71], v[112:115]
    v_add_f32 v13, v13, v78
    v_mfma_f32_16x16x32_bf16 v[112:115], v[40:43], a[72:75], v[112:115]
    v_exp_f32 v80, v80
    v_mfma_f32_16x16x32_bf16 v[112:115], v[44:47], a[76:79], v[112:115]
    v_add_f32 v13, v13, v79
    v_mfma_f32_16x16x32_bf16 v[120:123], v[44:47], a[108:111], v[28:31]
    v_cvt_pk_bf16_f32 v75, v78, v79
    v_mfma_f32_16x16x32_bf16 v[120:123], v[40:43], a[104:107], v[120:123]
    v_exp_f32 v81, v81
    v_mfma_f32_16x16x32_bf16 v[120:123], v[36:39], a[100:103], v[120:123]
    v_exp_f32 v82, v82
    v_mfma_f32_16x16x32_bf16 v[120:123], v[32:35], a[96:99], v[120:123]
    s_waitcnt vmcnt(12) lgkmcnt(0)
    v_add_f32 v14, v80, v81
    v_mfma_f32_16x16x32_bf16 v[124:127], v[48:51], a[96:99], v[28:31]
    ds_read_b128 v[32:35], v2 offset:33024
    v_mfma_f32_16x16x32_bf16 v[124:127], v[52:55], a[100:103], v[124:127]
    ds_read_b128 v[36:39], v2 offset:35072
    v_cvt_pk_bf16_f32 v80, v80, v81
    v_mfma_f32_16x16x32_bf16 v[124:127], v[56:59], a[104:107], v[124:127]
    v_exp_f32 v83, v83
    v_mfma_f32_16x16x32_bf16 v[124:127], v[60:63], a[108:111], v[124:127]
    s_waitcnt vmcnt(8)
    v_add_f32 v14, v14, v82
    v_mfma_f32_16x16x32_bf16 v[116:119], v[60:63], a[76:79], v[24:27]
    ds_read_b128 v[40:43], v2 offset:37120
    v_mfma_f32_16x16x32_bf16 v[116:119], v[56:59], a[72:75], v[116:119]
    ds_read_b128 v[44:47], v2 offset:39168
    v_mfma_f32_16x16x32_bf16 v[116:119], v[52:55], a[68:71], v[116:119]
    v_exp_f32 v84, v84
    v_mfma_f32_16x16x32_bf16 v[116:119], v[48:51], a[64:67], v[116:119]
    v_add_f32 v14, v14, v83
    v_cvt_pk_bf16_f32 v81, v82, v83
    v_mfma_f32_16x16x32_bf16 v[108:111], v[48:51], a[32:35], v[20:23]
    v_exp_f32 v85, v85
    v_mfma_f32_16x16x32_bf16 v[108:111], v[52:55], a[36:39], v[108:111]
    v_mfma_f32_16x16x32_bf16 v[108:111], v[56:59], a[40:43], v[108:111]
    v_add_f32 v14, v14, v84
    v_mfma_f32_16x16x32_bf16 v[108:111], v[60:63], a[44:47], v[108:111]
    v_exp_f32 v86, v86
    v_mfma_f32_16x16x32_bf16 v[100:103], v[60:63], a[12:15], v[16:19]
    v_add_f32 v14, v14, v85
    v_mfma_f32_16x16x32_bf16 v[100:103], v[56:59], a[8:11], v[100:103]
    v_cvt_pk_bf16_f32 v82, v84, v85
    v_mfma_f32_16x16x32_bf16 v[100:103], v[52:55], a[4:7], v[100:103]
    v_exp_f32 v87, v87
    v_mfma_f32_16x16x32_bf16 v[100:103], v[48:51], a[0:3], v[100:103]
    s_waitcnt lgkmcnt(0)
    v_add_f32 v14, v14, v86
    v_mfma_f32_16x16x32_bf16 v[100:103], v[32:35], a[16:19], v[100:103]
    ds_read_b128 v[48:51], v2 offset:32768
    v_mfma_f32_16x16x32_bf16 v[100:103], v[36:39], a[20:23], v[100:103]
    ds_read_b128 v[52:55], v2 offset:34816
    v_mfma_f32_16x16x32_bf16 v[100:103], v[40:43], a[24:27], v[100:103]
    v_exp_f32 v88, v88
    v_mfma_f32_16x16x32_bf16 v[100:103], v[44:47], a[28:31], v[100:103]
    v_add_f32 v14, v14, v87
    v_cvt_pk_bf16_f32 v83, v86, v87
    v_mfma_f32_16x16x32_bf16 v[108:111], v[44:47], a[60:63], v[108:111]
    ds_read_b128 v[56:59], v2 offset:36864
    v_mfma_f32_16x16x32_bf16 v[108:111], v[40:43], a[56:59], v[108:111]
    ds_read_b128 v[60:63], v2 offset:38912
    v_mfma_f32_16x16x32_bf16 v[108:111], v[36:39], a[52:55], v[108:111]
    v_exp_f32 v89, v89
    v_mfma_f32_16x16x32_bf16 v[108:111], v[32:35], a[48:51], v[108:111]
    v_exp_f32 v90, v90
    v_mfma_f32_16x16x32_bf16 v[116:119], v[32:35], a[80:83], v[116:119]
    v_add_f32 v15, v88, v89
    v_cvt_pk_bf16_f32 v88, v88, v89
    v_mfma_f32_16x16x32_bf16 v[116:119], v[36:39], a[84:87], v[116:119]
    v_exp_f32 v91, v91
    v_mfma_f32_16x16x32_bf16 v[116:119], v[40:43], a[88:91], v[116:119]
    v_add_f32 v15, v15, v90
    v_mfma_f32_16x16x32_bf16 v[116:119], v[44:47], a[92:95], v[116:119]
    v_exp_f32 v92, v92
    v_mfma_f32_16x16x32_bf16 v[124:127], v[44:47], a[124:127], v[124:127]
    v_add_f32 v15, v15, v91
    v_mfma_f32_16x16x32_bf16 v[124:127], v[40:43], a[120:123], v[124:127]
    v_cvt_pk_bf16_f32 v89, v90, v91
    v_mfma_f32_16x16x32_bf16 v[124:127], v[36:39], a[116:119], v[124:127]
    v_exp_f32 v93, v93
    v_mfma_f32_16x16x32_bf16 v[124:127], v[32:35], a[112:115], v[124:127]
    s_waitcnt lgkmcnt(0)
    v_add_f32 v15, v15, v92
    v_mfma_f32_16x16x32_bf16 v[120:123], v[48:51], a[112:115], v[120:123]
    ds_read_b64_tr_b16 v[32:33], v3 offset:8192
    ds_read_b64_tr_b16 v[34:35], v3 offset:8448
    v_mfma_f32_16x16x32_bf16 v[120:123], v[52:55], a[116:119], v[120:123]
    v_exp_f32 v94, v94
    v_mfma_f32_16x16x32_bf16 v[120:123], v[56:59], a[120:123], v[120:123]
    v_mfma_f32_16x16x32_bf16 v[120:123], v[60:63], a[124:127], v[120:123]
    v_add_f32 v15, v15, v93
    v_cvt_pk_bf16_f32 v90, v92, v93
    v_mfma_f32_16x16x32_bf16 v[112:115], v[60:63], a[92:95], v[112:115]
    ds_read_b64_tr_b16 v[36:37], v3 offset:9216
    ds_read_b64_tr_b16 v[38:39], v3 offset:9472
    v_mfma_f32_16x16x32_bf16 v[112:115], v[56:59], a[88:91], v[112:115]
    v_exp_f32 v95, v95
    v_mfma_f32_16x16x32_bf16 v[112:115], v[52:55], a[84:87], v[112:115]
    v_mfma_f32_16x16x32_bf16 v[112:115], v[48:51], a[80:83], v[112:115]
    v_add_f32 v15, v15, v94
    v_max3_f32 v7, v12, v13, v14
    v_mfma_f32_16x16x32_bf16 v[104:107], v[48:51], a[48:51], v[104:107]
    ds_read_b64_tr_b16 v[40:41], v3 offset:10240
    ds_read_b64_tr_b16 v[42:43], v3 offset:10496
    v_mfma_f32_16x16x32_bf16 v[104:107], v[52:55], a[52:55], v[104:107]
    v_add_f32 v15, v15, v95
L_pk6:
    s_cbranch_execz L_pkdone
    v_mfma_f32_16x16x32_bf16 v[104:107], v[56:59], a[56:59], v[104:107]
    v_cvt_pk_bf16_f32 v91, v94, v95
    v_mfma_f32_16x16x32_bf16 v[104:107], v[60:63], a[60:63], v[104:107]
    v_add_f32 v7, v7, v15
    v_cmp_nge_f32 vcc, s62, v7
    v_mfma_f32_16x16x32_bf16 v[96:99], v[60:63], a[28:31], v[96:99]
    ds_read_b64_tr_b16 v[44:45], v3 offset:11264
    ds_read_b64_tr_b16 v[46:47], v3 offset:11520
    v_mfma_f32_16x16x32_bf16 v[96:99], v[56:59], a[24:27], v[96:99]
    v_mfma_f32_16x16x32_bf16 v[96:99], v[52:55], a[20:23], v[96:99]
    v_mfma_f32_16x16x32_bf16 v[96:99], v[48:51], a[16:19], v[96:99]
    s_waitcnt lgkmcnt(4)
    s_cbranch_vccnz L_stub_i8
L_back_i8:
    v_mfma_f32_16x16x32_bf16 v[128:131], v[32:35], v[64:67], v[128:131]
    ds_read_b64_tr_b16 v[48:49], v3 offset:12288
    ds_read_b64_tr_b16 v[50:51], v3 offset:12544
    v_mfma_f32_16x16x32_bf16 v[132:135], v[36:39], v[64:67], v[132:135]
    s_add_u32 m0, s57, 12288
    v_add_f32 v8, v8, v12
    v_add_f32 v9, v9, v13
    v_mfma_f32_16x16x32_bf16 v[196:199], v[36:39], v[72:75], v[196:199]
    global_load_lds_dwordx4 v4, s[60:61] offset:-4096 sc1
    v_mfma_f32_16x16x32_bf16 v[192:195], v[32:35], v[72:75], v[192:195]
    v_add_f32 v10, v10, v14
    v_add_f32 v11, v11, v15
    v_mfma_f32_16x16x32_bf16 a[128:131], v[32:35], v[80:83], a[128:131]
    ds_read_b64_tr_b16 v[52:53], v3 offset:13312
    ds_read_b64_tr_b16 v[54:55], v3 offset:13568
    v_mfma_f32_16x16x32_bf16 a[132:135], v[36:39], v[80:83], a[132:135]
    v_mfma_f32_16x16x32_bf16 a[196:199], v[36:39], v[88:91], a[196:199]
    global_load_lds_dwordx4 v4, s[60:61] offset:-3072 sc1
    v_mfma_f32_16x16x32_bf16 a[192:195], v[32:35], v[88:91], a[192:195]
    s_waitcnt lgkmcnt(4)
    v_exp_f32 v96, v96
    v_mfma_f32_16x16x32_bf16 a[200:203], v[40:43], v[88:91], a[200:203]
    ds_read_b64_tr_b16 v[56:57], v3 offset:14336
    ds_read_b64_tr_b16 v[58:59], v3 offset:14592
    v_mfma_f32_16x16x32_bf16 a[204:207], v[44:47], v[88:91], a[204:207]
    v_exp_f32 v97, v97
    v_mfma_f32_16x16x32_bf16 a[140:143], v[44:47], v[80:83], a[140:143]
    global_load_lds_dwordx4 v4, s[60:61] offset:-2048 sc1
    v_mfma_f32_16x16x32_bf16 a[136:139], v[40:43], v[80:83], a[136:139]
    v_mfma_f32_16x16x32_bf16 v[200:203], v[40:43], v[72:75], v[200:203]
    ds_read_b64_tr_b16 v[60:61], v3 offset:15360
    ds_read_b64_tr_b16 v[62:63], v3 offset:15616
    v_mfma_f32_16x16x32_bf16 v[204:207], v[44:47], v[72:75], v[204:207]
    v_exp_f32 v98, v98
    v_mfma_f32_16x16x32_bf16 v[140:143], v[44:47], v[64:67], v[140:143]
    global_load_lds_dwordx4 v4, s[60:61] offset:-1024 sc1
    v_mfma_f32_16x16x32_bf16 v[136:139], v[40:43], v[64:67], v[136:139]
    s_waitcnt lgkmcnt(4)
    v_add_f32 v12, v96, v97
    v_mfma_f32_16x16x32_bf16 v[144:147], v[48:51], v[64:67], v[144:147]
    ds_read_b64_tr_b16 v[32:33], v3 offset:16384
    ds_read_b64_tr_b16 v[34:35], v3 offset:16640
    v_mfma_f32_16x16x32_bf16 v[148:151], v[52:55], v[64:67], v[148:151]
    v_cvt_pk_bf16_f32 v96, v96, v97
    v_mfma_f32_16x16x32_bf16 v[212:215], v[52:55], v[72:75], v[212:215]
    global_load_lds_dwordx4 v5, s[60:61] offset:0 sc1
    v_mfma_f32_16x16x32_bf16 v[208:211], v[48:51], v[72:75], v[208:211]
    v_exp_f32 v99, v99
    v_mfma_f32_16x16x32_bf16 a[144:147], v[48:51], v[80:83], a[144:147]
    ds_read_b64_tr_b16 v[36:37], v3 offset:17408
    ds_read_b64_tr_b16 v[38:39], v3 offset:17664
    v_mfma_f32_16x16x32_bf16 a[148:151], v[52:55], v[80:83], a[148:151]
    v_add_f32 v12, v12, v98
    v_mfma_f32_16x16x32_bf16 a[212:215], v[52:55], v[88:91], a[212:215]
    global_load_lds_dwordx4 v5, s[60:61] offset:1024 sc1
    v_mfma_f32_16x16x32_bf16 a[208:211], v[48:51], v[88:91], a[208:211]
    s_waitcnt lgkmcnt(4)
    v_exp_f32 v100, v100
    v_mfma_f32_16x16x32_bf16 a[216:219], v[56:59], v[88:91], a[216:219]
    ds_read_b64_tr_b16 v[40:41], v3 offset:18432
    ds_read_b64_tr_b16 v[42:43], v3 offset:18688
    v_mfma_f32_16x16x32_bf16 a[220:223], v[60:63], v[88:91], a[220:223]
    v_add_f32 v12, v12, v99
    v_mfma_f32_16x16x32_bf16 a[156:159], v[60:63], v[80:83], a[156:159]
    global_load_lds_dwordx4 v5, s[60:61] offset:2048 sc1
    v_mfma_f32_16x16x32_bf16 a[152:155], v[56:59], v[80:83], a[152:155]
    v_cvt_pk_bf16_f32 v97, v98, v99
    v_mfma_f32_16x16x32_bf16 v[216:219], v[56:59], v[72:75], v[216:219]
    ds_read_b64_tr_b16 v[44:45], v3 offset:19456
    ds_read_b64_tr_b16 v[46:47], v3 offset:19712
    v_mfma_f32_16x16x32_bf16 v[220:223], v[60:63], v[72:75], v[220:223]
    v_exp_f32 v101, v101
    v_mfma_f32_16x16x32_bf16 v[156:159], v[60:63], v[64:67], v[156:159]
    global_load_lds_dwordx4 v5, s[60:61] offset:3072 sc1
    v_mfma_f32_16x16x32_bf16 v[152:155], v[56:59], v[64:67], v[152:155]
    s_waitcnt lgkmcnt(4)
    s_add_u32 s60, s60, 16384
    s_addc_u32 s61, s61, 0
    v_add_f32 v12, v12, v100
    v_mfma_f32_16x16x32_bf16 v[160:163], v[32:35], v[64:67], v[160:163]
    ds_read_b64_tr_b16 v[48:49], v3 offset:20480
    ds_read_b64_tr_b16 v[50:51], v3 offset:20736
    v_mfma_f32_16x16x32_bf16 v[164:167], v[36:39], v[64:67], v[164:167]
    s_add_u32 m0, s57, 20480
    v_exp_f32 v102, v102
    v_mfma_f32_16x16x32_bf16 v[228:231], v[36:39], v[72:75], v[228:231]
    global_load_lds_dwordx4 v4, s[58:59] offset:-4096 sc1
    v_mfma_f32_16x16x32_bf16 v[224:227], v[32:35], v[72:75], v[224:227]
    v_mfma_f32_16x16x32_bf16 a[160:163], v[32:35], v[80:83], a[160:163]
    ds_read_b64_tr_b16 v[52:53], v3 offset:21504
    ds_read_b64_tr_b16 v[54:55], v3 offset:21760
    v_mfma_f32_16x16x32_bf16 a[164:167], v[36:39], v[80:83], a[164:167]
    v_add_f32 v12, v12, v101
    v_cvt_pk_bf16_f32 v98, v100, v101
    v_mfma_f32_16x16x32_bf16 a[228:231], v[36:39], v[88:91], a[228:231]
    global_load_lds_dwordx4 v4, s[58:59] offset:-3072 sc1
    v_mfma_f32_16x16x32_bf16 a[224:227], v[32:35], v[88:91], a[224:227]
    s_waitcnt lgkmcnt(4)
    v_exp_f32 v103, v103
    v_mfma_f32_16x16x32_bf16 a[232:235], v[40:43], v[88:91], a[232:235]
    ds_read_b64_tr_b16 v[56:57], v3 offset:22528
    ds_read_b64_tr_b16 v[58:59], v3 offset:22784
    v_mfma_f32_16x16x32_bf16 a[236:239], v[44:47], v[88:91], a[236:239]
    v_mfma_f32_16x16x32_bf16 a[172:175], v[44:47], v[80:83], a[172:175]
    global_load_lds_dwordx4 v4, s[58:59] offset:-2048 sc1
    v_mfma_f32_16x16x32_bf16 a[168:171], v[40:43], v[80:83], a[168:171]
    v_add_f32 v12, v12, v102
    v_mfma_f32_16x16x32_bf16 v[232:235], v[40:43], v[72:75], v[232:235]
    ds_read_b64_tr_b16 v[60:61], v3 offset:23552
    ds_read_b64_tr_b16 v[62:63], v3 offset:23808
    v_mfma_f32_16x16x32_bf16 v[236:239], v[44:47], v[72:75], v[236:239]
    v_exp_f32 v104, v104
    v_mfma_f32_16x16x32_bf16 v[172:175], v[44:47], v[64:67], v[172:175]
    global_load_lds_dwordx4 v4, s[58:59] offset:-1024 sc1
    v_mfma_f32_16x16x32_bf16 v[168:171], v[40:43], v[64:67], v[168:171]
    s_waitcnt vmcnt(12) lgkmcnt(4)
    v_add_f32 v12, v12, v103
    v_mfma_f32_16x16x32_bf16 v[176:179], v[48:51], v[64:67], v[176:179]
    ds_read_b128 v[32:35], v2 offset:0
    v_cvt_pk_bf16_f32 v99, v102, v103
    v_mfma_f32_16x16x32_bf16 v[180:183], v[52:55], v[64:67], v[180:183]
    ds_read_b128 v[36:39], v2 offset:2048
    v_mfma_f32_16x16x32_bf16 v[244:247], v[52:55], v[72:75], v[244:247]
    global_load_lds_dwordx4 v5, s[58:59] offset:0 sc1
    v_mfma_f32_16x16x32_bf16 v[240:243], v[48:51], v[72:75], v[240:243]
    v_exp_f32 v105, v105
    v_mfma_f32_16x16x32_bf16 a[176:179], v[48:51], v[80:83], a[176:179]
    ds_read_b128 v[40:43], v2 offset:4096
    v_mfma_f32_16x16x32_bf16 a[180:183], v[52:55], v[80:83], a[180:183]
    ds_read_b128 v[44:47], v2 offset:6144
    v_mfma_f32_16x16x32_bf16 a[244:247], v[52:55], v[88:91], a[244:247]
    global_load_lds_dwordx4 v5, s[58:59] offset:1024 sc1
    v_mfma_f32_16x16x32_bf16 a[240:243], v[48:51], v[88:91], a[240:243]
    s_waitcnt lgkmcnt(4)
    v_exp_f32 v106, v106
    v_mfma_f32_16x16x32_bf16 a[248:251], v[56:59], v[88:91], a[248:251]
    v_add_f32 v13, v104, v105
    v_cvt_pk_bf16_f32 v104, v104, v105
    v_mfma_f32_16x16x32_bf16 a[252:255], v[60:63], v[88:91], a[252:255]
    v_exp_f32 v107, v107
    v_mfma_f32_16x16x32_bf16 a[188:191], v[60:63], v[80:83], a[188:191]
    global_load_lds_dwordx4 v5, s[58:59] offset:2048 sc1
    v_mfma_f32_16x16x32_bf16 a[184:187], v[56:59], v[80:83], a[184:187]
    v_mfma_f32_16x16x32_bf16 v[248:251], v[56:59], v[72:75], v[248:251]
    v_add_f32 v13, v13, v106
    v_mfma_f32_16x16x32_bf16 v[252:255], v[60:63], v[72:75], v[252:255]
    v_exp_f32 v108, v108
    v_mfma_f32_16x16x32_bf16 v[188:191], v[60:63], v[64:67], v[188:191]
    global_load_lds_dwordx4 v5, s[58:59] offset:3072 sc1
    v_mfma_f32_16x16x32_bf16 v[184:187], v[56:59], v[64:67], v[184:187]
    s_waitcnt lgkmcnt(0)
    s_add_u32 s58, s58, 16384
    s_addc_u32 s59, s59, 0
    v_add_f32 v13, v13, v107
    v_mfma_f32_16x16x32_bf16 v[64:67], v[32:35], a[0:3], v[16:19]
    ds_read_b128 v[48:51], v2 offset:256
    v_cvt_pk_bf16_f32 v105, v106, v107
    v_mfma_f32_16x16x32_bf16 v[64:67], v[36:39], a[4:7], v[64:67]
    ds_read_b128 v[52:55], v2 offset:2304
    v_mfma_f32_16x16x32_bf16 v[64:67], v[40:43], a[8:11], v[64:67]
    v_exp_f32 v109, v109
    v_mfma_f32_16x16x32_bf16 v[64:67], v[44:47], a[12:15], v[64:67]
    v_add_f32 v13, v13, v108
    v_mfma_f32_16x16x32_bf16 v[72:75], v[44:47], a[44:47], v[20:23]
    ds_read_b128 v[56:59], v2 offset:4352
    v_mfma_f32_16x16x32_bf16 v[72:75], v[40:43], a[40:43], v[72:75]
    ds_read_b128 v[60:63], v2 offset:6400
    v_mfma_f32_16x16x32_bf16 v[72:75], v[36:39], a[36:39], v[72:75]
    v_exp_f32 v110, v110
    v_mfma_f32_16x16x32_bf16 v[72:75], v[32:35], a[32:35], v[72:75]
    v_add_f32 v13, v13, v109
    v_cvt_pk_bf16_f32 v106, v108, v109
    v_mfma_f32_16x16x32_bf16 v[80:83], v[32:35], a[64:67], v[24:27]
    v_exp_f32 v111, v111
    v_mfma_f32_16x16x32_bf16 v[80:83], v[36:39], a[68:71], v[80:83]
    v_add_f32 v13, v13, v110
    v_mfma_f32_16x16x32_bf16 v[80:83], v[40:43], a[72:75], v[80:83]
    v_exp_f32 v112, v112
    v_mfma_f32_16x16x32_bf16 v[80:83], v[44:47], a[76:79], v[80:83]
    v_add_f32 v13, v13, v111
    v_mfma_f32_16x16x32_bf16 v[88:91], v[44:47], a[108:111], v[28:31]
    v_cvt_pk_bf16_f32 v107, v110, v111
    v_mfma_f32_16x16x32_bf16 v[88:91], v[40:43], a[104:107], v[88:91]
    v_exp_f32 v113, v113
    v_mfma_f32_16x16x32_bf16 v[88:91], v[36:39], a[100:103], v[88:91]
    v_exp_f32 v114, v114
    v_mfma_f32_16x16x32_bf16 v[88:91], v[32:35], a[96:99], v[88:91]
    s_waitcnt vmcnt(12) lgkmcnt(0)
    v_add_f32 v14, v112, v113
    v_mfma_f32_16x16x32_bf16 v[92:95], v[48:51], a[96:99], v[28:31]
    ds_read_b128 v[32:35], v2 offset:8448
    v_mfma_f32_16x16x32_bf16 v[92:95], v[52:55], a[100:103], v[92:95]
    ds_read_b128 v[36:39], v2 offset:10496
    v_cvt_pk_bf16_f32 v112, v112, v113
    v_mfma_f32_16x16x32_bf16 v[92:95], v[56:59], a[104:107], v[92:95]
    v_exp_f32 v115, v115
    v_mfma_f32_16x16x32_bf16 v[92:95], v[60:63], a[108:111], v[92:95]
    s_waitcnt vmcnt(8)
    v_add_f32 v14, v14, v114
    v_mfma_f32_16x16x32_bf16 v[84:87], v[60:63], a[76:79], v[24:27]
    ds_read_b128 v[40:43], v2 offset:12544
    v_mfma_f32_16x16x32_bf16 v[84:87], v[56:59], a[72:75], v[84:87]
    ds_read_b128 v[44:47], v2 offset:14592
    v_mfma_f32_16x16x32_bf16 v[84:87], v[52:55], a[68:71], v[84:87]
    v_exp_f32 v116, v116
    v_mfma_f32_16x16x32_bf16 v[84:87], v[48:51], a[64:67], v[84:87]
    v_add_f32 v14, v14, v115
    v_cvt_pk_bf16_f32 v113, v114, v115
    v_mfma_f32_16x16x32_bf16 v[76:79], v[48:51], a[32:35], v[20:23]
    v_exp_f32 v117, v117
    v_mfma_f32_16x16x32_bf16 v[76:79], v[52:55], a[36:39], v[76:79]
    v_mfma_f32_16x16x32_bf16 v[76:79], v[56:59], a[40:43], v[76:79]
    v_add_f32 v14, v14, v116
    v_mfma_f32_16x16x32_bf16 v[76:79], v[60:63], a[44:47], v[76:79]
    v_exp_f32 v118, v118
    v_mfma_f32_16x16x32_bf16 v[68:71], v[60:63], a[12:15], v[16:19]
    v_add_f32 v14, v14, v117
    v_mfma_f32_16x16x32_bf16 v[68:71], v[56:59], a[8:11], v[68:71]
    v_cvt_pk_bf16_f32 v114, v116, v117
    v_mfma_f32_16x16x32_bf16 v[68:71], v[52:55], a[4:7], v[68:71]
    v_exp_f32 v119, v119
    v_mfma_f32_16x16x32_bf16 v[68:71], v[48:51], a[0:3], v[68:71]
    s_waitcnt lgkmcnt(0)
    v_add_f32 v14, v14, v118
    v_mfma_f32_16x16x32_bf16 v[68:71], v[32:35], a[16:19], v[68:71]
    ds_read_b128 v[48:51], v2 offset:8192
    v_mfma_f32_16x16x32_bf16 v[68:71], v[36:39], a[20:23], v[68:71]
    ds_read_b128 v[52:55], v2 offset:10240
    v_mfma_f32_16x16x32_bf16 v[68:71], v[40:43], a[24:27], v[68:71]
    v_exp_f32 v120, v120
    v_mfma_f32_16x16x32_bf16 v[68:71], v[44:47], a[28:31], v[68:71]
    v_add_f32 v14, v14, v119
    v_cvt_pk_bf16_f32 v115, v118, v119
    v_mfma_f32_16x16x32_bf16 v[76:79], v[44:47], a[60:63], v[76:79]
    ds_read_b128 v[56:59], v2 offset:12288
    v_mfma_f32_16x16x32_bf16 v[76:79], v[40:43], a[56:59], v[76:79]
    ds_read_b128 v[60:63], v2 offset:14336
    v_mfma_f32_16x16x32_bf16 v[76:79], v[36:39], a[52:55], v[76:79]
    v_exp_f32 v121, v121
    v_mfma_f32_16x16x32_bf16 v[76:79], v[32:35], a[48:51], v[76:79]
    v_exp_f32 v122, v122
    v_mfma_f32_16x16x32_bf16 v[84:87], v[32:35], a[80:83], v[84:87]
    v_add_f32 v15, v120, v121
    v_cvt_pk_bf16_f32 v120, v120, v121
    v_mfma_f32_16x16x32_bf16 v[84:87], v[36:39], a[84:87], v[84:87]
    v_exp_f32 v123, v123
    v_mfma_f32_16x16x32_bf16 v[84:87], v[40:43], a[88:91], v[84:87]
    v_add_f32 v15, v15, v122
    v_mfma_f32_16x16x32_bf16 v[84:87], v[44:47], a[92:95], v[84:87]
    v_exp_f32 v124, v124
    v_mfma_f32_16x16x32_bf16 v[92:95], v[44:47], a[124:127], v[92:95]
    v_add_f32 v15, v15, v123
    v_mfma_f32_16x16x32_bf16 v[92:95], v[40:43], a[120:123], v[92:95]
    v_cvt_pk_bf16_f32 v121, v122, v123
    v_mfma_f32_16x16x32_bf16 v[92:95], v[36:39], a[116:119], v[92:95]
    v_exp_f32 v125, v125
    v_mfma_f32_16x16x32_bf16 v[92:95], v[32:35], a[112:115], v[92:95]
    s_waitcnt lgkmcnt(0)
    v_add_f32 v15, v15, v124
    v_mfma_f32_16x16x32_bf16 v[88:91], v[48:51], a[112:115], v[88:91]
    ds_read_b64_tr_b16 v[32:33], v3 offset:24576
    ds_read_b64_tr_b16 v[34:35], v3 offset:24832
    v_mfma_f32_16x16x32_bf16 v[88:91], v[52:55], a[116:119], v[88:91]
    v_exp_f32 v126, v126
    v_mfma_f32_16x16x32_bf16 v[88:91], v[56:59], a[120:123], v[88:91]
    v_mfma_f32_16x16x32_bf16 v[88:91], v[60:63], a[124:127], v[88:91]
    v_add_f32 v15, v15, v125
    v_cvt_pk_bf16_f32 v122, v124, v125
    v_mfma_f32_16x16x32_bf16 v[80:83], v[60:63], a[92:95], v[80:83]
    ds_read_b64_tr_b16 v[36:37], v3 offset:25600
    ds_read_b64_tr_b16 v[38:39], v3 offset:25856
    v_mfma_f32_16x16x32_bf16 v[80:83], v[56:59], a[88:91], v[80:83]
    v_exp_f32 v127, v127
    v_mfma_f32_16x16x32_bf16 v[80:83], v[52:55], a[84:87], v[80:83]
    v_mfma_f32_16x16x32_bf16 v[80:83], v[48:51], a[80:83], v[80:83]
    v_add_f32 v15, v15, v126
    v_max3_f32 v7, v12, v13, v14
    v_mfma_f32_16x16x32_bf16 v[72:75], v[48:51], a[48:51], v[72:75]
    ds_read_b64_tr_b16 v[40:41], v3 offset:26624
    ds_read_b64_tr_b16 v[42:43], v3 offset:26880
    v_mfma_f32_16x16x32_bf16 v[72:75], v[52:55], a[52:55], v[72:75]
    v_add_f32 v15, v15, v127
    v_mfma_f32_16x16x32_bf16 v[72:75], v[56:59], a[56:59], v[72:75]
    v_cvt_pk_bf16_f32 v123, v126, v127
    v_mfma_f32_16x16x32_bf16 v[72:75], v[60:63], a[60:63], v[72:75]
    v_add_f32 v7, v7, v15
    v_cmp_nge_f32 vcc, s62, v7
    v_mfma_f32_16x16x32_bf16 v[64:67], v[60:63], a[28:31], v[64:67]
    ds_read_b64_tr_b16 v[44:45], v3 offset:27648
    ds_read_b64_tr_b16 v[46:47], v3 offset:27904
    v_mfma_f32_16x16x32_bf16 v[64:67], v[56:59], a[24:27], v[64:67]
    v_mfma_f32_16x16x32_bf16 v[64:67], v[52:55], a[20:23], v[64:67]
    v_mfma_f32_16x16x32_bf16 v[64:67], v[48:51], a[16:19], v[64:67]
    s_waitcnt lgkmcnt(4)
    s_cbranch_vccnz L_stub_i9
L_back_i9:
    v_mfma_f32_16x16x32_bf16 v[128:131], v[32:35], v[96:99], v[128:131]
    ds_read_b64_tr_b16 v[48:49], v3 offset:28672
    ds_read_b64_tr_b16 v[50:51], v3 offset:28928
    v_mfma_f32_16x16x32_bf16 v[132:135], v[36:39], v[96:99], v[132:135]
    s_add_u32 m0, s57, 28672
    v_add_f32 v8, v8, v12
    v_add_f32 v9, v9, v13
    v_mfma_f32_16x16x32_bf16 v[196:199], v[36:39], v[104:107], v[196:199]
    global_load_lds_dwordx4 v4, s[60:61] offset:-4096 sc1
    v_mfma_f32_16x16x32_bf16 v[192:195], v[32:35], v[104:107], v[192:195]
    v_add_f32 v10, v10, v14
    v_add_f32 v11, v11, v15
    v_mfma_f32_16x16x32_bf16 a[128:131], v[32:35], v[112:115], a[128:131]
    ds_read_b64_tr_b16 v[52:53], v3 offset:29696
    ds_read_b64_tr_b16 v[54:55], v3 offset:29952
    v_mfma_f32_16x16x32_bf16 a[132:135], v[36:39], v[112:115], a[132:135]
    v_mfma_f32_16x16x32_bf16 a[196:199], v[36:39], v[120:123], a[196:199]
    global_load_lds_dwordx4 v4, s[60:61] offset:-3072 sc1
    v_mfma_f32_16x16x32_bf16 a[192:195], v[32:35], v[120:123], a[192:195]
    s_waitcnt lgkmcnt(4)
    v_exp_f32 v64, v64
    v_mfma_f32_16x16x32_bf16 a[200:203], v[40:43], v[120:123], a[200:203]
    ds_read_b64_tr_b16 v[56:57], v3 offset:30720
    ds_read_b64_tr_b16 v[58:59], v3 offset:30976
    v_mfma_f32_16x16x32_bf16 a[204:207], v[44:47], v[120:123], a[204:207]
    v_exp_f32 v65, v65
    v_mfma_f32_16x16x32_bf16 a[140:143], v[44:47], v[112:115], a[140:143]
    global_load_lds_dwordx4 v4, s[60:61] offset:-2048 sc1
    v_mfma_f32_16x16x32_bf16 a[136:139], v[40:43], v[112:115], a[136:139]
    v_mfma_f32_16x16x32_bf16 v[200:203], v[40:43], v[104:107], v[200:203]
    ds_read_b64_tr_b16 v[60:61], v3 offset:31744
    ds_read_b64_tr_b16 v[62:63], v3 offset:32000
    v_mfma_f32_16x16x32_bf16 v[204:207], v[44:47], v[104:107], v[204:207]
    v_exp_f32 v66, v66
    v_mfma_f32_16x16x32_bf16 v[140:143], v[44:47], v[96:99], v[140:143]
    global_load_lds_dwordx4 v4, s[60:61] offset:-1024 sc1
    v_mfma_f32_16x16x32_bf16 v[136:139], v[40:43], v[96:99], v[136:139]
    s_waitcnt lgkmcnt(4)
    v_add_f32 v12, v64, v65
    v_mfma_f32_16x16x32_bf16 v[144:147], v[48:51], v[96:99], v[144:147]
    ds_read_b64_tr_b16 v[32:33], v3 offset:32768
    ds_read_b64_tr_b16 v[34:35], v3 offset:33024
    v_mfma_f32_16x16x32_bf16 v[148:151], v[52:55], v[96:99], v[148:151]
    v_cvt_pk_bf16_f32 v64, v64, v65
    v_mfma_f32_16x16x32_bf16 v[212:215], v[52:55], v[104:107], v[212:215]
    global_load_lds_dwordx4 v5, s[60:61] offset:0 sc1
    v_mfma_f32_16x16x32_bf16 v[208:211], v[48:51], v[104:107], v[208:211]
    v_exp_f32 v67, v67
    v_mfma_f32_16x16x32_bf16 a[144:147], v[48:51], v[112:115], a[144:147]
    ds_read_b64_tr_b16 v[36:37], v3 offset:33792
    ds_read_b64_tr_b16 v[38:39], v3 offset:34048
    v_mfma_f32_16x16x32_bf16 a[148:151], v[52:55], v[112:115], a[148:151]
    v_add_f32 v12, v12, v66
    v_mfma_f32_16x16x32_bf16 a[212:215], v[52:55], v[120:123], a[212:215]
    global_load_lds_dwordx4 v5, s[60:61] offset:1024 sc1
    v_mfma_f32_16x16x32_bf16 a[208:211], v[48:51], v[120:123], a[208:211]
    s_waitcnt lgkmcnt(4)
    v_exp_f32 v68, v68
    v_mfma_f32_16x16x32_bf16 a[216:219], v[56:59], v[120:123], a[216:219]
    ds_read_b64_tr_b16 v[40:41], v3 offset:34816
    ds_read_b64_tr_b16 v[42:43], v3 offset:35072
    v_mfma_f32_16x16x32_bf16 a[220:223], v[60:63], v[120:123], a[220:223]
    v_add_f32 v12, v12, v67
    v_mfma_f32_16x16x32_bf16 a[156:159], v[60:63], v[112:115], a[156:159]
    global_load_lds_dwordx4 v5, s[60:61] offset:2048 sc1
    v_mfma_f32_16x16x32_bf16 a[152:155], v[56:59], v[112:115], a[152:155]
    v_cvt_pk_bf16_f32 v65, v66, v67
    v_mfma_f32_16x16x32_bf16 v[216:219], v[56:59], v[104:107], v[216:219]
    ds_read_b64_tr_b16 v[44:45], v3 offset:35840
    ds_read_b64_tr_b16 v[46:47], v3 offset:36096
    v_mfma_f32_16x16x32_bf16 v[220:223], v[60:63], v[104:107], v[220:223]
    v_exp_f32 v69, v69
    v_mfma_f32_16x16x32_bf16 v[156:159], v[60:63], v[96:99], v[156:159]
    global_load_lds_dwordx4 v5, s[60:61] offset:3072 sc1
    v_mfma_f32_16x16x32_bf16 v[152:155], v[56:59], v[96:99], v[152:155]
    s_waitcnt lgkmcnt(4)
    s_add_u32 s60, s60, 16384
    s_addc_u32 s61, s61, 0
    v_add_f32 v12, v12, v68
    v_mfma_f32_16x16x32_bf16 v[160:163], v[32:35], v[96:99], v[160:163]
    ds_read_b64_tr_b16 v[48:49], v3 offset:36864
    ds_read_b64_tr_b16 v[50:51], v3 offset:37120
    v_mfma_f32_16x16x32_bf16 v[164:167], v[36:39], v[96:99], v[164:167]
    s_add_u32 m0, s57, 36864
    v_exp_f32 v70, v70
    v_mfma_f32_16x16x32_bf16 v[228:231], v[36:39], v[104:107], v[228:231]
    global_load_lds_dwordx4 v4, s[58:59] offset:-4096 sc1
    v_mfma_f32_16x16x32_bf16 v[224:227], v[32:35], v[104:107], v[224:227]
    v_mfma_f32_16x16x32_bf16 a[160:163], v[32:35], v[112:115], a[160:163]
    ds_read_b64_tr_b16 v[52:53], v3 offset:37888
    ds_read_b64_tr_b16 v[54:55], v3 offset:38144
    v_mfma_f32_16x16x32_bf16 a[164:167], v[36:39], v[112:115], a[164:167]
    v_add_f32 v12, v12, v69
    v_cvt_pk_bf16_f32 v66, v68, v69
    v_mfma_f32_16x16x32_bf16 a[228:231], v[36:39], v[120:123], a[228:231]
    global_load_lds_dwordx4 v4, s[58:59] offset:-3072 sc1
    v_mfma_f32_16x16x32_bf16 a[224:227], v[32:35], v[120:123], a[224:227]
    s_waitcnt lgkmcnt(4)
    v_exp_f32 v71, v71
    v_mfma_f32_16x16x32_bf16 a[232:235], v[40:43], v[120:123], a[232:235]
    ds_read_b64_tr_b16 v[56:57], v3 offset:38912
    ds_read_b64_tr_b16 v[58:59], v3 offset:39168
    v_mfma_f32_16x16x32_bf16 a[236:239], v[44:47], v[120:123], a[236:239]
    v_mfma_f32_16x16x32_bf16 a[172:175], v[44:47], v[112:115], a[172:175]
    global_load_lds_dwordx4 v4, s[58:59] offset:-2048 sc1
    v_mfma_f32_16x16x32_bf16 a[168:171], v[40:43], v[112:115], a[168:171]
    v_add_f32 v12, v12, v70
    v_mfma_f32_16x16x32_bf16 v[232:235], v[40:43], v[104:107], v[232:235]
    ds_read_b64_tr_b16 v[60:61], v3 offset:39936
    ds_read_b64_tr_b16 v[62:63], v3 offset:40192
    v_mfma_f32_16x16x32_bf16 v[236:239], v[44:47], v[104:107], v[236:239]
    v_exp_f32 v72, v72
    v_mfma_f32_16x16x32_bf16 v[172:175], v[44:47], v[96:99], v[172:175]
    global_load_lds_dwordx4 v4, s[58:59] offset:-1024 sc1
    v_mfma_f32_16x16x32_bf16 v[168:171], v[40:43], v[96:99], v[168:171]
    s_waitcnt vmcnt(12) lgkmcnt(4)
    v_add_f32 v12, v12, v71
    v_mfma_f32_16x16x32_bf16 v[176:179], v[48:51], v[96:99], v[176:179]
    ds_read_b128 v[32:35], v2 offset:16384
    v_cvt_pk_bf16_f32 v67, v70, v71
    v_mfma_f32_16x16x32_bf16 v[180:183], v[52:55], v[96:99], v[180:183]
    ds_read_b128 v[36:39], v2 offset:18432
    v_mfma_f32_16x16x32_bf16 v[244:247], v[52:55], v[104:107], v[244:247]
    global_load_lds_dwordx4 v5, s[58:59] offset:0 sc1
    v_mfma_f32_16x16x32_bf16 v[240:243], v[48:51], v[104:107], v[240:243]
    v_exp_f32 v73, v73
    v_mfma_f32_16x16x32_bf16 a[176:179], v[48:51], v[112:115], a[176:179]
    ds_read_b128 v[40:43], v2 offset:20480
    v_mfma_f32_16x16x32_bf16 a[180:183], v[52:55], v[112:115], a[180:183]
    ds_read_b128 v[44:47], v2 offset:22528
    v_mfma_f32_16x16x32_bf16 a[244:247], v[52:55], v[120:123], a[244:247]
    global_load_lds_dwordx4 v5, s[58:59] offset:1024 sc1
    v_mfma_f32_16x16x32_bf16 a[240:243], v[48:51], v[120:123], a[240:243]
    s_waitcnt lgkmcnt(4)
    v_exp_f32 v74, v74
    v_mfma_f32_16x16x32_bf16 a[248:251], v[56:59], v[120:123], a[248:251]
    v_add_f32 v13, v72, v73
    v_cvt_pk_bf16_f32 v72, v72, v73
    v_mfma_f32_16x16x32_bf16 a[252:255], v[60:63], v[120:123], a[252:255]
    v_exp_f32 v75, v75
    v_mfma_f32_16x16x32_bf16 a[188:191], v[60:63], v[112:115], a[188:191]
    global_load_lds_dwordx4 v5, s[58:59] offset:2048 sc1
    v_mfma_f32_16x16x32_bf16 a[184:187], v[56:59], v[112:115], a[184:187]
    v_mfma_f32_16x16x32_bf16 v[248:251], v[56:59], v[104:107], v[248:251]
    v_add_f32 v13, v13, v74
    v_mfma_f32_16x16x32_bf16 v[252:255], v[60:63], v[104:107], v[252:255]
    v_exp_f32 v76, v76
    v_mfma_f32_16x16x32_bf16 v[188:191], v[60:63], v[96:99], v[188:191]
    global_load_lds_dwordx4 v5, s[58:59] offset:3072 sc1
    v_mfma_f32_16x16x32_bf16 v[184:187], v[56:59], v[96:99], v[184:187]
    s_waitcnt lgkmcnt(0)
    s_add_u32 s58, s58, 16384
    s_addc_u32 s59, s59, 0
    v_add_f32 v13, v13, v75
    v_mfma_f32_16x16x32_bf16 v[96:99], v[32:35], a[0:3], v[16:19]
    ds_read_b128 v[48:51], v2 offset:16640
    v_cvt_pk_bf16_f32 v73, v74, v75
    v_mfma_f32_16x16x32_bf16 v[96:99], v[36:39], a[4:7], v[96:99]
    ds_read_b128 v[52:55], v2 offset:18688
    v_mfma_f32_16x16x32_bf16 v[96:99], v[40:43], a[8:11], v[96:99]
    v_exp_f32 v77, v77
    v_mfma_f32_16x16x32_bf16 v[96:99], v[44:47], a[12:15], v[96:99]
    v_add_f32 v13, v13, v76
    v_mfma_f32_16x16x32_bf16 v[104:107], v[44:47], a[44:47], v[20:23]
    ds_read_b128 v[56:59], v2 offset:20736
    v_mfma_f32_16x16x32_bf16 v[104:107], v[40:43], a[40:43], v[104:107]
    ds_read_b128 v[60:63], v2 offset:22784
    v_mfma_f32_16x16x32_bf16 v[104:107], v[36:39], a[36:39], v[104:107]
    v_exp_f32 v78, v78
    v_mfma_f32_16x16x32_bf16 v[104:107], v[32:35], a[32:35], v[104:107]
    v_add_f32 v13, v13, v77
    v_cvt_pk_bf16_f32 v74, v76, v77
    v_mfma_f32_16x16x32_bf16 v[112:115], v[32:35], a[64:67], v[24:27]
    v_exp_f32 v79, v79
    v_mfma_f32_16x16x32_bf16 v[112:115], v[36:39], a[68:71], v[112:115]
    v_add_f32 v13, v13, v78
    v_mfma_f32_16x16x32_bf16 v[112:115], v[40:43], a[72:75], v[112:115]
    v_exp_f32 v80, v80
    v_mfma_f32_16x16x32_bf16 v[112:115], v[44:47], a[76:79], v[112:115]
    v_add_f32 v13, v13, v79
    v_mfma_f32_16x16x32_bf16 v[120:123], v[44:47], a[108:111], v[28:31]
    v_cvt_pk_bf16_f32 v75, v78, v79
    v_mfma_f32_16x16x32_bf16 v[120:123], v[40:43], a[104:107], v[120:123]
    v_exp_f32 v81, v81
    v_mfma_f32_16x16x32_bf16 v[120:123], v[36:39], a[100:103], v[120:123]
    v_exp_f32 v82, v82
    v_mfma_f32_16x16x32_bf16 v[120:123], v[32:35], a[96:99], v[120:123]
    s_waitcnt vmcnt(12) lgkmcnt(0)
    v_add_f32 v14, v80, v81
    v_mfma_f32_16x16x32_bf16 v[124:127], v[48:51], a[96:99], v[28:31]
    ds_read_b128 v[32:35], v2 offset:24832
    v_mfma_f32_16x16x32_bf16 v[124:127], v[52:55], a[100:103], v[124:127]
    ds_read_b128 v[36:39], v2 offset:26880
    v_cvt_pk_bf16_f32 v80, v80, v81
    v_mfma_f32_16x16x32_bf16 v[124:127], v[56:59], a[104:107], v[124:127]
    v_exp_f32 v83, v83
    v_mfma_f32_16x16x32_bf16 v[124:127], v[60:63], a[108:111], v[124:127]
    s_waitcnt vmcnt(8)
    v_add_f32 v14, v14, v82
    v_mfma_f32_16x16x32_bf16 v[116:119], v[60:63], a[76:79], v[24:27]
    ds_read_b128 v[40:43], v2 offset:28928
    v_mfma_f32_16x16x32_bf16 v[116:119], v[56:59], a[72:75], v[116:119]
    ds_read_b128 v[44:47], v2 offset:30976
    v_mfma_f32_16x16x32_bf16 v[116:119], v[52:55], a[68:71], v[116:119]
    v_exp_f32 v84, v84
    v_mfma_f32_16x16x32_bf16 v[116:119], v[48:51], a[64:67], v[116:119]
    v_add_f32 v14, v14, v83
    v_cvt_pk_bf16_f32 v81, v82, v83
    v_mfma_f32_16x16x32_bf16 v[108:111], v[48:51], a[32:35], v[20:23]
    v_exp_f32 v85, v85
    v_mfma_f32_16x16x32_bf16 v[108:111], v[52:55], a[36:39], v[108:111]
    v_mfma_f32_16x16x32_bf16 v[108:111], v[56:59], a[40:43], v[108:111]
    v_add_f32 v14, v14, v84
    v_mfma_f32_16x16x32_bf16 v[108:111], v[60:63], a[44:47], v[108:111]
    v_exp_f32 v86, v86
    v_mfma_f32_16x16x32_bf16 v[100:103], v[60:63], a[12:15], v[16:19]
    v_add_f32 v14, v14, v85
    v_mfma_f32_16x16x32_bf16 v[100:103], v[56:59], a[8:11], v[100:103]
    v_cvt_pk_bf16_f32 v82, v84, v85
    v_mfma_f32_16x16x32_bf16 v[100:103], v[52:55], a[4:7], v[100:103]
    v_exp_f32 v87, v87
    v_mfma_f32_16x16x32_bf16 v[100:103], v[48:51], a[0:3], v[100:103]
    s_waitcnt lgkmcnt(0)
    v_add_f32 v14, v14, v86
    v_mfma_f32_16x16x32_bf16 v[100:103], v[32:35], a[16:19], v[100:103]
    ds_read_b128 v[48:51], v2 offset:24576
    v_mfma_f32_16x16x32_bf16 v[100:103], v[36:39], a[20:23], v[100:103]
    ds_read_b128 v[52:55], v2 offset:26624
    v_mfma_f32_16x16x32_bf16 v[100:103], v[40:43], a[24:27], v[100:103]
    v_exp_f32 v88, v88
    v_mfma_f32_16x16x32_bf16 v[100:103], v[44:47], a[28:31], v[100:103]
    v_add_f32 v14, v14, v87
    v_cvt_pk_bf16_f32 v83, v86, v87
    v_mfma_f32_16x16x32_bf16 v[108:111], v[44:47], a[60:63], v[108:111]
    ds_read_b128 v[56:59], v2 offset:28672
    v_mfma_f32_16x16x32_bf16 v[108:111], v[40:43], a[56:59], v[108:111]
    ds_read_b128 v[60:63], v2 offset:30720
    v_mfma_f32_16x16x32_bf16 v[108:111], v[36:39], a[52:55], v[108:111]
    v_exp_f32 v89, v89
    v_mfma_f32_16x16x32_bf16 v[108:111], v[32:35], a[48:51], v[108:111]
    v_exp_f32 v90, v90
    v_mfma_f32_16x16x32_bf16 v[116:119], v[32:35], a[80:83], v[116:119]
    v_add_f32 v15, v88, v89
    v_cvt_pk_bf16_f32 v88, v88, v89
    v_mfma_f32_16x16x32_bf16 v[116:119], v[36:39], a[84:87], v[116:119]
    v_exp_f32 v91, v91
    v_mfma_f32_16x16x32_bf16 v[116:119], v[40:43], a[88:91], v[116:119]
    v_add_f32 v15, v15, v90
    v_mfma_f32_16x16x32_bf16 v[116:119], v[44:47], a[92:95], v[116:119]
    v_exp_f32 v92, v92
    v_mfma_f32_16x16x32_bf16 v[124:127], v[44:47], a[124:127], v[124:127]
    v_add_f32 v15, v15, v91
    v_mfma_f32_16x16x32_bf16 v[124:127], v[40:43], a[120:123], v[124:127]
    v_cvt_pk_bf16_f32 v89, v90, v91
    v_mfma_f32_16x16x32_bf16 v[124:127], v[36:39], a[116:119], v[124:127]
    v_exp_f32 v93, v93
    v_mfma_f32_16x16x32_bf16 v[124:127], v[32:35], a[112:115], v[124:127]
    s_waitcnt lgkmcnt(0)
    v_add_f32 v15, v15, v92
    v_mfma_f32_16x16x32_bf16 v[120:123], v[48:51], a[112:115], v[120:123]
    ds_read_b64_tr_b16 v[32:33], v3 offset:0
    ds_read_b64_tr_b16 v[34:35], v3 offset:256
    v_mfma_f32_16x16x32_bf16 v[120:123], v[52:55], a[116:119], v[120:123]
    v_exp_f32 v94, v94
    v_mfma_f32_16x16x32_bf16 v[120:123], v[56:59], a[120:123], v[120:123]
    v_mfma_f32_16x16x32_bf16 v[120:123], v[60:63], a[124:127], v[120:123]
    v_add_f32 v15, v15, v93
    v_cvt_pk_bf16_f32 v90, v92, v93
    v_mfma_f32_16x16x32_bf16 v[112:115], v[60:63], a[92:95], v[112:115]
    ds_read_b64_tr_b16 v[36:37], v3 offset:1024
    ds_read_b64_tr_b16 v[38:39], v3 offset:1280
    v_mfma_f32_16x16x32_bf16 v[112:115], v[56:59], a[88:91], v[112:115]
    v_exp_f32 v95, v95
    v_mfma_f32_16x16x32_bf16 v[112:115], v[52:55], a[84:87], v[112:115]
    v_mfma_f32_16x16x32_bf16 v[112:115], v[48:51], a[80:83], v[112:115]
    v_add_f32 v15, v15, v94
    v_max3_f32 v7, v12, v13, v14
    v_mfma_f32_16x16x32_bf16 v[104:107], v[48:51], a[48:51], v[104:107]
    ds_read_b64_tr_b16 v[40:41], v3 offset:2048
    ds_read_b64_tr_b16 v[42:43], v3 offset:2304
    v_mfma_f32_16x16x32_bf16 v[104:107], v[52:55], a[52:55], v[104:107]
    v_add_f32 v15, v15, v95
    v_mfma_f32_16x16x32_bf16 v[104:107], v[56:59], a[56:59], v[104:107]
    v_cvt_pk_bf16_f32 v91, v94, v95
    v_mfma_f32_16x16x32_bf16 v[104:107], v[60:63], a[60:63], v[104:107]
    v_add_f32 v7, v7, v15
    v_cmp_nge_f32 vcc, s62, v7
    v_mfma_f32_16x16x32_bf16 v[96:99], v[60:63], a[28:31], v[96:99]
    ds_read_b64_tr_b16 v[44:45], v3 offset:3072
    ds_read_b64_tr_b16 v[46:47], v3 offset:3328
    v_mfma_f32_16x16x32_bf16 v[96:99], v[56:59], a[24:27], v[96:99]
L_pk7:
    s_cbranch_execz L_pkdone
    v_mfma_f32_16x16x32_bf16 v[96:99], v[52:55], a[20:23], v[96:99]
    v_mfma_f32_16x16x32_bf16 v[96:99], v[48:51], a[16:19], v[96:99]
    s_waitcnt lgkmcnt(4)
    s_cbranch_vccnz L_stub_i10
L_back_i10:
    v_mfma_f32_16x16x32_bf16 v[128:131], v[32:35], v[64:67], v[128:131]
    ds_read_b64_tr_b16 v[48:49], v3 offset:4096
    ds_read_b64_tr_b16 v[50:51], v3 offset:4352
    v_mfma_f32_16x16x32_bf16 v[132:135], v[36:39], v[64:67], v[132:135]
    s_add_u32 m0, s57, 4096
    v_add_f32 v8, v8, v12
    v_add_f32 v9, v9, v13
    v_mfma_f32_16x16x32_bf16 v[196:199], v[36:39], v[72:75], v[196:199]
    global_load_lds_dwordx4 v4, s[60:61] offset:-4096 sc1
    v_mfma_f32_16x16x32_bf16 v[192:195], v[32:35], v[72:75], v[192:195]
    v_add_f32 v10, v10, v14
    v_add_f32 v11, v11, v15
    v_mfma_f32_16x16x32_bf16 a[128:131], v[32:35], v[80:83], a[128:131]
    ds_read_b64_tr_b16 v[52:53], v3 offset:5120
    ds_read_b64_tr_b16 v[54:55], v3 offset:5376
    v_mfma_f32_16x16x32_bf16 a[132:135], v[36:39], v[80:83], a[132:135]
    v_mfma_f32_16x16x32_bf16 a[196:199], v[36:39], v[88:91], a[196:199]
    global_load_lds_dwordx4 v4, s[60:61] offset:-3072 sc1
    v_mfma_f32_16x16x32_bf16 a[192:195], v[32:35], v[88:91], a[192:195]
    s_waitcnt lgkmcnt(4)
    v_exp_f32 v96, v96
    v_mfma_f32_16x16x32_bf16 a[200:203], v[40:43], v[88:91], a[200:203]
    ds_read_b64_tr_b16 v[56:57], v3 offset:6144
    ds_read_b64_tr_b16 v[58:59], v3 offset:6400
    v_mfma_f32_16x16x32_bf16 a[204:207], v[44:47], v[88:91], a[204:207]
    v_exp_f32 v97, v97
    v_mfma_f32_16x16x32_bf16 a[140:143], v[44:47], v[80:83], a[140:143]
    global_load_lds_dwordx4 v4, s[60:61] offset:-2048 sc1
    v_mfma_f32_16x16x32_bf16 a[136:139], v[40:43], v[80:83], a[136:139]
    v_mfma_f32_16x16x32_bf16 v[200:203], v[40:43], v[72:75], v[200:203]
    ds_read_b64_tr_b16 v[60:61], v3 offset:7168
    ds_read_b64_tr_b16 v[62:63], v3 offset:7424
    v_mfma_f32_16x16x32_bf16 v[204:207], v[44:47], v[72:75], v[204:207]
    v_exp_f32 v98, v98
    v_mfma_f32_16x16x32_bf16 v[140:143], v[44:47], v[64:67], v[140:143]
    global_load_lds_dwordx4 v4, s[60:61] offset:-1024 sc1
    v_mfma_f32_16x16x32_bf16 v[136:139], v[40:43], v[64:67], v[136:139]
    s_waitcnt lgkmcnt(4)
    v_add_f32 v12, v96, v97
    v_mfma_f32_16x16x32_bf16 v[144:147], v[48:51], v[64:67], v[144:147]
    ds_read_b64_tr_b16 v[32:33], v3 offset:8192
    ds_read_b64_tr_b16 v[34:35], v3 offset:8448
    v_mfma_f32_16x16x32_bf16 v[148:151], v[52:55], v[64:67], v[148:151]
    v_cvt_pk_bf16_f32 v96, v96, v97
    v_mfma_f32_16x16x32_bf16 v[212:215], v[52:55], v[72:75], v[212:215]
    global_load_lds_dwordx4 v5, s[60:61] offset:0 sc1
    v_mfma_f32_16x16x32_bf16 v[208:211], v[48:51], v[72:75], v[208:211]
    v_exp_f32 v99, v99
    v_mfma_f32_16x16x32_bf16 a[144:147], v[48:51], v[80:83], a[144:147]
    ds_read_b64_tr_b16 v[36:37], v3 offset:9216
    ds_read_b64_tr_b16 v[38:39], v3 offset:9472
    v_mfma_f32_16x16x32_bf16 a[148:151], v[52:55], v[80:83], a[148:151]
    v_add_f32 v12, v12, v98
    v_mfma_f32_16x16x32_bf16 a[212:215], v[52:55], v[88:91], a[212:215]
    global_load_lds_dwordx4 v5, s[60:61] offset:1024 sc1
    v_mfma_f32_16x16x32_bf16 a[208:211], v[48:51], v[88:91], a[208:211]
    s_waitcnt lgkmcnt(4)
    v_exp_f32 v100, v100
    v_mfma_f32_16x16x32_bf16 a[216:219], v[56:59], v[88:91], a[216:219]
    ds_read_b64_tr_b16 v[40:41], v3 offset:10240
    ds_read_b64_tr_b16 v[42:43], v3 offset:10496
    v_mfma_f32_16x16x32_bf16 a[220:223], v[60:63], v[88:91], a[220:223]
    v_add_f32 v12, v12, v99
    v_mfma_f32_16x16x32_bf16 a[156:159], v[60:63], v[80:83], a[156:159]
    global_load_lds_dwordx4 v5, s[60:61] offset:2048 sc1
    v_mfma_f32_16x16x32_bf16 a[152:155], v[56:59], v[80:83], a[152:155]
    v_cvt_pk_bf16_f32 v97, v98, v99
    v_mfma_f32_16x16x32_bf16 v[216:219], v[56:59], v[72:75], v[216:219]
    ds_read_b64_tr_b16 v[44:45], v3 offset:11264
    ds_read_b64_tr_b16 v[46:47], v3 offset:11520
    v_mfma_f32_16x16x32_bf16 v[220:223], v[60:63], v[72:75], v[220:223]
    v_exp_f32 v101, v101
    v_mfma_f32_16x16x32_bf16 v[156:159], v[60:63], v[64:67], v[156:159]
    global_load_lds_dwordx4 v5, s[60:61] offset:3072 sc1
    v_mfma_f32_16x16x32_bf16 v[152:155], v[56:59], v[64:67], v[152:155]
    s_waitcnt lgkmcnt(4)
    s_add_u32 s60, s60, 16384
    s_addc_u32 s61, s61, 0
    v_add_f32 v12, v12, v100
    v_mfma_f32_16x16x32_bf16 v[160:163], v[32:35], v[64:67], v[160:163]
    ds_read_b64_tr_b16 v[48:49], v3 offset:12288
    ds_read_b64_tr_b16 v[50:51], v3 offset:12544
    v_mfma_f32_16x16x32_bf16 v[164:167], v[36:39], v[64:67], v[164:167]
    s_add_u32 m0, s57, 12288
    v_exp_f32 v102, v102
    v_mfma_f32_16x16x32_bf16 v[228:231], v[36:39], v[72:75], v[228:231]
    global_load_lds_dwordx4 v4, s[58:59] offset:-4096 sc1
    v_mfma_f32_16x16x32_bf16 v[224:227], v[32:35], v[72:75], v[224:227]
    v_mfma_f32_16x16x32_bf16 a[160:163], v[32:35], v[80:83], a[160:163]
    ds_read_b64_tr_b16 v[52:53], v3 offset:13312
    ds_read_b64_tr_b16 v[54:55], v3 offset:13568
    v_mfma_f32_16x16x32_bf16 a[164:167], v[36:39], v[80:83], a[164:167]
    v_add_f32 v12, v12, v101
    v_cvt_pk_bf16_f32 v98, v100, v101
    v_mfma_f32_16x16x32_bf16 a[228:231], v[36:39], v[88:91], a[228:231]
    global_load_lds_dwordx4 v4, s[58:59] offset:-3072 sc1
    v_mfma_f32_16x16x32_bf16 a[224:227], v[32:35], v[88:91], a[224:227]
    s_waitcnt lgkmcnt(4)
    v_exp_f32 v103, v103
    v_mfma_f32_16x16x32_bf16 a[232:235], v[40:43], v[88:91], a[232:235]
    ds_read_b64_tr_b16 v[56:57], v3 offset:14336
    ds_read_b64_tr_b16 v[58:59], v3 offset:14592
    v_mfma_f32_16x16x32_bf16 a[236:239], v[44:47], v[88:91], a[236:239]
    v_mfma_f32_16x16x32_bf16 a[172:175], v[44:47], v[80:83], a[172:175]
    global_load_lds_dwordx4 v4, s[58:59] offset:-2048 sc1
    v_mfma_f32_16x16x32_bf16 a[168:171], v[40:43], v[80:83], a[168:171]
    v_add_f32 v12, v12, v102
    v_mfma_f32_16x16x32_bf16 v[232:235], v[40:43], v[72:75], v[232:235]
    ds_read_b64_tr_b16 v[60:61], v3 offset:15360
    ds_read_b64_tr_b16 v[62:63], v3 offset:15616
    v_mfma_f32_16x16x32_bf16 v[236:239], v[44:47], v[72:75], v[236:239]
    v_exp_f32 v104, v104
    v_mfma_f32_16x16x32_bf16 v[172:175], v[44:47], v[64:67], v[172:175]
    global_load_lds_dwordx4 v4, s[58:59] offset:-1024 sc1
    v_mfma_f32_16x16x32_bf16 v[168:171], v[40:43], v[64:67], v[168:171]
    s_waitcnt vmcnt(12) lgkmcnt(4)
    v_add_f32 v12, v12, v103
    v_mfma_f32_16x16x32_bf16 v[176:179], v[48:51], v[64:67], v[176:179]
    ds_read_b128 v[32:35], v2 offset:32768
    v_cvt_pk_bf16_f32 v99, v102, v103
    v_mfma_f32_16x16x32_bf16 v[180:183], v[52:55], v[64:67], v[180:183]
    ds_read_b128 v[36:39], v2 offset:34816
    v_mfma_f32_16x16x32_bf16 v[244:247], v[52:55], v[72:75], v[244:247]
    global_load_lds_dwordx4 v5, s[58:59] offset:0 sc1
    v_mfma_f32_16x16x32_bf16 v[240:243], v[48:51], v[72:75], v[240:243]
    v_exp_f32 v105, v105
    v_mfma_f32_16x16x32_bf16 a[176:179], v[48:51], v[80:83], a[176:179]
    ds_read_b128 v[40:43], v2 offset:36864
    v_mfma_f32_16x16x32_bf16 a[180:183], v[52:55], v[80:83], a[180:183]
    ds_read_b128 v[44:47], v2 offset:38912
    v_mfma_f32_16x16x32_bf16 a[244:247], v[52:55], v[88:91], a[244:247]
    global_load_lds_dwordx4 v5, s[58:59] offset:1024 sc1
    v_mfma_f32_16x16x32_bf16 a[240:243], v[48:51], v[88:91], a[240:243]
    s_waitcnt lgkmcnt(4)
    v_exp_f32 v106, v106
    v_mfma_f32_16x16x32_bf16 a[248:251], v[56:59], v[88:91], a[248:251]
    v_add_f32 v13, v104, v105
    v_cvt_pk_bf16_f32 v104, v104, v105
    v_mfma_f32_16x16x32_bf16 a[252:255], v[60:63], v[88:91], a[252:255]
    v_exp_f32 v107, v107
    v_mfma_f32_16x16x32_bf16 a[188:191], v[60:63], v[80:83], a[188:191]
    global_load_lds_dwordx4 v5, s[58:59] offset:2048 sc1
    v_mfma_f32_16x16x32_bf16 a[184:187], v[56:59], v[80:83], a[184:187]
    v_mfma_f32_16x16x32_bf16 v[248:251], v[56:59], v[72:75], v[248:251]
    v_add_f32 v13, v13, v106
    v_mfma_f32_16x16x32_bf16 v[252:255], v[60:63], v[72:75], v[252:255]
    v_exp_f32 v108, v108
    v_mfma_f32_16x16x32_bf16 v[188:191], v[60:63], v[64:67], v[188:191]
    global_load_lds_dwordx4 v5, s[58:59] offset:3072 sc1
    v_mfma_f32_16x16x32_bf16 v[184:187], v[56:59], v[64:67], v[184:187]
    s_waitcnt lgkmcnt(0)
    s_add_u32 s58, s58, 16384
    s_addc_u32 s59, s59, 0
    v_add_f32 v13, v13, v107
    v_mfma_f32_16x16x32_bf16 v[64:67], v[32:35], a[0:3], v[16:19]
    ds_read_b128 v[48:51], v2 offset:33024
    v_cvt_pk_bf16_f32 v105, v106, v107
    v_mfma_f32_16x16x32_bf16 v[64:67], v[36:39], a[4:7], v[64:67]
    ds_read_b128 v[52:55], v2 offset:35072
    v_mfma_f32_16x16x32_bf16 v[64:67], v[40:43], a[8:11], v[64:67]
    v_exp_f32 v109, v109
    v_mfma_f32_16x16x32_bf16 v[64:67], v[44:47], a[12:15], v[64:67]
    v_add_f32 v13, v13, v108
    v_mfma_f32_16x16x32_bf16 v[72:75], v[44:47], a[44:47], v[20:23]
    ds_read_b128 v[56:59], v2 offset:37120
    v_mfma_f32_16x16x32_bf16 v[72:75], v[40:43], a[40:43], v[72:75]
    ds_read_b128 v[60:63], v2 offset:39168
    v_mfma_f32_16x16x32_bf16 v[72:75], v[36:39], a[36:39], v[72:75]
    v_exp_f32 v110, v110
    v_mfma_f32_16x16x32_bf16 v[72:75], v[32:35], a[32:35], v[72:75]
    v_add_f32 v13, v13, v109
    v_cvt_pk_bf16_f32 v106, v108, v109
    v_mfma_f32_16x16x32_bf16 v[80:83], v[32:35], a[64:67], v[24:27]
    v_exp_f32 v111, v111
    v_mfma_f32_16x16x32_bf16 v[80:83], v[36:39], a[68:71], v[80:83]
    v_add_f32 v13, v13, v110
    v_mfma_f32_16x16x32_bf16 v[80:83], v[40:43], a[72:75], v[80:83]
    v_exp_f32 v112, v112
    v_mfma_f32_16x16x32_bf16 v[80:83], v[44:47], a[76:79], v[80:83]
    v_add_f32 v13, v13, v111
    v_mfma_f32_16x16x32_bf16 v[88:91], v[44:47], a[108:111], v[28:31]
    v_cvt_pk_bf16_f32 v107, v110, v111
    v_mfma_f32_16x16x32_bf16 v[88:91], v[40:43], a[104:107], v[88:91]
    v_exp_f32 v113, v113
    v_mfma_f32_16x16x32_bf16 v[88:91], v[36:39], a[100:103], v[88:91]
    v_exp_f32 v114, v114
    v_mfma_f32_16x16x32_bf16 v[88:91], v[32:35], a[96:99], v[88:91]
    s_waitcnt vmcnt(12) lgkmcnt(0)
    v_add_f32 v14, v112, v113
    v_mfma_f32_16x16x32_bf16 v[92:95], v[48:51], a[96:99], v[28:31]
    ds_read_b128 v[32:35], v2 offset:256
    v_mfma_f32_16x16x32_bf16 v[92:95], v[52:55], a[100:103], v[92:95]
    ds_read_b128 v[36:39], v2 offset:2304
    v_cvt_pk_bf16_f32 v112, v112, v113
    v_mfma_f32_16x16x32_bf16 v[92:95], v[56:59], a[104:107], v[92:95]
    v_exp_f32 v115, v115
    v_mfma_f32_16x16x32_bf16 v[92:95], v[60:63], a[108:111], v[92:95]
    s_waitcnt vmcnt(8)
    v_add_f32 v14, v14, v114
    v_mfma_f32_16x16x32_bf16 v[84:87], v[60:63], a[76:79], v[24:27]
    ds_read_b128 v[40:43], v2 offset:4352
    v_mfma_f32_16x16x32_bf16 v[84:87], v[56:59], a[72:75], v[84:87]
    ds_read_b128 v[44:47], v2 offset:6400
    v_mfma_f32_16x16x32_bf16 v[84:87], v[52:55], a[68:71], v[84:87]
    v_exp_f32 v116, v116
    v_mfma_f32_16x16x32_bf16 v[84:87], v[48:51], a[64:67], v[84:87]
    v_add_f32 v14, v14, v115
    v_cvt_pk_bf16_f32 v113, v114, v115
    v_mfma_f32_16x16x32_bf16 v[76:79], v[48:51], a[32:35], v[20:23]
    v_exp_f32 v117, v117
    v_mfma_f32_16x16x32_bf16 v[76:79], v[52:55], a[36:39], v[76:79]
    v_mfma_f32_16x16x32_bf16 v[76:79], v[56:59], a[40:43], v[76:79]
    v_add_f32 v14, v14, v116
    v_mfma_f32_16x16x32_bf16 v[76:79], v[60:63], a[44:47], v[76:79]
    v_exp_f32 v118, v118
    v_mfma_f32_16x16x32_bf16 v[68:71], v[60:63], a[12:15], v[16:19]
    v_add_f32 v14, v14, v117
    v_mfma_f32_16x16x32_bf16 v[68:71], v[56:59], a[8:11], v[68:71]
    v_cvt_pk_bf16_f32 v114, v116, v117
    v_mfma_f32_16x16x32_bf16 v[68:71], v[52:55], a[4:7], v[68:71]
    v_exp_f32 v119, v119
    v_mfma_f32_16x16x32_bf16 v[68:71], v[48:51], a[0:3], v[68:71]
    s_waitcnt lgkmcnt(0)
    v_add_f32 v14, v14, v118
    v_mfma_f32_16x16x32_bf16 v[68:71], v[32:35], a[16:19], v[68:71]
    ds_read_b128 v[48:51], v2 offset:0
    v_mfma_f32_16x16x32_bf16 v[68:71], v[36:39], a[20:23], v[68:71]
    ds_read_b128 v[52:55], v2 offset:2048
    v_mfma_f32_16x16x32_bf16 v[68:71], v[40:43], a[24:27], v[68:71]
    v_exp_f32 v120, v120
    v_mfma_f32_16x16x32_bf16 v[68:71], v[44:47], a[28:31], v[68:71]
    v_add_f32 v14, v14, v119
    v_cvt_pk_bf16_f32 v115, v118, v119
    v_mfma_f32_16x16x32_bf16 v[76:79], v[44:47], a[60:63], v[76:79]
    ds_read_b128 v[56:59], v2 offset:4096
    v_mfma_f32_16x16x32_bf16 v[76:79], v[40:43], a[56:59], v[76:79]
    ds_read_b128 v[60:63], v2 offset:6144
    v_mfma_f32_16x16x32_bf16 v[76:79], v[36:39], a[52:55], v[76:79]
    v_exp_f32 v121, v121
    v_mfma_f32_16x16x32_bf16 v[76:79], v[32:35], a[48:51], v[76:79]
    v_exp_f32 v122, v122
    v_mfma_f32_16x16x32_bf16 v[84:87], v[32:35], a[80:83], v[84:87]
    v_add_f32 v15, v120, v121
    v_cvt_pk_bf16_f32 v120, v120, v121
    v_mfma_f32_16x16x32_bf16 v[84:87], v[36:39], a[84:87], v[84:87]
    v_exp_f32 v123, v123
    v_mfma_f32_16x16x32_bf16 v[84:87], v[40:43], a[88:91], v[84:87]
    v_add_f32 v15, v15, v122
    v_mfma_f32_16x16x32_bf16 v[84:87], v[44:47], a[92:95], v[84:87]
    v_exp_f32 v124, v124
    v_mfma_f32_16x16x32_bf16 v[92:95], v[44:47], a[124:127], v[92:95]
    v_add_f32 v15, v15, v123
    v_mfma_f32_16x16x32_bf16 v[92:95], v[40:43], a[120:123], v[92:95]
    v_cvt_pk_bf16_f32 v121, v122, v123
    v_mfma_f32_16x16x32_bf16 v[92:95], v[36:39], a[116:119], v[92:95]
    v_exp_f32 v125, v125
    v_mfma_f32_16x16x32_bf16 v[92:95], v[32:35], a[112:115], v[92:95]
    s_waitcnt lgkmcnt(0)
    v_add_f32 v15, v15, v124
    v_mfma_f32_16x16x32_bf16 v[88:91], v[48:51], a[112:115], v[88:91]
    ds_read_b64_tr_b16 v[32:33], v3 offset:16384
    ds_read_b64_tr_b16 v[34:35], v3 offset:16640
    v_mfma_f32_16x16x32_bf16 v[88:91], v[52:55], a[116:119], v[88:91]
    v_exp_f32 v126, v126
    v_mfma_f32_16x16x32_bf16 v[88:91], v[56:59], a[120:123], v[88:91]
    v_mfma_f32_16x16x32_bf16 v[88:91], v[60:63], a[124:127], v[88:91]
    v_add_f32 v15, v15, v125
    v_cvt_pk_bf16_f32 v122, v124, v125
    v_mfma_f32_16x16x32_bf16 v[80:83], v[60:63], a[92:95], v[80:83]
    ds_read_b64_tr_b16 v[36:37], v3 offset:17408
    ds_read_b64_tr_b16 v[38:39], v3 offset:17664
    v_mfma_f32_16x16x32_bf16 v[80:83], v[56:59], a[88:91], v[80:83]
    v_exp_f32 v127, v127
    v_mfma_f32_16x16x32_bf16 v[80:83], v[52:55], a[84:87], v[80:83]
    v_mfma_f32_16x16x32_bf16 v[80:83], v[48:51], a[80:83], v[80:83]
    v_add_f32 v15, v15, v126
    v_max3_f32 v7, v12, v13, v14
    v_mfma_f32_16x16x32_bf16 v[72:75], v[48:51], a[48:51], v[72:75]
    ds_read_b64_tr_b16 v[40:41], v3 offset:18432
    ds_read_b64_tr_b16 v[42:43], v3 offset:18688
    v_mfma_f32_16x16x32_bf16 v[72:75], v[52:55], a[52:55], v[72:75]
    v_add_f32 v15, v15, v127
    v_mfma_f32_16x16x32_bf16 v[72:75], v[56:59], a[56:59], v[72:75]
    v_cvt_pk_bf16_f32 v123, v126, v127
    v_mfma_f32_16x16x32_bf16 v[72:75], v[60:63], a[60:63], v[72:75]
    v_add_f32 v7, v7, v15
    v_cmp_nge_f32 vcc, s62, v7
    v_mfma_f32_16x16x32_bf16 v[64:67], v[60:63], a[28:31], v[64:67]
    ds_read_b64_tr_b16 v[44:45], v3 offset:19456
    ds_read_b64_tr_b16 v[46:47], v3 offset:19712
    v_mfma_f32_16x16x32_bf16 v[64:67], v[56:59], a[24:27], v[64:67]
    v_mfma_f32_16x16x32_bf16 v[64:67], v[52:55], a[20:23], v[64:67]
    v_mfma_f32_16x16x32_bf16 v[64:67], v[48:51], a[16:19], v[64:67]
    s_waitcnt lgkmcnt(4)
    s_cbranch_vccnz L_stub_i11
L_back_i11:
    v_mfma_f32_16x16x32_bf16 v[128:131], v[32:35], v[96:99], v[128:131]
    ds_read_b64_tr_b16 v[48:49], v3 offset:20480
    ds_read_b64_tr_b16 v[50:51], v3 offset:20736
    v_mfma_f32_16x16x32_bf16 v[132:135], v[36:39], v[96:99], v[132:135]
    s_add_u32 m0, s57, 20480
    v_add_f32 v8, v8, v12
    v_add_f32 v9, v9, v13
    v_mfma_f32_16x16x32_bf16 v[196:199], v[36:39], v[104:107], v[196:199]
    global_load_lds_dwordx4 v4, s[60:61] offset:-4096 sc1
    v_mfma_f32_16x16x32_bf16 v[192:195], v[32:35], v[104:107], v[192:195]
    v_add_f32 v10, v10, v14
    v_add_f32 v11, v11, v15
    v_mfma_f32_16x16x32_bf16 a[128:131], v[32:35], v[112:115], a[128:131]
    ds_read_b64_tr_b16 v[52:53], v3 offset:21504
    ds_read_b64_tr_b16 v[54:55], v3 offset:21760
    v_mfma_f32_16x16x32_bf16 a[132:135], v[36:39], v[112:115], a[132:135]
    s_and_b32 s70, s83, 0xffffff80
    v_and_b32 v6, 3, v1
    v_mfma_f32_16x16x32_bf16 a[196:199], v[36:39], v[120:123], a[196:199]
    global_load_lds_dwordx4 v4, s[60:61] offset:-3072 sc1
    v_mfma_f32_16x16x32_bf16 a[192:195], v[32:35], v[120:123], a[192:195]
    s_waitcnt lgkmcnt(4)
    s_lshl_b32 s71, s52, 7
    v_lshl_add_u32 v6, v6, 2, s70
    v_mfma_f32_16x16x32_bf16 a[200:203], v[40:43], v[120:123], a[200:203]
    ds_read_b64_tr_b16 v[56:57], v3 offset:22528
    ds_read_b64_tr_b16 v[58:59], v3 offset:22784
    v_mfma_f32_16x16x32_bf16 a[204:207], v[44:47], v[120:123], a[204:207]
    s_add_u32 s71, s71, 36864
    v_lshrrev_b32 v0, 5, v1
    v_mfma_f32_16x16x32_bf16 a[140:143], v[44:47], v[112:115], a[140:143]
    global_load_lds_dwordx4 v4, s[60:61] offset:-2048 sc1
    v_mfma_f32_16x16x32_bf16 a[136:139], v[40:43], v[112:115], a[136:139]
    s_sub_u32 s71, s71, s70
    v_mad_u32_u24 v6, v0, s71, v6
    v_mfma_f32_16x16x32_bf16 v[200:203], v[40:43], v[104:107], v[200:203]
    ds_read_b64_tr_b16 v[60:61], v3 offset:23552
    ds_read_b64_tr_b16 v[62:63], v3 offset:23808
    v_mfma_f32_16x16x32_bf16 v[204:207], v[44:47], v[104:107], v[204:207]
    s_cmp_eq_u32 s55, 0
    s_cselect_b32 s70, 0, 128
    v_nop
    v_mfma_f32_16x16x32_bf16 v[140:143], v[44:47], v[96:99], v[140:143]
    global_load_lds_dwordx4 v4, s[60:61] offset:-1024 sc1
    v_mfma_f32_16x16x32_bf16 v[136:139], v[40:43], v[96:99], v[136:139]
    s_waitcnt lgkmcnt(4)
    s_sub_u32 s70, s83, s70
    v_writelane_b32 v6, s70, 4
    v_mfma_f32_16x16x32_bf16 v[144:147], v[48:51], v[96:99], v[144:147]
    ds_read_b64_tr_b16 v[32:33], v3 offset:24576
    ds_read_b64_tr_b16 v[34:35], v3 offset:24832
    v_mfma_f32_16x16x32_bf16 v[148:151], v[52:55], v[96:99], v[148:151]
    s_cmp_ge_u32 s55, 124
    s_cselect_b32 s70, 0, 128
    v_nop
    v_mfma_f32_16x16x32_bf16 v[212:215], v[52:55], v[104:107], v[212:215]
    global_load_lds_dwordx4 v5, s[60:61] offset:0 sc1
    v_mfma_f32_16x16x32_bf16 v[208:211], v[48:51], v[104:107], v[208:211]
    s_add_u32 s70, s83, s70
    v_writelane_b32 v6, s70, 5
    v_mfma_f32_16x16x32_bf16 a[144:147], v[48:51], v[112:115], a[144:147]
    ds_read_b64_tr_b16 v[36:37], v3 offset:25600
    ds_read_b64_tr_b16 v[38:39], v3 offset:25856
    v_mfma_f32_16x16x32_bf16 a[148:151], v[52:55], v[112:115], a[148:151]
    v_exp_f32 v64, v64
    v_mfma_f32_16x16x32_bf16 a[212:215], v[52:55], v[120:123], a[212:215]
    global_load_lds_dwordx4 v5, s[60:61] offset:1024 sc1
    v_mfma_f32_16x16x32_bf16 a[208:211], v[48:51], v[120:123], a[208:211]
    s_waitcnt lgkmcnt(4)
    v_exp_f32 v65, v65
    v_mfma_f32_16x16x32_bf16 a[216:219], v[56:59], v[120:123], a[216:219]
    ds_read_b64_tr_b16 v[40:41], v3 offset:26624
    ds_read_b64_tr_b16 v[42:43], v3 offset:26880
    v_mfma_f32_16x16x32_bf16 a[220:223], v[60:63], v[120:123], a[220:223]
    v_exp_f32 v66, v66
    v_mfma_f32_16x16x32_bf16 a[156:159], v[60:63], v[112:115], a[156:159]
    global_load_lds_dwordx4 v5, s[60:61] offset:2048 sc1
    v_mfma_f32_16x16x32_bf16 a[152:155], v[56:59], v[112:115], a[152:155]
    v_add_f32 v12, v64, v65
    v_cvt_pk_bf16_f32 v64, v64, v65
    v_mfma_f32_16x16x32_bf16 v[216:219], v[56:59], v[104:107], v[216:219]
    ds_read_b64_tr_b16 v[44:45], v3 offset:27648
    ds_read_b64_tr_b16 v[46:47], v3 offset:27904
    v_mfma_f32_16x16x32_bf16 v[220:223], v[60:63], v[104:107], v[220:223]
    v_exp_f32 v67, v67
    v_mfma_f32_16x16x32_bf16 v[156:159], v[60:63], v[96:99], v[156:159]
    global_load_lds_dwordx4 v5, s[60:61] offset:3072 sc1
    v_mfma_f32_16x16x32_bf16 v[152:155], v[56:59], v[96:99], v[152:155]
    s_waitcnt lgkmcnt(4)
    s_add_u32 s60, s60, 16384
    s_addc_u32 s61, s61, 0
    v_add_f32 v12, v12, v66
    v_mfma_f32_16x16x32_bf16 v[160:163], v[32:35], v[96:99], v[160:163]
    ds_read_b64_tr_b16 v[48:49], v3 offset:28672
    ds_read_b64_tr_b16 v[50:51], v3 offset:28928
    v_mfma_f32_16x16x32_bf16 v[164:167], v[36:39], v[96:99], v[164:167]
    s_add_u32 m0, s57, 28672
    v_exp_f32 v68, v68
    v_mfma_f32_16x16x32_bf16 v[228:231], v[36:39], v[104:107], v[228:231]
    global_load_lds_dwordx4 v4, s[58:59] offset:-4096 sc1
    v_mfma_f32_16x16x32_bf16 v[224:227], v[32:35], v[104:107], v[224:227]
    v_add_f32 v12, v12, v67
    v_cvt_pk_bf16_f32 v65, v66, v67
    v_mfma_f32_16x16x32_bf16 a[160:163], v[32:35], v[112:115], a[160:163]
    ds_read_b64_tr_b16 v[52:53], v3 offset:29696
    ds_read_b64_tr_b16 v[54:55], v3 offset:29952
    v_mfma_f32_16x16x32_bf16 a[164:167], v[36:39], v[112:115], a[164:167]
    v_exp_f32 v69, v69
    v_mfma_f32_16x16x32_bf16 a[228:231], v[36:39], v[120:123], a[228:231]
    global_load_lds_dwordx4 v4, s[58:59] offset:-3072 sc1
    v_mfma_f32_16x16x32_bf16 a[224:227], v[32:35], v[120:123], a[224:227]
    s_waitcnt lgkmcnt(4)
    v_add_f32 v12, v12, v68
    v_mfma_f32_16x16x32_bf16 a[232:235], v[40:43], v[120:123], a[232:235]
    ds_read_b64_tr_b16 v[56:57], v3 offset:30720
    ds_read_b64_tr_b16 v[58:59], v3 offset:30976
    v_mfma_f32_16x16x32_bf16 a[236:239], v[44:47], v[120:123], a[236:239]
    v_exp_f32 v70, v70
    v_mfma_f32_16x16x32_bf16 a[172:175], v[44:47], v[112:115], a[172:175]
    global_load_lds_dwordx4 v4, s[58:59] offset:-2048 sc1
    v_mfma_f32_16x16x32_bf16 a[168:171], v[40:43], v[112:115], a[168:171]
    v_add_f32 v12, v12, v69
    v_cvt_pk_bf16_f32 v66, v68, v69
    v_mfma_f32_16x16x32_bf16 v[232:235], v[40:43], v[104:107], v[232:235]
    ds_read_b64_tr_b16 v[60:61], v3 offset:31744
    ds_read_b64_tr_b16 v[62:63], v3 offset:32000
    v_mfma_f32_16x16x32_bf16 v[236:239], v[44:47], v[104:107], v[236:239]
    v_exp_f32 v71, v71
    v_mfma_f32_16x16x32_bf16 v[172:175], v[44:47], v[96:99], v[172:175]
    global_load_lds_dwordx4 v4, s[58:59] offset:-1024 sc1
    v_mfma_f32_16x16x32_bf16 v[168:171], v[40:43], v[96:99], v[168:171]
    s_waitcnt vmcnt(12) lgkmcnt(4)
    v_add_f32 v12, v12, v70
    v_mfma_f32_16x16x32_bf16 v[176:179], v[48:51], v[96:99], v[176:179]
    ds_read_b128 v[32:35], v2 offset:8192
    v_mfma_f32_16x16x32_bf16 v[180:183], v[52:55], v[96:99], v[180:183]
    ds_read_b128 v[36:39], v2 offset:10240
    v_mfma_f32_16x16x32_bf16 v[244:247], v[52:55], v[104:107], v[244:247]
    global_load_lds_dwordx4 v5, s[58:59] offset:0 sc1
    v_mfma_f32_16x16x32_bf16 v[240:243], v[48:51], v[104:107], v[240:243]
    v_exp_f32 v72, v72
    v_mfma_f32_16x16x32_bf16 a[176:179], v[48:51], v[112:115], a[176:179]
    ds_read_b128 v[40:43], v2 offset:12288
    v_add_f32 v12, v12, v71
    v_mfma_f32_16x16x32_bf16 a[180:183], v[52:55], v[112:115], a[180:183]
    ds_read_b128 v[44:47], v2 offset:14336
    v_cvt_pk_bf16_f32 v67, v70, v71
    v_mfma_f32_16x16x32_bf16 a[244:247], v[52:55], v[120:123], a[244:247]
    global_load_lds_dwordx4 v5, s[58:59] offset:1024 sc1
    v_mfma_f32_16x16x32_bf16 a[240:243], v[48:51], v[120:123], a[240:243]
    s_waitcnt lgkmcnt(4)
    v_exp_f32 v73, v73
    v_mfma_f32_16x16x32_bf16 a[248:251], v[56:59], v[120:123], a[248:251]
    v_exp_f32 v74, v74
    v_mfma_f32_16x16x32_bf16 a[252:255], v[60:63], v[120:123], a[252:255]
    v_add_f32 v13, v72, v73
    v_cvt_pk_bf16_f32 v72, v72, v73
    v_mfma_f32_16x16x32_bf16 a[188:191], v[60:63], v[112:115], a[188:191]
    global_load_lds_dwordx4 v5, s[58:59] offset:2048 sc1
    v_mfma_f32_16x16x32_bf16 a[184:187], v[56:59], v[112:115], a[184:187]
    v_exp_f32 v75, v75
    v_mfma_f32_16x16x32_bf16 v[248:251], v[56:59], v[104:107], v[248:251]
    v_add_f32 v13, v13, v74
    v_mfma_f32_16x16x32_bf16 v[252:255], v[60:63], v[104:107], v[252:255]
    v_exp_f32 v76, v76
    v_mfma_f32_16x16x32_bf16 v[188:191], v[60:63], v[96:99], v[188:191]
    global_load_lds_dwordx4 v5, s[58:59] offset:3072 sc1
    v_mfma_f32_16x16x32_bf16 v[184:187], v[56:59], v[96:99], v[184:187]
    s_waitcnt lgkmcnt(0)
    s_add_u32 s58, s58, 16384
    s_addc_u32 s59, s59, 0
    v_add_f32 v13, v13, v75
    v_mfma_f32_16x16x32_bf16 v[96:99], v[32:35], a[0:3], v[16:19]
    ds_read_b128 v[48:51], v2 offset:8448
    v_cvt_pk_bf16_f32 v73, v74, v75
    v_mfma_f32_16x16x32_bf16 v[96:99], v[36:39], a[4:7], v[96:99]
    ds_read_b128 v[52:55], v2 offset:10496
    v_mfma_f32_16x16x32_bf16 v[96:99], v[40:43], a[8:11], v[96:99]
    buffer_load_dword v0, v6, s[40:43], 0 offen sc1
    v_mfma_f32_16x16x32_bf16 v[96:99], v[44:47], a[12:15], v[96:99]
    v_exp_f32 v77, v77
    v_mfma_f32_16x16x32_bf16 v[104:107], v[44:47], a[44:47], v[20:23]
    ds_read_b128 v[56:59], v2 offset:12544
    v_add_f32 v13, v13, v76
    v_mfma_f32_16x16x32_bf16 v[104:107], v[40:43], a[40:43], v[104:107]
    ds_read_b128 v[60:63], v2 offset:14592
    v_mfma_f32_16x16x32_bf16 v[104:107], v[36:39], a[36:39], v[104:107]
    v_exp_f32 v78, v78
    v_mfma_f32_16x16x32_bf16 v[104:107], v[32:35], a[32:35], v[104:107]
    v_add_f32 v13, v13, v77
    v_mfma_f32_16x16x32_bf16 v[112:115], v[32:35], a[64:67], v[24:27]
    v_cvt_pk_bf16_f32 v74, v76, v77
    v_mfma_f32_16x16x32_bf16 v[112:115], v[36:39], a[68:71], v[112:115]
    v_exp_f32 v79, v79
    v_mfma_f32_16x16x32_bf16 v[112:115], v[40:43], a[72:75], v[112:115]
    v_add_f32 v13, v13, v78
    v_mfma_f32_16x16x32_bf16 v[112:115], v[44:47], a[76:79], v[112:115]
    v_exp_f32 v80, v80
    v_mfma_f32_16x16x32_bf16 v[120:123], v[44:47], a[108:111], v[28:31]
    v_add_f32 v13, v13, v79
    v_cvt_pk_bf16_f32 v75, v78, v79
    v_mfma_f32_16x16x32_bf16 v[120:123], v[40:43], a[104:107], v[120:123]
    v_exp_f32 v81, v81
    v_mfma_f32_16x16x32_bf16 v[120:123], v[36:39], a[100:103], v[120:123]
    v_mfma_f32_16x16x32_bf16 v[120:123], v[32:35], a[96:99], v[120:123]
    s_waitcnt vmcnt(13) lgkmcnt(0)
    v_exp_f32 v82, v82
    v_mfma_f32_16x16x32_bf16 v[124:127], v[48:51], a[96:99], v[28:31]
    ds_read_b128 v[32:35], v2 offset:16640
    v_mfma_f32_16x16x32_bf16 v[124:127], v[52:55], a[100:103], v[124:127]
    ds_read_b128 v[36:39], v2 offset:18688
    v_add_f32 v14, v80, v81
    v_mfma_f32_16x16x32_bf16 v[124:127], v[56:59], a[104:107], v[124:127]
    v_cvt_pk_bf16_f32 v80, v80, v81
    v_mfma_f32_16x16x32_bf16 v[124:127], v[60:63], a[108:111], v[124:127]
    s_waitcnt vmcnt(9)
    v_exp_f32 v83, v83
    v_mfma_f32_16x16x32_bf16 v[116:119], v[60:63], a[76:79], v[24:27]
    ds_read_b128 v[40:43], v2 offset:20736
    v_add_f32 v14, v14, v82
    v_mfma_f32_16x16x32_bf16 v[116:119], v[56:59], a[72:75], v[116:119]
    ds_read_b128 v[44:47], v2 offset:22784
    v_mfma_f32_16x16x32_bf16 v[116:119], v[52:55], a[68:71], v[116:119]
    v_exp_f32 v84, v84
    v_mfma_f32_16x16x32_bf16 v[116:119], v[48:51], a[64:67], v[116:119]
    v_add_f32 v14, v14, v83
    v_mfma_f32_16x16x32_bf16 v[108:111], v[48:51], a[32:35], v[20:23]
    v_cvt_pk_bf16_f32 v81, v82, v83
    v_mfma_f32_16x16x32_bf16 v[108:111], v[52:55], a[36:39], v[108:111]
    v_exp_f32 v85, v85
    v_mfma_f32_16x16x32_bf16 v[108:111], v[56:59], a[40:43], v[108:111]
    v_add_f32 v14, v14, v84
    v_mfma_f32_16x16x32_bf16 v[108:111], v[60:63], a[44:47], v[108:111]
    v_exp_f32 v86, v86
    v_mfma_f32_16x16x32_bf16 v[100:103], v[60:63], a[12:15], v[16:19]
    v_add_f32 v14, v14, v85
    v_mfma_f32_16x16x32_bf16 v[100:103], v[56:59], a[8:11], v[100:103]
    v_cvt_pk_bf16_f32 v82, v84, v85
    v_mfma_f32_16x16x32_bf16 v[100:103], v[52:55], a[4:7], v[100:103]
    v_exp_f32 v87, v87
    v_mfma_f32_16x16x32_bf16 v[100:103], v[48:51], a[0:3], v[100:103]
    s_waitcnt lgkmcnt(0)
    v_add_f32 v14, v14, v86
    v_mfma_f32_16x16x32_bf16 v[100:103], v[32:35], a[16:19], v[100:103]
    ds_read_b128 v[48:51], v2 offset:16384
    v_mfma_f32_16x16x32_bf16 v[100:103], v[36:39], a[20:23], v[100:103]
    ds_read_b128 v[52:55], v2 offset:18432
    v_mfma_f32_16x16x32_bf16 v[100:103], v[40:43], a[24:27], v[100:103]
    v_exp_f32 v88, v88
    v_mfma_f32_16x16x32_bf16 v[100:103], v[44:47], a[28:31], v[100:103]
    v_add_f32 v14, v14, v87
    v_cvt_pk_bf16_f32 v83, v86, v87
    v_mfma_f32_16x16x32_bf16 v[108:111], v[44:47], a[60:63], v[108:111]
    ds_read_b128 v[56:59], v2 offset:20480
    v_mfma_f32_16x16x32_bf16 v[108:111], v[40:43], a[56:59], v[108:111]
    ds_read_b128 v[60:63], v2 offset:22528
    v_mfma_f32_16x16x32_bf16 v[108:111], v[36:39], a[52:55], v[108:111]
    v_exp_f32 v89, v89
    v_mfma_f32_16x16x32_bf16 v[108:111], v[32:35], a[48:51], v[108:111]
    v_exp_f32 v90, v90
    v_mfma_f32_16x16x32_bf16 v[116:119], v[32:35], a[80:83], v[116:119]
    v_add_f32 v15, v88, v89
    v_cvt_pk_bf16_f32 v88, v88, v89
    v_mfma_f32_16x16x32_bf16 v[116:119], v[36:39], a[84:87], v[116:119]
    v_exp_f32 v91, v91
    v_mfma_f32_16x16x32_bf16 v[116:119], v[40:43], a[88:91], v[116:119]
    v_add_f32 v15, v15, v90
    v_mfma_f32_16x16x32_bf16 v[116:119], v[44:47], a[92:95], v[116:119]
    v_exp_f32 v92, v92
    v_mfma_f32_16x16x32_bf16 v[124:127], v[44:47], a[124:127], v[124:127]
    v_add_f32 v15, v15, v91
    v_mfma_f32_16x16x32_bf16 v[124:127], v[40:43], a[120:123], v[124:127]
    v_cvt_pk_bf16_f32 v89, v90, v91
    v_mfma_f32_16x16x32_bf16 v[124:127], v[36:39], a[116:119], v[124:127]
    v_exp_f32 v93, v93
    v_mfma_f32_16x16x32_bf16 v[124:127], v[32:35], a[112:115], v[124:127]
    s_waitcnt lgkmcnt(0)
    v_add_f32 v15, v15, v92
    v_mfma_f32_16x16x32_bf16 v[120:123], v[48:51], a[112:115], v[120:123]
    ds_read_b64_tr_b16 v[32:33], v3 offset:32768
    ds_read_b64_tr_b16 v[34:35], v3 offset:33024
    v_mfma_f32_16x16x32_bf16 v[120:123], v[52:55], a[116:119], v[120:123]
    v_exp_f32 v94, v94
    v_mfma_f32_16x16x32_bf16 v[120:123], v[56:59], a[120:123], v[120:123]
    v_add_f32 v15, v15, v93
    v_mfma_f32_16x16x32_bf16 v[120:123], v[60:63], a[124:127], v[120:123]
    v_cvt_pk_bf16_f32 v90, v92, v93
    v_mfma_f32_16x16x32_bf16 v[112:115], v[60:63], a[92:95], v[112:115]
    ds_read_b64_tr_b16 v[36:37], v3 offset:33792
    ds_read_b64_tr_b16 v[38:39], v3 offset:34048
    v_mfma_f32_16x16x32_bf16 v[112:115], v[56:59], a[88:91], v[112:115]
    v_exp_f32 v95, v95
    v_mfma_f32_16x16x32_bf16 v[112:115], v[52:55], a[84:87], v[112:115]
    v_add_f32 v15, v15, v94
L_pk8:
    s_cbranch_execz L_pkdone
    v_mfma_f32_16x16x32_bf16 v[112:115], v[48:51], a[80:83], v[112:115]
    v_max3_f32 v7, v12, v13, v14
    v_mfma_f32_16x16x32_bf16 v[104:107], v[48:51], a[48:51], v[104:107]
    ds_read_b64_tr_b16 v[40:41], v3 offset:34816
    ds_read_b64_tr_b16 v[42:43], v3 offset:35072
    v_mfma_f32_16x16x32_bf16 v[104:107], v[52:55], a[52:55], v[104:107]
    v_add_f32 v15, v15, v95
    v_cvt_pk_bf16_f32 v91, v94, v95
    v_mfma_f32_16x16x32_bf16 v[104:107], v[56:59], a[56:59], v[104:107]
    v_add_f32 v7, v7, v15
    v_mfma_f32_16x16x32_bf16 v[104:107], v[60:63], a[60:63], v[104:107]
    v_cmp_nge_f32 vcc, s62, v7
    v_mfma_f32_16x16x32_bf16 v[96:99], v[60:63], a[28:31], v[96:99]
    ds_read_b64_tr_b16 v[44:45], v3 offset:35840
    ds_read_b64_tr_b16 v[46:47], v3 offset:36096
    v_mfma_f32_16x16x32_bf16 v[96:99], v[56:59], a[24:27], v[96:99]
    v_mfma_f32_16x16x32_bf16 v[96:99], v[52:55], a[20:23], v[96:99]
    v_mfma_f32_16x16x32_bf16 v[96:99], v[48:51], a[16:19], v[96:99]
    s_waitcnt lgkmcnt(4)
    s_cbranch_vccnz L_stub_i12
L_back_i12:
    v_mfma_f32_16x16x32_bf16 v[128:131], v[32:35], v[64:67], v[128:131]
    ds_read_b64_tr_b16 v[48:49], v3 offset:36864
    ds_read_b64_tr_b16 v[50:51], v3 offset:37120
    v_mfma_f32_16x16x32_bf16 v[132:135], v[36:39], v[64:67], v[132:135]
    s_add_u32 m0, s57, 36864
    v_add_f32 v8, v8, v12
    v_add_f32 v9, v9, v13
    v_mfma_f32_16x16x32_bf16 v[196:199], v[36:39], v[72:75], v[196:199]
    global_load_lds_dwordx4 v4, s[60:61] offset:-4096 sc1
    v_mfma_f32_16x16x32_bf16 v[192:195], v[32:35], v[72:75], v[192:195]
    v_add_f32 v10, v10, v14
    v_add_f32 v11, v11, v15
    v_mfma_f32_16x16x32_bf16 a[128:131], v[32:35], v[80:83], a[128:131]
    ds_read_b64_tr_b16 v[52:53], v3 offset:37888
    ds_read_b64_tr_b16 v[54:55], v3 offset:38144
    v_mfma_f32_16x16x32_bf16 a[132:135], v[36:39], v[80:83], a[132:135]
    s_waitcnt vmcnt(1)
    v_cmp_ne_u32 vcc, s56, v0
    v_mfma_f32_16x16x32_bf16 a[196:199], v[36:39], v[88:91], a[196:199]
    global_load_lds_dwordx4 v4, s[60:61] offset:-3072 sc1
    v_mfma_f32_16x16x32_bf16 a[192:195], v[32:35], v[88:91], a[192:195]
    s_waitcnt lgkmcnt(4)
    v_exp_f32 v96, v96
    v_mfma_f32_16x16x32_bf16 a[200:203], v[40:43], v[88:91], a[200:203]
    ds_read_b64_tr_b16 v[56:57], v3 offset:38912
    ds_read_b64_tr_b16 v[58:59], v3 offset:39168
    v_mfma_f32_16x16x32_bf16 a[204:207], v[44:47], v[88:91], a[204:207]
    s_cbranch_vccnz L_spin_tl
L_back_tl:
    v_mfma_f32_16x16x32_bf16 a[140:143], v[44:47], v[80:83], a[140:143]
    global_load_lds_dwordx4 v4, s[60:61] offset:-2048 sc1
    v_mfma_f32_16x16x32_bf16 a[136:139], v[40:43], v[80:83], a[136:139]
    v_exp_f32 v97, v97
    v_mfma_f32_16x16x32_bf16 v[200:203], v[40:43], v[72:75], v[200:203]
    ds_read_b64_tr_b16 v[60:61], v3 offset:39936
    ds_read_b64_tr_b16 v[62:63], v3 offset:40192
    v_mfma_f32_16x16x32_bf16 v[204:207], v[44:47], v[72:75], v[204:207]
    v_bfe_u32 v0, v1, 2, 1
    v_mfma_f32_16x16x32_bf16 v[140:143], v[44:47], v[64:67], v[140:143]
    global_load_lds_dwordx4 v4, s[60:61] offset:-1024 sc1
    v_mfma_f32_16x16x32_bf16 v[136:139], v[40:43], v[64:67], v[136:139]
    s_waitcnt lgkmcnt(4)
    s_lshl_b32 s70, s55, 14
    v_mul_u32_u24 v0, 192, v0
    v_mfma_f32_16x16x32_bf16 v[144:147], v[48:51], v[64:67], v[144:147]
    ds_read_b64_tr_b16 v[32:33], v3 offset:0
    ds_read_b64_tr_b16 v[34:35], v3 offset:256
    v_mfma_f32_16x16x32_bf16 v[148:151], v[52:55], v[64:67], v[148:151]
    s_lshl_b32 s71, s52, 12
    v_add_u32 v0, v0, v2
    v_mfma_f32_16x16x32_bf16 v[212:215], v[52:55], v[72:75], v[212:215]
    global_load_lds_dwordx4 v5, s[60:61] offset:0 sc1
    v_mfma_f32_16x16x32_bf16 v[208:211], v[48:51], v[72:75], v[208:211]
    s_add_u32 s70, s70, s71
    v_lshlrev_b32 v6, 4, v1
    v_mfma_f32_16x16x32_bf16 a[144:147], v[48:51], v[80:83], a[144:147]
    ds_read_b64_tr_b16 v[36:37], v3 offset:1024
    ds_read_b64_tr_b16 v[38:39], v3 offset:1280
    v_mfma_f32_16x16x32_bf16 a[148:151], v[52:55], v[80:83], a[148:151]
    s_sub_u32 s70, s70, s57
    v_add_u32 v0, s70, v0
    v_mfma_f32_16x16x32_bf16 a[212:215], v[52:55], v[88:91], a[212:215]
    global_load_lds_dwordx4 v5, s[60:61] offset:1024 sc1
    v_mfma_f32_16x16x32_bf16 a[208:211], v[48:51], v[88:91], a[208:211]
    s_waitcnt lgkmcnt(4)
    s_add_u32 s71, s71, 6815744
    v_nop
    v_mfma_f32_16x16x32_bf16 a[216:219], v[56:59], v[88:91], a[216:219]
    ds_read_b64_tr_b16 v[40:41], v3 offset:2048
    ds_read_b64_tr_b16 v[42:43], v3 offset:2304
    v_mfma_f32_16x16x32_bf16 a[220:223], v[60:63], v[88:91], a[220:223]
    v_exp_f32 v98, v98
    v_mfma_f32_16x16x32_bf16 a[156:159], v[60:63], v[80:83], a[156:159]
    global_load_lds_dwordx4 v5, s[60:61] offset:2048 sc1
    v_mfma_f32_16x16x32_bf16 a[152:155], v[56:59], v[80:83], a[152:155]
    v_add_f32 v12, v96, v97
    v_cvt_pk_bf16_f32 v96, v96, v97
    v_mfma_f32_16x16x32_bf16 v[216:219], v[56:59], v[72:75], v[216:219]
    ds_read_b64_tr_b16 v[44:45], v3 offset:3072
    ds_read_b64_tr_b16 v[46:47], v3 offset:3328
    v_mfma_f32_16x16x32_bf16 v[220:223], v[60:63], v[72:75], v[220:223]
    v_exp_f32 v99, v99
    v_mfma_f32_16x16x32_bf16 v[156:159], v[60:63], v[64:67], v[156:159]
    global_load_lds_dwordx4 v5, s[60:61] offset:3072 sc1
    v_mfma_f32_16x16x32_bf16 v[152:155], v[56:59], v[64:67], v[152:155]
    s_waitcnt lgkmcnt(4)
    s_add_u32 s60, s60, 16384
    s_addc_u32 s61, s61, 0
    v_add_f32 v12, v12, v98
    v_mfma_f32_16x16x32_bf16 v[160:163], v[32:35], v[64:67], v[160:163]
    ds_read_b64_tr_b16 v[48:49], v3 offset:4096
    ds_read_b64_tr_b16 v[50:51], v3 offset:4352
    v_mfma_f32_16x16x32_bf16 v[164:167], v[36:39], v[64:67], v[164:167]
    s_add_u32 m0, s57, 4096
    v_exp_f32 v100, v100
    v_mfma_f32_16x16x32_bf16 v[228:231], v[36:39], v[72:75], v[228:231]
    global_load_lds_dwordx4 v4, s[58:59] offset:-4096 sc1
    v_mfma_f32_16x16x32_bf16 v[224:227], v[32:35], v[72:75], v[224:227]
    v_add_f32 v12, v12, v99
    v_cvt_pk_bf16_f32 v97, v98, v99
    v_mfma_f32_16x16x32_bf16 a[160:163], v[32:35], v[80:83], a[160:163]
    ds_read_b64_tr_b16 v[52:53], v3 offset:5120
    ds_read_b64_tr_b16 v[54:55], v3 offset:5376
    v_mfma_f32_16x16x32_bf16 a[164:167], v[36:39], v[80:83], a[164:167]
    v_exp_f32 v101, v101
    v_mfma_f32_16x16x32_bf16 a[228:231], v[36:39], v[88:91], a[228:231]
    global_load_lds_dwordx4 v4, s[58:59] offset:-3072 sc1
    v_mfma_f32_16x16x32_bf16 a[224:227], v[32:35], v[88:91], a[224:227]
    s_waitcnt lgkmcnt(4)
    v_add_f32 v12, v12, v100
    v_mfma_f32_16x16x32_bf16 a[232:235], v[40:43], v[88:91], a[232:235]
    ds_read_b64_tr_b16 v[56:57], v3 offset:6144
    ds_read_b64_tr_b16 v[58:59], v3 offset:6400
    v_mfma_f32_16x16x32_bf16 a[236:239], v[44:47], v[88:91], a[236:239]
    v_exp_f32 v102, v102
    v_mfma_f32_16x16x32_bf16 a[172:175], v[44:47], v[80:83], a[172:175]
    global_load_lds_dwordx4 v4, s[58:59] offset:-2048 sc1
    v_mfma_f32_16x16x32_bf16 a[168:171], v[40:43], v[80:83], a[168:171]
    v_add_f32 v12, v12, v101
    v_cvt_pk_bf16_f32 v98, v100, v101
    v_mfma_f32_16x16x32_bf16 v[232:235], v[40:43], v[72:75], v[232:235]
    ds_read_b64_tr_b16 v[60:61], v3 offset:7168
    ds_read_b64_tr_b16 v[62:63], v3 offset:7424
    v_mfma_f32_16x16x32_bf16 v[236:239], v[44:47], v[72:75], v[236:239]
    v_exp_f32 v103, v103
    v_mfma_f32_16x16x32_bf16 v[172:175], v[44:47], v[64:67], v[172:175]
    global_load_lds_dwordx4 v4, s[58:59] offset:-1024 sc1
    v_mfma_f32_16x16x32_bf16 v[168:171], v[40:43], v[64:67], v[168:171]
    s_waitcnt lgkmcnt(4)
    v_add_f32 v12, v12, v102
    v_mfma_f32_16x16x32_bf16 v[176:179], v[48:51], v[64:67], v[176:179]
    ds_read_b128 v[32:35], v2 offset:24576
    v_mfma_f32_16x16x32_bf16 v[180:183], v[52:55], v[64:67], v[180:183]
    ds_read_b128 v[36:39], v2 offset:26624
    v_mfma_f32_16x16x32_bf16 v[244:247], v[52:55], v[72:75], v[244:247]
    global_load_lds_dwordx4 v5, s[58:59] offset:0 sc1
    v_mfma_f32_16x16x32_bf16 v[240:243], v[48:51], v[72:75], v[240:243]
    v_exp_f32 v104, v104
    v_mfma_f32_16x16x32_bf16 a[176:179], v[48:51], v[80:83], a[176:179]
    ds_read_b128 v[40:43], v2 offset:28672
    v_add_f32 v12, v12, v103
    v_mfma_f32_16x16x32_bf16 a[180:183], v[52:55], v[80:83], a[180:183]
    ds_read_b128 v[44:47], v2 offset:30720
    v_cvt_pk_bf16_f32 v99, v102, v103
    v_mfma_f32_16x16x32_bf16 a[244:247], v[52:55], v[88:91], a[244:247]
    global_load_lds_dwordx4 v5, s[58:59] offset:1024 sc1
    v_mfma_f32_16x16x32_bf16 a[240:243], v[48:51], v[88:91], a[240:243]
    s_waitcnt lgkmcnt(4)
    v_exp_f32 v105, v105
    v_mfma_f32_16x16x32_bf16 a[248:251], v[56:59], v[88:91], a[248:251]
    v_exp_f32 v106, v106
    v_mfma_f32_16x16x32_bf16 a[252:255], v[60:63], v[88:91], a[252:255]
    v_add_f32 v13, v104, v105
    v_cvt_pk_bf16_f32 v104, v104, v105
    v_mfma_f32_16x16x32_bf16 a[188:191], v[60:63], v[80:83], a[188:191]
    global_load_lds_dwordx4 v5, s[58:59] offset:2048 sc1
    v_mfma_f32_16x16x32_bf16 a[184:187], v[56:59], v[80:83], a[184:187]
    v_exp_f32 v107, v107
    v_mfma_f32_16x16x32_bf16 v[248:251], v[56:59], v[72:75], v[248:251]
    v_add_f32 v13, v13, v106
    v_mfma_f32_16x16x32_bf16 v[252:255], v[60:63], v[72:75], v[252:255]
    v_exp_f32 v108, v108
    v_mfma_f32_16x16x32_bf16 v[188:191], v[60:63], v[64:67], v[188:191]
    global_load_lds_dwordx4 v5, s[58:59] offset:3072 sc1
    v_mfma_f32_16x16x32_bf16 v[184:187], v[56:59], v[64:67], v[184:187]
    s_waitcnt lgkmcnt(0)
    s_add_u32 s58, s58, 16384
    s_addc_u32 s59, s59, 0
    v_add_f32 v13, v13, v107
    v_mfma_f32_16x16x32_bf16 v[64:67], v[32:35], a[0:3], v[16:19]
    ds_read_b128 v[48:51], v2 offset:24832
    v_cvt_pk_bf16_f32 v105, v106, v107
    v_mfma_f32_16x16x32_bf16 v[64:67], v[36:39], a[4:7], v[64:67]
    ds_read_b128 v[52:55], v2 offset:26880
    v_mfma_f32_16x16x32_bf16 v[64:67], v[40:43], a[8:11], v[64:67]
    v_exp_f32 v109, v109
    v_mfma_f32_16x16x32_bf16 v[64:67], v[44:47], a[12:15], v[64:67]
    v_add_f32 v13, v13, v108
    v_mfma_f32_16x16x32_bf16 v[72:75], v[44:47], a[44:47], v[20:23]
    ds_read_b128 v[56:59], v2 offset:28928
    v_mfma_f32_16x16x32_bf16 v[72:75], v[40:43], a[40:43], v[72:75]
    ds_read_b128 v[60:63], v2 offset:30976
    v_mfma_f32_16x16x32_bf16 v[72:75], v[36:39], a[36:39], v[72:75]
    v_exp_f32 v110, v110
    v_mfma_f32_16x16x32_bf16 v[72:75], v[32:35], a[32:35], v[72:75]
    v_add_f32 v13, v13, v109
    v_cvt_pk_bf16_f32 v106, v108, v109
    v_mfma_f32_16x16x32_bf16 v[80:83], v[32:35], a[64:67], v[24:27]
    v_exp_f32 v111, v111
    v_mfma_f32_16x16x32_bf16 v[80:83], v[36:39], a[68:71], v[80:83]
    v_add_f32 v13, v13, v110
    v_mfma_f32_16x16x32_bf16 v[80:83], v[40:43], a[72:75], v[80:83]
    v_exp_f32 v112, v112
    v_mfma_f32_16x16x32_bf16 v[80:83], v[44:47], a[76:79], v[80:83]
    v_add_f32 v13, v13, v111
    v_mfma_f32_16x16x32_bf16 v[88:91], v[44:47], a[108:111], v[28:31]
    v_cvt_pk_bf16_f32 v107, v110, v111
    v_mfma_f32_16x16x32_bf16 v[88:91], v[40:43], a[104:107], v[88:91]
    v_exp_f32 v113, v113
    v_mfma_f32_16x16x32_bf16 v[88:91], v[36:39], a[100:103], v[88:91]
    v_exp_f32 v114, v114
    v_mfma_f32_16x16x32_bf16 v[88:91], v[32:35], a[96:99], v[88:91]
    s_waitcnt vmcnt(12) lgkmcnt(0)
    v_add_f32 v14, v112, v113
    v_mfma_f32_16x16x32_bf16 v[92:95], v[48:51], a[96:99], v[28:31]
    ds_read_b128 v[32:35], v2 offset:33024
    v_mfma_f32_16x16x32_bf16 v[92:95], v[52:55], a[100:103], v[92:95]
    ds_read_b128 v[36:39], v2 offset:35072
    v_cvt_pk_bf16_f32 v112, v112, v113
    v_mfma_f32_16x16x32_bf16 v[92:95], v[56:59], a[104:107], v[92:95]
    v_exp_f32 v115, v115
    v_mfma_f32_16x16x32_bf16 v[92:95], v[60:63], a[108:111], v[92:95]
    s_waitcnt vmcnt(8)
    v_add_f32 v14, v14, v114
    v_mfma_f32_16x16x32_bf16 v[84:87], v[60:63], a[76:79], v[24:27]
    ds_read_b128 v[40:43], v2 offset:37120
    v_mfma_f32_16x16x32_bf16 v[84:87], v[56:59], a[72:75], v[84:87]
    ds_read_b128 v[44:47], v2 offset:39168
    v_mfma_f32_16x16x32_bf16 v[84:87], v[52:55], a[68:71], v[84:87]
    v_exp_f32 v116, v116
    v_mfma_f32_16x16x32_bf16 v[84:87], v[48:51], a[64:67], v[84:87]
    v_add_f32 v14, v14, v115
    v_cvt_pk_bf16_f32 v113, v114, v115
    v_mfma_f32_16x16x32_bf16 v[76:79], v[48:51], a[32:35], v[20:23]
    v_exp_f32 v117, v117
    v_mfma_f32_16x16x32_bf16 v[76:79], v[52:55], a[36:39], v[76:79]
    v_mfma_f32_16x16x32_bf16 v[76:79], v[56:59], a[40:43], v[76:79]
    v_add_f32 v14, v14, v116
    v_mfma_f32_16x16x32_bf16 v[76:79], v[60:63], a[44:47], v[76:79]
    v_exp_f32 v118, v118
    v_mfma_f32_16x16x32_bf16 v[68:71], v[60:63], a[12:15], v[16:19]
    v_add_f32 v14, v14, v117
    v_mfma_f32_16x16x32_bf16 v[68:71], v[56:59], a[8:11], v[68:71]
    v_cvt_pk_bf16_f32 v114, v116, v117
    v_mfma_f32_16x16x32_bf16 v[68:71], v[52:55], a[4:7], v[68:71]
    v_exp_f32 v119, v119
    v_mfma_f32_16x16x32_bf16 v[68:71], v[48:51], a[0:3], v[68:71]
    s_waitcnt lgkmcnt(0)
    v_add_f32 v14, v14, v118
    v_mfma_f32_16x16x32_bf16 v[68:71], v[32:35], a[16:19], v[68:71]
    ds_read_b128 v[48:51], v2 offset:32768
    v_mfma_f32_16x16x32_bf16 v[68:71], v[36:39], a[20:23], v[68:71]
    ds_read_b128 v[52:55], v2 offset:34816
    v_mfma_f32_16x16x32_bf16 v[68:71], v[40:43], a[24:27], v[68:71]
    v_exp_f32 v120, v120
    v_mfma_f32_16x16x32_bf16 v[68:71], v[44:47], a[28:31], v[68:71]
    v_add_f32 v14, v14, v119
    v_cvt_pk_bf16_f32 v115, v118, v119
    v_mfma_f32_16x16x32_bf16 v[76:79], v[44:47], a[60:63], v[76:79]
    ds_read_b128 v[56:59], v2 offset:36864
    v_mfma_f32_16x16x32_bf16 v[76:79], v[40:43], a[56:59], v[76:79]
    ds_read_b128 v[60:63], v2 offset:38912
    v_mfma_f32_16x16x32_bf16 v[76:79], v[36:39], a[52:55], v[76:79]
    v_exp_f32 v121, v121
    v_mfma_f32_16x16x32_bf16 v[76:79], v[32:35], a[48:51], v[76:79]
    v_exp_f32 v122, v122
    v_mfma_f32_16x16x32_bf16 v[84:87], v[32:35], a[80:83], v[84:87]
    v_add_f32 v15, v120, v121
    v_cvt_pk_bf16_f32 v120, v120, v121
    v_mfma_f32_16x16x32_bf16 v[84:87], v[36:39], a[84:87], v[84:87]
    v_exp_f32 v123, v123
    v_mfma_f32_16x16x32_bf16 v[84:87], v[40:43], a[88:91], v[84:87]
    v_add_f32 v15, v15, v122
    v_mfma_f32_16x16x32_bf16 v[84:87], v[44:47], a[92:95], v[84:87]
    v_exp_f32 v124, v124
    v_mfma_f32_16x16x32_bf16 v[92:95], v[44:47], a[124:127], v[92:95]
    v_add_f32 v15, v15, v123
    v_mfma_f32_16x16x32_bf16 v[92:95], v[40:43], a[120:123], v[92:95]
    v_cvt_pk_bf16_f32 v121, v122, v123
    v_mfma_f32_16x16x32_bf16 v[92:95], v[36:39], a[116:119], v[92:95]
    v_exp_f32 v125, v125
    v_mfma_f32_16x16x32_bf16 v[92:95], v[32:35], a[112:115], v[92:95]
    s_waitcnt lgkmcnt(0)
    v_add_f32 v15, v15, v124
    v_mfma_f32_16x16x32_bf16 v[88:91], v[48:51], a[112:115], v[88:91]
    ds_read_b64_tr_b16 v[32:33], v3 offset:8192
    ds_read_b64_tr_b16 v[34:35], v3 offset:8448
    v_mfma_f32_16x16x32_bf16 v[88:91], v[52:55], a[116:119], v[88:91]
    v_exp_f32 v126, v126
    v_mfma_f32_16x16x32_bf16 v[88:91], v[56:59], a[120:123], v[88:91]
    v_mfma_f32_16x16x32_bf16 v[88:91], v[60:63], a[124:127], v[88:91]
    v_add_f32 v15, v15, v125
    v_cvt_pk_bf16_f32 v122, v124, v125
    v_mfma_f32_16x16x32_bf16 v[80:83], v[60:63], a[92:95], v[80:83]
    ds_read_b64_tr_b16 v[36:37], v3 offset:9216
    ds_read_b64_tr_b16 v[38:39], v3 offset:9472
    v_mfma_f32_16x16x32_bf16 v[80:83], v[56:59], a[88:91], v[80:83]
    v_exp_f32 v127, v127
    v_mfma_f32_16x16x32_bf16 v[80:83], v[52:55], a[84:87], v[80:83]
    v_mfma_f32_16x16x32_bf16 v[80:83], v[48:51], a[80:83], v[80:83]
    v_add_f32 v15, v15, v126
    v_max3_f32 v7, v12, v13, v14
    v_mfma_f32_16x16x32_bf16 v[72:75], v[48:51], a[48:51], v[72:75]
    ds_read_b64_tr_b16 v[40:41], v3 offset:10240
    ds_read_b64_tr_b16 v[42:43], v3 offset:10496
    v_mfma_f32_16x16x32_bf16 v[72:75], v[52:55], a[52:55], v[72:75]
    v_add_f32 v15, v15, v127
    v_mfma_f32_16x16x32_bf16 v[72:75], v[56:59], a[56:59], v[72:75]
    v_cvt_pk_bf16_f32 v123, v126, v127
    v_mfma_f32_16x16x32_bf16 v[72:75], v[60:63], a[60:63], v[72:75]
    v_add_f32 v7, v7, v15
    v_cmp_nge_f32 vcc, s62, v7
    v_mfma_f32_16x16x32_bf16 v[64:67], v[60:63], a[28:31], v[64:67]
    ds_read_b64_tr_b16 v[44:45], v3 offset:11264
    ds_read_b64_tr_b16 v[46:47], v3 offset:11520
    v_mfma_f32_16x16x32_bf16 v[64:67], v[56:59], a[24:27], v[64:67]
    v_mfma_f32_16x16x32_bf16 v[64:67], v[52:55], a[20:23], v[64:67]
    v_mfma_f32_16x16x32_bf16 v[64:67], v[48:51], a[16:19], v[64:67]
    s_waitcnt lgkmcnt(4)
    s_cbranch_vccnz L_stub_i13
L_back_i13:
    v_mfma_f32_16x16x32_bf16 v[128:131], v[32:35], v[96:99], v[128:131]
    ds_read_b64_tr_b16 v[48:49], v3 offset:12288
    ds_read_b64_tr_b16 v[50:51], v3 offset:12544
    v_mfma_f32_16x16x32_bf16 v[132:135], v[36:39], v[96:99], v[132:135]
    s_add_u32 m0, s57, 12288
    v_add_f32 v8, v8, v12
    v_add_f32 v9, v9, v13
    v_mfma_f32_16x16x32_bf16 v[196:199], v[36:39], v[104:107], v[196:199]
    global_load_lds_dwordx4 v4, s[60:61] offset:-4096 sc1
    v_mfma_f32_16x16x32_bf16 v[192:195], v[32:35], v[104:107], v[192:195]
    v_add_f32 v10, v10, v14
    v_add_f32 v11, v11, v15
    v_mfma_f32_16x16x32_bf16 a[128:131], v[32:35], v[112:115], a[128:131]
    ds_read_b64_tr_b16 v[52:53], v3 offset:13312
    ds_read_b64_tr_b16 v[54:55], v3 offset:13568
    v_mfma_f32_16x16x32_bf16 a[132:135], v[36:39], v[112:115], a[132:135]
    v_mfma_f32_16x16x32_bf16 a[196:199], v[36:39], v[120:123], a[196:199]
    global_load_lds_dwordx4 v4, s[60:61] offset:-3072 sc1
    v_mfma_f32_16x16x32_bf16 a[192:195], v[32:35], v[120:123], a[192:195]
    s_waitcnt lgkmcnt(4)
    v_exp_f32 v64, v64
    v_mfma_f32_16x16x32_bf16 a[200:203], v[40:43], v[120:123], a[200:203]
    ds_read_b64_tr_b16 v[56:57], v3 offset:14336
    ds_read_b64_tr_b16 v[58:59], v3 offset:14592
    v_mfma_f32_16x16x32_bf16 a[204:207], v[44:47], v[120:123], a[204:207]
    v_exp_f32 v65, v65
    v_mfma_f32_16x16x32_bf16 a[140:143], v[44:47], v[112:115], a[140:143]
    global_load_lds_dwordx4 v4, s[60:61] offset:-2048 sc1
    v_mfma_f32_16x16x32_bf16 a[136:139], v[40:43], v[112:115], a[136:139]
    v_exp_f32 v66, v66
    v_mfma_f32_16x16x32_bf16 v[200:203], v[40:43], v[104:107], v[200:203]
    ds_read_b64_tr_b16 v[60:61], v3 offset:15360
    ds_read_b64_tr_b16 v[62:63], v3 offset:15616
    v_mfma_f32_16x16x32_bf16 v[204:207], v[44:47], v[104:107], v[204:207]
    v_mfma_f32_16x16x32_bf16 v[140:143], v[44:47], v[96:99], v[140:143]
    global_load_lds_dwordx4 v4, s[60:61] offset:-1024 sc1
    v_mfma_f32_16x16x32_bf16 v[136:139], v[40:43], v[96:99], v[136:139]
    s_waitcnt lgkmcnt(4)
    v_add_f32 v12, v64, v65
    v_cvt_pk_bf16_f32 v64, v64, v65
    v_mfma_f32_16x16x32_bf16 v[144:147], v[48:51], v[96:99], v[144:147]
    ds_read_b64_tr_b16 v[32:33], v3 offset:16384
    ds_read_b64_tr_b16 v[34:35], v3 offset:16640
    v_mfma_f32_16x16x32_bf16 v[148:151], v[52:55], v[96:99], v[148:151]
    v_exp_f32 v67, v67
    v_mfma_f32_16x16x32_bf16 v[212:215], v[52:55], v[104:107], v[212:215]
    global_load_lds_dwordx4 v5, s[60:61] offset:0 sc1
    v_mfma_f32_16x16x32_bf16 v[208:211], v[48:51], v[104:107], v[208:211]
    v_mfma_f32_16x16x32_bf16 a[144:147], v[48:51], v[112:115], a[144:147]
    ds_read_b64_tr_b16 v[36:37], v3 offset:17408
    ds_read_b64_tr_b16 v[38:39], v3 offset:17664
    v_mfma_f32_16x16x32_bf16 a[148:151], v[52:55], v[112:115], a[148:151]
    v_add_f32 v12, v12, v66
    v_mfma_f32_16x16x32_bf16 a[212:215], v[52:55], v[120:123], a[212:215]
    global_load_lds_dwordx4 v5, s[60:61] offset:1024 sc1
    v_mfma_f32_16x16x32_bf16 a[208:211], v[48:51], v[120:123], a[208:211]
    s_waitcnt lgkmcnt(4)
    v_exp_f32 v68, v68
    v_mfma_f32_16x16x32_bf16 a[216:219], v[56:59], v[120:123], a[216:219]
    ds_read_b64_tr_b16 v[40:41], v3 offset:18432
    ds_read_b64_tr_b16 v[42:43], v3 offset:18688
    v_mfma_f32_16x16x32_bf16 a[220:223], v[60:63], v[120:123], a[220:223]
    v_add_f32 v12, v12, v67
    v_cvt_pk_bf16_f32 v65, v66, v67
    v_mfma_f32_16x16x32_bf16 a[156:159], v[60:63], v[112:115], a[156:159]
    global_load_lds_dwordx4 v5, s[60:61] offset:2048 sc1
    v_mfma_f32_16x16x32_bf16 a[152:155], v[56:59], v[112:115], a[152:155]
    v_exp_f32 v69, v69
    v_mfma_f32_16x16x32_bf16 v[216:219], v[56:59], v[104:107], v[216:219]
    ds_read_b64_tr_b16 v[44:45], v3 offset:19456
    ds_read_b64_tr_b16 v[46:47], v3 offset:19712
    v_mfma_f32_16x16x32_bf16 v[220:223], v[60:63], v[104:107], v[220:223]
    v_add_f32 v12, v12, v68
    v_mfma_f32_16x16x32_bf16 v[156:159], v[60:63], v[96:99], v[156:159]
    global_load_lds_dwordx4 v5, s[60:61] offset:3072 sc1
    v_mfma_f32_16x16x32_bf16 v[152:155], v[56:59], v[96:99], v[152:155]
    s_waitcnt lgkmcnt(4)
    s_add_u32 s60, s60, 16384
    s_addc_u32 s61, s61, 0
    v_exp_f32 v70, v70
    v_mfma_f32_16x16x32_bf16 v[160:163], v[32:35], v[96:99], v[160:163]
    ds_read_b64_tr_b16 v[48:49], v3 offset:20480
    ds_read_b64_tr_b16 v[50:51], v3 offset:20736
    v_mfma_f32_16x16x32_bf16 v[164:167], v[36:39], v[96:99], v[164:167]
    s_add_u32 m0, s57, 16384
    s_lshr_b32 s70, s3, 3
    s_lshl_b32 s70, s70, 2
    v_lshlrev_b32 v4, 7, v1
    v_mfma_f32_16x16x32_bf16 v[228:231], v[36:39], v[104:107], v[228:231]
    buffer_load_dwordx4 v0, s[44:47], 0 offen offset:0 sc1 lds
    v_mfma_f32_16x16x32_bf16 v[224:227], v[32:35], v[104:107], v[224:227]
    s_add_u32 s70, s70, s52
    s_and_b32 s70, s70, 63
    v_nop
    v_mfma_f32_16x16x32_bf16 a[160:163], v[32:35], v[112:115], a[160:163]
    ds_read_b64_tr_b16 v[52:53], v3 offset:21504
    ds_read_b64_tr_b16 v[54:55], v3 offset:21760
    v_mfma_f32_16x16x32_bf16 a[164:167], v[36:39], v[112:115], a[164:167]
    s_add_u32 m0, s57, 15360
    s_mul_i32 s70, s70, 6144
    s_add_u32 s70, s70, 6422528
    v_min_u32 v4, 6016, v4
    v_add_f32 v12, v12, v69
    v_mfma_f32_16x16x32_bf16 a[228:231], v[36:39], v[120:123], a[228:231]
    buffer_load_dwordx4 v0, s[44:47], 0 offen offset:2048 sc1 lds
    v_mfma_f32_16x16x32_bf16 a[224:227], v[32:35], v[120:123], a[224:227]
    s_waitcnt lgkmcnt(4)
    v_cvt_pk_bf16_f32 v66, v68, v69
    v_mfma_f32_16x16x32_bf16 a[232:235], v[40:43], v[120:123], a[232:235]
    ds_read_b64_tr_b16 v[56:57], v3 offset:22528
    ds_read_b64_tr_b16 v[58:59], v3 offset:22784
    v_mfma_f32_16x16x32_bf16 a[236:239], v[44:47], v[120:123], a[236:239]
    s_add_u32 m0, s57, 18368
    v_exp_f32 v71, v71
    v_mfma_f32_16x16x32_bf16 a[172:175], v[44:47], v[112:115], a[172:175]
    buffer_load_dwordx4 v0, s[44:47], 0 offen offset:64 sc1 lds
    v_mfma_f32_16x16x32_bf16 a[168:171], v[40:43], v[112:115], a[168:171]
    buffer_load_dword v5, v4, s[40:43], s70 offen
    v_mfma_f32_16x16x32_bf16 v[232:235], v[40:43], v[104:107], v[232:235]
    ds_read_b64_tr_b16 v[60:61], v3 offset:23552
    ds_read_b64_tr_b16 v[62:63], v3 offset:23808
    v_mfma_f32_16x16x32_bf16 v[236:239], v[44:47], v[104:107], v[236:239]
    s_add_u32 m0, s57, 17344
    v_add_f32 v12, v12, v70
    v_mfma_f32_16x16x32_bf16 v[172:175], v[44:47], v[96:99], v[172:175]
    buffer_load_dwordx4 v0, s[44:47], 0 offen offset:2112 sc1 lds
    v_mfma_f32_16x16x32_bf16 v[168:171], v[40:43], v[96:99], v[168:171]
    s_waitcnt vmcnt(13) lgkmcnt(4)
    v_exp_f32 v72, v72
    v_mfma_f32_16x16x32_bf16 v[176:179], v[48:51], v[96:99], v[176:179]
    ds_read_b128 v[32:35], v2 offset:0
    v_mfma_f32_16x16x32_bf16 v[180:183], v[52:55], v[96:99], v[180:183]
    s_add_u32 m0, s57, 20480
    ds_read_b128 v[36:39], v2 offset:2048
    v_add_f32 v12, v12, v71
    v_mfma_f32_16x16x32_bf16 v[244:247], v[52:55], v[104:107], v[244:247]
    buffer_load_dwordx4 v6, s[40:43], s71 offen offset:0 sc1 lds
    v_mfma_f32_16x16x32_bf16 v[240:243], v[48:51], v[104:107], v[240:243]
    v_cvt_pk_bf16_f32 v67, v70, v71
    v_mfma_f32_16x16x32_bf16 a[176:179], v[48:51], v[112:115], a[176:179]
    ds_read_b128 v[40:43], v2 offset:4096
    v_mfma_f32_16x16x32_bf16 a[180:183], v[52:55], v[112:115], a[180:183]
    ds_read_b128 v[44:47], v2 offset:6144
    v_mfma_f32_16x16x32_bf16 a[244:247], v[52:55], v[120:123], a[244:247]
    buffer_load_dwordx4 v6, s[40:43], s71 offen offset:1024 sc1 lds
    v_mfma_f32_16x16x32_bf16 a[240:243], v[48:51], v[120:123], a[240:243]
    s_waitcnt lgkmcnt(4)
    v_exp_f32 v73, v73
    v_mfma_f32_16x16x32_bf16 a[248:251], v[56:59], v[120:123], a[248:251]
    v_exp_f32 v74, v74
    v_mfma_f32_16x16x32_bf16 a[252:255], v[60:63], v[120:123], a[252:255]
    v_add_f32 v13, v72, v73
    v_cvt_pk_bf16_f32 v72, v72, v73
    v_mfma_f32_16x16x32_bf16 a[188:191], v[60:63], v[112:115], a[188:191]
    buffer_load_dwordx4 v6, s[40:43], s71 offen offset:2048 sc1 lds
    v_mfma_f32_16x16x32_bf16 a[184:187], v[56:59], v[112:115], a[184:187]
    v_exp_f32 v75, v75
    v_mfma_f32_16x16x32_bf16 v[248:251], v[56:59], v[104:107], v[248:251]
    v_add_f32 v13, v13, v74
    v_mfma_f32_16x16x32_bf16 v[252:255], v[60:63], v[104:107], v[252:255]
    v_exp_f32 v76, v76
    v_mfma_f32_16x16x32_bf16 v[188:191], v[60:63], v[96:99], v[188:191]
    buffer_load_dwordx4 v6, s[40:43], s71 offen offset:3072 sc1 lds
    v_mfma_f32_16x16x32_bf16 v[184:187], v[56:59], v[96:99], v[184:187]
    s_waitcnt lgkmcnt(0)
    v_add_f32 v13, v13, v75
    s_cmp_lg_u32 s64, 0
    s_cbranch_scc1 L_n15
    v_mfma_f32_16x16x32_bf16 v[96:99], v[32:35], a[0:3], v[16:19]
    ds_read_b128 v[48:51], v2 offset:256
    v_cvt_pk_bf16_f32 v73, v74, v75
    v_mfma_f32_16x16x32_bf16 v[96:99], v[36:39], a[4:7], v[96:99]
    s_lshl_b32 s70, s55, 4
    s_sub_u32 s70, s70, 4
    ds_read_b128 v[52:55], v2 offset:2304
    v_mov_b32 v0, v6
    v_mfma_f32_16x16x32_bf16 v[96:99], v[40:43], a[8:11], v[96:99]
    v_exp_f32 v77, v77
    v_mfma_f32_16x16x32_bf16 v[96:99], v[44:47], a[12:15], v[96:99]
    s_lshl_b32 s81, s52, 15
    v_lshrrev_b32 v4, 5, v1
    v_add_f32 v13, v13, v76
    v_mfma_f32_16x16x32_bf16 v[104:107], v[44:47], a[44:47], v[20:23]
    ds_read_b128 v[56:59], v2 offset:4352
    v_mfma_f32_16x16x32_bf16 v[104:107], v[40:43], a[40:43], v[104:107]
    s_add_u32 s81, s81, 6422528
    ds_read_b128 v[60:63], v2 offset:6400
    v_mul_u32_u24 v6, 40, v4
    v_mfma_f32_16x16x32_bf16 v[104:107], v[36:39], a[36:39], v[104:107]
    v_exp_f32 v78, v78
    v_mfma_f32_16x16x32_bf16 v[104:107], v[32:35], a[32:35], v[104:107]
    v_sub_u32 v6, v1, v6
    v_add_f32 v13, v13, v77
    v_mfma_f32_16x16x32_bf16 v[112:115], v[32:35], a[64:67], v[24:27]
    v_cvt_pk_bf16_f32 v74, v76, v77
    v_mfma_f32_16x16x32_bf16 v[112:115], v[36:39], a[68:71], v[112:115]
    v_add_u32 v6, s70, v6
    v_mfma_f32_16x16x32_bf16 v[112:115], v[40:43], a[72:75], v[112:115]
    v_exp_f32 v79, v79
    v_mfma_f32_16x16x32_bf16 v[112:115], v[44:47], a[76:79], v[112:115]
    s_movk_i32 s70, 2000
    v_cmp_gt_u32 s[72:73], s70, v6
    v_add_f32 v13, v13, v78
    v_mfma_f32_16x16x32_bf16 v[120:123], v[44:47], a[108:111], v[28:31]
    v_exp_f32 v80, v80
    v_mfma_f32_16x16x32_bf16 v[120:123], v[40:43], a[104:107], v[120:123]
    v_mul_u32_u24 v4, 256000, v4
    v_add_f32 v13, v13, v79
    v_mfma_f32_16x16x32_bf16 v[120:123], v[36:39], a[100:103], v[120:123]
    v_cvt_pk_bf16_f32 v75, v78, v79
    v_mfma_f32_16x16x32_bf16 v[120:123], v[32:35], a[96:99], v[120:123]
    s_waitcnt vmcnt(13) lgkmcnt(0)
    v_lshl_add_u32 v6, v6, 4, v4
    v_mfma_f32_16x16x32_bf16 v[124:127], v[48:51], a[96:99], v[28:31]
    ds_read_b128 v[32:35], v2 offset:8448
    v_mfma_f32_16x16x32_bf16 v[124:127], v[52:55], a[100:103], v[124:127]
    s_and_b32 s72, s72, 0xffffff
    s_and_b32 s73, s73, 0xffffff00
    ds_read_b128 v[36:39], v2 offset:10496
    v_mov_b32 v4, 0x40000000
    v_mfma_f32_16x16x32_bf16 v[124:127], v[56:59], a[104:107], v[124:127]
    v_exp_f32 v81, v81
    v_mfma_f32_16x16x32_bf16 v[124:127], v[60:63], a[108:111], v[124:127]
    s_waitcnt vmcnt(9)
    s_mul_i32 s71, s52, 512000
    v_cndmask_b32 v6, v4, v6, s[72:73]
    v_mfma_f32_16x16x32_bf16 v[116:119], v[60:63], a[76:79], v[24:27]
    ds_read_b128 v[40:43], v2 offset:12544
    v_mfma_f32_16x16x32_bf16 v[116:119], v[56:59], a[72:75], v[116:119]
    ds_read_b128 v[44:47], v2 offset:14592
    v_mfma_f32_16x16x32_bf16 v[116:119], v[52:55], a[68:71], v[116:119]
    v_exp_f32 v82, v82
    v_mfma_f32_16x16x32_bf16 v[116:119], v[48:51], a[64:67], v[116:119]
    v_add_f32 v14, v80, v81
    v_cvt_pk_bf16_f32 v80, v80, v81
    v_mfma_f32_16x16x32_bf16 v[108:111], v[48:51], a[32:35], v[20:23]
    v_exp_f32 v83, v83
    v_mfma_f32_16x16x32_bf16 v[108:111], v[52:55], a[36:39], v[108:111]
    v_add_f32 v14, v14, v82
    v_mfma_f32_16x16x32_bf16 v[108:111], v[56:59], a[40:43], v[108:111]
    v_exp_f32 v84, v84
    v_mfma_f32_16x16x32_bf16 v[108:111], v[60:63], a[44:47], v[108:111]
    v_add_f32 v14, v14, v83
    v_cvt_pk_bf16_f32 v81, v82, v83
    v_mfma_f32_16x16x32_bf16 v[100:103], v[60:63], a[12:15], v[16:19]
    v_exp_f32 v85, v85
    v_mfma_f32_16x16x32_bf16 v[100:103], v[56:59], a[8:11], v[100:103]
    s_lshl_b32 s70, s55, 14
    s_lshl_b32 s72, s52, 7
    v_lshrrev_b32 v4, 3, v1
    v_add_f32 v14, v14, v84
    v_mfma_f32_16x16x32_bf16 v[100:103], v[52:55], a[4:7], v[100:103]
    v_exp_f32 v86, v86
    v_mfma_f32_16x16x32_bf16 v[100:103], v[48:51], a[0:3], v[100:103]
    s_waitcnt lgkmcnt(0)
    s_add_u32 s70, s70, s72
    v_mul_u32_u24 v4, 384, v4
    v_add_f32 v14, v14, v85
    v_mfma_f32_16x16x32_bf16 v[100:103], v[32:35], a[16:19], v[100:103]
    ds_read_b128 v[48:51], v2 offset:8192
    v_cvt_pk_bf16_f32 v82, v84, v85
    v_mfma_f32_16x16x32_bf16 v[100:103], v[36:39], a[20:23], v[100:103]
    ds_read_b128 v[52:55], v2 offset:10240
    v_add_u32 v4, v4, v0
    v_mfma_f32_16x16x32_bf16 v[100:103], v[40:43], a[24:27], v[100:103]
    v_exp_f32 v87, v87
    v_mfma_f32_16x16x32_bf16 v[100:103], v[44:47], a[28:31], v[100:103]
    v_add_f32 v14, v14, v86
    v_mfma_f32_16x16x32_bf16 v[108:111], v[44:47], a[60:63], v[108:111]
    ds_read_b128 v[56:59], v2 offset:12288
    v_mfma_f32_16x16x32_bf16 v[108:111], v[40:43], a[56:59], v[108:111]
    ds_read_b128 v[60:63], v2 offset:14336
L_pk9:
    s_cbranch_execz L_pk10
    v_mfma_f32_16x16x32_bf16 v[108:111], v[36:39], a[52:55], v[108:111]
    v_exp_f32 v88, v88
    v_mfma_f32_16x16x32_bf16 v[108:111], v[32:35], a[48:51], v[108:111]
    v_add_f32 v14, v14, v87
    v_cvt_pk_bf16_f32 v83, v86, v87
    v_mfma_f32_16x16x32_bf16 v[116:119], v[32:35], a[80:83], v[116:119]
    v_exp_f32 v89, v89
    v_mfma_f32_16x16x32_bf16 v[116:119], v[36:39], a[84:87], v[116:119]
    s_lshl_b32 s82, s52, 7
    s_add_u32 s82, s82, 36880
    v_exp_f32 v90, v90
    v_mfma_f32_16x16x32_bf16 v[116:119], v[40:43], a[88:91], v[116:119]
    v_add_f32 v15, v88, v89
    v_cvt_pk_bf16_f32 v88, v88, v89
    v_mfma_f32_16x16x32_bf16 v[116:119], v[44:47], a[92:95], v[116:119]
    buffer_load_dword v5, off, s[40:43], s82 sc1
    v_mfma_f32_16x16x32_bf16 v[124:127], v[44:47], a[124:127], v[124:127]
    v_exp_f32 v91, v91
    v_mfma_f32_16x16x32_bf16 v[124:127], v[40:43], a[120:123], v[124:127]
    v_add_f32 v15, v15, v90
    v_mfma_f32_16x16x32_bf16 v[124:127], v[36:39], a[116:119], v[124:127]
    v_exp_f32 v92, v92
    v_mfma_f32_16x16x32_bf16 v[124:127], v[32:35], a[112:115], v[124:127]
    s_waitcnt lgkmcnt(0)
    v_add_f32 v15, v15, v91
    v_cvt_pk_bf16_f32 v89, v90, v91
    v_mfma_f32_16x16x32_bf16 v[120:123], v[48:51], a[112:115], v[120:123]
    ds_read_b64_tr_b16 v[32:33], v3 offset:24576
    ds_read_b64_tr_b16 v[34:35], v3 offset:24832
    v_mfma_f32_16x16x32_bf16 v[120:123], v[52:55], a[116:119], v[120:123]
    v_exp_f32 v93, v93
    v_mfma_f32_16x16x32_bf16 v[120:123], v[56:59], a[120:123], v[120:123]
    v_add_f32 v15, v15, v92
    v_mfma_f32_16x16x32_bf16 v[120:123], v[60:63], a[124:127], v[120:123]
    v_exp_f32 v94, v94
    v_mfma_f32_16x16x32_bf16 v[112:115], v[60:63], a[92:95], v[112:115]
    ds_read_b64_tr_b16 v[36:37], v3 offset:25600
    ds_read_b64_tr_b16 v[38:39], v3 offset:25856
    v_mfma_f32_16x16x32_bf16 v[112:115], v[56:59], a[88:91], v[112:115]
    v_add_f32 v15, v15, v93
    v_cvt_pk_bf16_f32 v90, v92, v93
    v_mfma_f32_16x16x32_bf16 v[112:115], v[52:55], a[84:87], v[112:115]
    v_exp_f32 v95, v95
    v_mfma_f32_16x16x32_bf16 v[112:115], v[48:51], a[80:83], v[112:115]
    v_add_f32 v15, v15, v94
    v_mfma_f32_16x16x32_bf16 v[104:107], v[48:51], a[48:51], v[104:107]
    ds_read_b64_tr_b16 v[40:41], v3 offset:26624
    ds_read_b64_tr_b16 v[42:43], v3 offset:26880
    v_mfma_f32_16x16x32_bf16 v[104:107], v[52:55], a[52:55], v[104:107]
    v_max3_f32 v7, v12, v13, v14
    v_add_f32 v15, v15, v95
    v_mfma_f32_16x16x32_bf16 v[104:107], v[56:59], a[56:59], v[104:107]
    v_cvt_pk_bf16_f32 v91, v94, v95
    v_add_f32 v7, v7, v15
    v_mfma_f32_16x16x32_bf16 v[104:107], v[60:63], a[60:63], v[104:107]
    v_cmp_nge_f32 vcc, s62, v7
    v_mfma_f32_16x16x32_bf16 v[96:99], v[60:63], a[28:31], v[96:99]
    ds_read_b64_tr_b16 v[44:45], v3 offset:27648
    ds_read_b64_tr_b16 v[46:47], v3 offset:27904
    v_mfma_f32_16x16x32_bf16 v[96:99], v[56:59], a[24:27], v[96:99]
    v_mfma_f32_16x16x32_bf16 v[96:99], v[52:55], a[20:23], v[96:99]
    v_mfma_f32_16x16x32_bf16 v[96:99], v[48:51], a[16:19], v[96:99]
    s_waitcnt lgkmcnt(4)
    s_cbranch_vccnz L_stub_i14
L_back_i14:
    v_mfma_f32_16x16x32_bf16 v[128:131], v[32:35], v[64:67], v[128:131]
    ds_read_b64_tr_b16 v[48:49], v3 offset:28672
    ds_read_b64_tr_b16 v[50:51], v3 offset:28928
    v_mfma_f32_16x16x32_bf16 v[132:135], v[36:39], v[64:67], v[132:135]
    v_add_f32 v8, v8, v12
    v_add_f32 v9, v9, v13
    v_mfma_f32_16x16x32_bf16 v[196:199], v[36:39], v[72:75], v[196:199]
    v_mfma_f32_16x16x32_bf16 v[192:195], v[32:35], v[72:75], v[192:195]
    v_add_f32 v10, v10, v14
    v_add_f32 v11, v11, v15
    v_mfma_f32_16x16x32_bf16 a[128:131], v[32:35], v[80:83], a[128:131]
    ds_read_b64_tr_b16 v[52:53], v3 offset:29696
    ds_read_b64_tr_b16 v[54:55], v3 offset:29952
    v_mfma_f32_16x16x32_bf16 a[132:135], v[36:39], v[80:83], a[132:135]
    s_add_u32 m0, s57, 24576
    v_mfma_f32_16x16x32_bf16 a[196:199], v[36:39], v[88:91], a[196:199]
    buffer_load_dwordx4 v6, s[36:39], s71 offen sc1 lds
    v_mfma_f32_16x16x32_bf16 a[192:195], v[32:35], v[88:91], a[192:195]
    s_waitcnt lgkmcnt(4)
    s_add_u32 s71, s71, 32000
    v_exp_f32 v96, v96
    v_mfma_f32_16x16x32_bf16 a[200:203], v[40:43], v[88:91], a[200:203]
    ds_read_b64_tr_b16 v[56:57], v3 offset:30720
    ds_read_b64_tr_b16 v[58:59], v3 offset:30976
    v_mfma_f32_16x16x32_bf16 a[204:207], v[44:47], v[88:91], a[204:207]
    v_exp_f32 v97, v97
    v_mfma_f32_16x16x32_bf16 a[140:143], v[44:47], v[80:83], a[140:143]
    v_exp_f32 v98, v98
    v_mfma_f32_16x16x32_bf16 a[136:139], v[40:43], v[80:83], a[136:139]
    v_add_f32 v12, v96, v97
    v_cvt_pk_bf16_f32 v96, v96, v97
    v_mfma_f32_16x16x32_bf16 v[200:203], v[40:43], v[72:75], v[200:203]
    ds_read_b64_tr_b16 v[60:61], v3 offset:31744
    ds_read_b64_tr_b16 v[62:63], v3 offset:32000
    v_mfma_f32_16x16x32_bf16 v[204:207], v[44:47], v[72:75], v[204:207]
    s_add_u32 m0, s57, 25616
    v_exp_f32 v99, v99
    v_mfma_f32_16x16x32_bf16 v[140:143], v[44:47], v[64:67], v[140:143]
    buffer_load_dwordx4 v6, s[36:39], s71 offen sc1 lds
    v_mfma_f32_16x16x32_bf16 v[136:139], v[40:43], v[64:67], v[136:139]
    s_waitcnt lgkmcnt(4)
    s_add_u32 s71, s71, 32000
    v_add_f32 v12, v12, v98
    v_mfma_f32_16x16x32_bf16 v[144:147], v[48:51], v[64:67], v[144:147]
    ds_read_b64_tr_b16 v[32:33], v3 offset:32768
    ds_read_b64_tr_b16 v[34:35], v3 offset:33024
    v_mfma_f32_16x16x32_bf16 v[148:151], v[52:55], v[64:67], v[148:151]
    v_exp_f32 v100, v100
    v_mfma_f32_16x16x32_bf16 v[212:215], v[52:55], v[72:75], v[212:215]
    v_add_f32 v12, v12, v99
    v_cvt_pk_bf16_f32 v97, v98, v99
    v_mfma_f32_16x16x32_bf16 v[208:211], v[48:51], v[72:75], v[208:211]
    v_exp_f32 v101, v101
    v_mfma_f32_16x16x32_bf16 a[144:147], v[48:51], v[80:83], a[144:147]
    ds_read_b64_tr_b16 v[36:37], v3 offset:33792
    ds_read_b64_tr_b16 v[38:39], v3 offset:34048
    v_mfma_f32_16x16x32_bf16 a[148:151], v[52:55], v[80:83], a[148:151]
    s_add_u32 m0, s57, 26656
    v_add_f32 v12, v12, v100
    v_mfma_f32_16x16x32_bf16 a[212:215], v[52:55], v[88:91], a[212:215]
    buffer_load_dwordx4 v6, s[36:39], s71 offen sc1 lds
    v_mfma_f32_16x16x32_bf16 a[208:211], v[48:51], v[88:91], a[208:211]
    s_waitcnt lgkmcnt(4)
    s_add_u32 s71, s71, 32000
    v_exp_f32 v102, v102
    v_mfma_f32_16x16x32_bf16 a[216:219], v[56:59], v[88:91], a[216:219]
    ds_read_b64_tr_b16 v[40:41], v3 offset:34816
    ds_read_b64_tr_b16 v[42:43], v3 offset:35072
    v_mfma_f32_16x16x32_bf16 a[220:223], v[60:63], v[88:91], a[220:223]
    v_add_f32 v12, v12, v101
    v_cvt_pk_bf16_f32 v98, v100, v101
    v_mfma_f32_16x16x32_bf16 a[156:159], v[60:63], v[80:83], a[156:159]
    v_exp_f32 v103, v103
    v_mfma_f32_16x16x32_bf16 a[152:155], v[56:59], v[80:83], a[152:155]
    v_add_f32 v12, v12, v102
    v_mfma_f32_16x16x32_bf16 v[216:219], v[56:59], v[72:75], v[216:219]
    ds_read_b64_tr_b16 v[44:45], v3 offset:35840
    ds_read_b64_tr_b16 v[46:47], v3 offset:36096
    v_mfma_f32_16x16x32_bf16 v[220:223], v[60:63], v[72:75], v[220:223]
    s_add_u32 m0, s57, 27696
    v_exp_f32 v104, v104
    v_mfma_f32_16x16x32_bf16 v[156:159], v[60:63], v[64:67], v[156:159]
    buffer_load_dwordx4 v6, s[36:39], s71 offen sc1 lds
    v_mfma_f32_16x16x32_bf16 v[152:155], v[56:59], v[64:67], v[152:155]
    s_waitcnt lgkmcnt(4)
    s_add_u32 s71, s71, 32000
    v_add_f32 v12, v12, v103
    v_cvt_pk_bf16_f32 v99, v102, v103
    v_mfma_f32_16x16x32_bf16 v[160:163], v[32:35], v[64:67], v[160:163]
    ds_read_b64_tr_b16 v[48:49], v3 offset:36864
    ds_read_b64_tr_b16 v[50:51], v3 offset:37120
    v_mfma_f32_16x16x32_bf16 v[164:167], v[36:39], v[64:67], v[164:167]
    s_waitcnt vmcnt(4)
    v_cmp_ne_u32 vcc, s56, v5
    v_mfma_f32_16x16x32_bf16 v[228:231], v[36:39], v[72:75], v[228:231]
    v_exp_f32 v105, v105
    v_mfma_f32_16x16x32_bf16 v[224:227], v[32:35], v[72:75], v[224:227]
    s_cbranch_vccnz L_spin_fi14
L_back_fi14:
    v_mfma_f32_16x16x32_bf16 a[160:163], v[32:35], v[80:83], a[160:163]
    ds_read_b64_tr_b16 v[52:53], v3 offset:37888
    ds_read_b64_tr_b16 v[54:55], v3 offset:38144
    v_mfma_f32_16x16x32_bf16 a[164:167], v[36:39], v[80:83], a[164:167]
    s_add_u32 m0, s57, 28736
    v_exp_f32 v106, v106
    v_mfma_f32_16x16x32_bf16 a[228:231], v[36:39], v[88:91], a[228:231]
    buffer_load_dwordx4 v6, s[36:39], s71 offen sc1 lds
    v_mfma_f32_16x16x32_bf16 a[224:227], v[32:35], v[88:91], a[224:227]
    s_waitcnt lgkmcnt(4)
    s_add_u32 s71, s71, 32000
    v_add_f32 v13, v104, v105
    v_cvt_pk_bf16_f32 v104, v104, v105
    v_mfma_f32_16x16x32_bf16 a[232:235], v[40:43], v[88:91], a[232:235]
    ds_read_b64_tr_b16 v[56:57], v3 offset:38912
    ds_read_b64_tr_b16 v[58:59], v3 offset:39168
    v_mfma_f32_16x16x32_bf16 a[236:239], v[44:47], v[88:91], a[236:239]
    s_add_u32 m0, s57, 33792
    v_exp_f32 v107, v107
    v_mfma_f32_16x16x32_bf16 a[172:175], v[44:47], v[80:83], a[172:175]
    buffer_load_dwordx4 v4, s[28:31], s70 offen lds
    v_mfma_f32_16x16x32_bf16 a[168:171], v[40:43], v[80:83], a[168:171]
    s_add_u32 s70, s70, 4096
    v_add_f32 v13, v13, v106
    v_mfma_f32_16x16x32_bf16 v[232:235], v[40:43], v[72:75], v[232:235]
    ds_read_b64_tr_b16 v[60:61], v3 offset:39936
    ds_read_b64_tr_b16 v[62:63], v3 offset:40192
    v_mfma_f32_16x16x32_bf16 v[236:239], v[44:47], v[72:75], v[236:239]
    s_add_u32 m0, s57, 29776
    v_exp_f32 v108, v108
    v_mfma_f32_16x16x32_bf16 v[172:175], v[44:47], v[64:67], v[172:175]
    buffer_load_dwordx4 v6, s[36:39], s71 offen sc1 lds
    v_mfma_f32_16x16x32_bf16 v[168:171], v[40:43], v[64:67], v[168:171]
    s_waitcnt lgkmcnt(4)
    s_add_u32 s71, s71, 32000
    v_add_f32 v13, v13, v107
    v_cvt_pk_bf16_f32 v105, v106, v107
    v_mfma_f32_16x16x32_bf16 v[176:179], v[48:51], v[64:67], v[176:179]
    ds_read_b64_tr_b16 v[32:33], v3 offset:0
    ds_read_b64_tr_b16 v[34:35], v3 offset:256
    v_mfma_f32_16x16x32_bf16 v[180:183], v[52:55], v[64:67], v[180:183]
    s_add_u32 m0, s57, 34816
    v_exp_f32 v109, v109
    v_mfma_f32_16x16x32_bf16 v[244:247], v[52:55], v[72:75], v[244:247]
    buffer_load_dwordx4 v4, s[28:31], s70 offen lds
    v_mfma_f32_16x16x32_bf16 v[240:243], v[48:51], v[72:75], v[240:243]
    s_add_u32 s70, s70, 4096
    v_add_f32 v13, v13, v108
    v_mfma_f32_16x16x32_bf16 a[176:179], v[48:51], v[80:83], a[176:179]
    ds_read_b64_tr_b16 v[36:37], v3 offset:1024
    ds_read_b64_tr_b16 v[38:39], v3 offset:1280
    v_mfma_f32_16x16x32_bf16 a[180:183], v[52:55], v[80:83], a[180:183]
    s_add_u32 m0, s57, 30816
    v_exp_f32 v110, v110
    v_mfma_f32_16x16x32_bf16 a[244:247], v[52:55], v[88:91], a[244:247]
    buffer_load_dwordx4 v6, s[36:39], s71 offen sc1 lds
    v_mfma_f32_16x16x32_bf16 a[240:243], v[48:51], v[88:91], a[240:243]
    s_waitcnt lgkmcnt(4)
    s_add_u32 s71, s71, 32000
    v_add_f32 v13, v13, v109
    v_cvt_pk_bf16_f32 v106, v108, v109
    v_mfma_f32_16x16x32_bf16 a[248:251], v[56:59], v[88:91], a[248:251]
    ds_read_b64_tr_b16 v[40:41], v3 offset:2048
    ds_read_b64_tr_b16 v[42:43], v3 offset:2304
    v_mfma_f32_16x16x32_bf16 a[252:255], v[60:63], v[88:91], a[252:255]
    s_add_u32 m0, s57, 35840
    v_exp_f32 v111, v111
    v_mfma_f32_16x16x32_bf16 a[188:191], v[60:63], v[80:83], a[188:191]
    buffer_load_dwordx4 v4, s[28:31], s70 offen lds
    v_mfma_f32_16x16x32_bf16 a[184:187], v[56:59], v[80:83], a[184:187]
    s_add_u32 s70, s70, 4096
    s_add_u32 m0, s57, 36864
    v_add_f32 v13, v13, v110
    v_mfma_f32_16x16x32_bf16 v[248:251], v[56:59], v[72:75], v[248:251]
    ds_read_b64_tr_b16 v[44:45], v3 offset:3072
    ds_read_b64_tr_b16 v[46:47], v3 offset:3328
    buffer_load_dwordx4 v4, s[28:31], s70 offen lds
    v_mfma_f32_16x16x32_bf16 v[252:255], v[60:63], v[72:75], v[252:255]
    s_add_u32 m0, s57, 31856
    v_exp_f32 v112, v112
    v_mfma_f32_16x16x32_bf16 v[188:191], v[60:63], v[64:67], v[188:191]
    buffer_load_dwordx4 v6, s[36:39], s71 offen sc1 lds
    v_mfma_f32_16x16x32_bf16 v[184:187], v[56:59], v[64:67], v[184:187]
    s_waitcnt lgkmcnt(0)
    s_add_u32 s71, s71, 32000
    v_add_f32 v13, v13, v111
    v_cvt_pk_bf16_f32 v107, v110, v111
    v_exp_f32 v113, v113
    v_exp_f32 v114, v114
    v_add_f32 v14, v112, v113
    v_cvt_pk_bf16_f32 v112, v112, v113
    v_exp_f32 v115, v115
    v_add_f32 v14, v14, v114
    v_exp_f32 v116, v116
    v_add_f32 v14, v14, v115
    v_cvt_pk_bf16_f32 v113, v114, v115
    v_exp_f32 v117, v117
    v_add_f32 v14, v14, v116
    v_exp_f32 v118, v118
    v_add_f32 v14, v14, v117
    v_cvt_pk_bf16_f32 v114, v116, v117
    v_exp_f32 v119, v119
    v_add_f32 v14, v14, v118
    v_exp_f32 v120, v120
    v_add_f32 v14, v14, v119
    v_cvt_pk_bf16_f32 v115, v118, v119
    v_exp_f32 v121, v121
    v_exp_f32 v122, v122
    v_add_f32 v15, v120, v121
    v_cvt_pk_bf16_f32 v120, v120, v121
    v_exp_f32 v123, v123
    v_add_f32 v15, v15, v122
    v_exp_f32 v124, v124
    v_add_f32 v15, v15, v123
    v_cvt_pk_bf16_f32 v121, v122, v123
    v_exp_f32 v125, v125
    v_add_f32 v15, v15, v124
    v_exp_f32 v126, v126
    v_add_f32 v15, v15, v125
    v_cvt_pk_bf16_f32 v122, v124, v125
    v_exp_f32 v127, v127
    v_add_f32 v15, v15, v126
    v_max3_f32 v7, v12, v13, v14
    v_add_f32 v15, v15, v127
    v_cvt_pk_bf16_f32 v123, v126, v127
    v_add_f32 v7, v7, v15
    v_cmp_nge_f32 vcc, s62, v7
    s_cbranch_vccnz L_stub_i15
L_back_i15:
    v_mfma_f32_16x16x32_bf16 v[128:131], v[32:35], v[96:99], v[128:131]
    ds_read_b64_tr_b16 v[48:49], v3 offset:4096
    ds_read_b64_tr_b16 v[50:51], v3 offset:4352
    v_mfma_f32_16x16x32_bf16 v[132:135], v[36:39], v[96:99], v[132:135]
    v_add_f32 v8, v8, v12
    v_add_f32 v9, v9, v13
    v_mfma_f32_16x16x32_bf16 v[196:199], v[36:39], v[104:107], v[196:199]
    buffer_load_dwordx4 a[0:3], v0, s[40:43], s81 offen offset:0 sc1
    v_mfma_f32_16x16x32_bf16 v[192:195], v[32:35], v[104:107], v[192:195]
    v_add_f32 v10, v10, v14
    v_add_f32 v11, v11, v15
    v_mfma_f32_16x16x32_bf16 a[128:131], v[32:35], v[112:115], a[128:131]
    ds_read_b64_tr_b16 v[52:53], v3 offset:5120
    ds_read_b64_tr_b16 v[54:55], v3 offset:5376
    v_mfma_f32_16x16x32_bf16 a[132:135], v[36:39], v[112:115], a[132:135]
    v_permlane32_swap_b32 v16, v24
    v_mfma_f32_16x16x32_bf16 a[196:199], v[36:39], v[120:123], a[196:199]
    buffer_load_dwordx4 a[4:7], v0, s[40:43], s81 offen offset:1024 sc1
    v_mfma_f32_16x16x32_bf16 a[192:195], v[32:35], v[120:123], a[192:195]
    v_permlane32_swap_b32 v20, v28
    v_mfma_f32_16x16x32_bf16 a[200:203], v[40:43], v[120:123], a[200:203]
    ds_read_b64_tr_b16 v[56:57], v3 offset:6144
    ds_read_b64_tr_b16 v[58:59], v3 offset:6400
    v_mfma_f32_16x16x32_bf16 a[204:207], v[44:47], v[120:123], a[204:207]
    v_permlane32_swap_b32 v8, v10
    v_mfma_f32_16x16x32_bf16 a[140:143], v[44:47], v[112:115], a[140:143]
    buffer_load_dwordx4 a[8:11], v0, s[40:43], s81 offen offset:2048 sc1
    v_mfma_f32_16x16x32_bf16 a[136:139], v[40:43], v[112:115], a[136:139]
    v_permlane32_swap_b32 v9, v11
    v_mfma_f32_16x16x32_bf16 v[200:203], v[40:43], v[104:107], v[200:203]
    ds_read_b64_tr_b16 v[60:61], v3 offset:7168
    ds_read_b64_tr_b16 v[62:63], v3 offset:7424
    v_mfma_f32_16x16x32_bf16 v[204:207], v[44:47], v[104:107], v[204:207]
    v_add_f32 v8, v8, v10
    v_add_f32 v10, v9, v11
    v_mfma_f32_16x16x32_bf16 v[140:143], v[44:47], v[96:99], v[140:143]
    buffer_load_dwordx4 a[12:15], v0, s[40:43], s81 offen offset:3072 sc1
    v_mfma_f32_16x16x32_bf16 v[136:139], v[40:43], v[96:99], v[136:139]
    s_waitcnt lgkmcnt(4)
    s_add_u32 s81, s81, 4096
    v_permlane16_swap_b32 v16, v20
    v_mfma_f32_16x16x32_bf16 v[144:147], v[48:51], v[96:99], v[144:147]
    ds_read_b64_tr_b16 v[32:33], v3 offset:8192
    ds_read_b64_tr_b16 v[34:35], v3 offset:8448
    v_mfma_f32_16x16x32_bf16 v[148:151], v[52:55], v[96:99], v[148:151]
    v_lshl_add_u32 v28, v1, 3, s57
    s_nop 0
    v_mfma_f32_16x16x32_bf16 v[212:215], v[52:55], v[104:107], v[212:215]
    buffer_load_dwordx4 a[16:19], v0, s[40:43], s81 offen offset:0 sc1
    v_mfma_f32_16x16x32_bf16 v[208:211], v[48:51], v[104:107], v[208:211]
    v_permlane16_swap_b32 v8, v10
    v_mfma_f32_16x16x32_bf16 a[144:147], v[48:51], v[112:115], a[144:147]
    ds_read_b64_tr_b16 v[36:37], v3 offset:9216
    ds_read_b64_tr_b16 v[38:39], v3 offset:9472
    v_mfma_f32_16x16x32_bf16 a[148:151], v[52:55], v[112:115], a[148:151]
    v_mov_b32 v9, v16
    v_add_f32 v8, v8, v10
    v_mfma_f32_16x16x32_bf16 a[212:215], v[52:55], v[120:123], a[212:215]
    buffer_load_dwordx4 a[20:23], v0, s[40:43], s81 offen offset:1024 sc1
    v_mfma_f32_16x16x32_bf16 a[208:211], v[48:51], v[120:123], a[208:211]
    s_waitcnt lgkmcnt(4)
    ds_write_b64 v28, v[8:9] offset:39936
    v_mfma_f32_16x16x32_bf16 a[216:219], v[56:59], v[120:123], a[216:219]
    s_xor_b32 s70, s52, 1
    s_mul_i32 s70, s70, 40960
    ds_read_b64_tr_b16 v[40:41], v3 offset:10240
    ds_read_b64_tr_b16 v[42:43], v3 offset:10496
    v_mfma_f32_16x16x32_bf16 a[220:223], v[60:63], v[120:123], a[220:223]
    s_xor_b32 s71, s52, 2
    s_mul_i32 s71, s71, 40960
    v_add_u32 v22, s57, v0
    v_and_b32 v26, 15, v1
    v_mfma_f32_16x16x32_bf16 a[156:159], v[60:63], v[112:115], a[156:159]
    buffer_load_dwordx4 a[24:27], v0, s[40:43], s81 offen offset:2048 sc1
    v_mfma_f32_16x16x32_bf16 a[152:155], v[56:59], v[112:115], a[152:155]
    s_xor_b32 s72, s52, 3
    s_mul_i32 s72, s72, 40960
    v_add_u32 v23, s70, v0
    v_lshl_add_u32 v29, v1, 3, s70
    v_mfma_f32_16x16x32_bf16 v[216:219], v[56:59], v[104:107], v[216:219]
    ds_read_b64_tr_b16 v[44:45], v3 offset:11264
    ds_read_b64_tr_b16 v[46:47], v3 offset:11520
    v_mfma_f32_16x16x32_bf16 v[220:223], v[60:63], v[104:107], v[220:223]
    v_add_u32 v24, s71, v0
    v_lshl_add_u32 v30, v1, 3, s71
    v_mfma_f32_16x16x32_bf16 v[156:159], v[60:63], v[96:99], v[156:159]
    buffer_load_dwordx4 a[28:31], v0, s[40:43], s81 offen offset:3072 sc1
    v_mfma_f32_16x16x32_bf16 v[152:155], v[56:59], v[96:99], v[152:155]
    s_waitcnt lgkmcnt(5)
    s_add_u32 s81, s81, 4096
    v_add_u32 v25, s72, v0
    v_lshl_add_u32 v31, v1, 3, s72
    v_mfma_f32_16x16x32_bf16 v[160:163], v[32:35], v[96:99], v[160:163]
    ds_read_b64_tr_b16 v[48:49], v3 offset:12288
    ds_read_b64_tr_b16 v[50:51], v3 offset:12544
    v_mfma_f32_16x16x32_bf16 v[164:167], v[36:39], v[96:99], v[164:167]
    v_lshrrev_b32 v27, 4, v1
    v_lshl_add_u32 v6, v26, 4, s57
    v_mfma_f32_16x16x32_bf16 v[228:231], v[36:39], v[104:107], v[228:231]
    buffer_load_dwordx4 a[32:35], v0, s[40:43], s81 offen offset:0 sc1
    v_mfma_f32_16x16x32_bf16 v[224:227], v[32:35], v[104:107], v[224:227]
    s_waitcnt vmcnt(9) lgkmcnt(6)
    v_lshlrev_b32 v27, 2, v27
    v_sub_u32 v26, v26, v27
    s_barrier
    v_mfma_f32_16x16x32_bf16 a[160:163], v[32:35], v[112:115], a[160:163]
    ds_read_b64_tr_b16 v[52:53], v3 offset:13312
    ds_read_b64_tr_b16 v[54:55], v3 offset:13568
    v_mfma_f32_16x16x32_bf16 a[164:167], v[36:39], v[112:115], a[164:167]
    v_and_b32 v27, 1, v26
    v_lshlrev_b32 v27, 4, v27
    v_mfma_f32_16x16x32_bf16 a[228:231], v[36:39], v[120:123], a[228:231]
    buffer_load_dwordx4 a[36:39], v0, s[40:43], s81 offen offset:1024 sc1
    v_mfma_f32_16x16x32_bf16 a[224:227], v[32:35], v[120:123], a[224:227]
    s_waitcnt lgkmcnt(4)
    v_mov_b32 v7, 0x3f80
    v_lshlrev_b32 v27, v27, v7
    v_mfma_f32_16x16x32_bf16 a[232:235], v[40:43], v[120:123], a[232:235]
    ds_read_b64_tr_b16 v[56:57], v3 offset:14336
    ds_read_b64_tr_b16 v[58:59], v3 offset:14592
    v_mfma_f32_16x16x32_bf16 a[236:239], v[44:47], v[120:123], a[236:239]
    ds_read_b64 v[10:11], v29 offset:39936
    ds_read_b64 v[12:13], v30 offset:39936
    v_mfma_f32_16x16x32_bf16 a[172:175], v[44:47], v[112:115], a[172:175]
    buffer_load_dwordx4 a[40:43], v0, s[40:43], s81 offen offset:2048 sc1
    v_mfma_f32_16x16x32_bf16 a[168:171], v[40:43], v[112:115], a[168:171]
    ds_read_b64 v[14:15], v31 offset:39936
    ds_read_b128 v[64:67], v22 offset:16384
    v_mfma_f32_16x16x32_bf16 v[232:235], v[40:43], v[104:107], v[232:235]
    ds_read_b64_tr_b16 v[60:61], v3 offset:15360
    ds_read_b64_tr_b16 v[62:63], v3 offset:15616
    v_mfma_f32_16x16x32_bf16 v[236:239], v[44:47], v[104:107], v[236:239]
    ds_read_b128 v[68:71], v22 offset:18432
    ds_read_b128 v[72:75], v22 offset:17408
    v_mfma_f32_16x16x32_bf16 v[172:175], v[44:47], v[96:99], v[172:175]
    buffer_load_dwordx4 a[44:47], v0, s[40:43], s81 offen offset:3072 sc1
    v_mfma_f32_16x16x32_bf16 v[168:171], v[40:43], v[96:99], v[168:171]
    s_waitcnt lgkmcnt(10)
    s_add_u32 s81, s81, 4096
    ds_read_b128 v[76:79], v22 offset:19456
    ds_read_b128 v[80:83], v23 offset:16384
    v_mfma_f32_16x16x32_bf16 v[176:179], v[48:51], v[96:99], v[176:179]
    ds_read_b128 v[84:87], v23 offset:18432
    ds_read_b128 v[88:91], v23 offset:17408
    v_mfma_f32_16x16x32_bf16 v[180:183], v[52:55], v[96:99], v[180:183]
    ds_read_b128 v[92:95], v23 offset:19456
    v_mfma_f32_16x16x32_bf16 v[244:247], v[52:55], v[104:107], v[244:247]
    buffer_load_dwordx4 a[48:51], v0, s[40:43], s81 offen offset:0 sc1
    v_mfma_f32_16x16x32_bf16 v[240:243], v[48:51], v[104:107], v[240:243]
    ds_read_b128 v[32:35], v24 offset:16384
    ds_read_b128 v[36:39], v24 offset:18432
    v_mfma_f32_16x16x32_bf16 a[176:179], v[48:51], v[112:115], a[176:179]
    ds_read_b128 v[40:43], v24 offset:17408
    ds_read_b128 v[44:47], v24 offset:19456
    v_mfma_f32_16x16x32_bf16 a[180:183], v[52:55], v[112:115], a[180:183]
    v_lshrrev_b32 v26, 1, v26
    v_mov_b32 v16, 0
    v_mfma_f32_16x16x32_bf16 a[244:247], v[52:55], v[120:123], a[244:247]
    buffer_load_dwordx4 a[52:55], v0, s[40:43], s81 offen offset:1024 sc1
    v_mfma_f32_16x16x32_bf16 a[240:243], v[48:51], v[120:123], a[240:243]
    s_waitcnt lgkmcnt(11)
    v_cmp_eq_u32 vcc, 0, v26
    v_mov_b32 v17, 0
    v_mfma_f32_16x16x32_bf16 a[248:251], v[56:59], v[120:123], a[248:251]
    v_mov_b32 v20, 0
    v_cndmask_b32 v18, v16, v27, vcc
    v_mfma_f32_16x16x32_bf16 a[252:255], v[60:63], v[120:123], a[252:255]
    v_cmp_eq_u32 vcc, 1, v26
    v_mov_b32 v21, 0
    v_mfma_f32_16x16x32_bf16 a[188:191], v[60:63], v[112:115], a[188:191]
    buffer_load_dwordx4 a[56:59], v0, s[40:43], s81 offen offset:2048 sc1
    v_mfma_f32_16x16x32_bf16 a[184:187], v[56:59], v[112:115], a[184:187]
    v_xor_b32 v2, v9, v11
    v_cndmask_b32 v19, v16, v27, vcc
    v_mfma_f32_16x16x32_bf16 v[248:251], v[56:59], v[104:107], v[248:251]
    v_xor_b32 v4, v9, v13
    v_xor_b32 v5, v9, v15
    v_mfma_f32_16x16x32_bf16 v[252:255], v[60:63], v[104:107], v[252:255]
    v_or3_b32 v2, v2, v4, v5
    v_cmp_ne_u32 vcc, 0, v2
    v_mfma_f32_16x16x32_bf16 v[188:191], v[60:63], v[96:99], v[188:191]
    buffer_load_dwordx4 a[60:63], v0, s[40:43], s81 offen offset:3072 sc1
    v_mfma_f32_16x16x32_bf16 v[184:187], v[56:59], v[96:99], v[184:187]
    s_waitcnt lgkmcnt(0)
    s_add_u32 s81, s81, 4096
L_tail:
    s_cbranch_vccnz L_slowA
L_back_slowA:
    s_waitcnt vmcnt(15)
    v_mfma_f32_16x16x32_bf16 v[96:99], v[64:67], a[0:3], 0
    v_cvt_pk_bf16_f32 v144, v144, v145
    v_cvt_pk_bf16_f32 v145, v146, v147
    s_waitcnt vmcnt(14)
    v_mfma_f32_16x16x32_bf16 v[104:107], v[64:67], a[4:7], 0
    v_cvt_pk_bf16_f32 v146, v148, v149
    v_cvt_pk_bf16_f32 v147, v150, v151
    s_waitcnt vmcnt(13)
    v_mfma_f32_16x16x32_bf16 v[112:115], v[64:67], a[8:11], 0
    ds_write_b128 v22, v[144:147] offset:0
    buffer_load_dwordx4 a[64:67], v0, s[40:43], s81 offen offset:0 sc1
    v_cvt_pk_bf16_f32 v152, v152, v153
    v_cvt_pk_bf16_f32 v153, v154, v155
    s_waitcnt vmcnt(13)
    v_mfma_f32_16x16x32_bf16 v[120:123], v[64:67], a[12:15], 0
    v_cvt_pk_bf16_f32 v154, v156, v157
    v_cvt_pk_bf16_f32 v155, v158, v159
    v_mfma_f32_16x16x32_bf16 v[100:103], v[68:71], a[0:3], 0
    ds_write_b128 v22, v[152:155] offset:1024
    buffer_load_dwordx4 a[68:71], v0, s[40:43], s81 offen offset:1024 sc1
    v_mfma_f32_16x16x32_bf16 v[108:111], v[68:71], a[4:7], 0
    v_cvt_pk_bf16_f32 v208, v208, v209
    v_cvt_pk_bf16_f32 v209, v210, v211
    v_mfma_f32_16x16x32_bf16 v[116:119], v[68:71], a[8:11], 0
    v_cvt_pk_bf16_f32 v210, v212, v213
    v_cvt_pk_bf16_f32 v211, v214, v215
    v_mfma_f32_16x16x32_bf16 v[124:127], v[68:71], a[12:15], 0
    s_waitcnt vmcnt(10)
    ds_write_b128 v22, v[208:211] offset:2048
    buffer_load_dwordx4 a[72:75], v0, s[40:43], s81 offen offset:2048 sc1
    v_mfma_f32_16x16x32_bf16 v[96:99], v[72:75], a[16:19], v[96:99]
    v_cvt_pk_bf16_f32 v216, v216, v217
    v_cvt_pk_bf16_f32 v217, v218, v219
    v_mfma_f32_16x16x32_bf16 v[104:107], v[72:75], a[20:23], v[104:107]
    v_cvt_pk_bf16_f32 v218, v220, v221
    v_cvt_pk_bf16_f32 v219, v222, v223
    v_mfma_f32_16x16x32_bf16 v[112:115], v[72:75], a[24:27], v[112:115]
    ds_write_b128 v22, v[216:219] offset:3072
    buffer_load_dwordx4 a[76:79], v0, s[40:43], s81 offen offset:3072 sc1
    v_cvt_pk_bf16_f32 v160, v160, v161
    v_cvt_pk_bf16_f32 v161, v162, v163
    v_mfma_f32_16x16x32_bf16 v[120:123], v[72:75], a[28:31], v[120:123]
    s_add_u32 s81, s81, 4096
    v_cvt_pk_bf16_f32 v162, v164, v165
    v_cvt_pk_bf16_f32 v163, v166, v167
    v_mfma_f32_16x16x32_bf16 v[100:103], v[76:79], a[16:19], v[100:103]
    ds_write_b128 v22, v[160:163] offset:4096
    buffer_load_dwordx4 a[80:83], v0, s[40:43], s81 offen offset:0 sc1
    v_mfma_f32_16x16x32_bf16 v[108:111], v[76:79], a[20:23], v[108:111]
    v_cvt_pk_bf16_f32 v168, v168, v169
    v_cvt_pk_bf16_f32 v169, v170, v171
    v_mfma_f32_16x16x32_bf16 v[116:119], v[76:79], a[24:27], v[116:119]
    v_cvt_pk_bf16_f32 v170, v172, v173
    v_cvt_pk_bf16_f32 v171, v174, v175
    v_mfma_f32_16x16x32_bf16 v[124:127], v[76:79], a[28:31], v[124:127]
    s_waitcnt vmcnt(9)
    ds_write_b128 v22, v[168:171] offset:5120
    buffer_load_dwordx4 a[84:87], v0, s[40:43], s81 offen offset:1024 sc1
    v_mfma_f32_16x16x32_bf16 v[96:99], v[80:83], a[32:35], v[96:99]
    v_cvt_pk_bf16_f32 v224, v224, v225
    v_cvt_pk_bf16_f32 v225, v226, v227
    v_mfma_f32_16x16x32_bf16 v[104:107], v[80:83], a[36:39], v[104:107]
    v_cvt_pk_bf16_f32 v226, v228, v229
    v_cvt_pk_bf16_f32 v227, v230, v231
    v_mfma_f32_16x16x32_bf16 v[112:115], v[80:83], a[40:43], v[112:115]
    ds_write_b128 v22, v[224:227] offset:6144
    buffer_load_dwordx4 a[88:91], v0, s[40:43], s81 offen offset:2048 sc1
    v_cvt_pk_bf16_f32 v232, v232, v233
    v_cvt_pk_bf16_f32 v233, v234, v235
    v_mfma_f32_16x16x32_bf16 v[120:123], v[80:83], a[44:47], v[120:123]
    v_cvt_pk_bf16_f32 v234, v236, v237
    v_cvt_pk_bf16_f32 v235, v238, v239
    v_mfma_f32_16x16x32_bf16 v[100:103], v[84:87], a[32:35], v[100:103]
    ds_write_b128 v22, v[232:235] offset:7168
    buffer_load_dwordx4 a[92:95], v0, s[40:43], s81 offen offset:3072 sc1
    v_mfma_f32_16x16x32_bf16 v[108:111], v[84:87], a[36:39], v[108:111]
    s_add_u32 s81, s81, 4096
    v_cvt_pk_bf16_f32 v176, v176, v177
    v_cvt_pk_bf16_f32 v177, v178, v179
    v_mfma_f32_16x16x32_bf16 v[116:119], v[84:87], a[40:43], v[116:119]
    v_cvt_pk_bf16_f32 v178, v180, v181
    v_cvt_pk_bf16_f32 v179, v182, v183
    v_mfma_f32_16x16x32_bf16 v[124:127], v[84:87], a[44:47], v[124:127]
    s_waitcnt vmcnt(8)
    ds_write_b128 v22, v[176:179] offset:8192
    buffer_load_dwordx4 a[96:99], v0, s[40:43], s81 offen offset:0 sc1
    v_mfma_f32_16x16x32_bf16 v[96:99], v[88:91], a[48:51], v[96:99]
    v_cvt_pk_bf16_f32 v184, v184, v185
    v_cvt_pk_bf16_f32 v185, v186, v187
    v_mfma_f32_16x16x32_bf16 v[104:107], v[88:91], a[52:55], v[104:107]
    v_cvt_pk_bf16_f32 v186, v188, v189
    v_cvt_pk_bf16_f32 v187, v190, v191
    v_mfma_f32_16x16x32_bf16 v[112:115], v[88:91], a[56:59], v[112:115]
    ds_write_b128 v22, v[184:187] offset:9216
    buffer_load_dwordx4 a[100:103], v0, s[40:43], s81 offen offset:1024 sc1
    v_cvt_pk_bf16_f32 v240, v240, v241
    v_cvt_pk_bf16_f32 v241, v242, v243
    v_mfma_f32_16x16x32_bf16 v[120:123], v[88:91], a[60:63], v[120:123]
    v_cvt_pk_bf16_f32 v242, v244, v245
    v_cvt_pk_bf16_f32 v243, v246, v247
    v_mfma_f32_16x16x32_bf16 v[100:103], v[92:95], a[48:51], v[100:103]
    ds_write_b128 v22, v[240:243] offset:10240
    buffer_load_dwordx4 a[104:107], v0, s[40:43], s81 offen offset:2048 sc1
    v_mfma_f32_16x16x32_bf16 v[108:111], v[92:95], a[52:55], v[108:111]
    v_cvt_pk_bf16_f32 v248, v248, v249
    v_cvt_pk_bf16_f32 v249, v250, v251
    v_mfma_f32_16x16x32_bf16 v[116:119], v[92:95], a[56:59], v[116:119]
    v_cvt_pk_bf16_f32 v250, v252, v253
    v_cvt_pk_bf16_f32 v251, v254, v255
    v_mfma_f32_16x16x32_bf16 v[124:127], v[92:95], a[60:63], v[124:127]
    s_waitcnt vmcnt(7)
    ds_write_b128 v22, v[248:251] offset:11264
    v_mfma_f32_16x16x32_bf16 v[96:99], v[32:35], a[64:67], v[96:99]
    s_lshl_b32 s71, s2, 2
    s_add_u32 s71, s71, s52
L_pk10:
    s_cbranch_execz L_pk11
    v_add_f32 v8, v8, v10
    v_add_f32 v12, v12, v14
    v_mfma_f32_16x16x32_bf16 v[104:107], v[32:35], a[68:71], v[104:107]
    s_lshl_b32 s82, s71, 13
    s_add_u32 s82, s82, 8388608
    v_and_b32 v4, 15, v1
    v_lshrrev_b32 v5, 4, v1
    v_mfma_f32_16x16x32_bf16 v[112:115], v[32:35], a[72:75], v[112:115]
    buffer_load_dwordx4 a[108:111], v0, s[40:43], s81 offen offset:3072 sc1
    v_mfma_f32_16x16x32_bf16 v[120:123], v[32:35], a[76:79], v[120:123]
    s_lshl_b32 s73, s71, 7
    s_add_u32 s73, s73, 147456
    s_add_u32 s81, s81, 4096
    v_add_f32 v8, v8, v12
    v_lshlrev_b32 v29, 3, v1
    v_mfma_f32_16x16x32_bf16 v[100:103], v[36:39], a[64:67], v[100:103]
    s_add_u32 s70, s82, 4096
    s_lshl_b32 s71, s55, 14
    v_mfma_f32_16x16x32_bf16 v[108:111], v[36:39], a[68:71], v[108:111]
    s_waitcnt lgkmcnt(0)
    s_lshl_b32 s72, s52, 7
    s_add_u32 s71, s71, s72
    s_barrier
    v_mfma_f32_16x16x32_bf16 v[116:119], v[36:39], a[72:75], v[116:119]
    ds_read_b128 v[144:147], v23 offset:0
    ds_read_b128 v[148:151], v23 offset:1024
    v_mfma_f32_16x16x32_bf16 v[124:127], v[36:39], a[76:79], v[124:127]
    s_waitcnt vmcnt(4)
    ds_read_b128 v[152:155], v23 offset:2048
    ds_read_b128 v[156:159], v23 offset:3072
    v_mfma_f32_16x16x32_bf16 v[96:99], v[40:43], a[80:83], v[96:99]
    ds_read_b128 v[160:163], v24 offset:4096
    ds_read_b128 v[164:167], v24 offset:5120
    v_mfma_f32_16x16x32_bf16 v[104:107], v[40:43], a[84:87], v[104:107]
    ds_read_b128 v[168:171], v24 offset:6144
    ds_read_b128 v[172:175], v24 offset:7168
    v_mfma_f32_16x16x32_bf16 v[112:115], v[40:43], a[88:91], v[112:115]
    ds_read_b128 v[176:179], v25 offset:8192
    ds_read_b128 v[180:183], v25 offset:9216
    v_mfma_f32_16x16x32_bf16 v[120:123], v[40:43], a[92:95], v[120:123]
    ds_read_b128 v[184:187], v25 offset:10240
    ds_read_b128 v[188:191], v25 offset:11264
    v_mfma_f32_16x16x32_bf16 v[100:103], v[44:47], a[80:83], v[100:103]
    buffer_load_dwordx4 a[112:115], v0, s[40:43], s81 offen offset:0 sc1
    v_mfma_f32_16x16x32_bf16 v[108:111], v[44:47], a[84:87], v[108:111]
    ds_read_b128 v[48:51], v25 offset:16384
    ds_read_b128 v[52:55], v25 offset:18432
    v_mfma_f32_16x16x32_bf16 v[116:119], v[44:47], a[88:91], v[116:119]
    ds_read_b128 v[56:59], v25 offset:17408
    ds_read_b128 v[60:63], v25 offset:19456
    v_mfma_f32_16x16x32_bf16 v[124:127], v[44:47], a[92:95], v[124:127]
    v_lshrrev_b32 v14, 3, v4
    v_lshlrev_b32 v13, 11, v5
    s_waitcnt lgkmcnt(15)
    v_mfma_f32_16x16x32_bf16 v[128:131], v[18:21], v[144:147], v[128:131]
    v_lshl_add_u32 v13, v4, 4, v13
    v_mul_u32_u24 v28, 384, v14
    v_mfma_f32_16x16x32_bf16 v[132:135], v[16:19], v[144:147], v[132:135]
    buffer_load_dwordx4 a[116:119], v0, s[40:43], s81 offen offset:1024 sc1
    s_waitcnt lgkmcnt(14)
    v_mfma_f32_16x16x32_bf16 v[136:139], v[18:21], v[148:151], v[136:139]
    v_add3_u32 v13, v13, v28, s71
    v_lshlrev_b32 v28, 9, v5
    v_mfma_f32_16x16x32_bf16 v[140:143], v[16:19], v[148:151], v[140:143]
    v_lshl_add_u32 v28, v4, 4, v28
    v_mul_u32_u24 v14, 120, v14
    s_waitcnt lgkmcnt(13)
    v_mfma_f32_16x16x32_bf16 v[192:195], v[18:21], v[152:155], v[192:195]
    v_sub_u32 v28, v28, v14
    v_add_u32 v28, s57, v28
    v_mfma_f32_16x16x32_bf16 v[196:199], v[16:19], v[152:155], v[196:199]
    buffer_load_dwordx4 a[120:123], v0, s[40:43], s81 offen offset:2048 sc1
    s_waitcnt lgkmcnt(12)
    v_mfma_f32_16x16x32_bf16 v[200:203], v[18:21], v[156:159], v[200:203]
    v_add_u32 v14, 8192, v13
    v_mov_b32 v2, 0xc0f556e3
    v_mfma_f32_16x16x32_bf16 v[204:207], v[16:19], v[156:159], v[204:207]
    v_mov_b32 v3, 0xc0735486
    v_mov_b32 v10, v8
    s_waitcnt lgkmcnt(11)
    v_mfma_f32_16x16x32_bf16 v[128:131], v[18:21], v[160:163], v[128:131]
    v_mov_b32 v11, v9
    v_and_b32 v15, 1, v5
    v_mfma_f32_16x16x32_bf16 v[132:135], v[16:19], v[160:163], v[132:135]
    buffer_load_dwordx4 a[124:127], v0, s[40:43], s81 offen offset:3072 sc1
    s_waitcnt lgkmcnt(10)
    v_mfma_f32_16x16x32_bf16 v[136:139], v[18:21], v[164:167], v[136:139]
    s_add_u32 s81, s81, 102400
    v_lshrrev_b32 v12, 1, v5
    v_lshl_add_u32 v15, v15, 1, v12
    v_mfma_f32_16x16x32_bf16 v[140:143], v[16:19], v[164:167], v[140:143]
    v_lshrrev_b32 v27, 3, v4
    v_mul_u32_u24 v12, 12, v27
    s_waitcnt lgkmcnt(9)
    v_mfma_f32_16x16x32_bf16 v[192:195], v[18:21], v[168:171], v[192:195]
    v_xor_b32 v12, v12, v4
    v_mul_u32_u24 v12, 1040, v12
    v_mfma_f32_16x16x32_bf16 v[196:199], v[16:19], v[168:171], v[196:199]
    buffer_load_dwordx4 a[0:3], v0, s[40:43], s81 offen offset:0 sc1
    s_waitcnt lgkmcnt(8)
    v_mfma_f32_16x16x32_bf16 v[200:203], v[18:21], v[172:175], v[200:203]
    v_mul_u32_u24 v27, 640, v27
    v_lshl_add_u32 v12, v15, 6, v12
    v_mfma_f32_16x16x32_bf16 v[204:207], v[16:19], v[172:175], v[204:207]
    v_add3_u32 v12, v12, v27, s57
    v_lshrrev_b32 v26, 1, v15
    s_waitcnt lgkmcnt(7)
    v_mfma_f32_16x16x32_bf16 v[128:131], v[18:21], v[176:179], v[128:131]
    v_lshrrev_b32 v27, 3, v4
    v_lshl_add_u32 v26, v26, 1, v27
    v_mfma_f32_16x16x32_bf16 v[132:135], v[16:19], v[176:179], v[132:135]
    buffer_load_dwordx4 a[4:7], v0, s[40:43], s81 offen offset:1024 sc1
    s_waitcnt lgkmcnt(6)
    v_mfma_f32_16x16x32_bf16 v[136:139], v[18:21], v[180:183], v[136:139]
    v_lshlrev_b32 v26, 10, v26
    v_bfe_u32 v27, v4, 1, 1
    v_mfma_f32_16x16x32_bf16 v[140:143], v[16:19], v[180:183], v[140:143]
    v_lshl_add_u32 v26, v27, 9, v26
    v_bfe_u32 v27, v4, 2, 1
    s_waitcnt lgkmcnt(5)
    v_mfma_f32_16x16x32_bf16 v[192:195], v[18:21], v[184:187], v[192:195]
    v_lshl_add_u32 v26, v27, 8, v26
    v_and_b32 v27, 1, v15
    v_mfma_f32_16x16x32_bf16 v[196:199], v[16:19], v[184:187], v[196:199]
    buffer_store_dwordx2 v[8:9], v29, s[40:43], s70 offen sc1
    s_waitcnt lgkmcnt(4)
    v_mfma_f32_16x16x32_bf16 v[200:203], v[18:21], v[188:191], v[200:203]
    v_lshl_add_u32 v26, v27, 7, v26
    v_and_b32 v27, 1, v4
    v_mfma_f32_16x16x32_bf16 v[204:207], v[16:19], v[188:191], v[204:207]
    s_waitcnt vmcnt(7) lgkmcnt(3)
    v_lshl_add_u32 v26, v27, 3, v26
    v_bfe_u32 v27, v26, 8, 2
    v_mfma_f32_16x16x32_bf16 v[96:99], v[48:51], a[96:99], v[96:99]
    v_lshl_add_u32 v26, v27, 5, v26
    v_bfe_u32 v27, v26, 10, 1
    s_barrier
    v_mfma_f32_16x16x32_bf16 v[104:107], v[48:51], a[100:103], v[104:107]
    v_cvt_pk_bf16_f32 v128, v128, v129
    v_cvt_pk_bf16_f32 v129, v130, v131
    v_mfma_f32_16x16x32_bf16 v[112:115], v[48:51], a[104:107], v[112:115]
    v_cvt_pk_bf16_f32 v130, v132, v133
    v_cvt_pk_bf16_f32 v131, v134, v135
    v_mfma_f32_16x16x32_bf16 v[120:123], v[48:51], a[108:111], v[120:123]
    s_waitcnt lgkmcnt(2)
    buffer_store_dwordx4 v[128:131], v0, s[40:43], s82 offen offset:0 sc1
    v_mfma_f32_16x16x32_bf16 v[100:103], v[52:55], a[96:99], v[100:103]
    v_lshl_add_u32 v26, v27, 4, v26
    v_add_u32 v15, s57, v26
    v_mfma_f32_16x16x32_bf16 v[108:111], v[52:55], a[100:103], v[108:111]
    v_cvt_pk_bf16_f32 v136, v136, v137
    v_cvt_pk_bf16_f32 v137, v138, v139
    v_mfma_f32_16x16x32_bf16 v[116:119], v[52:55], a[104:107], v[116:119]
    v_cvt_pk_bf16_f32 v138, v140, v141
    v_cvt_pk_bf16_f32 v139, v142, v143
    v_mfma_f32_16x16x32_bf16 v[124:127], v[52:55], a[108:111], v[124:127]
    s_waitcnt vmcnt(4) lgkmcnt(1)
    buffer_store_dwordx4 v[136:139], v0, s[40:43], s82 offen offset:1024 sc1
    v_mfma_f32_16x16x32_bf16 v[96:99], v[56:59], a[112:115], v[96:99]
    v_and_b32 v27, 31, v1
    v_lshlrev_b32 v27, 3, v27
    v_mfma_f32_16x16x32_bf16 v[104:107], v[56:59], a[116:119], v[104:107]
    v_cvt_pk_bf16_f32 v192, v192, v193
    v_cvt_pk_bf16_f32 v193, v194, v195
    v_mfma_f32_16x16x32_bf16 v[112:115], v[56:59], a[120:123], v[112:115]
    v_cvt_pk_bf16_f32 v194, v196, v197
    v_cvt_pk_bf16_f32 v195, v198, v199
    v_mfma_f32_16x16x32_bf16 v[120:123], v[56:59], a[124:127], v[120:123]
    s_waitcnt lgkmcnt(0)
    buffer_store_dwordx4 v[192:195], v0, s[40:43], s82 offen offset:2048 sc1
    v_mfma_f32_16x16x32_bf16 v[100:103], v[60:63], a[112:115], v[100:103]
    v_mov_b32 v4, 0x3e99be61
    v_lshlrev_b32 v5, 5, v5
    v_mfma_f32_16x16x32_bf16 v[108:111], v[60:63], a[116:119], v[108:111]
    v_cvt_pk_bf16_f32 v200, v200, v201
    v_cvt_pk_bf16_f32 v201, v202, v203
    v_mfma_f32_16x16x32_bf16 v[116:119], v[60:63], a[120:123], v[116:119]
    v_cvt_pk_bf16_f32 v202, v204, v205
    v_cvt_pk_bf16_f32 v203, v206, v207
    v_mfma_f32_16x16x32_bf16 v[124:127], v[60:63], a[124:127], v[124:127]
    buffer_store_dwordx4 v[200:203], v0, s[40:43], s82 offen offset:3072 sc1
    v_mov_b32 v7, s56
    v_lshlrev_b32 v30, 2, v1
    v_permlane32_swap_b32 v10, v8
    v_permlane32_swap_b32 v11, v9
    v_accvgpr_read_b32 v32, a144
    v_accvgpr_read_b32 v33, a145
    v_accvgpr_read_b32 v34, a146
    v_accvgpr_read_b32 v35, a147
    v_accvgpr_read_b32 v36, a148
    v_accvgpr_read_b32 v37, a149
    v_accvgpr_read_b32 v38, a150
    v_accvgpr_read_b32 v39, a151
    v_cvt_pk_bf16_f32 v32, v32, v33
    v_cvt_pk_bf16_f32 v33, v34, v35
    v_cvt_pk_bf16_f32 v34, v36, v37
    v_cvt_pk_bf16_f32 v35, v38, v39
    ds_read_b128 v[144:147], v6 offset:20480
    ds_read_b128 v[148:151], v6 offset:20736
    ds_write_b128 v22, v[32:35] offset:0
    v_accvgpr_read_b32 v40, a152
    v_accvgpr_read_b32 v41, a153
    v_accvgpr_read_b32 v42, a154
    v_accvgpr_read_b32 v43, a155
    v_accvgpr_read_b32 v44, a156
    v_accvgpr_read_b32 v45, a157
    v_accvgpr_read_b32 v46, a158
    v_accvgpr_read_b32 v47, a159
    v_cvt_pk_bf16_f32 v40, v40, v41
    v_cvt_pk_bf16_f32 v41, v42, v43
    v_cvt_pk_bf16_f32 v42, v44, v45
    v_cvt_pk_bf16_f32 v43, v46, v47
    ds_read_b128 v[152:155], v6 offset:20992
    ds_read_b128 v[156:159], v6 offset:21248
    ds_write_b128 v22, v[40:43] offset:1024
    v_accvgpr_read_b32 v48, a208
    v_accvgpr_read_b32 v49, a209
    v_accvgpr_read_b32 v50, a210
    v_accvgpr_read_b32 v51, a211
    v_accvgpr_read_b32 v52, a212
    v_accvgpr_read_b32 v53, a213
    v_accvgpr_read_b32 v54, a214
    v_accvgpr_read_b32 v55, a215
    v_cvt_pk_bf16_f32 v48, v48, v49
    v_cvt_pk_bf16_f32 v49, v50, v51
    v_cvt_pk_bf16_f32 v50, v52, v53
    v_cvt_pk_bf16_f32 v51, v54, v55
    ds_read_b128 v[160:163], v6 offset:21504
    ds_read_b128 v[164:167], v6 offset:21760
    ds_write_b128 v22, v[48:51] offset:2048
    v_accvgpr_read_b32 v56, a216
    v_accvgpr_read_b32 v57, a217
    v_accvgpr_read_b32 v58, a218
    v_accvgpr_read_b32 v59, a219
    v_accvgpr_read_b32 v60, a220
    v_accvgpr_read_b32 v61, a221
    v_accvgpr_read_b32 v62, a222
    v_accvgpr_read_b32 v63, a223
    v_cvt_pk_bf16_f32 v56, v56, v57
    v_cvt_pk_bf16_f32 v57, v58, v59
    v_cvt_pk_bf16_f32 v58, v60, v61
    v_cvt_pk_bf16_f32 v59, v62, v63
    ds_read_b128 v[168:171], v6 offset:22016
    ds_read_b128 v[172:175], v6 offset:22272
    ds_write_b128 v22, v[56:59] offset:3072
    v_accvgpr_read_b32 v64, a160
    v_accvgpr_read_b32 v65, a161
    v_accvgpr_read_b32 v66, a162
    v_accvgpr_read_b32 v67, a163
    v_accvgpr_read_b32 v68, a164
    v_accvgpr_read_b32 v69, a165
    v_accvgpr_read_b32 v70, a166
    v_accvgpr_read_b32 v71, a167
    v_cvt_pk_bf16_f32 v64, v64, v65
    v_cvt_pk_bf16_f32 v65, v66, v67
    v_cvt_pk_bf16_f32 v66, v68, v69
    v_cvt_pk_bf16_f32 v67, v70, v71
    ds_read_b128 v[176:179], v6 offset:22528
    ds_read_b128 v[180:183], v6 offset:22784
    ds_write_b128 v22, v[64:67] offset:4096
    v_accvgpr_read_b32 v72, a168
    v_accvgpr_read_b32 v73, a169
    v_accvgpr_read_b32 v74, a170
    v_accvgpr_read_b32 v75, a171
    v_accvgpr_read_b32 v76, a172
    v_accvgpr_read_b32 v77, a173
    v_accvgpr_read_b32 v78, a174
    v_accvgpr_read_b32 v79, a175
    v_cvt_pk_bf16_f32 v72, v72, v73
    v_cvt_pk_bf16_f32 v73, v74, v75
    v_cvt_pk_bf16_f32 v74, v76, v77
    v_cvt_pk_bf16_f32 v75, v78, v79
    ds_read_b128 v[184:187], v6 offset:23040
    ds_read_b128 v[188:191], v6 offset:23296
    ds_write_b128 v22, v[72:75] offset:5120
    v_accvgpr_read_b32 v32, a224
    v_accvgpr_read_b32 v33, a225
    v_accvgpr_read_b32 v34, a226
    v_accvgpr_read_b32 v35, a227
    v_accvgpr_read_b32 v36, a228
    v_accvgpr_read_b32 v37, a229
    v_accvgpr_read_b32 v38, a230
    v_accvgpr_read_b32 v39, a231
    v_cvt_pk_bf16_f32 v32, v32, v33
    v_cvt_pk_bf16_f32 v33, v34, v35
    v_cvt_pk_bf16_f32 v34, v36, v37
    v_cvt_pk_bf16_f32 v35, v38, v39
    ds_read_b128 v[208:211], v6 offset:23552
    ds_read_b128 v[212:215], v6 offset:23808
    ds_write_b128 v22, v[32:35] offset:6144
    v_accvgpr_read_b32 v40, a232
    v_accvgpr_read_b32 v41, a233
    v_accvgpr_read_b32 v42, a234
    v_accvgpr_read_b32 v43, a235
    v_accvgpr_read_b32 v44, a236
    v_accvgpr_read_b32 v45, a237
    v_accvgpr_read_b32 v46, a238
    v_accvgpr_read_b32 v47, a239
    v_cvt_pk_bf16_f32 v40, v40, v41
    v_cvt_pk_bf16_f32 v41, v42, v43
    v_cvt_pk_bf16_f32 v42, v44, v45
    v_cvt_pk_bf16_f32 v43, v46, v47
    ds_read_b128 v[216:219], v6 offset:24064
    ds_read_b128 v[220:223], v6 offset:24320
    ds_write_b128 v22, v[40:43] offset:7168
    v_accvgpr_read_b32 v48, a176
    v_accvgpr_read_b32 v49, a177
    v_accvgpr_read_b32 v50, a178
    v_accvgpr_read_b32 v51, a179
    v_accvgpr_read_b32 v52, a180
    v_accvgpr_read_b32 v53, a181
    v_accvgpr_read_b32 v54, a182
    v_accvgpr_read_b32 v55, a183
    v_cvt_pk_bf16_f32 v48, v48, v49
    v_cvt_pk_bf16_f32 v49, v50, v51
    v_cvt_pk_bf16_f32 v50, v52, v53
    v_cvt_pk_bf16_f32 v51, v54, v55
    ds_write_b128 v22, v[48:51] offset:8192
    v_accvgpr_read_b32 v56, a184
    v_accvgpr_read_b32 v57, a185
    v_accvgpr_read_b32 v58, a186
    v_accvgpr_read_b32 v59, a187
    v_accvgpr_read_b32 v60, a188
    v_accvgpr_read_b32 v61, a189
    v_accvgpr_read_b32 v62, a190
    v_accvgpr_read_b32 v63, a191
    v_cvt_pk_bf16_f32 v56, v56, v57
    v_cvt_pk_bf16_f32 v57, v58, v59
    v_cvt_pk_bf16_f32 v58, v60, v61
    v_cvt_pk_bf16_f32 v59, v62, v63
    ds_write_b128 v22, v[56:59] offset:9216
    v_accvgpr_read_b32 v64, a240
    v_accvgpr_read_b32 v65, a241
    v_accvgpr_read_b32 v66, a242
    v_accvgpr_read_b32 v67, a243
    v_accvgpr_read_b32 v68, a244
    v_accvgpr_read_b32 v69, a245
    v_accvgpr_read_b32 v70, a246
    v_accvgpr_read_b32 v71, a247
    v_cvt_pk_bf16_f32 v64, v64, v65
    v_cvt_pk_bf16_f32 v65, v66, v67
    v_cvt_pk_bf16_f32 v66, v68, v69
    v_cvt_pk_bf16_f32 v67, v70, v71
    ds_write_b128 v22, v[64:67] offset:10240
    buffer_load_dwordx4 a[8:11], v0, s[40:43], s81 offen offset:2048 sc1
    v_accvgpr_read_b32 v72, a248
    v_accvgpr_read_b32 v73, a249
    v_accvgpr_read_b32 v74, a250
    v_accvgpr_read_b32 v75, a251
    v_accvgpr_read_b32 v76, a252
    v_accvgpr_read_b32 v77, a253
    v_accvgpr_read_b32 v78, a254
    v_accvgpr_read_b32 v79, a255
    v_cvt_pk_bf16_f32 v72, v72, v73
    v_cvt_pk_bf16_f32 v73, v74, v75
    v_cvt_pk_bf16_f32 v74, v76, v77
    v_cvt_pk_bf16_f32 v75, v78, v79
    ds_write_b128 v22, v[72:75] offset:11264
    buffer_load_dwordx4 a[12:15], v0, s[40:43], s81 offen offset:3072 sc1
    s_add_u32 s81, s81, 4096
    v_pk_mul_f32 v[80:81], v[96:97], v[96:97]
    v_pk_mul_f32 v[82:83], v[98:99], v[98:99]
    v_pk_mul_f32 v[84:85], v[100:101], v[100:101]
    v_pk_mul_f32 v[86:87], v[102:103], v[102:103]
    v_pk_fma_f32 v[80:81], v[80:81], v[2:3], v[2:3] op_sel:[0,1,0] op_sel_hi:[1,1,0]
    v_pk_fma_f32 v[82:83], v[82:83], v[2:3], v[2:3] op_sel:[0,1,0] op_sel_hi:[1,1,0]
    v_pk_fma_f32 v[84:85], v[84:85], v[2:3], v[2:3] op_sel:[0,1,0] op_sel_hi:[1,1,0]
    v_pk_fma_f32 v[86:87], v[86:87], v[2:3], v[2:3] op_sel:[0,1,0] op_sel_hi:[1,1,0]
    v_pk_mul_f32 v[80:81], v[80:81], v[96:97]
    v_pk_mul_f32 v[82:83], v[82:83], v[98:99]
    v_pk_mul_f32 v[84:85], v[84:85], v[100:101]
    v_pk_mul_f32 v[86:87], v[86:87], v[102:103]
    ds_read_b128 v[32:35], v12 offset:24576
    ds_read_b128 v[36:39], v12 offset:24592
    buffer_load_dwordx4 a[16:19], v0, s[40:43], s81 offen offset:0 sc1
    v_exp_f32 v80, v80
    v_exp_f32 v81, v81
    v_exp_f32 v82, v82
    v_exp_f32 v83, v83
    v_exp_f32 v84, v84
    v_exp_f32 v85, v85
    v_exp_f32 v86, v86
    v_exp_f32 v87, v87
    v_pk_fma_f32 v[80:81], v[80:81], v[4:5], v[4:5] op_sel_hi:[1,0,0]
    v_pk_fma_f32 v[82:83], v[82:83], v[4:5], v[4:5] op_sel_hi:[1,0,0]
    v_pk_fma_f32 v[84:85], v[84:85], v[4:5], v[4:5] op_sel_hi:[1,0,0]
    v_pk_fma_f32 v[86:87], v[86:87], v[4:5], v[4:5] op_sel_hi:[1,0,0]
    ds_read_b128 v[40:43], v12 offset:24608
    ds_read_b128 v[44:47], v12 offset:24624
    buffer_load_dwordx4 a[20:23], v0, s[40:43], s81 offen offset:1024 sc1
    s_waitcnt vmcnt(4)
    s_mov_b32 exec_hi, 0
    buffer_store_dword v7, v30, s[40:43], s73 offen sc1
    s_mov_b32 exec_hi, -1
    s_xor_b32 s73, s73, 512
    s_xor_b32 s82, s82, 32768
    s_add_u32 s72, s82, 4096
    v_rcp_f32 v80, v80
    v_rcp_f32 v81, v81
    v_rcp_f32 v82, v82
    v_rcp_f32 v83, v83
    v_rcp_f32 v84, v84
    v_rcp_f32 v85, v85
    v_rcp_f32 v86, v86
    v_rcp_f32 v87, v87
    v_pk_mul_f32 v[96:97], v[96:97], v[80:81]
    v_pk_mul_f32 v[98:99], v[98:99], v[82:83]
    v_pk_mul_f32 v[100:101], v[100:101], v[84:85]
    v_pk_mul_f32 v[102:103], v[102:103], v[86:87]
    ds_read_b128 v[48:51], v12 offset:24640
    ds_read_b128 v[52:55], v12 offset:24656
    buffer_load_dwordx4 a[24:27], v0, s[40:43], s81 offen offset:2048 sc1
    buffer_load_dwordx4 a[28:31], v0, s[40:43], s81 offen offset:3072 sc1
    s_add_u32 s81, s81, 4096
    v_pk_mul_f32 v[80:81], v[104:105], v[104:105]
    v_pk_mul_f32 v[82:83], v[106:107], v[106:107]
    v_pk_mul_f32 v[84:85], v[108:109], v[108:109]
    v_pk_mul_f32 v[86:87], v[110:111], v[110:111]
    v_pk_fma_f32 v[80:81], v[80:81], v[2:3], v[2:3] op_sel:[0,1,0] op_sel_hi:[1,1,0]
    v_pk_fma_f32 v[82:83], v[82:83], v[2:3], v[2:3] op_sel:[0,1,0] op_sel_hi:[1,1,0]
    v_pk_fma_f32 v[84:85], v[84:85], v[2:3], v[2:3] op_sel:[0,1,0] op_sel_hi:[1,1,0]
    v_pk_fma_f32 v[86:87], v[86:87], v[2:3], v[2:3] op_sel:[0,1,0] op_sel_hi:[1,1,0]
    v_pk_mul_f32 v[80:81], v[80:81], v[104:105]
    v_pk_mul_f32 v[82:83], v[82:83], v[106:107]
    v_pk_mul_f32 v[84:85], v[84:85], v[108:109]
    v_pk_mul_f32 v[86:87], v[86:87], v[110:111]
    ds_read_b128 v[56:59], v12 offset:24672
    ds_read_b128 v[60:63], v12 offset:24688
    buffer_load_dwordx4 a[32:35], v0, s[40:43], s81 offen offset:0 sc1
    v_exp_f32 v80, v80
    v_exp_f32 v81, v81
    v_exp_f32 v82, v82
    v_exp_f32 v83, v83
    v_exp_f32 v84, v84
    v_exp_f32 v85, v85
    v_exp_f32 v86, v86
    v_exp_f32 v87, v87
    v_pk_fma_f32 v[80:81], v[80:81], v[4:5], v[4:5] op_sel_hi:[1,0,0]
    v_pk_fma_f32 v[82:83], v[82:83], v[4:5], v[4:5] op_sel_hi:[1,0,0]
    v_pk_fma_f32 v[84:85], v[84:85], v[4:5], v[4:5] op_sel_hi:[1,0,0]
    v_pk_fma_f32 v[86:87], v[86:87], v[4:5], v[4:5] op_sel_hi:[1,0,0]
    ds_read_b128 v[64:67], v12 offset:24704
    ds_read_b128 v[68:71], v12 offset:24720
    buffer_load_dwordx4 a[36:39], v0, s[40:43], s81 offen offset:1024 sc1
    v_rcp_f32 v80, v80
    v_rcp_f32 v81, v81
    v_rcp_f32 v82, v82
    v_rcp_f32 v83, v83
    v_rcp_f32 v84, v84
    v_rcp_f32 v85, v85
    v_rcp_f32 v86, v86
    v_rcp_f32 v87, v87
    v_pk_mul_f32 v[104:105], v[104:105], v[80:81]
    v_pk_mul_f32 v[106:107], v[106:107], v[82:83]
    v_pk_mul_f32 v[108:109], v[108:109], v[84:85]
    v_pk_mul_f32 v[110:111], v[110:111], v[86:87]
    ds_read_b128 v[72:75], v12 offset:24736
    ds_read_b128 v[76:79], v12 offset:24752
    buffer_load_dwordx4 a[40:43], v0, s[40:43], s81 offen offset:2048 sc1
    buffer_load_dwordx4 a[44:47], v0, s[40:43], s81 offen offset:3072 sc1
    s_add_u32 s81, s81, 4096
    v_pk_mul_f32 v[80:81], v[112:113], v[112:113]
    v_pk_mul_f32 v[82:83], v[114:115], v[114:115]
    v_pk_mul_f32 v[84:85], v[116:117], v[116:117]
    v_pk_mul_f32 v[86:87], v[118:119], v[118:119]
    v_pk_fma_f32 v[80:81], v[80:81], v[2:3], v[2:3] op_sel:[0,1,0] op_sel_hi:[1,1,0]
    v_pk_fma_f32 v[82:83], v[82:83], v[2:3], v[2:3] op_sel:[0,1,0] op_sel_hi:[1,1,0]
    v_pk_fma_f32 v[84:85], v[84:85], v[2:3], v[2:3] op_sel:[0,1,0] op_sel_hi:[1,1,0]
    v_pk_fma_f32 v[86:87], v[86:87], v[2:3], v[2:3] op_sel:[0,1,0] op_sel_hi:[1,1,0]
    v_pk_mul_f32 v[80:81], v[80:81], v[112:113]
    v_pk_mul_f32 v[82:83], v[82:83], v[114:115]
    v_pk_mul_f32 v[84:85], v[84:85], v[116:117]
    v_pk_mul_f32 v[86:87], v[86:87], v[118:119]
    buffer_load_dwordx4 a[48:51], v0, s[40:43], s81 offen offset:0 sc1
    v_exp_f32 v80, v80
    v_exp_f32 v81, v81
    v_exp_f32 v82, v82
    v_exp_f32 v83, v83
    v_exp_f32 v84, v84
    v_exp_f32 v85, v85
    v_exp_f32 v86, v86
    v_exp_f32 v87, v87
    v_pk_fma_f32 v[80:81], v[80:81], v[4:5], v[4:5] op_sel_hi:[1,0,0]
    v_pk_fma_f32 v[82:83], v[82:83], v[4:5], v[4:5] op_sel_hi:[1,0,0]
    v_pk_fma_f32 v[84:85], v[84:85], v[4:5], v[4:5] op_sel_hi:[1,0,0]
    v_pk_fma_f32 v[86:87], v[86:87], v[4:5], v[4:5] op_sel_hi:[1,0,0]
    buffer_load_dwordx4 a[52:55], v0, s[40:43], s81 offen offset:1024 sc1
    v_rcp_f32 v80, v80
    v_rcp_f32 v81, v81
    v_rcp_f32 v82, v82
    v_rcp_f32 v83, v83
    v_rcp_f32 v84, v84
    v_rcp_f32 v85, v85
    v_rcp_f32 v86, v86
    v_rcp_f32 v87, v87
    v_pk_mul_f32 v[112:113], v[112:113], v[80:81]
    v_pk_mul_f32 v[114:115], v[114:115], v[82:83]
    v_pk_mul_f32 v[116:117], v[116:117], v[84:85]
    v_pk_mul_f32 v[118:119], v[118:119], v[86:87]
    buffer_load_dwordx4 a[56:59], v0, s[40:43], s81 offen offset:2048 sc1
    buffer_load_dwordx4 a[60:63], v0, s[40:43], s81 offen offset:3072 sc1
    s_add_u32 s81, s81, 4096
    v_pk_mul_f32 v[80:81], v[120:121], v[120:121]
    v_pk_mul_f32 v[82:83], v[122:123], v[122:123]
    v_pk_mul_f32 v[84:85], v[124:125], v[124:125]
    v_pk_mul_f32 v[86:87], v[126:127], v[126:127]
    v_pk_fma_f32 v[80:81], v[80:81], v[2:3], v[2:3] op_sel:[0,1,0] op_sel_hi:[1,1,0]
    v_pk_fma_f32 v[82:83], v[82:83], v[2:3], v[2:3] op_sel:[0,1,0] op_sel_hi:[1,1,0]
    v_pk_fma_f32 v[84:85], v[84:85], v[2:3], v[2:3] op_sel:[0,1,0] op_sel_hi:[1,1,0]
    v_pk_fma_f32 v[86:87], v[86:87], v[2:3], v[2:3] op_sel:[0,1,0] op_sel_hi:[1,1,0]
    v_pk_mul_f32 v[80:81], v[80:81], v[120:121]
    v_pk_mul_f32 v[82:83], v[82:83], v[122:123]
    v_pk_mul_f32 v[84:85], v[84:85], v[124:125]
    v_pk_mul_f32 v[86:87], v[86:87], v[126:127]
    buffer_load_dwordx4 a[64:67], v0, s[40:43], s81 offen offset:0 sc1
    v_exp_f32 v80, v80
    v_exp_f32 v81, v81
    v_exp_f32 v82, v82
    v_exp_f32 v83, v83
    v_exp_f32 v84, v84
    v_exp_f32 v85, v85
    v_exp_f32 v86, v86
    v_exp_f32 v87, v87
    v_pk_fma_f32 v[80:81], v[80:81], v[4:5], v[4:5] op_sel_hi:[1,0,0]
    v_pk_fma_f32 v[82:83], v[82:83], v[4:5], v[4:5] op_sel_hi:[1,0,0]
    v_pk_fma_f32 v[84:85], v[84:85], v[4:5], v[4:5] op_sel_hi:[1,0,0]
    v_pk_fma_f32 v[86:87], v[86:87], v[4:5], v[4:5] op_sel_hi:[1,0,0]
    buffer_load_dwordx4 a[68:71], v0, s[40:43], s81 offen offset:1024 sc1
    v_rcp_f32 v80, v80
    v_rcp_f32 v81, v81
    v_rcp_f32 v82, v82
    v_rcp_f32 v83, v83
    v_rcp_f32 v84, v84
    v_rcp_f32 v85, v85
    v_rcp_f32 v86, v86
    v_rcp_f32 v87, v87
    v_pk_mul_f32 v[120:121], v[120:121], v[80:81]
    v_pk_mul_f32 v[122:123], v[122:123], v[82:83]
    v_pk_mul_f32 v[124:125], v[124:125], v[84:85]
    v_pk_mul_f32 v[126:127], v[126:127], v[86:87]
    buffer_load_dwordx4 a[72:75], v0, s[40:43], s81 offen offset:2048 sc1
    buffer_load_dwordx4 a[76:79], v0, s[40:43], s81 offen offset:3072 sc1
    s_add_u32 s81, s81, 4096
    v_mov_b32 v6, s73
    s_waitcnt lgkmcnt(11)
    v_dot2_f32_bf16 v224, v32, v144, 0
    v_dot2_f32_bf16 v232, v33, v145, 0
    v_dot2_f32_bf16 v240, v34, v146, 0
    v_dot2_f32_bf16 v248, v35, v147, 0
    s_waitcnt lgkmcnt(10)
    v_dot2_f32_bf16 v226, v36, v144, 0
    v_dot2_f32_bf16 v234, v37, v145, 0
    v_dot2_f32_bf16 v242, v38, v146, 0
    v_dot2_f32_bf16 v250, v39, v147, 0
    v_dot2_f32_bf16 v225, v36, v176, 0
    v_dot2_f32_bf16 v233, v37, v177, 0
    v_dot2_f32_bf16 v241, v38, v178, 0
    v_dot2_f32_bf16 v249, v39, v179, 0
    v_dot2c_f32_bf16 v224, v36, v148
    v_dot2c_f32_bf16 v232, v37, v149
    v_dot2c_f32_bf16 v240, v38, v150
    v_dot2c_f32_bf16 v248, v39, v151
    buffer_load_dwordx4 a[80:83], v0, s[40:43], s81 offen offset:0 sc1
    s_waitcnt lgkmcnt(9)
    v_dot2_f32_bf16 v228, v40, v144, 0
    v_dot2_f32_bf16 v236, v41, v145, 0
    v_dot2_f32_bf16 v244, v42, v146, 0
    v_dot2_f32_bf16 v252, v43, v147, 0
    v_dot2_f32_bf16 v227, v40, v176, 0
    v_dot2_f32_bf16 v235, v41, v177, 0
    v_dot2_f32_bf16 v243, v42, v178, 0
    v_dot2_f32_bf16 v251, v43, v179, 0
    v_dot2c_f32_bf16 v226, v40, v148
    v_dot2c_f32_bf16 v234, v41, v149
    v_dot2c_f32_bf16 v242, v42, v150
    v_dot2c_f32_bf16 v250, v43, v151
    v_dot2c_f32_bf16 v225, v40, v180
    v_dot2c_f32_bf16 v233, v41, v181
    v_dot2c_f32_bf16 v241, v42, v182
    v_dot2c_f32_bf16 v249, v43, v183
    v_dot2c_f32_bf16 v224, v40, v152
    v_dot2c_f32_bf16 v232, v41, v153
L_pk11:
    s_cbranch_execz L_pk12
    v_dot2c_f32_bf16 v240, v42, v154
    v_dot2c_f32_bf16 v248, v43, v155
    buffer_load_dwordx4 a[84:87], v0, s[40:43], s81 offen offset:1024 sc1
    buffer_load_dwordx4 a[88:91], v0, s[40:43], s81 offen offset:2048 sc1
    s_waitcnt lgkmcnt(8)
    v_dot2_f32_bf16 v230, v44, v144, 0
    v_dot2_f32_bf16 v238, v45, v145, 0
    v_dot2_f32_bf16 v246, v46, v146, 0
    v_dot2_f32_bf16 v254, v47, v147, 0
    v_dot2_f32_bf16 v229, v44, v176, 0
    v_dot2_f32_bf16 v237, v45, v177, 0
    v_dot2_f32_bf16 v245, v46, v178, 0
    v_dot2_f32_bf16 v253, v47, v179, 0
    v_dot2c_f32_bf16 v228, v44, v148
    v_dot2c_f32_bf16 v236, v45, v149
    v_dot2c_f32_bf16 v244, v46, v150
    v_dot2c_f32_bf16 v252, v47, v151
    v_dot2c_f32_bf16 v227, v44, v180
    v_dot2c_f32_bf16 v235, v45, v181
    v_dot2c_f32_bf16 v243, v46, v182
    v_dot2c_f32_bf16 v251, v47, v183
    v_dot2c_f32_bf16 v226, v44, v152
    v_dot2c_f32_bf16 v234, v45, v153
    v_dot2c_f32_bf16 v242, v46, v154
    v_dot2c_f32_bf16 v250, v47, v155
    v_dot2c_f32_bf16 v225, v44, v184
    v_dot2c_f32_bf16 v233, v45, v185
    v_dot2c_f32_bf16 v241, v46, v186
    v_dot2c_f32_bf16 v249, v47, v187
    v_dot2c_f32_bf16 v224, v44, v156
    v_dot2c_f32_bf16 v232, v45, v157
    v_dot2c_f32_bf16 v240, v46, v158
    v_dot2c_f32_bf16 v248, v47, v159
    buffer_load_dwordx4 a[92:95], v0, s[40:43], s81 offen offset:3072 sc1
    s_add_u32 s81, s81, 4096
    buffer_load_dwordx4 a[96:99], v0, s[40:43], s81 offen offset:0 sc1
    s_waitcnt lgkmcnt(7)
    v_dot2_f32_bf16 v231, v48, v176, 0
    v_dot2_f32_bf16 v239, v49, v177, 0
    v_dot2_f32_bf16 v247, v50, v178, 0
    v_dot2_f32_bf16 v255, v51, v179, 0
    v_dot2c_f32_bf16 v230, v48, v148
    v_dot2c_f32_bf16 v238, v49, v149
    v_dot2c_f32_bf16 v246, v50, v150
    v_dot2c_f32_bf16 v254, v51, v151
    v_dot2c_f32_bf16 v229, v48, v180
    v_dot2c_f32_bf16 v237, v49, v181
    v_dot2c_f32_bf16 v245, v50, v182
    v_dot2c_f32_bf16 v253, v51, v183
    v_dot2c_f32_bf16 v228, v48, v152
    v_dot2c_f32_bf16 v236, v49, v153
    v_dot2c_f32_bf16 v244, v50, v154
    v_dot2c_f32_bf16 v252, v51, v155
    v_dot2c_f32_bf16 v227, v48, v184
    v_dot2c_f32_bf16 v235, v49, v185
    v_dot2c_f32_bf16 v243, v50, v186
    v_dot2c_f32_bf16 v251, v51, v187
    v_dot2c_f32_bf16 v226, v48, v156
    v_dot2c_f32_bf16 v234, v49, v157
    v_dot2c_f32_bf16 v242, v50, v158
    v_dot2c_f32_bf16 v250, v51, v159
    v_dot2c_f32_bf16 v225, v48, v188
    v_dot2c_f32_bf16 v233, v49, v189
    v_dot2c_f32_bf16 v241, v50, v190
    v_dot2c_f32_bf16 v249, v51, v191
    v_dot2c_f32_bf16 v224, v48, v160
    v_dot2c_f32_bf16 v232, v49, v161
    v_dot2c_f32_bf16 v240, v50, v162
    v_dot2c_f32_bf16 v248, v51, v163
    buffer_load_dword v7, v6, s[40:43], 0 offen sc1
    buffer_load_dwordx4 a[100:103], v0, s[40:43], s81 offen offset:1024 sc1
    buffer_load_dwordx4 a[104:107], v0, s[40:43], s81 offen offset:2048 sc1
    ds_read_b64 v[128:129], v28 offset:33792
    ds_read_b64 v[130:131], v28 offset:33920
    ds_read_b64 v[132:133], v28 offset:34048
    ds_read_b64 v[134:135], v28 offset:34176
    s_waitcnt lgkmcnt(10)
    v_dot2c_f32_bf16 v231, v52, v180
    v_dot2c_f32_bf16 v239, v53, v181
    v_dot2c_f32_bf16 v247, v54, v182
    v_dot2c_f32_bf16 v255, v55, v183
    v_dot2c_f32_bf16 v230, v52, v152
    v_dot2c_f32_bf16 v238, v53, v153
    v_dot2c_f32_bf16 v246, v54, v154
    v_dot2c_f32_bf16 v254, v55, v155
    v_dot2c_f32_bf16 v229, v52, v184
    v_dot2c_f32_bf16 v237, v53, v185
    v_dot2c_f32_bf16 v245, v54, v186
    v_dot2c_f32_bf16 v253, v55, v187
    v_dot2c_f32_bf16 v228, v52, v156
    v_dot2c_f32_bf16 v236, v53, v157
    v_dot2c_f32_bf16 v244, v54, v158
    v_dot2c_f32_bf16 v252, v55, v159
    v_dot2c_f32_bf16 v227, v52, v188
    v_dot2c_f32_bf16 v235, v53, v189
    v_dot2c_f32_bf16 v243, v54, v190
    v_dot2c_f32_bf16 v251, v55, v191
    v_dot2c_f32_bf16 v226, v52, v160
    v_dot2c_f32_bf16 v234, v53, v161
    v_dot2c_f32_bf16 v242, v54, v162
    v_dot2c_f32_bf16 v250, v55, v163
    v_dot2c_f32_bf16 v225, v52, v208
    v_dot2c_f32_bf16 v233, v53, v209
    v_dot2c_f32_bf16 v241, v54, v210
    v_dot2c_f32_bf16 v249, v55, v211
    v_dot2c_f32_bf16 v224, v52, v164
    v_dot2c_f32_bf16 v232, v53, v165
    v_dot2c_f32_bf16 v240, v54, v166
    v_dot2c_f32_bf16 v248, v55, v167
    buffer_load_dwordx4 a[108:111], v0, s[40:43], s81 offen offset:3072 sc1
    s_add_u32 s81, s81, 4096
    buffer_load_dwordx4 a[112:115], v0, s[40:43], s81 offen offset:0 sc1
    ds_read_b64 v[136:137], v28 offset:35840
    ds_read_b64 v[138:139], v28 offset:35968
    ds_read_b64 v[140:141], v28 offset:36096
    ds_read_b64 v[142:143], v28 offset:36224
    s_waitcnt lgkmcnt(13)
    v_dot2c_f32_bf16 v231, v56, v184
    v_dot2c_f32_bf16 v239, v57, v185
    v_dot2c_f32_bf16 v247, v58, v186
    v_dot2c_f32_bf16 v255, v59, v187
    v_dot2c_f32_bf16 v230, v56, v156
    v_dot2c_f32_bf16 v238, v57, v157
    v_dot2c_f32_bf16 v246, v58, v158
    v_dot2c_f32_bf16 v254, v59, v159
    v_dot2c_f32_bf16 v229, v56, v188
    v_dot2c_f32_bf16 v237, v57, v189
    v_dot2c_f32_bf16 v245, v58, v190
    v_dot2c_f32_bf16 v253, v59, v191
    v_dot2c_f32_bf16 v228, v56, v160
    v_dot2c_f32_bf16 v236, v57, v161
    v_dot2c_f32_bf16 v244, v58, v162
    v_dot2c_f32_bf16 v252, v59, v163
    v_dot2c_f32_bf16 v227, v56, v208
    v_dot2c_f32_bf16 v235, v57, v209
    v_dot2c_f32_bf16 v243, v58, v210
    v_dot2c_f32_bf16 v251, v59, v211
    v_dot2c_f32_bf16 v226, v56, v164
    v_dot2c_f32_bf16 v234, v57, v165
    v_dot2c_f32_bf16 v242, v58, v166
    v_dot2c_f32_bf16 v250, v59, v167
    v_dot2c_f32_bf16 v225, v56, v212
    v_dot2c_f32_bf16 v233, v57, v213
    v_dot2c_f32_bf16 v241, v58, v214
    v_dot2c_f32_bf16 v249, v59, v215
    v_dot2c_f32_bf16 v224, v56, v168
    v_dot2c_f32_bf16 v232, v57, v169
    v_dot2c_f32_bf16 v240, v58, v170
    v_dot2c_f32_bf16 v248, v59, v171
    buffer_load_dwordx4 a[116:119], v0, s[40:43], s81 offen offset:1024 sc1
    buffer_load_dwordx4 a[120:123], v0, s[40:43], s81 offen offset:2048 sc1
    s_waitcnt lgkmcnt(12)
    v_dot2c_f32_bf16 v231, v60, v188
    v_dot2c_f32_bf16 v239, v61, v189
    v_dot2c_f32_bf16 v247, v62, v190
    v_dot2c_f32_bf16 v255, v63, v191
    v_dot2c_f32_bf16 v230, v60, v160
    v_dot2c_f32_bf16 v238, v61, v161
    v_dot2c_f32_bf16 v246, v62, v162
    v_dot2c_f32_bf16 v254, v63, v163
    v_dot2c_f32_bf16 v229, v60, v208
    v_dot2c_f32_bf16 v237, v61, v209
    v_dot2c_f32_bf16 v245, v62, v210
    v_dot2c_f32_bf16 v253, v63, v211
    v_dot2c_f32_bf16 v228, v60, v164
    v_dot2c_f32_bf16 v236, v61, v165
    v_dot2c_f32_bf16 v244, v62, v166
    v_dot2c_f32_bf16 v252, v63, v167
    v_dot2c_f32_bf16 v227, v60, v212
    v_dot2c_f32_bf16 v235, v61, v213
    v_dot2c_f32_bf16 v243, v62, v214
    v_dot2c_f32_bf16 v251, v63, v215
    v_dot2c_f32_bf16 v226, v60, v168
    v_dot2c_f32_bf16 v234, v61, v169
    v_dot2c_f32_bf16 v242, v62, v170
    v_dot2c_f32_bf16 v250, v63, v171
    v_dot2c_f32_bf16 v225, v60, v216
    v_dot2c_f32_bf16 v233, v61, v217
    v_dot2c_f32_bf16 v241, v62, v218
    v_dot2c_f32_bf16 v249, v63, v219
    v_dot2c_f32_bf16 v224, v60, v172
    v_dot2c_f32_bf16 v232, v61, v173
    v_dot2c_f32_bf16 v240, v62, v174
    v_dot2c_f32_bf16 v248, v63, v175
    buffer_load_dwordx4 a[124:127], v0, s[40:43], s81 offen offset:3072 sc1
    s_add_u32 s81, s81, 102400
    buffer_load_dwordx4 a[144:147], v0, s[40:43], s81 offen offset:0 sc1
    s_waitcnt lgkmcnt(11)
    v_dot2c_f32_bf16 v231, v64, v208
    v_dot2c_f32_bf16 v239, v65, v209
    v_dot2c_f32_bf16 v247, v66, v210
    v_dot2c_f32_bf16 v255, v67, v211
    v_dot2c_f32_bf16 v230, v64, v164
    v_dot2c_f32_bf16 v238, v65, v165
    v_dot2c_f32_bf16 v246, v66, v166
    v_dot2c_f32_bf16 v254, v67, v167
    v_dot2c_f32_bf16 v229, v64, v212
    v_dot2c_f32_bf16 v237, v65, v213
    v_dot2c_f32_bf16 v245, v66, v214
    v_dot2c_f32_bf16 v253, v67, v215
    v_dot2c_f32_bf16 v228, v64, v168
    v_dot2c_f32_bf16 v236, v65, v169
    v_dot2c_f32_bf16 v244, v66, v170
    v_dot2c_f32_bf16 v252, v67, v171
    v_dot2c_f32_bf16 v227, v64, v216
    v_dot2c_f32_bf16 v235, v65, v217
    v_dot2c_f32_bf16 v243, v66, v218
    v_dot2c_f32_bf16 v251, v67, v219
    v_dot2c_f32_bf16 v226, v64, v172
    v_dot2c_f32_bf16 v234, v65, v173
    v_dot2c_f32_bf16 v242, v66, v174
    v_dot2c_f32_bf16 v250, v67, v175
    v_dot2c_f32_bf16 v225, v64, v220
    v_dot2c_f32_bf16 v233, v65, v221
    v_dot2c_f32_bf16 v241, v66, v222
    v_dot2c_f32_bf16 v249, v67, v223
    buffer_load_dwordx4 a[148:151], v0, s[40:43], s81 offen offset:1024 sc1
    s_waitcnt lgkmcnt(10)
    v_dot2c_f32_bf16 v231, v68, v212
    v_dot2c_f32_bf16 v239, v69, v213
    v_dot2c_f32_bf16 v247, v70, v214
    v_dot2c_f32_bf16 v255, v71, v215
    v_dot2c_f32_bf16 v230, v68, v168
    v_dot2c_f32_bf16 v238, v69, v169
    v_dot2c_f32_bf16 v246, v70, v170
    v_dot2c_f32_bf16 v254, v71, v171
    v_dot2c_f32_bf16 v229, v68, v216
    v_dot2c_f32_bf16 v237, v69, v217
    v_dot2c_f32_bf16 v245, v70, v218
    v_dot2c_f32_bf16 v253, v71, v219
    v_dot2c_f32_bf16 v228, v68, v172
    v_dot2c_f32_bf16 v236, v69, v173
    v_dot2c_f32_bf16 v244, v70, v174
    v_dot2c_f32_bf16 v252, v71, v175
    v_dot2c_f32_bf16 v227, v68, v220
    v_dot2c_f32_bf16 v235, v69, v221
    v_dot2c_f32_bf16 v243, v70, v222
    v_dot2c_f32_bf16 v251, v71, v223
    s_waitcnt lgkmcnt(9)
    v_dot2c_f32_bf16 v231, v72, v216
    v_dot2c_f32_bf16 v239, v73, v217
    v_dot2c_f32_bf16 v247, v74, v218
    v_dot2c_f32_bf16 v255, v75, v219
    v_dot2c_f32_bf16 v230, v72, v172
    v_dot2c_f32_bf16 v238, v73, v173
    v_dot2c_f32_bf16 v246, v74, v174
    v_dot2c_f32_bf16 v254, v75, v175
    v_dot2c_f32_bf16 v229, v72, v220
    v_dot2c_f32_bf16 v237, v73, v221
    v_dot2c_f32_bf16 v245, v74, v222
    v_dot2c_f32_bf16 v253, v75, v223
    s_waitcnt lgkmcnt(8)
    v_dot2c_f32_bf16 v231, v76, v220
    v_dot2c_f32_bf16 v239, v77, v221
    v_dot2c_f32_bf16 v247, v78, v222
    v_dot2c_f32_bf16 v255, v79, v223
    v_pk_mul_f32 v[224:225], v[224:225], v[96:97]
    v_pk_mul_f32 v[232:233], v[232:233], v[104:105]
    v_pk_mul_f32 v[240:241], v[240:241], v[112:113]
    v_pk_mul_f32 v[248:249], v[248:249], v[120:121]
    v_cvt_pk_bf16_f32 v208, v224, v232
    v_cvt_pk_bf16_f32 v209, v240, v248
    v_cvt_pk_bf16_f32 v210, v225, v233
    v_cvt_pk_bf16_f32 v211, v241, v249
    v_xor_b32 v10, 0, v15
    v_xor_b32 v11, 16, v15
    ds_write_b64 v10, v[208:209] offset:12288
    ds_write_b64 v11, v[210:211] offset:12288
    buffer_load_dwordx4 a[152:155], v0, s[40:43], s81 offen offset:2048 sc1
    buffer_load_dwordx4 a[156:159], v0, s[40:43], s81 offen offset:3072 sc1
    s_add_u32 s81, s81, 4096
    s_waitcnt vmcnt(11)
    v_cmp_ne_u32 vcc, s56, v7
    v_pk_mul_f32 v[226:227], v[226:227], v[98:99]
    v_pk_mul_f32 v[234:235], v[234:235], v[106:107]
    v_pk_mul_f32 v[242:243], v[242:243], v[114:115]
    v_pk_mul_f32 v[250:251], v[250:251], v[122:123]
    s_cbranch_vccnz L_spin_xc
L_back_xc:
    v_cvt_pk_bf16_f32 v212, v226, v234
    v_cvt_pk_bf16_f32 v213, v242, v250
    v_cvt_pk_bf16_f32 v214, v227, v235
    v_cvt_pk_bf16_f32 v215, v243, v251
    v_xor_b32 v10, 32, v15
    v_xor_b32 v11, 48, v15
    ds_write_b64 v10, v[212:213] offset:12288
    ds_write_b64 v11, v[214:215] offset:12288
    buffer_load_dwordx2 v[88:89], v27, s[40:43], s72 offen sc1
    buffer_load_dwordx4 v[192:195], v0, s[40:43], s82 offen offset:0 sc1
    v_pk_mul_f32 v[228:229], v[228:229], v[100:101]
    v_pk_mul_f32 v[236:237], v[236:237], v[108:109]
    v_pk_mul_f32 v[244:245], v[244:245], v[116:117]
    v_pk_mul_f32 v[252:253], v[252:253], v[124:125]
    v_cvt_pk_bf16_f32 v216, v228, v236
    v_cvt_pk_bf16_f32 v217, v244, v252
    v_cvt_pk_bf16_f32 v218, v229, v237
    v_cvt_pk_bf16_f32 v219, v245, v253
    v_xor_b32 v10, 64, v15
    v_xor_b32 v11, 80, v15
    ds_write_b64 v10, v[216:217] offset:12288
    ds_write_b64 v11, v[218:219] offset:12288
    buffer_load_dwordx4 v[196:199], v0, s[40:43], s82 offen offset:1024 sc1
    buffer_load_dwordx4 v[200:203], v0, s[40:43], s82 offen offset:2048 sc1
    v_pk_mul_f32 v[230:231], v[230:231], v[102:103]
    v_pk_mul_f32 v[238:239], v[238:239], v[110:111]
    v_pk_mul_f32 v[246:247], v[246:247], v[118:119]
    v_pk_mul_f32 v[254:255], v[254:255], v[126:127]
    v_cvt_pk_bf16_f32 v220, v230, v238
    v_cvt_pk_bf16_f32 v221, v246, v254
    v_cvt_pk_bf16_f32 v222, v231, v239
    v_cvt_pk_bf16_f32 v223, v247, v255
    v_xor_b32 v10, 96, v15
    v_xor_b32 v11, 112, v15
    ds_write_b64 v10, v[220:221] offset:12288
    ds_write_b64 v11, v[222:223] offset:12288
    buffer_load_dwordx4 v[204:207], v0, s[40:43], s82 offen offset:3072 sc1
    v_xor_b32 v80, v5, v22
    v_xor_b32 v82, v5, v23
    v_xor_b32 v84, v5, v24
    v_xor_b32 v86, v5, v25
    v_xor_b32 v81, 16, v80
    v_xor_b32 v83, 16, v82
    v_xor_b32 v85, 16, v84
    v_xor_b32 v87, 16, v86
    s_waitcnt lgkmcnt(15)
    v_lshlrev_b32 v32, 16, v128
    v_and_b32 v36, s67, v128
    v_lshlrev_b32 v40, 16, v129
    v_and_b32 v44, s67, v129
    s_waitcnt lgkmcnt(14)
    v_lshlrev_b32 v33, 16, v130
    v_and_b32 v37, s67, v130
    v_lshlrev_b32 v41, 16, v131
    v_and_b32 v45, s67, v131
    s_waitcnt lgkmcnt(0)
    s_barrier
    ds_read_b128 v[64:67], v80 offset:12288
    ds_read_b128 v[68:71], v80 offset:14336
    ds_read_b128 v[72:75], v81 offset:13312
    ds_read_b128 v[144:147], v23 offset:0
    ds_read_b128 v[160:163], v24 offset:4096
    ds_read_b128 v[176:179], v25 offset:8192
    ds_read_b128 v[148:151], v23 offset:1024
    v_lshlrev_b32 v34, 16, v132
    v_and_b32 v38, s67, v132
    v_lshlrev_b32 v42, 16, v133
    v_and_b32 v46, s67, v133
    v_lshlrev_b32 v35, 16, v134
    v_and_b32 v39, s67, v134
    v_lshlrev_b32 v43, 16, v135
    v_and_b32 v47, s67, v135
    v_lshlrev_b32 v48, 16, v136
    v_and_b32 v52, s67, v136
    v_lshlrev_b32 v56, 16, v137
    v_and_b32 v60, s67, v137
    v_lshlrev_b32 v49, 16, v138
    v_and_b32 v53, s67, v138
    v_lshlrev_b32 v57, 16, v139
    v_and_b32 v61, s67, v139
    v_lshlrev_b32 v50, 16, v140
    v_and_b32 v54, s67, v140
    v_lshlrev_b32 v58, 16, v141
    v_and_b32 v62, s67, v141
    v_lshlrev_b32 v51, 16, v142
    v_and_b32 v55, s67, v142
    v_lshlrev_b32 v59, 16, v143
    v_and_b32 v63, s67, v143
    s_waitcnt lgkmcnt(6)
    v_mfma_f32_16x16x32_bf16 v[32:35], v[64:67], a[0:3], v[32:35]
    ds_read_b128 v[76:79], v81 offset:15360
    v_mfma_f32_16x16x32_bf16 v[36:39], v[64:67], a[4:7], v[36:39]
    ds_read_b128 v[164:167], v24 offset:5120
    ds_read_b128 v[180:183], v25 offset:9216
    v_mfma_f32_16x16x32_bf16 v[40:43], v[64:67], a[8:11], v[40:43]
    buffer_load_dwordx4 a[160:163], v0, s[40:43], s81 offen offset:0 sc1
    v_mfma_f32_16x16x32_bf16 v[44:47], v[64:67], a[12:15], v[44:47]
    s_waitcnt lgkmcnt(8)
    ds_read_b128 v[152:155], v23 offset:2048
    ds_read_b128 v[168:171], v24 offset:6144
    v_mfma_f32_16x16x32_bf16 v[48:51], v[68:71], a[0:3], v[48:51]
    ds_read_b128 v[64:67], v82 offset:12288
    v_mfma_f32_16x16x32_bf16 v[52:55], v[68:71], a[4:7], v[52:55]
    ds_read_b128 v[184:187], v25 offset:10240
    ds_read_b128 v[156:159], v23 offset:3072
    v_mfma_f32_16x16x32_bf16 v[56:59], v[68:71], a[8:11], v[56:59]
    buffer_load_dwordx4 a[164:167], v0, s[40:43], s81 offen offset:1024 sc1
    v_mfma_f32_16x16x32_bf16 v[60:63], v[68:71], a[12:15], v[60:63]
    s_waitcnt lgkmcnt(12)
    ds_read_b128 v[172:175], v24 offset:7168
    ds_read_b128 v[188:191], v25 offset:11264
    v_mfma_f32_16x16x32_bf16 v[32:35], v[72:75], a[16:19], v[32:35]
    ds_read_b128 v[68:71], v82 offset:14336
    v_mfma_f32_16x16x32_bf16 v[36:39], v[72:75], a[20:23], v[36:39]
    v_mfma_f32_16x16x32_bf16 v[40:43], v[72:75], a[24:27], v[40:43]
    buffer_load_dwordx4 a[168:171], v0, s[40:43], s81 offen offset:2048 sc1
    v_mfma_f32_16x16x32_bf16 v[44:47], v[72:75], a[28:31], v[44:47]
    s_waitcnt vmcnt(7) lgkmcnt(10)
    v_cmp_ne_u32 vcc, v9, v89
    v_mfma_f32_16x16x32_bf16 v[48:51], v[76:79], a[16:19], v[48:51]
    ds_read_b128 v[72:75], v83 offset:13312
    v_mfma_f32_16x16x32_bf16 v[52:55], v[76:79], a[20:23], v[52:55]
    s_cbranch_vccnz L_slowB
L_back_slowB:
    v_mfma_f32_16x16x32_bf16 v[56:59], v[76:79], a[24:27], v[56:59]
    buffer_load_dwordx4 a[172:175], v0, s[40:43], s81 offen offset:3072 sc1
    v_mfma_f32_16x16x32_bf16 v[60:63], v[76:79], a[28:31], v[60:63]
    s_waitcnt vmcnt(7)
    s_add_u32 s81, s81, 4096
    v_add_f32 v8, v8, v88
    v_mfma_f32_16x16x32_bf16 a[128:131], v[18:21], v[144:147], a[128:131]
    v_mul_f32 v8, 0x3e99be61, v8
    v_mfma_f32_16x16x32_bf16 a[128:131], v[18:21], v[160:163], a[128:131]
    v_rcp_f32 v8, v8
    v_mfma_f32_16x16x32_bf16 a[128:131], v[18:21], v[176:179], a[128:131]
    buffer_load_dwordx4 a[176:179], v0, s[40:43], s81 offen offset:0 sc1
    v_mfma_f32_16x16x32_bf16 a[128:131], v[18:21], v[192:195], a[128:131]
    v_mov_b32 v9, v8
    v_mfma_f32_16x16x32_bf16 a[132:135], v[16:19], v[192:195], a[132:135]
    v_mfma_f32_16x16x32_bf16 a[132:135], v[16:19], v[176:179], a[132:135]
    v_permlane16_swap_b32 v8, v9
    v_mfma_f32_16x16x32_bf16 a[132:135], v[16:19], v[160:163], a[132:135]
    buffer_load_dwordx4 a[180:183], v0, s[40:43], s81 offen offset:1024 sc1
    v_mfma_f32_16x16x32_bf16 a[132:135], v[16:19], v[144:147], a[132:135]
    s_waitcnt vmcnt(8) lgkmcnt(9)
    v_mfma_f32_16x16x32_bf16 a[136:139], v[18:21], v[148:151], a[136:139]
    v_mfma_f32_16x16x32_bf16 a[136:139], v[18:21], v[164:167], a[136:139]
    s_nop 1
    v_mfma_f32_16x16x32_bf16 a[136:139], v[18:21], v[180:183], a[136:139]
    buffer_load_dwordx4 a[184:187], v0, s[40:43], s81 offen offset:2048 sc1
    v_mfma_f32_16x16x32_bf16 a[136:139], v[18:21], v[196:199], a[136:139]
    s_nop 1
    v_mfma_f32_16x16x32_bf16 a[140:143], v[16:19], v[196:199], a[140:143]
    v_accvgpr_read_b32 v96, a128
    v_accvgpr_read_b32 v97, a129
    v_mfma_f32_16x16x32_bf16 a[140:143], v[16:19], v[180:183], a[140:143]
    v_accvgpr_read_b32 v98, a130
    v_accvgpr_read_b32 v99, a131
    v_mfma_f32_16x16x32_bf16 a[140:143], v[16:19], v[164:167], a[140:143]
    buffer_load_dwordx4 a[188:191], v0, s[40:43], s81 offen offset:3072 sc1
    v_mfma_f32_16x16x32_bf16 a[140:143], v[16:19], v[148:151], a[140:143]
    s_waitcnt vmcnt(9) lgkmcnt(5)
    s_add_u32 s81, s81, 4096
    v_accvgpr_read_b32 v100, a132
    v_accvgpr_read_b32 v101, a133
    v_mfma_f32_16x16x32_bf16 a[192:195], v[18:21], v[152:155], a[192:195]
    v_accvgpr_read_b32 v102, a134
    v_accvgpr_read_b32 v103, a135
    v_mfma_f32_16x16x32_bf16 a[192:195], v[18:21], v[168:171], a[192:195]
    v_mul_f32 v96, v8, v96
    v_mul_f32 v97, v8, v97
    v_mfma_f32_16x16x32_bf16 a[192:195], v[18:21], v[184:187], a[192:195]
    buffer_load_dwordx4 a[208:211], v0, s[40:43], s81 offen offset:0 sc1
    v_mfma_f32_16x16x32_bf16 a[192:195], v[18:21], v[200:203], a[192:195]
    v_mul_f32 v98, v8, v98
    v_mul_f32 v99, v8, v99
    v_mfma_f32_16x16x32_bf16 a[196:199], v[16:19], v[200:203], a[196:199]
    v_mul_f32 v100, v8, v100
    v_mul_f32 v101, v8, v101
    v_mfma_f32_16x16x32_bf16 a[196:199], v[16:19], v[184:187], a[196:199]
    v_mul_f32 v102, v8, v102
    v_mul_f32 v103, v8, v103
    v_mfma_f32_16x16x32_bf16 a[196:199], v[16:19], v[168:171], a[196:199]
    buffer_load_dwordx4 a[212:215], v0, s[40:43], s81 offen offset:1024 sc1
    v_mfma_f32_16x16x32_bf16 a[196:199], v[16:19], v[152:155], a[196:199]
    s_waitcnt vmcnt(10) lgkmcnt(2)
    v_cvt_pk_bf16_f32 v96, v96, v97
    v_cvt_pk_bf16_f32 v97, v98, v99
    v_mfma_f32_16x16x32_bf16 a[200:203], v[18:21], v[156:159], a[200:203]
    v_cvt_pk_bf16_f32 v98, v100, v101
    v_cvt_pk_bf16_f32 v99, v102, v103
    v_mfma_f32_16x16x32_bf16 a[200:203], v[18:21], v[172:175], a[200:203]
    ds_write_b128 v22, v[96:99] offset:20480
    v_mfma_f32_16x16x32_bf16 a[200:203], v[18:21], v[188:191], a[200:203]
    buffer_load_dwordx4 a[216:219], v0, s[40:43], s81 offen offset:2048 sc1
    v_mfma_f32_16x16x32_bf16 a[200:203], v[18:21], v[204:207], a[200:203]
    v_accvgpr_read_b32 v104, a136
    v_accvgpr_read_b32 v105, a137
    v_mfma_f32_16x16x32_bf16 a[204:207], v[16:19], v[204:207], a[204:207]
    v_accvgpr_read_b32 v106, a138
    v_accvgpr_read_b32 v107, a139
    v_mfma_f32_16x16x32_bf16 a[204:207], v[16:19], v[188:191], a[204:207]
    v_accvgpr_read_b32 v108, a140
    v_accvgpr_read_b32 v109, a141
    v_mfma_f32_16x16x32_bf16 a[204:207], v[16:19], v[172:175], a[204:207]
    buffer_load_dwordx4 a[220:223], v0, s[40:43], s81 offen offset:3072 sc1
    v_mfma_f32_16x16x32_bf16 a[204:207], v[16:19], v[156:159], a[204:207]
    s_add_u32 s81, s81, 4096
    v_accvgpr_read_b32 v110, a142
    v_accvgpr_read_b32 v111, a143
    v_mfma_f32_16x16x32_bf16 v[32:35], v[64:67], a[32:35], v[32:35]
    ds_read_b128 v[76:79], v83 offset:15360
    v_mul_f32 v104, v8, v104
    v_mfma_f32_16x16x32_bf16 v[36:39], v[64:67], a[36:39], v[36:39]
    v_mul_f32 v105, v8, v105
    v_mul_f32 v106, v8, v106
    v_mfma_f32_16x16x32_bf16 v[40:43], v[64:67], a[40:43], v[40:43]
    buffer_load_dwordx4 a[224:227], v0, s[40:43], s81 offen offset:0 sc1
    v_mfma_f32_16x16x32_bf16 v[44:47], v[64:67], a[44:47], v[44:47]
    s_waitcnt lgkmcnt(3)
    v_mul_f32 v107, v8, v107
    v_mul_f32 v108, v8, v108
    v_mfma_f32_16x16x32_bf16 v[48:51], v[68:71], a[32:35], v[48:51]
    ds_read_b128 v[64:67], v84 offset:12288
    v_mul_f32 v109, v8, v109
    v_mfma_f32_16x16x32_bf16 v[52:55], v[68:71], a[36:39], v[52:55]
    v_mul_f32 v110, v8, v110
    v_mul_f32 v111, v8, v111
    v_mfma_f32_16x16x32_bf16 v[56:59], v[68:71], a[40:43], v[56:59]
    buffer_load_dwordx4 a[228:231], v0, s[40:43], s81 offen offset:1024 sc1
    v_mfma_f32_16x16x32_bf16 v[60:63], v[68:71], a[44:47], v[60:63]
    s_waitcnt lgkmcnt(3)
    v_cvt_pk_bf16_f32 v104, v104, v105
    v_cvt_pk_bf16_f32 v105, v106, v107
    v_mfma_f32_16x16x32_bf16 v[32:35], v[72:75], a[48:51], v[32:35]
    ds_read_b128 v[68:71], v84 offset:14336
    v_cvt_pk_bf16_f32 v106, v108, v109
    v_mfma_f32_16x16x32_bf16 v[36:39], v[72:75], a[52:55], v[36:39]
    v_cvt_pk_bf16_f32 v107, v110, v111
    v_mfma_f32_16x16x32_bf16 v[40:43], v[72:75], a[56:59], v[40:43]
    buffer_load_dwordx4 a[232:235], v0, s[40:43], s81 offen offset:2048 sc1
    v_mfma_f32_16x16x32_bf16 v[44:47], v[72:75], a[60:63], v[44:47]
    s_waitcnt lgkmcnt(2)
    ds_write_b128 v22, v[104:107] offset:21504
    v_mfma_f32_16x16x32_bf16 v[48:51], v[76:79], a[48:51], v[48:51]
    ds_read_b128 v[72:75], v85 offset:13312
    v_accvgpr_read_b32 v112, a192
    v_mfma_f32_16x16x32_bf16 v[52:55], v[76:79], a[52:55], v[52:55]
    v_accvgpr_read_b32 v113, a193
    v_accvgpr_read_b32 v114, a194
    v_mfma_f32_16x16x32_bf16 v[56:59], v[76:79], a[56:59], v[56:59]
    buffer_load_dwordx4 a[236:239], v0, s[40:43], s81 offen offset:3072 sc1
    v_mfma_f32_16x16x32_bf16 v[60:63], v[76:79], a[60:63], v[60:63]
    s_waitcnt lgkmcnt(3)
    s_add_u32 s81, s81, 4096
    v_accvgpr_read_b32 v115, a195
    v_accvgpr_read_b32 v116, a196
    v_mfma_f32_16x16x32_bf16 v[32:35], v[64:67], a[64:67], v[32:35]
    ds_read_b128 v[76:79], v85 offset:15360
    v_accvgpr_read_b32 v117, a197
    v_mfma_f32_16x16x32_bf16 v[36:39], v[64:67], a[68:71], v[36:39]
    v_accvgpr_read_b32 v118, a198
    v_accvgpr_read_b32 v119, a199
    v_mfma_f32_16x16x32_bf16 v[40:43], v[64:67], a[72:75], v[40:43]
    buffer_load_dwordx4 a[240:243], v0, s[40:43], s81 offen offset:0 sc1
    v_mfma_f32_16x16x32_bf16 v[44:47], v[64:67], a[76:79], v[44:47]
    s_waitcnt lgkmcnt(3)
    v_mul_f32 v112, v9, v112
    v_mul_f32 v113, v9, v113
    v_mfma_f32_16x16x32_bf16 v[48:51], v[68:71], a[64:67], v[48:51]
    ds_read_b128 v[64:67], v86 offset:12288
    v_mul_f32 v114, v9, v114
    v_mfma_f32_16x16x32_bf16 v[52:55], v[68:71], a[68:71], v[52:55]
    v_mul_f32 v115, v9, v115
    v_mul_f32 v116, v9, v116
    v_mfma_f32_16x16x32_bf16 v[56:59], v[68:71], a[72:75], v[56:59]
    buffer_load_dwordx4 a[244:247], v0, s[40:43], s81 offen offset:1024 sc1
    v_mfma_f32_16x16x32_bf16 v[60:63], v[68:71], a[76:79], v[60:63]
    s_waitcnt lgkmcnt(2)
    v_mul_f32 v117, v9, v117
    v_mul_f32 v118, v9, v118
    v_mfma_f32_16x16x32_bf16 v[32:35], v[72:75], a[80:83], v[32:35]
    ds_read_b128 v[68:71], v86 offset:14336
    v_mul_f32 v119, v9, v119
    v_mfma_f32_16x16x32_bf16 v[36:39], v[72:75], a[84:87], v[36:39]
    v_cvt_pk_bf16_f32 v112, v112, v113
    v_cvt_pk_bf16_f32 v113, v114, v115
    v_mfma_f32_16x16x32_bf16 v[40:43], v[72:75], a[88:91], v[40:43]
    buffer_load_dwordx4 a[248:251], v0, s[40:43], s81 offen offset:2048 sc1
    v_mfma_f32_16x16x32_bf16 v[44:47], v[72:75], a[92:95], v[44:47]
    s_waitcnt lgkmcnt(2)
    v_cvt_pk_bf16_f32 v114, v116, v117
    v_cvt_pk_bf16_f32 v115, v118, v119
    v_mfma_f32_16x16x32_bf16 v[48:51], v[76:79], a[80:83], v[48:51]
    ds_read_b128 v[72:75], v87 offset:13312
    v_mfma_f32_16x16x32_bf16 v[52:55], v[76:79], a[84:87], v[52:55]
    ds_write_b128 v22, v[112:115] offset:22528
    v_mfma_f32_16x16x32_bf16 v[56:59], v[76:79], a[88:91], v[56:59]
    buffer_load_dwordx4 a[252:255], v0, s[40:43], s81 offen offset:3072 sc1
    v_mfma_f32_16x16x32_bf16 v[60:63], v[76:79], a[92:95], v[60:63]
    s_waitcnt lgkmcnt(3)
    s_add_u32 s81, s81, 4096
    v_accvgpr_read_b32 v120, a200
    v_accvgpr_read_b32 v121, a201
    v_mfma_f32_16x16x32_bf16 v[32:35], v[64:67], a[96:99], v[32:35]
    ds_read_b128 v[76:79], v87 offset:15360
    v_accvgpr_read_b32 v122, a202
    v_mfma_f32_16x16x32_bf16 v[36:39], v[64:67], a[100:103], v[36:39]
    s_nop 0
    v_accvgpr_read_b32 v123, a203
    v_accvgpr_read_b32 v124, a204
    v_accvgpr_read_b32 v125, a205
    v_accvgpr_read_b32 v126, a206
    v_accvgpr_read_b32 v127, a207
    v_mul_f32 v120, v9, v120
    v_mul_f32 v121, v9, v121
    v_mul_f32 v122, v9, v122
    v_mul_f32 v123, v9, v123
    v_mul_f32 v124, v9, v124
    v_mul_f32 v125, v9, v125
    v_mul_f32 v126, v9, v126
    v_mul_f32 v127, v9, v127
    v_cvt_pk_bf16_f32 v120, v120, v121
    v_cvt_pk_bf16_f32 v121, v122, v123
    v_cvt_pk_bf16_f32 v122, v124, v125
    v_cvt_pk_bf16_f32 v123, v126, v127
    ds_write_b128 v22, v[120:123] offset:23552
    v_mfma_f32_16x16x32_bf16 v[40:43], v[64:67], a[104:107], v[40:43]
    buffer_load_dwordx4 v[208:211], v0, s[40:43], s81 offen offset:0 sc1
    v_mfma_f32_16x16x32_bf16 v[44:47], v[64:67], a[108:111], v[44:47]
    s_waitcnt lgkmcnt(4)
    v_mfma_f32_16x16x32_bf16 v[48:51], v[68:71], a[96:99], v[48:51]
    v_mfma_f32_16x16x32_bf16 v[52:55], v[68:71], a[100:103], v[52:55]
    s_waitcnt lgkmcnt(0)
    s_barrier
    v_mfma_f32_16x16x32_bf16 v[56:59], v[68:71], a[104:107], v[56:59]
    ds_read_b128 v[144:147], v22 offset:20480
    v_mfma_f32_16x16x32_bf16 v[60:63], v[68:71], a[108:111], v[60:63]
    ds_read_b128 v[148:151], v22 offset:22528
    v_mfma_f32_16x16x32_bf16 v[32:35], v[72:75], a[112:115], v[32:35]
    ds_read_b128 v[152:155], v22 offset:21504
    v_mfma_f32_16x16x32_bf16 v[36:39], v[72:75], a[116:119], v[36:39]
    ds_read_b128 v[156:159], v22 offset:23552
    v_mfma_f32_16x16x32_bf16 v[40:43], v[72:75], a[120:123], v[40:43]
    buffer_load_dwordx4 v[212:215], v0, s[40:43], s81 offen offset:1024 sc1
    v_mfma_f32_16x16x32_bf16 v[44:47], v[72:75], a[124:127], v[44:47]
    v_mfma_f32_16x16x32_bf16 v[48:51], v[76:79], a[112:115], v[48:51]
    v_mfma_f32_16x16x32_bf16 v[52:55], v[76:79], a[116:119], v[52:55]
    v_mfma_f32_16x16x32_bf16 v[56:59], v[76:79], a[120:123], v[56:59]
    buffer_load_dwordx4 v[216:219], v0, s[40:43], s81 offen offset:2048 sc1
    v_mfma_f32_16x16x32_bf16 v[60:63], v[76:79], a[124:127], v[60:63]
    s_waitcnt lgkmcnt(3)
    v_mfma_f32_16x16x32_bf16 v[32:35], v[144:147], a[144:147], v[32:35]
    ds_read_b128 v[160:163], v23 offset:20480
    v_mfma_f32_16x16x32_bf16 v[36:39], v[144:147], a[148:151], v[36:39]
    v_mfma_f32_16x16x32_bf16 v[40:43], v[144:147], a[152:155], v[40:43]
    buffer_load_dwordx4 v[220:223], v0, s[40:43], s81 offen offset:3072 sc1
    v_mfma_f32_16x16x32_bf16 v[44:47], v[144:147], a[156:159], v[44:47]
    s_waitcnt lgkmcnt(3)
    s_add_u32 s81, s81, 4096
    v_mfma_f32_16x16x32_bf16 v[48:51], v[148:151], a[144:147], v[48:51]
    ds_read_b128 v[164:167], v23 offset:21504
    v_mfma_f32_16x16x32_bf16 v[52:55], v[148:151], a[148:151], v[52:55]
    v_mfma_f32_16x16x32_bf16 v[56:59], v[148:151], a[152:155], v[56:59]
    buffer_load_dwordx4 v[224:227], v0, s[40:43], s81 offen offset:0 sc1
    v_mfma_f32_16x16x32_bf16 v[60:63], v[148:151], a[156:159], v[60:63]
    s_waitcnt vmcnt(21) lgkmcnt(3)
    v_mfma_f32_16x16x32_bf16 v[32:35], v[152:155], a[160:163], v[32:35]
    ds_read_b128 v[168:171], v24 offset:20480
    v_mfma_f32_16x16x32_bf16 v[36:39], v[152:155], a[164:167], v[36:39]
    v_mfma_f32_16x16x32_bf16 v[40:43], v[152:155], a[168:171], v[40:43]
    buffer_load_dwordx4 v[228:231], v0, s[40:43], s81 offen offset:1024 sc1
    v_mfma_f32_16x16x32_bf16 v[44:47], v[152:155], a[172:175], v[44:47]
    s_waitcnt lgkmcnt(3)
    v_mfma_f32_16x16x32_bf16 v[48:51], v[156:159], a[160:163], v[48:51]
    ds_read_b128 v[172:175], v24 offset:21504
    v_mfma_f32_16x16x32_bf16 v[52:55], v[156:159], a[164:167], v[52:55]
    v_mfma_f32_16x16x32_bf16 v[56:59], v[156:159], a[168:171], v[56:59]
    buffer_load_dwordx4 v[232:235], v0, s[40:43], s81 offen offset:2048 sc1
    v_mfma_f32_16x16x32_bf16 v[60:63], v[156:159], a[172:175], v[60:63]
    s_waitcnt vmcnt(19) lgkmcnt(3)
    v_mfma_f32_16x16x32_bf16 v[32:35], v[160:163], a[176:179], v[32:35]
    ds_read_b128 v[144:147], v25 offset:20480
    v_mfma_f32_16x16x32_bf16 v[36:39], v[160:163], a[180:183], v[36:39]
    v_mfma_f32_16x16x32_bf16 v[40:43], v[160:163], a[184:187], v[40:43]
    buffer_load_dwordx4 v[236:239], v0, s[40:43], s81 offen offset:3072 sc1
    v_mfma_f32_16x16x32_bf16 v[44:47], v[160:163], a[188:191], v[44:47]
    s_waitcnt vmcnt(16) lgkmcnt(3)
    s_add_u32 s81, s81, 102400
    v_mfma_f32_16x16x32_bf16 v[32:35], v[164:167], a[208:211], v[32:35]
    ds_read_b128 v[148:151], v25 offset:21504
    v_mfma_f32_16x16x32_bf16 v[36:39], v[164:167], a[212:215], v[36:39]
    v_mfma_f32_16x16x32_bf16 v[40:43], v[164:167], a[216:219], v[40:43]
    v_mfma_f32_16x16x32_bf16 v[44:47], v[164:167], a[220:223], v[44:47]
    s_waitcnt vmcnt(12) lgkmcnt(3)
    v_mfma_f32_16x16x32_bf16 v[32:35], v[168:171], a[224:227], v[32:35]
    ds_read_b128 v[152:155], v23 offset:22528
    v_mfma_f32_16x16x32_bf16 v[36:39], v[168:171], a[228:231], v[36:39]
    v_mfma_f32_16x16x32_bf16 v[40:43], v[168:171], a[232:235], v[40:43]
    v_mfma_f32_16x16x32_bf16 v[44:47], v[168:171], a[236:239], v[44:47]
    s_waitcnt vmcnt(8) lgkmcnt(3)
    v_mfma_f32_16x16x32_bf16 v[32:35], v[172:175], a[240:243], v[32:35]
    ds_read_b128 v[156:159], v23 offset:23552
    v_mfma_f32_16x16x32_bf16 v[36:39], v[172:175], a[244:247], v[36:39]
L_pk12:
    s_cbranch_execz L_pkdone2
    v_mfma_f32_16x16x32_bf16 v[40:43], v[172:175], a[248:251], v[40:43]
    v_mfma_f32_16x16x32_bf16 v[44:47], v[172:175], a[252:255], v[44:47]
    s_waitcnt vmcnt(4) lgkmcnt(3)
    v_mfma_f32_16x16x32_bf16 v[32:35], v[144:147], v[208:211], v[32:35]
    ds_read_b128 v[160:163], v24 offset:22528
    v_mfma_f32_16x16x32_bf16 v[36:39], v[144:147], v[212:215], v[36:39]
    v_mfma_f32_16x16x32_bf16 v[40:43], v[144:147], v[216:219], v[40:43]
    v_mfma_f32_16x16x32_bf16 v[44:47], v[144:147], v[220:223], v[44:47]
    s_waitcnt vmcnt(0) lgkmcnt(3)
    v_mfma_f32_16x16x32_bf16 v[32:35], v[148:151], v[224:227], v[32:35]
    ds_read_b128 v[164:167], v24 offset:23552
    v_mfma_f32_16x16x32_bf16 v[36:39], v[148:151], v[228:231], v[36:39]
    v_mfma_f32_16x16x32_bf16 v[40:43], v[148:151], v[232:235], v[40:43]
    v_mfma_f32_16x16x32_bf16 v[44:47], v[148:151], v[236:239], v[44:47]
    s_waitcnt lgkmcnt(3)
    v_mfma_f32_16x16x32_bf16 v[48:51], v[152:155], a[176:179], v[48:51]
    ds_read_b128 v[168:171], v25 offset:22528
    s_nop 0
    v_mfma_f32_16x16x32_bf16 v[52:55], v[152:155], a[180:183], v[52:55]
    s_nop 1
    v_mfma_f32_16x16x32_bf16 v[56:59], v[152:155], a[184:187], v[56:59]
    s_nop 1
    v_mfma_f32_16x16x32_bf16 v[60:63], v[152:155], a[188:191], v[60:63]
    s_waitcnt lgkmcnt(3)
    v_mfma_f32_16x16x32_bf16 v[48:51], v[156:159], a[208:211], v[48:51]
    ds_read_b128 v[172:175], v25 offset:23552
    v_cvt_pk_bf16_f32 v96, v32, v36
    v_mfma_f32_16x16x32_bf16 v[52:55], v[156:159], a[212:215], v[52:55]
    v_cvt_pk_bf16_f32 v97, v40, v44
    v_cvt_pk_bf16_f32 v98, v33, v37
    v_mfma_f32_16x16x32_bf16 v[56:59], v[156:159], a[216:219], v[56:59]
    v_cvt_pk_bf16_f32 v99, v41, v45
    v_mfma_f32_16x16x32_bf16 v[60:63], v[156:159], a[220:223], v[60:63]
    s_waitcnt lgkmcnt(3)
    v_mov_b32 v100, v96
    v_mov_b32 v101, v97
    v_mfma_f32_16x16x32_bf16 v[48:51], v[160:163], a[224:227], v[48:51]
    v_mov_b32_dpp v96, v98 row_ror:8 row_mask:0xf bank_mask:0xc
    v_mfma_f32_16x16x32_bf16 v[52:55], v[160:163], a[228:231], v[52:55]
    v_mov_b32_dpp v97, v99 row_ror:8 row_mask:0xf bank_mask:0xc
    v_mov_b32_dpp v98, v100 row_ror:8 row_mask:0xf bank_mask:0x3
    v_mfma_f32_16x16x32_bf16 v[56:59], v[160:163], a[232:235], v[56:59]
    v_mov_b32_dpp v99, v101 row_ror:8 row_mask:0xf bank_mask:0x3
    v_mfma_f32_16x16x32_bf16 v[60:63], v[160:163], a[236:239], v[60:63]
    s_waitcnt lgkmcnt(2)
    buffer_store_dwordx4 v[96:99], v13, s[48:51], 0 offen offset:0 sc1
    v_mfma_f32_16x16x32_bf16 v[48:51], v[164:167], a[240:243], v[48:51]
    v_cvt_pk_bf16_f32 v104, v34, v38
    v_cvt_pk_bf16_f32 v105, v42, v46
    v_mfma_f32_16x16x32_bf16 v[52:55], v[164:167], a[244:247], v[52:55]
    v_cvt_pk_bf16_f32 v106, v35, v39
    v_mfma_f32_16x16x32_bf16 v[56:59], v[164:167], a[248:251], v[56:59]
    v_cvt_pk_bf16_f32 v107, v43, v47
    v_mov_b32 v108, v104
    v_mfma_f32_16x16x32_bf16 v[60:63], v[164:167], a[252:255], v[60:63]
    s_waitcnt lgkmcnt(1)
    v_mov_b32 v109, v105
    v_mfma_f32_16x16x32_bf16 v[48:51], v[168:171], v[208:211], v[48:51]
    v_mov_b32_dpp v104, v106 row_ror:8 row_mask:0xf bank_mask:0xc
    v_mov_b32_dpp v105, v107 row_ror:8 row_mask:0xf bank_mask:0xc
    v_mfma_f32_16x16x32_bf16 v[52:55], v[168:171], v[212:215], v[52:55]
    v_mov_b32_dpp v106, v108 row_ror:8 row_mask:0xf bank_mask:0x3
    v_mfma_f32_16x16x32_bf16 v[56:59], v[168:171], v[216:219], v[56:59]
    v_mov_b32_dpp v107, v109 row_ror:8 row_mask:0xf bank_mask:0x3
    v_mfma_f32_16x16x32_bf16 v[60:63], v[168:171], v[220:223], v[60:63]
    s_waitcnt lgkmcnt(0)
    buffer_store_dwordx4 v[104:107], v13, s[48:51], 0 offen offset:1024 sc1
    v_mfma_f32_16x16x32_bf16 v[48:51], v[172:175], v[224:227], v[48:51]
    v_mfma_f32_16x16x32_bf16 v[52:55], v[172:175], v[228:231], v[52:55]
    v_mfma_f32_16x16x32_bf16 v[56:59], v[172:175], v[232:235], v[56:59]
    v_mfma_f32_16x16x32_bf16 v[60:63], v[172:175], v[236:239], v[60:63]
    s_nop 6
    v_cvt_pk_bf16_f32 v112, v48, v52
    v_cvt_pk_bf16_f32 v113, v56, v60
    v_cvt_pk_bf16_f32 v114, v49, v53
    v_cvt_pk_bf16_f32 v115, v57, v61
    v_cvt_pk_bf16_f32 v120, v50, v54
    v_cvt_pk_bf16_f32 v121, v58, v62
    v_cvt_pk_bf16_f32 v122, v51, v55
    v_cvt_pk_bf16_f32 v123, v59, v63
    v_mov_b32 v116, v112
    v_mov_b32 v117, v113
    v_mov_b32 v124, v120
    v_mov_b32 v125, v121
    v_mov_b32_dpp v112, v114 row_ror:8 row_mask:0xf bank_mask:0xc
    v_mov_b32_dpp v113, v115 row_ror:8 row_mask:0xf bank_mask:0xc
    v_mov_b32_dpp v114, v116 row_ror:8 row_mask:0xf bank_mask:0x3
    v_mov_b32_dpp v115, v117 row_ror:8 row_mask:0xf bank_mask:0x3
    buffer_store_dwordx4 v[112:115], v14, s[48:51], 0 offen offset:0 sc1
    v_mov_b32_dpp v120, v122 row_ror:8 row_mask:0xf bank_mask:0xc
    v_mov_b32_dpp v121, v123 row_ror:8 row_mask:0xf bank_mask:0xc
    v_mov_b32_dpp v122, v124 row_ror:8 row_mask:0xf bank_mask:0x3
    v_mov_b32_dpp v123, v125 row_ror:8 row_mask:0xf bank_mask:0x3
    buffer_store_dwordx4 v[120:123], v14, s[48:51], 0 offen offset:1024 sc1
    s_endpgm
L_spin_m:
    s_mov_b32 s80, 0
L_spinl_m:
    s_sleep 1
    buffer_load_dword v25, v166, s[40:43], 0 offen sc1
    s_add_u32 s80, s80, 1
    s_cmp_gt_u32 s80, 0x10000
    s_waitcnt vmcnt(0)
    s_cbranch_scc1 L_back_m
    v_cmp_ne_u32 vcc, s56, v25
    s_cbranch_vccnz L_spinl_m
    s_branch L_back_m
L_spin_xa:
    s_mov_b32 s80, 0
L_spinl_xa:
    s_sleep 1
    buffer_load_dword v24, v6, s[40:43], 0 offen sc1
    s_add_u32 s80, s80, 1
    s_cmp_gt_u32 s80, 0x10000
    s_waitcnt vmcnt(0)
    s_cbranch_scc1 L_back_xa
    v_cmp_ne_u32 vcc, s56, v24
    s_cbranch_vccnz L_spinl_xa
    s_branch L_back_xa
L_spin_tl:
    s_mov_b32 s80, 0
L_spinl_tl:
    s_sleep 1
    buffer_load_dword v0, v6, s[40:43], 0 offen sc1
    s_add_u32 s80, s80, 1
    s_cmp_gt_u32 s80, 0x10000
    s_waitcnt vmcnt(0)
    s_cbranch_scc1 L_back_tl
    v_cmp_ne_u32 vcc, s56, v0
    s_cbranch_vccnz L_spinl_tl
    s_branch L_back_tl
L_spin_fi14:
    s_mov_b32 s80, 0
L_spinl_fi14:
    s_sleep 1
    buffer_load_dword v5, off, s[40:43], s82 sc1
    s_add_u32 s80, s80, 1
    s_cmp_gt_u32 s80, 0x10000
    s_waitcnt vmcnt(0)
    s_cbranch_scc1 L_back_fi14
    v_cmp_ne_u32 vcc, s56, v5
    s_cbranch_vccnz L_spinl_fi14
    s_branch L_back_fi14
L_spin_fl14:
    s_mov_b32 s80, 0
L_spinl_fl14:
    s_sleep 1
    buffer_load_dword v5, off, s[40:43], s82 sc1
    s_add_u32 s80, s80, 1
    s_cmp_gt_u32 s80, 0x10000
    s_waitcnt vmcnt(0)
    s_cbranch_scc1 L_back_fl14
    v_cmp_ne_u32 vcc, s56, v5
    s_cbranch_vccnz L_spinl_fl14
    s_branch L_back_fl14
L_spin_xc:
    s_mov_b32 s80, 0
L_spinl_xc:
    s_sleep 1
    buffer_load_dword v7, v6, s[40:43], 0 offen sc1
    s_add_u32 s80, s80, 1
    s_cmp_gt_u32 s80, 0x10000
    s_waitcnt vmcnt(0)
    s_cbranch_scc1 L_back_xc
    v_cmp_ne_u32 vcc, s56, v7
    s_cbranch_vccnz L_spinl_xc
    s_branch L_back_xc
L_n15:
    v_cvt_pk_bf16_f32 v73, v74, v75
    s_lshl_b32 s70, s55, 4
    s_sub_u32 s70, s70, 4
    v_mov_b32 v0, v6
    v_exp_f32 v77, v77
    s_lshl_b32 s81, s52, 15
    v_lshrrev_b32 v4, 5, v1
    v_add_f32 v13, v13, v76
    v_exp_f32 v78, v78
    s_add_u32 s81, s81, 6422528
    v_mul_u32_u24 v6, 40, v4
    v_add_f32 v13, v13, v77
    v_cvt_pk_bf16_f32 v74, v76, v77
    v_sub_u32 v6, v1, v6
    v_exp_f32 v79, v79
    v_add_u32 v6, s70, v6
    v_add_f32 v13, v13, v78
    v_exp_f32 v80, v80
    s_movk_i32 s70, 2000
    v_cmp_gt_u32 s[72:73], s70, v6
    v_add_f32 v13, v13, v79
    v_mul_u32_u24 v4, 256000, v4
    v_cvt_pk_bf16_f32 v75, v78, v79
    v_exp_f32 v81, v81
    v_lshl_add_u32 v6, v6, 4, v4
    v_exp_f32 v82, v82
    s_and_b32 s72, s72, 0xffffff
    s_and_b32 s73, s73, 0xffffff00
    v_mov_b32 v4, 0x40000000
    v_add_f32 v14, v80, v81
    v_cvt_pk_bf16_f32 v80, v80, v81
    s_mul_i32 s71, s52, 512000
    v_cndmask_b32 v6, v4, v6, s[72:73]
    v_exp_f32 v83, v83
    v_add_f32 v14, v14, v82
    v_exp_f32 v84, v84
    v_add_f32 v14, v14, v83
    v_cvt_pk_bf16_f32 v81, v82, v83
    v_exp_f32 v85, v85
    v_add_f32 v14, v14, v84
    v_exp_f32 v86, v86
    v_add_f32 v14, v14, v85
    s_lshl_b32 s70, s55, 14
    s_lshl_b32 s72, s52, 7
    v_lshrrev_b32 v4, 3, v1
    v_cvt_pk_bf16_f32 v82, v84, v85
    v_exp_f32 v87, v87
    s_add_u32 s70, s70, s72
    v_mul_u32_u24 v4, 384, v4
    v_add_f32 v14, v14, v86
    v_add_u32 v4, v4, v0
    v_exp_f32 v88, v88
    v_add_f32 v14, v14, v87
    v_cvt_pk_bf16_f32 v83, v86, v87
    v_exp_f32 v89, v89
    v_exp_f32 v90, v90
    v_add_f32 v15, v88, v89
    v_cvt_pk_bf16_f32 v88, v88, v89
    s_lshl_b32 s82, s52, 7
    s_add_u32 s82, s82, 36880
    v_exp_f32 v91, v91
    v_add_f32 v15, v15, v90
    buffer_load_dword v5, off, s[40:43], s82 sc1
    v_exp_f32 v92, v92
    v_add_f32 v15, v15, v91
    v_cvt_pk_bf16_f32 v89, v90, v91
    v_exp_f32 v93, v93
    ds_read_b64_tr_b16 v[32:33], v3 offset:24576
    ds_read_b64_tr_b16 v[34:35], v3 offset:24832
    v_add_f32 v15, v15, v92
    v_exp_f32 v94, v94
    v_add_f32 v15, v15, v93
    ds_read_b64_tr_b16 v[36:37], v3 offset:25600
    ds_read_b64_tr_b16 v[38:39], v3 offset:25856
    v_cvt_pk_bf16_f32 v90, v92, v93
    v_exp_f32 v95, v95
    v_add_f32 v15, v15, v94
    v_max3_f32 v7, v12, v13, v14
    ds_read_b64_tr_b16 v[40:41], v3 offset:26624
    ds_read_b64_tr_b16 v[42:43], v3 offset:26880
    v_add_f32 v15, v15, v95
    v_cvt_pk_bf16_f32 v91, v94, v95
    v_add_f32 v7, v7, v15
    v_cmp_nge_f32 vcc, s62, v7
    ds_read_b64_tr_b16 v[44:45], v3 offset:27648
    ds_read_b64_tr_b16 v[46:47], v3 offset:27904
    s_waitcnt lgkmcnt(4)
    s_cbranch_vccnz L_stub_l14
L_back_l14:
    v_mfma_f32_16x16x32_bf16 v[128:131], v[32:35], v[64:67], v[128:131]
    ds_read_b64_tr_b16 v[48:49], v3 offset:28672
    ds_read_b64_tr_b16 v[50:51], v3 offset:28928
    v_mfma_f32_16x16x32_bf16 v[132:135], v[36:39], v[64:67], v[132:135]
    v_add_f32 v8, v8, v12
    v_add_f32 v9, v9, v13
    v_mfma_f32_16x16x32_bf16 v[196:199], v[36:39], v[72:75], v[196:199]
    v_mfma_f32_16x16x32_bf16 v[192:195], v[32:35], v[72:75], v[192:195]
    v_add_f32 v10, v10, v14
    v_add_f32 v11, v11, v15
    v_mfma_f32_16x16x32_bf16 a[128:131], v[32:35], v[80:83], a[128:131]
    ds_read_b64_tr_b16 v[52:53], v3 offset:29696
    ds_read_b64_tr_b16 v[54:55], v3 offset:29952
    v_mfma_f32_16x16x32_bf16 a[132:135], v[36:39], v[80:83], a[132:135]
    s_add_u32 m0, s57, 24576
    v_mfma_f32_16x16x32_bf16 a[196:199], v[36:39], v[88:91], a[196:199]
    buffer_load_dwordx4 v6, s[36:39], s71 offen sc1 lds
    v_mfma_f32_16x16x32_bf16 a[192:195], v[32:35], v[88:91], a[192:195]
    s_waitcnt lgkmcnt(4)
    s_add_u32 s71, s71, 32000
    v_mfma_f32_16x16x32_bf16 a[200:203], v[40:43], v[88:91], a[200:203]
    ds_read_b64_tr_b16 v[56:57], v3 offset:30720
    ds_read_b64_tr_b16 v[58:59], v3 offset:30976
    v_mfma_f32_16x16x32_bf16 a[204:207], v[44:47], v[88:91], a[204:207]
    v_mfma_f32_16x16x32_bf16 a[140:143], v[44:47], v[80:83], a[140:143]
    v_mfma_f32_16x16x32_bf16 a[136:139], v[40:43], v[80:83], a[136:139]
    v_mfma_f32_16x16x32_bf16 v[200:203], v[40:43], v[72:75], v[200:203]
    ds_read_b64_tr_b16 v[60:61], v3 offset:31744
    ds_read_b64_tr_b16 v[62:63], v3 offset:32000
    v_mfma_f32_16x16x32_bf16 v[204:207], v[44:47], v[72:75], v[204:207]
    s_add_u32 m0, s57, 25616
    v_mfma_f32_16x16x32_bf16 v[140:143], v[44:47], v[64:67], v[140:143]
    buffer_load_dwordx4 v6, s[36:39], s71 offen sc1 lds
    v_mfma_f32_16x16x32_bf16 v[136:139], v[40:43], v[64:67], v[136:139]
    s_waitcnt lgkmcnt(4)
    s_add_u32 s71, s71, 32000
    v_mfma_f32_16x16x32_bf16 v[144:147], v[48:51], v[64:67], v[144:147]
    ds_read_b64_tr_b16 v[32:33], v3 offset:32768
    ds_read_b64_tr_b16 v[34:35], v3 offset:33024
    v_mfma_f32_16x16x32_bf16 v[148:151], v[52:55], v[64:67], v[148:151]
    v_mfma_f32_16x16x32_bf16 v[212:215], v[52:55], v[72:75], v[212:215]
    v_mfma_f32_16x16x32_bf16 v[208:211], v[48:51], v[72:75], v[208:211]
    v_mfma_f32_16x16x32_bf16 a[144:147], v[48:51], v[80:83], a[144:147]
    ds_read_b64_tr_b16 v[36:37], v3 offset:33792
    ds_read_b64_tr_b16 v[38:39], v3 offset:34048
    v_mfma_f32_16x16x32_bf16 a[148:151], v[52:55], v[80:83], a[148:151]
    s_add_u32 m0, s57, 26656
    v_mfma_f32_16x16x32_bf16 a[212:215], v[52:55], v[88:91], a[212:215]
    buffer_load_dwordx4 v6, s[36:39], s71 offen sc1 lds
    v_mfma_f32_16x16x32_bf16 a[208:211], v[48:51], v[88:91], a[208:211]
    s_waitcnt lgkmcnt(4)
    s_add_u32 s71, s71, 32000
    v_mfma_f32_16x16x32_bf16 a[216:219], v[56:59], v[88:91], a[216:219]
    ds_read_b64_tr_b16 v[40:41], v3 offset:34816
    ds_read_b64_tr_b16 v[42:43], v3 offset:35072
    v_mfma_f32_16x16x32_bf16 a[220:223], v[60:63], v[88:91], a[220:223]
    v_mfma_f32_16x16x32_bf16 a[156:159], v[60:63], v[80:83], a[156:159]
    v_mfma_f32_16x16x32_bf16 a[152:155], v[56:59], v[80:83], a[152:155]
    v_mfma_f32_16x16x32_bf16 v[216:219], v[56:59], v[72:75], v[216:219]
    ds_read_b64_tr_b16 v[44:45], v3 offset:35840
    ds_read_b64_tr_b16 v[46:47], v3 offset:36096
    v_mfma_f32_16x16x32_bf16 v[220:223], v[60:63], v[72:75], v[220:223]
    s_add_u32 m0, s57, 27696
    v_mfma_f32_16x16x32_bf16 v[156:159], v[60:63], v[64:67], v[156:159]
    buffer_load_dwordx4 v6, s[36:39], s71 offen sc1 lds
    v_mfma_f32_16x16x32_bf16 v[152:155], v[56:59], v[64:67], v[152:155]
    s_waitcnt lgkmcnt(4)
    s_add_u32 s71, s71, 32000
    v_mfma_f32_16x16x32_bf16 v[160:163], v[32:35], v[64:67], v[160:163]
    ds_read_b64_tr_b16 v[48:49], v3 offset:36864
    ds_read_b64_tr_b16 v[50:51], v3 offset:37120
    v_mfma_f32_16x16x32_bf16 v[164:167], v[36:39], v[64:67], v[164:167]
    s_waitcnt vmcnt(4)
    v_cmp_ne_u32 vcc, s56, v5
    v_mfma_f32_16x16x32_bf16 v[228:231], v[36:39], v[72:75], v[228:231]
    v_mfma_f32_16x16x32_bf16 v[224:227], v[32:35], v[72:75], v[224:227]
    s_cbranch_vccnz L_spin_fl14
L_back_fl14:
    v_mfma_f32_16x16x32_bf16 a[160:163], v[32:35], v[80:83], a[160:163]
    ds_read_b64_tr_b16 v[52:53], v3 offset:37888
    ds_read_b64_tr_b16 v[54:55], v3 offset:38144
    v_mfma_f32_16x16x32_bf16 a[164:167], v[36:39], v[80:83], a[164:167]
    s_add_u32 m0, s57, 28736
    v_mfma_f32_16x16x32_bf16 a[228:231], v[36:39], v[88:91], a[228:231]
    buffer_load_dwordx4 v6, s[36:39], s71 offen sc1 lds
    v_mfma_f32_16x16x32_bf16 a[224:227], v[32:35], v[88:91], a[224:227]
    s_waitcnt lgkmcnt(4)
    s_add_u32 s71, s71, 32000
    v_mfma_f32_16x16x32_bf16 a[232:235], v[40:43], v[88:91], a[232:235]
    ds_read_b64_tr_b16 v[56:57], v3 offset:38912
    ds_read_b64_tr_b16 v[58:59], v3 offset:39168
    v_mfma_f32_16x16x32_bf16 a[236:239], v[44:47], v[88:91], a[236:239]
    s_add_u32 m0, s57, 33792
    v_mfma_f32_16x16x32_bf16 a[172:175], v[44:47], v[80:83], a[172:175]
    buffer_load_dwordx4 v4, s[28:31], s70 offen lds
    v_mfma_f32_16x16x32_bf16 a[168:171], v[40:43], v[80:83], a[168:171]
    s_add_u32 s70, s70, 4096
    v_mfma_f32_16x16x32_bf16 v[232:235], v[40:43], v[72:75], v[232:235]
    ds_read_b64_tr_b16 v[60:61], v3 offset:39936
    ds_read_b64_tr_b16 v[62:63], v3 offset:40192
    v_mfma_f32_16x16x32_bf16 v[236:239], v[44:47], v[72:75], v[236:239]
    s_add_u32 m0, s57, 29776
    v_mfma_f32_16x16x32_bf16 v[172:175], v[44:47], v[64:67], v[172:175]
    buffer_load_dwordx4 v6, s[36:39], s71 offen sc1 lds
    v_mfma_f32_16x16x32_bf16 v[168:171], v[40:43], v[64:67], v[168:171]
    s_waitcnt lgkmcnt(4)
    s_add_u32 s71, s71, 32000
    v_mfma_f32_16x16x32_bf16 v[176:179], v[48:51], v[64:67], v[176:179]
    v_mfma_f32_16x16x32_bf16 v[180:183], v[52:55], v[64:67], v[180:183]
    s_add_u32 m0, s57, 34816
    v_mfma_f32_16x16x32_bf16 v[244:247], v[52:55], v[72:75], v[244:247]
    buffer_load_dwordx4 v4, s[28:31], s70 offen lds
    v_mfma_f32_16x16x32_bf16 v[240:243], v[48:51], v[72:75], v[240:243]
    s_add_u32 s70, s70, 4096
    v_mfma_f32_16x16x32_bf16 a[176:179], v[48:51], v[80:83], a[176:179]
    v_mfma_f32_16x16x32_bf16 a[180:183], v[52:55], v[80:83], a[180:183]
    s_add_u32 m0, s57, 30816
    v_mfma_f32_16x16x32_bf16 a[244:247], v[52:55], v[88:91], a[244:247]
    buffer_load_dwordx4 v6, s[36:39], s71 offen sc1 lds
    v_mfma_f32_16x16x32_bf16 a[240:243], v[48:51], v[88:91], a[240:243]
    s_waitcnt lgkmcnt(0)
    s_add_u32 s71, s71, 32000
    v_mfma_f32_16x16x32_bf16 a[248:251], v[56:59], v[88:91], a[248:251]
    v_mfma_f32_16x16x32_bf16 a[252:255], v[60:63], v[88:91], a[252:255]
    s_add_u32 m0, s57, 35840
    v_mfma_f32_16x16x32_bf16 a[188:191], v[60:63], v[80:83], a[188:191]
    buffer_load_dwordx4 v4, s[28:31], s70 offen lds
    v_mfma_f32_16x16x32_bf16 a[184:187], v[56:59], v[80:83], a[184:187]
    s_add_u32 s70, s70, 4096
    s_add_u32 m0, s57, 36864
    v_mfma_f32_16x16x32_bf16 v[248:251], v[56:59], v[72:75], v[248:251]
    buffer_load_dwordx4 v4, s[28:31], s70 offen lds
    v_mfma_f32_16x16x32_bf16 v[252:255], v[60:63], v[72:75], v[252:255]
    s_add_u32 m0, s57, 31856
    v_mfma_f32_16x16x32_bf16 v[188:191], v[60:63], v[64:67], v[188:191]
    buffer_load_dwordx4 v6, s[36:39], s71 offen sc1 lds
    v_mfma_f32_16x16x32_bf16 v[184:187], v[56:59], v[64:67], v[184:187]
    s_add_u32 s71, s71, 32000
    buffer_load_dwordx4 a[0:3], v0, s[40:43], s81 offen offset:0 sc1
    buffer_load_dwordx4 a[4:7], v0, s[40:43], s81 offen offset:1024 sc1
    buffer_load_dwordx4 a[8:11], v0, s[40:43], s81 offen offset:2048 sc1
    buffer_load_dwordx4 a[12:15], v0, s[40:43], s81 offen offset:3072 sc1
    s_add_u32 s81, s81, 4096
    buffer_load_dwordx4 a[16:19], v0, s[40:43], s81 offen offset:0 sc1
    buffer_load_dwordx4 a[20:23], v0, s[40:43], s81 offen offset:1024 sc1
    buffer_load_dwordx4 a[24:27], v0, s[40:43], s81 offen offset:2048 sc1
    buffer_load_dwordx4 a[28:31], v0, s[40:43], s81 offen offset:3072 sc1
    s_add_u32 s81, s81, 4096
    buffer_load_dwordx4 a[32:35], v0, s[40:43], s81 offen offset:0 sc1
    buffer_load_dwordx4 a[36:39], v0, s[40:43], s81 offen offset:1024 sc1
    buffer_load_dwordx4 a[40:43], v0, s[40:43], s81 offen offset:2048 sc1
    buffer_load_dwordx4 a[44:47], v0, s[40:43], s81 offen offset:3072 sc1
    s_add_u32 s81, s81, 4096
    buffer_load_dwordx4 a[48:51], v0, s[40:43], s81 offen offset:0 sc1
    buffer_load_dwordx4 a[52:55], v0, s[40:43], s81 offen offset:1024 sc1
    buffer_load_dwordx4 a[56:59], v0, s[40:43], s81 offen offset:2048 sc1
    buffer_load_dwordx4 a[60:63], v0, s[40:43], s81 offen offset:3072 sc1
    s_add_u32 s81, s81, 4096
    v_permlane32_swap_b32 v16, v24
    v_permlane32_swap_b32 v20, v28
    v_permlane32_swap_b32 v8, v10
    v_permlane32_swap_b32 v9, v11
    v_add_f32 v8, v8, v10
    v_add_f32 v10, v9, v11
    v_permlane16_swap_b32 v16, v20
    v_lshl_add_u32 v28, v1, 3, s57
    s_nop 0
    v_permlane16_swap_b32 v8, v10
    v_mov_b32 v9, v16
    v_add_f32 v8, v8, v10
    ds_write_b64 v28, v[8:9] offset:39936
    s_xor_b32 s70, s52, 1
    s_mul_i32 s70, s70, 40960
    v_add_u32 v22, s57, v0
    v_and_b32 v26, 15, v1
    s_xor_b32 s71, s52, 2
    s_mul_i32 s71, s71, 40960
    v_add_u32 v23, s70, v0
    v_lshl_add_u32 v29, v1, 3, s70
    s_xor_b32 s72, s52, 3
    s_mul_i32 s72, s72, 40960
    v_add_u32 v24, s71, v0
    v_lshl_add_u32 v30, v1, 3, s71
    v_add_u32 v25, s72, v0
    v_lshl_add_u32 v31, v1, 3, s72
    v_lshrrev_b32 v27, 4, v1
    v_lshl_add_u32 v6, v26, 4, s57
    v_lshlrev_b32 v27, 2, v27
    v_sub_u32 v26, v26, v27
    v_and_b32 v27, 1, v26
    v_lshlrev_b32 v27, 4, v27
    v_mov_b32 v7, 0x3f80
    v_lshlrev_b32 v27, v27, v7
    s_waitcnt vmcnt(16) lgkmcnt(0)
    s_barrier
    ds_read_b64 v[10:11], v29 offset:39936
    ds_read_b64 v[12:13], v30 offset:39936
    ds_read_b64 v[14:15], v31 offset:39936
    ds_read_b128 v[64:67], v22 offset:16384
    ds_read_b128 v[68:71], v22 offset:18432
    ds_read_b128 v[72:75], v22 offset:17408
    ds_read_b128 v[76:79], v22 offset:19456
    ds_read_b128 v[80:83], v23 offset:16384
    ds_read_b128 v[84:87], v23 offset:18432
    ds_read_b128 v[88:91], v23 offset:17408
    ds_read_b128 v[92:95], v23 offset:19456
    ds_read_b128 v[32:35], v24 offset:16384
    ds_read_b128 v[36:39], v24 offset:18432
    ds_read_b128 v[40:43], v24 offset:17408
    ds_read_b128 v[44:47], v24 offset:19456
    v_lshrrev_b32 v26, 1, v26
    v_mov_b32 v16, 0
    v_cmp_eq_u32 vcc, 0, v26
    v_mov_b32 v17, 0
    v_mov_b32 v20, 0
    v_cndmask_b32 v18, v16, v27, vcc
    v_cmp_eq_u32 vcc, 1, v26
    v_mov_b32 v21, 0
    s_waitcnt lgkmcnt(14)
    v_xor_b32 v2, v9, v11
    v_cndmask_b32 v19, v16, v27, vcc
    s_waitcnt lgkmcnt(13)
    v_xor_b32 v4, v9, v13
    s_waitcnt lgkmcnt(12)
    v_xor_b32 v5, v9, v15
    v_or3_b32 v2, v2, v4, v5
    v_cmp_ne_u32 vcc, 0, v2
    s_waitcnt lgkmcnt(0)
    s_branch L_tail
L_fold:
    s_sub_u32 s53, s2, 252
    s_mov_b32 s32, s20
    s_mov_b32 s33, s21
    s_mov_b32 s34, 262144
    s_mov_b32 s35, 0x20000
    s_mov_b32 s36, s14
    s_mov_b32 s37, s15
    s_mov_b32 s38, 262144
    s_mov_b32 s39, 0x20000
    s_mov_b32 s28, s16
    s_mov_b32 s29, s17
    s_mov_b32 s30, 7680
    s_mov_b32 s31, 0x20000
    v_bfe_u32 v12, v0, 4, 3
    v_lshrrev_b32 v16, 7, v0
    v_lshl_add_u32 v12, v12, 1, v16
    v_lshlrev_b32 v12, 9, v12
    v_lshl_add_u32 v12, v8, 3, v12
    s_lshl_b32 s70, s53, 7
    v_add_u32 v12, s70, v12
    v_subrev_u32 v16, 512, v12
    buffer_load_dwordx2 v[2:3], v16, s[28:31], 0 offen
    buffer_load_dwordx2 v[4:5], v12, s[28:31], 0 offen
    s_lshl_b32 s72, s52, 15
    v_add_u32 v24, s72, v13
    v_bfe_u32 v16, v8, 2, 1
    v_bfe_u32 v17, v8, 3, 1
    v_lshl_add_u32 v16, v16, 1, v17
    v_and_b32 v17, 3, v8
    v_lshl_add_u32 v18, v16, 2, v17
    v_xor_b32 v18, v18, v10
    v_lshlrev_b32 v18, 4, v18
    v_lshl_add_u32 v16, v16, 3, v17
    v_lshl_add_u32 v18, v16, 9, v18
    v_add_u32 v32, s57, v18
    v_xor_b32 v18, v8, v10
    v_lshlrev_b32 v18, 4, v18
    v_lshl_add_u32 v18, v8, 9, v18
    v_add_u32 v36, s57, v18
    v_xor_b32 v33, 64, v32
    v_xor_b32 v34, 128, v32
    v_xor_b32 v35, 192, v32
    v_xor_b32 v37, 64, v36
    v_xor_b32 v38, 128, v36
    v_xor_b32 v39, 192, v36
    v_xor_b32 v40, 0, v24
    v_xor_b32 v41, 32, v24
    v_xor_b32 v42, 64, v24
    v_xor_b32 v43, 96, v24
    v_xor_b32 v44, 128, v24
    v_xor_b32 v45, 160, v24
    v_xor_b32 v46, 192, v24
    v_xor_b32 v47, 224, v24
    s_mov_b32 s28, s12
    s_mov_b32 s29, s13
    s_mov_b32 s30, 131072
    s_mov_b32 s31, 0x20000
    s_add_u32 m0, s57, 0
    s_mov_b32 s70, 0
    buffer_load_dwordx4 v40, s[28:31], s70 offen offset:0 lds
    buffer_load_dwordx4 v41, s[28:31], s70 offen offset:1024 lds
    buffer_load_dwordx4 v40, s[28:31], s70 offen offset:2048 lds
    buffer_load_dwordx4 v41, s[28:31], s70 offen offset:3072 lds
    s_add_u32 m0, s57, 4096
    s_mov_b32 s70, 4096
    buffer_load_dwordx4 v42, s[28:31], s70 offen offset:0 lds
    buffer_load_dwordx4 v43, s[28:31], s70 offen offset:1024 lds
    buffer_load_dwordx4 v42, s[28:31], s70 offen offset:2048 lds
    buffer_load_dwordx4 v43, s[28:31], s70 offen offset:3072 lds
    s_add_u32 m0, s57, 8192
    s_mov_b32 s70, 8192
    buffer_load_dwordx4 v44, s[28:31], s70 offen offset:0 lds
    buffer_load_dwordx4 v45, s[28:31], s70 offen offset:1024 lds
    buffer_load_dwordx4 v44, s[28:31], s70 offen offset:2048 lds
    buffer_load_dwordx4 v45, s[28:31], s70 offen offset:3072 lds
    s_add_u32 m0, s57, 12288
    s_mov_b32 s70, 12288
    buffer_load_dwordx4 v46, s[28:31], s70 offen offset:0 lds
    buffer_load_dwordx4 v47, s[28:31], s70 offen offset:1024 lds
    buffer_load_dwordx4 v46, s[28:31], s70 offen offset:2048 lds
    buffer_load_dwordx4 v47, s[28:31], s70 offen offset:3072 lds
    s_add_u32 m0, s57, 16384
    s_mov_b32 s70, 16384
    buffer_load_dwordx4 v40, s[28:31], s70 offen offset:0 lds
    buffer_load_dwordx4 v41, s[28:31], s70 offen offset:1024 lds
    buffer_load_dwordx4 v40, s[28:31], s70 offen offset:2048 lds
    buffer_load_dwordx4 v41, s[28:31], s70 offen offset:3072 lds
    s_add_u32 m0, s57, 20480
    s_mov_b32 s70, 20480
    buffer_load_dwordx4 v42, s[28:31], s70 offen offset:0 lds
    buffer_load_dwordx4 v43, s[28:31], s70 offen offset:1024 lds
    buffer_load_dwordx4 v42, s[28:31], s70 offen offset:2048 lds
    buffer_load_dwordx4 v43, s[28:31], s70 offen offset:3072 lds
    s_add_u32 m0, s57, 24576
    s_mov_b32 s70, 24576
    buffer_load_dwordx4 v44, s[28:31], s70 offen offset:0 lds
    buffer_load_dwordx4 v45, s[28:31], s70 offen offset:1024 lds
    buffer_load_dwordx4 v44, s[28:31], s70 offen offset:2048 lds
    buffer_load_dwordx4 v45, s[28:31], s70 offen offset:3072 lds
    s_add_u32 m0, s57, 28672
    s_mov_b32 s70, 28672
    buffer_load_dwordx4 v46, s[28:31], s70 offen offset:0 lds
    buffer_load_dwordx4 v47, s[28:31], s70 offen offset:1024 lds
    buffer_load_dwordx4 v46, s[28:31], s70 offen offset:2048 lds
    buffer_load_dwordx4 v47, s[28:31], s70 offen offset:3072 lds
    s_mov_b32 s70, 0x05040100
    s_mov_b32 s71, 0x07060302
    s_waitcnt vmcnt(32)
    v_perm_b32 v20, v4, v2, s70
    v_perm_b32 v21, v4, v2, s71
    v_perm_b32 v22, v5, v3, s70
    v_perm_b32 v23, v5, v3, s71
    s_waitcnt vmcnt(16)
    ds_read_b128 v[128:131], v32 offset:0
    ds_read_b128 v[132:135], v32 offset:2048
    ds_read_b128 v[144:147], v33 offset:0
    ds_read_b128 v[148:151], v33 offset:2048
    ds_read_b128 v[160:163], v34 offset:0
    ds_read_b128 v[164:167], v34 offset:2048
    ds_read_b128 v[176:179], v35 offset:0
    ds_read_b128 v[180:183], v35 offset:2048
    ds_read_b128 v[192:195], v32 offset:256
    ds_read_b128 v[196:199], v32 offset:2304
    ds_read_b128 v[208:211], v33 offset:256
    ds_read_b128 v[212:215], v33 offset:2304
    ds_read_b128 v[224:227], v34 offset:256
    ds_read_b128 v[228:231], v34 offset:2304
    ds_read_b128 v[240:243], v35 offset:256
    ds_read_b128 v[244:247], v35 offset:2304
    s_waitcnt lgkmcnt(0)
    s_mov_b32 s28, s18
    s_mov_b32 s29, s19
    s_mov_b32 s30, 131072
    s_mov_b32 s31, 0x20000
    s_add_u32 m0, s57, 0
    s_mov_b32 s70, 0
    buffer_load_dwordx4 v40, s[28:31], s70 offen offset:0 lds
    buffer_load_dwordx4 v41, s[28:31], s70 offen offset:1024 lds
    buffer_load_dwordx4 v40, s[28:31], s70 offen offset:2048 lds
    buffer_load_dwordx4 v41, s[28:31], s70 offen offset:3072 lds
    s_add_u32 m0, s57, 4096
    s_mov_b32 s70, 4096
    buffer_load_dwordx4 v42, s[28:31], s70 offen offset:0 lds
    buffer_load_dwordx4 v43, s[28:31], s70 offen offset:1024 lds
    buffer_load_dwordx4 v42, s[28:31], s70 offen offset:2048 lds
    buffer_load_dwordx4 v43, s[28:31], s70 offen offset:3072 lds
    s_add_u32 m0, s57, 8192
    s_mov_b32 s70, 8192
    buffer_load_dwordx4 v44, s[28:31], s70 offen offset:0 lds
    buffer_load_dwordx4 v45, s[28:31], s70 offen offset:1024 lds
    buffer_load_dwordx4 v44, s[28:31], s70 offen offset:2048 lds
    buffer_load_dwordx4 v45, s[28:31], s70 offen offset:3072 lds
    s_add_u32 m0, s57, 12288
    s_mov_b32 s70, 12288
    buffer_load_dwordx4 v46, s[28:31], s70 offen offset:0 lds
    buffer_load_dwordx4 v47, s[28:31], s70 offen offset:1024 lds
    buffer_load_dwordx4 v46, s[28:31], s70 offen offset:2048 lds
    buffer_load_dwordx4 v47, s[28:31], s70 offen offset:3072 lds
    s_waitcnt vmcnt(16)
    ds_read_b128 v[136:139], v32 offset:16384
    ds_read_b128 v[140:143], v32 offset:18432
    ds_read_b128 v[152:155], v33 offset:16384
    ds_read_b128 v[156:159], v33 offset:18432
    ds_read_b128 v[168:171], v34 offset:16384
    ds_read_b128 v[172:175], v34 offset:18432
    ds_read_b128 v[184:187], v35 offset:16384
    ds_read_b128 v[188:191], v35 offset:18432
    ds_read_b128 v[200:203], v32 offset:16640
    ds_read_b128 v[204:207], v32 offset:18688
    ds_read_b128 v[216:219], v33 offset:16640
    ds_read_b128 v[220:223], v33 offset:18688
    ds_read_b128 v[232:235], v34 offset:16640
    ds_read_b128 v[236:239], v34 offset:18688
    ds_read_b128 v[248:251], v35 offset:16640
    ds_read_b128 v[252:255], v35 offset:18688
    s_waitcnt lgkmcnt(0)
    s_add_u32 m0, s57, 16384
    s_mov_b32 s70, 16384
    buffer_load_dwordx4 v40, s[28:31], s70 offen offset:0 lds
    buffer_load_dwordx4 v41, s[28:31], s70 offen offset:1024 lds
    buffer_load_dwordx4 v40, s[28:31], s70 offen offset:2048 lds
    buffer_load_dwordx4 v41, s[28:31], s70 offen offset:3072 lds
    s_add_u32 m0, s57, 20480
    s_mov_b32 s70, 20480
    buffer_load_dwordx4 v42, s[28:31], s70 offen offset:0 lds
    buffer_load_dwordx4 v43, s[28:31], s70 offen offset:1024 lds
    buffer_load_dwordx4 v42, s[28:31], s70 offen offset:2048 lds
    buffer_load_dwordx4 v43, s[28:31], s70 offen offset:3072 lds
    s_add_u32 m0, s57, 24576
    s_mov_b32 s70, 24576
    buffer_load_dwordx4 v44, s[28:31], s70 offen offset:0 lds
    buffer_load_dwordx4 v45, s[28:31], s70 offen offset:1024 lds
    buffer_load_dwordx4 v44, s[28:31], s70 offen offset:2048 lds
    buffer_load_dwordx4 v45, s[28:31], s70 offen offset:3072 lds
    s_add_u32 m0, s57, 28672
    s_mov_b32 s70, 28672
    buffer_load_dwordx4 v46, s[28:31], s70 offen offset:0 lds
    buffer_load_dwordx4 v47, s[28:31], s70 offen offset:1024 lds
    buffer_load_dwordx4 v46, s[28:31], s70 offen offset:2048 lds
    buffer_load_dwordx4 v47, s[28:31], s70 offen offset:3072 lds
    s_waitcnt vmcnt(16)
    ds_read_b128 a[0:3], v32 offset:0
    ds_read_b128 a[4:7], v32 offset:2048
    ds_read_b128 a[16:19], v33 offset:0
    ds_read_b128 a[20:23], v33 offset:2048
    ds_read_b128 a[32:35], v34 offset:0
    ds_read_b128 a[36:39], v34 offset:2048
    ds_read_b128 a[48:51], v35 offset:0
    ds_read_b128 a[52:55], v35 offset:2048
    ds_read_b128 a[64:67], v32 offset:256
    ds_read_b128 a[68:71], v32 offset:2304
    ds_read_b128 a[80:83], v33 offset:256
    ds_read_b128 a[84:87], v33 offset:2304
    ds_read_b128 a[96:99], v34 offset:256
    ds_read_b128 a[100:103], v34 offset:2304
    ds_read_b128 a[112:115], v35 offset:256
    ds_read_b128 a[116:119], v35 offset:2304
    s_waitcnt lgkmcnt(0)
    s_mov_b32 s28, s10
    s_mov_b32 s29, s11
    s_mov_b32 s30, 131072
    s_mov_b32 s31, 0x20000
    s_add_u32 m0, s57, 0
    s_mov_b32 s70, 0
    buffer_load_dwordx4 v40, s[28:31], s70 offen offset:0 lds
    buffer_load_dwordx4 v41, s[28:31], s70 offen offset:1024 lds
    buffer_load_dwordx4 v42, s[28:31], s70 offen offset:2048 lds
    buffer_load_dwordx4 v43, s[28:31], s70 offen offset:3072 lds
    s_add_u32 m0, s57, 4096
    s_mov_b32 s70, 4096
    buffer_load_dwordx4 v44, s[28:31], s70 offen offset:0 lds
    buffer_load_dwordx4 v45, s[28:31], s70 offen offset:1024 lds
    buffer_load_dwordx4 v46, s[28:31], s70 offen offset:2048 lds
    buffer_load_dwordx4 v47, s[28:31], s70 offen offset:3072 lds
    s_add_u32 m0, s57, 8192
    s_mov_b32 s70, 8192
    buffer_load_dwordx4 v40, s[28:31], s70 offen offset:0 lds
    buffer_load_dwordx4 v41, s[28:31], s70 offen offset:1024 lds
    buffer_load_dwordx4 v42, s[28:31], s70 offen offset:2048 lds
    buffer_load_dwordx4 v43, s[28:31], s70 offen offset:3072 lds
    s_add_u32 m0, s57, 12288
    s_mov_b32 s70, 12288
    buffer_load_dwordx4 v44, s[28:31], s70 offen offset:0 lds
    buffer_load_dwordx4 v45, s[28:31], s70 offen offset:1024 lds
    buffer_load_dwordx4 v46, s[28:31], s70 offen offset:2048 lds
    buffer_load_dwordx4 v47, s[28:31], s70 offen offset:3072 lds
    s_waitcnt vmcnt(16)
    ds_read_b128 a[8:11], v32 offset:16384
    ds_read_b128 a[12:15], v32 offset:18432
    ds_read_b128 a[24:27], v33 offset:16384
    ds_read_b128 a[28:31], v33 offset:18432
    ds_read_b128 a[40:43], v34 offset:16384
    ds_read_b128 a[44:47], v34 offset:18432
    ds_read_b128 a[56:59], v35 offset:16384
    ds_read_b128 a[60:63], v35 offset:18432
    ds_read_b128 a[72:75], v32 offset:16640
    ds_read_b128 a[76:79], v32 offset:18688
    ds_read_b128 a[88:91], v33 offset:16640
    ds_read_b128 a[92:95], v33 offset:18688
    ds_read_b128 a[104:107], v34 offset:16640
    ds_read_b128 a[108:111], v34 offset:18688
    ds_read_b128 a[120:123], v35 offset:16640
    ds_read_b128 a[124:127], v35 offset:18688
    s_waitcnt lgkmcnt(0)
    s_add_u32 m0, s57, 16384
    s_mov_b32 s70, 16384
    buffer_load_dwordx4 v40, s[28:31], s70 offen offset:0 lds
    buffer_load_dwordx4 v41, s[28:31], s70 offen offset:1024 lds
    buffer_load_dwordx4 v42, s[28:31], s70 offen offset:2048 lds
    buffer_load_dwordx4 v43, s[28:31], s70 offen offset:3072 lds
    s_add_u32 m0, s57, 20480
    s_mov_b32 s70, 20480
    buffer_load_dwordx4 v44, s[28:31], s70 offen offset:0 lds
    buffer_load_dwordx4 v45, s[28:31], s70 offen offset:1024 lds
    buffer_load_dwordx4 v46, s[28:31], s70 offen offset:2048 lds
    buffer_load_dwordx4 v47, s[28:31], s70 offen offset:3072 lds
    s_add_u32 m0, s57, 24576
    s_mov_b32 s70, 24576
    buffer_load_dwordx4 v40, s[28:31], s70 offen offset:0 lds
    buffer_load_dwordx4 v41, s[28:31], s70 offen offset:1024 lds
    buffer_load_dwordx4 v42, s[28:31], s70 offen offset:2048 lds
    buffer_load_dwordx4 v43, s[28:31], s70 offen offset:3072 lds
    s_add_u32 m0, s57, 28672
    s_mov_b32 s70, 28672
    buffer_load_dwordx4 v44, s[28:31], s70 offen offset:0 lds
    buffer_load_dwordx4 v45, s[28:31], s70 offen offset:1024 lds
    buffer_load_dwordx4 v46, s[28:31], s70 offen offset:2048 lds
    buffer_load_dwordx4 v47, s[28:31], s70 offen offset:3072 lds
    s_waitcnt vmcnt(16)
    ds_read_b128 a[128:131], v36 offset:0
    ds_read_b128 a[132:135], v36 offset:8192
    ds_read_b128 a[144:147], v37 offset:0
    ds_read_b128 a[148:151], v37 offset:8192
    ds_read_b128 a[160:163], v38 offset:0
    ds_read_b128 a[164:167], v38 offset:8192
    ds_read_b128 a[176:179], v39 offset:0
    ds_read_b128 a[180:183], v39 offset:8192
    ds_read_b128 a[192:195], v36 offset:256
    ds_read_b128 a[196:199], v36 offset:8448
    ds_read_b128 a[208:211], v37 offset:256
    ds_read_b128 a[212:215], v37 offset:8448
    ds_read_b128 a[224:227], v38 offset:256
    ds_read_b128 a[228:231], v38 offset:8448
    ds_read_b128 a[240:243], v39 offset:256
    ds_read_b128 a[244:247], v39 offset:8448
    s_waitcnt vmcnt(0) lgkmcnt(0)
    ds_read_b128 a[136:139], v36 offset:16384
    ds_read_b128 a[140:143], v36 offset:24576
    ds_read_b128 a[152:155], v37 offset:16384
    ds_read_b128 a[156:159], v37 offset:24576
    ds_read_b128 a[168:171], v38 offset:16384
    ds_read_b128 a[172:175], v38 offset:24576
    ds_read_b128 a[184:187], v39 offset:16384
    ds_read_b128 a[188:191], v39 offset:24576
    ds_read_b128 a[200:203], v36 offset:16640
    ds_read_b128 a[204:207], v36 offset:24832
    ds_read_b128 a[216:219], v37 offset:16640
    ds_read_b128 a[220:223], v37 offset:24832
    ds_read_b128 a[232:235], v38 offset:16640
    ds_read_b128 a[236:239], v38 offset:24832
    ds_read_b128 a[248:251], v39 offset:16640
    ds_read_b128 a[252:255], v39 offset:24832
    s_waitcnt lgkmcnt(0)
    s_barrier
    v_lshrrev_b32 v12, 3, v1
    v_and_b32 v13, 7, v1
    v_lshlrev_b32 v13, 4, v13
    s_lshl_b32 s70, s52, 6
    v_add_u32 v12, s70, v12
    s_lshl_b32 s70, s53, 7
    v_add_u32 v13, s70, v13
    v_lshl_add_u32 v14, v12, 9, v13
    v_lshl_add_u32 v15, v12, 10, v13
    s_lshl_b32 s71, s52, 13
    s_add_u32 m0, s71, 0
    s_mov_b32 s70, 0
    buffer_load_dwordx4 v14, s[32:35], s70 offen lds
    s_add_u32 m0, s71, 1024
    s_mov_b32 s70, 4096
    buffer_load_dwordx4 v14, s[32:35], s70 offen lds
    s_add_u32 m0, s71, 2048
    s_mov_b32 s70, 8192
    buffer_load_dwordx4 v14, s[32:35], s70 offen lds
    s_add_u32 m0, s71, 3072
    s_mov_b32 s70, 12288
    buffer_load_dwordx4 v14, s[32:35], s70 offen lds
    s_add_u32 m0, s71, 4096
    s_mov_b32 s70, 16384
    buffer_load_dwordx4 v14, s[32:35], s70 offen lds
    s_add_u32 m0, s71, 5120
    s_mov_b32 s70, 20480
    buffer_load_dwordx4 v14, s[32:35], s70 offen lds
    s_add_u32 m0, s71, 6144
    s_mov_b32 s70, 24576
    buffer_load_dwordx4 v14, s[32:35], s70 offen lds
    s_add_u32 m0, s71, 7168
    s_mov_b32 s70, 28672
    buffer_load_dwordx4 v14, s[32:35], s70 offen lds
    s_add_u32 m0, s71, 32768
    s_mov_b32 s70, 131072
    buffer_load_dwordx4 v14, s[32:35], s70 offen lds
    s_add_u32 m0, s71, 33792
    s_mov_b32 s70, 135168
    buffer_load_dwordx4 v14, s[32:35], s70 offen lds
    s_add_u32 m0, s71, 34816
    s_mov_b32 s70, 139264
    buffer_load_dwordx4 v14, s[32:35], s70 offen lds
    s_add_u32 m0, s71, 35840
    s_mov_b32 s70, 143360
    buffer_load_dwordx4 v14, s[32:35], s70 offen lds
    s_add_u32 m0, s71, 36864
    s_mov_b32 s70, 147456
    buffer_load_dwordx4 v14, s[32:35], s70 offen lds
    s_add_u32 m0, s71, 37888
    s_mov_b32 s70, 151552
    buffer_load_dwordx4 v14, s[32:35], s70 offen lds
    s_add_u32 m0, s71, 38912
    s_mov_b32 s70, 155648
    buffer_load_dwordx4 v14, s[32:35], s70 offen lds
    s_add_u32 m0, s71, 39936
    s_mov_b32 s70, 159744
    buffer_load_dwordx4 v14, s[32:35], s70 offen lds
    s_add_u32 m0, s71, 98304
    s_mov_b32 s70, 0
    buffer_load_dwordx4 v15, s[36:39], s70 offen lds
    s_add_u32 m0, s71, 99328
    s_mov_b32 s70, 8192
    buffer_load_dwordx4 v15, s[36:39], s70 offen lds
    s_add_u32 m0, s71, 100352
    s_mov_b32 s70, 16384
    buffer_load_dwordx4 v15, s[36:39], s70 offen lds
    s_add_u32 m0, s71, 101376
    s_mov_b32 s70, 24576
    buffer_load_dwordx4 v15, s[36:39], s70 offen lds
    s_add_u32 m0, s71, 102400
    s_mov_b32 s70, 32768
    buffer_load_dwordx4 v15, s[36:39], s70 offen lds
    s_add_u32 m0, s71, 103424
    s_mov_b32 s70, 40960
    buffer_load_dwordx4 v15, s[36:39], s70 offen lds
    s_add_u32 m0, s71, 104448
    s_mov_b32 s70, 49152
    buffer_load_dwordx4 v15, s[36:39], s70 offen lds
    s_add_u32 m0, s71, 105472
    s_mov_b32 s70, 57344
    buffer_load_dwordx4 v15, s[36:39], s70 offen lds
    v_lshlrev_b32 v12, 4, v0
    s_mul_i32 s70, s53, 4096
    s_add_u32 s70, s70, 6815744
    buffer_store_dwordx4 v[20:23], v12, s[40:43], s70 offen sc1
    v_lshrrev_b32 v16, 2, v8
    v_lshl_add_u32 v16, v10, 3, v16
    v_lshlrev_b32 v16, 7, v16
    v_and_b32 v18, 3, v8
    v_lshl_add_u32 v26, v18, 3, v16
    v_add_u32 v27, 65536, v26
    v_lshlrev_b32 v31, 10, v18
    v_lshl_add_u32 v31, v9, 8, v31
    v_lshrrev_b32 v18, 2, v8
    v_lshl_add_u32 v31, v18, 4, v31
    s_lshl_b32 s70, s52, 13
    v_add_u32 v27, s70, v27
    v_add_u32 v31, s70, v31
    v_add_u32 v31, 65536, v31
    v_lshlrev_b32 v25, 4, v18
    v_sub_u32 v25, v31, v25
    v_and_b32 v24, 1, v18
    v_lshl_add_u32 v25, v24, 7, v25
    v_lshrrev_b32 v24, 1, v18
    v_lshl_add_u32 v25, v24, 4, v25
    v_lshlrev_b32 v28, 4, v1
    v_add_u32 v29, 131072, v28
    v_add_u32 v30, s70, v29
    s_xor_b32 s71, s52, s53
    s_lshl_b32 s71, s71, 13
    s_lshl_b32 s72, s53, 15
    s_add_u32 s82, s71, s72
    s_mul_i32 s56, s56, 1664525
    s_add_u32 s56, s56, 1013904223
    s_waitcnt vmcnt(1)
    s_barrier
    ds_read_b64_tr_b16 v[32:33], v27 offset:32768
    ds_read_b64_tr_b16 v[34:35], v27 offset:33280
    ds_read_b64_tr_b16 v[36:37], v27 offset:32800
    ds_read_b64_tr_b16 v[38:39], v27 offset:33312
    ds_read_b64_tr_b16 v[40:41], v27 offset:32832
    ds_read_b64_tr_b16 v[42:43], v27 offset:33344
    ds_read_b64_tr_b16 v[44:45], v27 offset:32864
    ds_read_b64_tr_b16 v[46:47], v27 offset:33376
    ds_read_b64_tr_b16 v[48:49], v27 offset:36864
    ds_read_b64_tr_b16 v[50:51], v27 offset:37376
    ds_read_b64_tr_b16 v[52:53], v27 offset:36896
    ds_read_b64_tr_b16 v[54:55], v27 offset:37408
    ds_read_b64_tr_b16 v[56:57], v27 offset:36928
    ds_read_b64_tr_b16 v[58:59], v27 offset:37440
    ds_read_b64_tr_b16 v[60:61], v27 offset:36960
    ds_read_b64_tr_b16 v[62:63], v27 offset:37472
    s_waitcnt lgkmcnt(14)
    ds_write_b128 v31, v[32:35] offset:0
    s_waitcnt lgkmcnt(13)
    ds_write_b128 v31, v[36:39] offset:64
    s_waitcnt lgkmcnt(12)
    ds_write_b128 v31, v[40:43] offset:128
    s_waitcnt lgkmcnt(11)
    ds_write_b128 v31, v[44:47] offset:192
    s_waitcnt lgkmcnt(10)
    ds_write_b128 v31, v[48:51] offset:4096
    s_waitcnt lgkmcnt(9)
    ds_write_b128 v31, v[52:55] offset:4160
    s_waitcnt lgkmcnt(8)
    ds_write_b128 v31, v[56:59] offset:4224
    s_waitcnt lgkmcnt(7)
    ds_write_b128 v31, v[60:63] offset:4288
    s_waitcnt lgkmcnt(0)
    v_subrev_u32 v12, 65536, v30
    ds_read_b128 v[64:67], v12 offset:0
    ds_read_b128 v[68:71], v12 offset:1024
    ds_read_b128 v[72:75], v12 offset:2048
    ds_read_b128 v[76:79], v12 offset:3072
    ds_read_b128 v[80:83], v12 offset:4096
    ds_read_b128 v[84:87], v12 offset:5120
    ds_read_b128 v[88:91], v12 offset:6144
    ds_read_b128 v[92:95], v12 offset:7168
    s_add_u32 s70, s82, 6422528
    s_waitcnt lgkmcnt(7)
    buffer_store_dwordx4 v[64:67], v28, s[40:43], s70 offen offset:0 sc1
    s_waitcnt lgkmcnt(6)
    buffer_store_dwordx4 v[68:71], v28, s[40:43], s70 offen offset:1024 sc1
    s_waitcnt lgkmcnt(5)
    buffer_store_dwordx4 v[72:75], v28, s[40:43], s70 offen offset:2048 sc1
    s_waitcnt lgkmcnt(4)
    buffer_store_dwordx4 v[76:79], v28, s[40:43], s70 offen offset:3072 sc1
    s_add_u32 s70, s82, 6426624
    s_waitcnt lgkmcnt(3)
    buffer_store_dwordx4 v[80:83], v28, s[40:43], s70 offen offset:0 sc1
    s_waitcnt lgkmcnt(2)
    buffer_store_dwordx4 v[84:87], v28, s[40:43], s70 offen offset:1024 sc1
    s_waitcnt lgkmcnt(1)
    buffer_store_dwordx4 v[88:91], v28, s[40:43], s70 offen offset:2048 sc1
    s_waitcnt lgkmcnt(0)
    buffer_store_dwordx4 v[92:95], v28, s[40:43], s70 offen offset:3072 sc1
    ds_read_b64_tr_b16 v[32:33], v26 offset:0
    ds_read_b64_tr_b16 v[34:35], v26 offset:512
    ds_read_b64_tr_b16 v[36:37], v26 offset:32
    ds_read_b64_tr_b16 v[38:39], v26 offset:544
    ds_read_b64_tr_b16 v[40:41], v26 offset:64
    ds_read_b64_tr_b16 v[42:43], v26 offset:576
    ds_read_b64_tr_b16 v[44:45], v26 offset:96
    ds_read_b64_tr_b16 v[46:47], v26 offset:608
    s_waitcnt lgkmcnt(0)
    ds_read_b64_tr_b16 v[48:49], v26 offset:4096
    ds_read_b64_tr_b16 v[50:51], v26 offset:4608
    ds_read_b64_tr_b16 v[52:53], v26 offset:4128
    ds_read_b64_tr_b16 v[54:55], v26 offset:4640
    ds_read_b64_tr_b16 v[56:57], v26 offset:4160
    ds_read_b64_tr_b16 v[58:59], v26 offset:4672
    ds_read_b64_tr_b16 v[60:61], v26 offset:4192
    ds_read_b64_tr_b16 v[62:63], v26 offset:4704
    v_mfma_f32_16x16x32_bf16 v[64:67], v[128:131], v[32:35], 0
    v_mfma_f32_16x16x32_bf16 v[68:71], v[128:131], v[36:39], 0
    v_mfma_f32_16x16x32_bf16 v[72:75], v[128:131], v[40:43], 0
    v_mfma_f32_16x16x32_bf16 v[76:79], v[128:131], v[44:47], 0
    v_mfma_f32_16x16x32_bf16 v[80:83], v[132:135], v[32:35], 0
    v_mfma_f32_16x16x32_bf16 v[84:87], v[132:135], v[36:39], 0
    v_mfma_f32_16x16x32_bf16 v[88:91], v[132:135], v[40:43], 0
    v_mfma_f32_16x16x32_bf16 v[92:95], v[132:135], v[44:47], 0
    v_mfma_f32_16x16x32_bf16 v[96:99], v[136:139], v[32:35], 0
    v_mfma_f32_16x16x32_bf16 v[100:103], v[136:139], v[36:39], 0
    v_mfma_f32_16x16x32_bf16 v[104:107], v[136:139], v[40:43], 0
    v_mfma_f32_16x16x32_bf16 v[108:111], v[136:139], v[44:47], 0
    v_mfma_f32_16x16x32_bf16 v[112:115], v[140:143], v[32:35], 0
    v_mfma_f32_16x16x32_bf16 v[116:119], v[140:143], v[36:39], 0
    v_mfma_f32_16x16x32_bf16 v[120:123], v[140:143], v[40:43], 0
    v_mfma_f32_16x16x32_bf16 v[124:127], v[140:143], v[44:47], 0
    s_waitcnt lgkmcnt(0)
    ds_read_b64_tr_b16 v[32:33], v26 offset:8192
    ds_read_b64_tr_b16 v[34:35], v26 offset:8704
    ds_read_b64_tr_b16 v[36:37], v26 offset:8224
    ds_read_b64_tr_b16 v[38:39], v26 offset:8736
    ds_read_b64_tr_b16 v[40:41], v26 offset:8256
    ds_read_b64_tr_b16 v[42:43], v26 offset:8768
    ds_read_b64_tr_b16 v[44:45], v26 offset:8288
    ds_read_b64_tr_b16 v[46:47], v26 offset:8800
    v_mfma_f32_16x16x32_bf16 v[64:67], v[144:147], v[48:51], v[64:67]
    v_mfma_f32_16x16x32_bf16 v[68:71], v[144:147], v[52:55], v[68:71]
    v_mfma_f32_16x16x32_bf16 v[72:75], v[144:147], v[56:59], v[72:75]
    v_mfma_f32_16x16x32_bf16 v[76:79], v[144:147], v[60:63], v[76:79]
    v_mfma_f32_16x16x32_bf16 v[80:83], v[148:151], v[48:51], v[80:83]
    v_mfma_f32_16x16x32_bf16 v[84:87], v[148:151], v[52:55], v[84:87]
    v_mfma_f32_16x16x32_bf16 v[88:91], v[148:151], v[56:59], v[88:91]
    v_mfma_f32_16x16x32_bf16 v[92:95], v[148:151], v[60:63], v[92:95]
    v_mfma_f32_16x16x32_bf16 v[96:99], v[152:155], v[48:51], v[96:99]
    v_mfma_f32_16x16x32_bf16 v[100:103], v[152:155], v[52:55], v[100:103]
    v_mfma_f32_16x16x32_bf16 v[104:107], v[152:155], v[56:59], v[104:107]
    v_mfma_f32_16x16x32_bf16 v[108:111], v[152:155], v[60:63], v[108:111]
    v_mfma_f32_16x16x32_bf16 v[112:115], v[156:159], v[48:51], v[112:115]
    v_mfma_f32_16x16x32_bf16 v[116:119], v[156:159], v[52:55], v[116:119]
    v_mfma_f32_16x16x32_bf16 v[120:123], v[156:159], v[56:59], v[120:123]
    v_mfma_f32_16x16x32_bf16 v[124:127], v[156:159], v[60:63], v[124:127]
    s_waitcnt lgkmcnt(0)
    ds_read_b64_tr_b16 v[48:49], v26 offset:12288
    ds_read_b64_tr_b16 v[50:51], v26 offset:12800
    ds_read_b64_tr_b16 v[52:53], v26 offset:12320
    ds_read_b64_tr_b16 v[54:55], v26 offset:12832
    ds_read_b64_tr_b16 v[56:57], v26 offset:12352
    ds_read_b64_tr_b16 v[58:59], v26 offset:12864
    ds_read_b64_tr_b16 v[60:61], v26 offset:12384
    ds_read_b64_tr_b16 v[62:63], v26 offset:12896
    v_mfma_f32_16x16x32_bf16 v[64:67], v[160:163], v[32:35], v[64:67]
    v_mfma_f32_16x16x32_bf16 v[68:71], v[160:163], v[36:39], v[68:71]
    v_mfma_f32_16x16x32_bf16 v[72:75], v[160:163], v[40:43], v[72:75]
    v_mfma_f32_16x16x32_bf16 v[76:79], v[160:163], v[44:47], v[76:79]
    v_mfma_f32_16x16x32_bf16 v[80:83], v[164:167], v[32:35], v[80:83]
    v_mfma_f32_16x16x32_bf16 v[84:87], v[164:167], v[36:39], v[84:87]
    v_mfma_f32_16x16x32_bf16 v[88:91], v[164:167], v[40:43], v[88:91]
    v_mfma_f32_16x16x32_bf16 v[92:95], v[164:167], v[44:47], v[92:95]
    v_mfma_f32_16x16x32_bf16 v[96:99], v[168:171], v[32:35], v[96:99]
    v_mfma_f32_16x16x32_bf16 v[100:103], v[168:171], v[36:39], v[100:103]
    v_mfma_f32_16x16x32_bf16 v[104:107], v[168:171], v[40:43], v[104:107]
    v_mfma_f32_16x16x32_bf16 v[108:111], v[168:171], v[44:47], v[108:111]
    v_mfma_f32_16x16x32_bf16 v[112:115], v[172:175], v[32:35], v[112:115]
    v_mfma_f32_16x16x32_bf16 v[116:119], v[172:175], v[36:39], v[116:119]
    v_mfma_f32_16x16x32_bf16 v[120:123], v[172:175], v[40:43], v[120:123]
    v_mfma_f32_16x16x32_bf16 v[124:127], v[172:175], v[44:47], v[124:127]
    s_waitcnt lgkmcnt(0)
    ds_read_b64_tr_b16 v[32:33], v26 offset:16384
    ds_read_b64_tr_b16 v[34:35], v26 offset:16896
    ds_read_b64_tr_b16 v[36:37], v26 offset:16416
    ds_read_b64_tr_b16 v[38:39], v26 offset:16928
    ds_read_b64_tr_b16 v[40:41], v26 offset:16448
    ds_read_b64_tr_b16 v[42:43], v26 offset:16960
    ds_read_b64_tr_b16 v[44:45], v26 offset:16480
    ds_read_b64_tr_b16 v[46:47], v26 offset:16992
    v_mfma_f32_16x16x32_bf16 v[64:67], v[176:179], v[48:51], v[64:67]
    v_mfma_f32_16x16x32_bf16 v[68:71], v[176:179], v[52:55], v[68:71]
    v_mfma_f32_16x16x32_bf16 v[72:75], v[176:179], v[56:59], v[72:75]
    v_mfma_f32_16x16x32_bf16 v[76:79], v[176:179], v[60:63], v[76:79]
    v_mfma_f32_16x16x32_bf16 v[80:83], v[180:183], v[48:51], v[80:83]
    v_mfma_f32_16x16x32_bf16 v[84:87], v[180:183], v[52:55], v[84:87]
    v_mfma_f32_16x16x32_bf16 v[88:91], v[180:183], v[56:59], v[88:91]
    v_mfma_f32_16x16x32_bf16 v[92:95], v[180:183], v[60:63], v[92:95]
    v_mfma_f32_16x16x32_bf16 v[96:99], v[184:187], v[48:51], v[96:99]
    v_mfma_f32_16x16x32_bf16 v[100:103], v[184:187], v[52:55], v[100:103]
    v_mfma_f32_16x16x32_bf16 v[104:107], v[184:187], v[56:59], v[104:107]
    v_mfma_f32_16x16x32_bf16 v[108:111], v[184:187], v[60:63], v[108:111]
    v_mfma_f32_16x16x32_bf16 v[112:115], v[188:191], v[48:51], v[112:115]
    v_mfma_f32_16x16x32_bf16 v[116:119], v[188:191], v[52:55], v[116:119]
    v_mfma_f32_16x16x32_bf16 v[120:123], v[188:191], v[56:59], v[120:123]
    v_mfma_f32_16x16x32_bf16 v[124:127], v[188:191], v[60:63], v[124:127]
    s_waitcnt lgkmcnt(0)
    ds_read_b64_tr_b16 v[48:49], v26 offset:20480
    ds_read_b64_tr_b16 v[50:51], v26 offset:20992
    ds_read_b64_tr_b16 v[52:53], v26 offset:20512
    ds_read_b64_tr_b16 v[54:55], v26 offset:21024
    ds_read_b64_tr_b16 v[56:57], v26 offset:20544
    ds_read_b64_tr_b16 v[58:59], v26 offset:21056
    ds_read_b64_tr_b16 v[60:61], v26 offset:20576
    ds_read_b64_tr_b16 v[62:63], v26 offset:21088
    v_mfma_f32_16x16x32_bf16 v[64:67], v[192:195], v[32:35], v[64:67]
    v_mfma_f32_16x16x32_bf16 v[68:71], v[192:195], v[36:39], v[68:71]
    v_mfma_f32_16x16x32_bf16 v[72:75], v[192:195], v[40:43], v[72:75]
    v_mfma_f32_16x16x32_bf16 v[76:79], v[192:195], v[44:47], v[76:79]
    v_mfma_f32_16x16x32_bf16 v[80:83], v[196:199], v[32:35], v[80:83]
    v_mfma_f32_16x16x32_bf16 v[84:87], v[196:199], v[36:39], v[84:87]
    v_mfma_f32_16x16x32_bf16 v[88:91], v[196:199], v[40:43], v[88:91]
    v_mfma_f32_16x16x32_bf16 v[92:95], v[196:199], v[44:47], v[92:95]
    v_mfma_f32_16x16x32_bf16 v[96:99], v[200:203], v[32:35], v[96:99]
    v_mfma_f32_16x16x32_bf16 v[100:103], v[200:203], v[36:39], v[100:103]
    v_mfma_f32_16x16x32_bf16 v[104:107], v[200:203], v[40:43], v[104:107]
    v_mfma_f32_16x16x32_bf16 v[108:111], v[200:203], v[44:47], v[108:111]
    v_mfma_f32_16x16x32_bf16 v[112:115], v[204:207], v[32:35], v[112:115]
    v_mfma_f32_16x16x32_bf16 v[116:119], v[204:207], v[36:39], v[116:119]
    v_mfma_f32_16x16x32_bf16 v[120:123], v[204:207], v[40:43], v[120:123]
    v_mfma_f32_16x16x32_bf16 v[124:127], v[204:207], v[44:47], v[124:127]
    s_waitcnt lgkmcnt(0)
    ds_read_b64_tr_b16 v[32:33], v26 offset:24576
    ds_read_b64_tr_b16 v[34:35], v26 offset:25088
    ds_read_b64_tr_b16 v[36:37], v26 offset:24608
    ds_read_b64_tr_b16 v[38:39], v26 offset:25120
    ds_read_b64_tr_b16 v[40:41], v26 offset:24640
    ds_read_b64_tr_b16 v[42:43], v26 offset:25152
    ds_read_b64_tr_b16 v[44:45], v26 offset:24672
    ds_read_b64_tr_b16 v[46:47], v26 offset:25184
    v_mfma_f32_16x16x32_bf16 v[64:67], v[208:211], v[48:51], v[64:67]
    v_mfma_f32_16x16x32_bf16 v[68:71], v[208:211], v[52:55], v[68:71]
    v_mfma_f32_16x16x32_bf16 v[72:75], v[208:211], v[56:59], v[72:75]
    v_mfma_f32_16x16x32_bf16 v[76:79], v[208:211], v[60:63], v[76:79]
    v_mfma_f32_16x16x32_bf16 v[80:83], v[212:215], v[48:51], v[80:83]
    v_mfma_f32_16x16x32_bf16 v[84:87], v[212:215], v[52:55], v[84:87]
    v_mfma_f32_16x16x32_bf16 v[88:91], v[212:215], v[56:59], v[88:91]
    v_mfma_f32_16x16x32_bf16 v[92:95], v[212:215], v[60:63], v[92:95]
    v_mfma_f32_16x16x32_bf16 v[96:99], v[216:219], v[48:51], v[96:99]
    v_mfma_f32_16x16x32_bf16 v[100:103], v[216:219], v[52:55], v[100:103]
    v_mfma_f32_16x16x32_bf16 v[104:107], v[216:219], v[56:59], v[104:107]
    v_mfma_f32_16x16x32_bf16 v[108:111], v[216:219], v[60:63], v[108:111]
    v_mfma_f32_16x16x32_bf16 v[112:115], v[220:223], v[48:51], v[112:115]
    v_mfma_f32_16x16x32_bf16 v[116:119], v[220:223], v[52:55], v[116:119]
    v_mfma_f32_16x16x32_bf16 v[120:123], v[220:223], v[56:59], v[120:123]
    v_mfma_f32_16x16x32_bf16 v[124:127], v[220:223], v[60:63], v[124:127]
    s_waitcnt lgkmcnt(0)
    ds_read_b64_tr_b16 v[48:49], v26 offset:28672
    ds_read_b64_tr_b16 v[50:51], v26 offset:29184
    ds_read_b64_tr_b16 v[52:53], v26 offset:28704
    ds_read_b64_tr_b16 v[54:55], v26 offset:29216
    ds_read_b64_tr_b16 v[56:57], v26 offset:28736
    ds_read_b64_tr_b16 v[58:59], v26 offset:29248
    ds_read_b64_tr_b16 v[60:61], v26 offset:28768
    ds_read_b64_tr_b16 v[62:63], v26 offset:29280
    v_mfma_f32_16x16x32_bf16 v[64:67], v[224:227], v[32:35], v[64:67]
    v_mfma_f32_16x16x32_bf16 v[68:71], v[224:227], v[36:39], v[68:71]
    v_mfma_f32_16x16x32_bf16 v[72:75], v[224:227], v[40:43], v[72:75]
    v_mfma_f32_16x16x32_bf16 v[76:79], v[224:227], v[44:47], v[76:79]
    v_mfma_f32_16x16x32_bf16 v[80:83], v[228:231], v[32:35], v[80:83]
    v_mfma_f32_16x16x32_bf16 v[84:87], v[228:231], v[36:39], v[84:87]
    v_mfma_f32_16x16x32_bf16 v[88:91], v[228:231], v[40:43], v[88:91]
    v_mfma_f32_16x16x32_bf16 v[92:95], v[228:231], v[44:47], v[92:95]
    v_mfma_f32_16x16x32_bf16 v[96:99], v[232:235], v[32:35], v[96:99]
    v_mfma_f32_16x16x32_bf16 v[100:103], v[232:235], v[36:39], v[100:103]
    v_mfma_f32_16x16x32_bf16 v[104:107], v[232:235], v[40:43], v[104:107]
    v_mfma_f32_16x16x32_bf16 v[108:111], v[232:235], v[44:47], v[108:111]
    v_mfma_f32_16x16x32_bf16 v[112:115], v[236:239], v[32:35], v[112:115]
    v_mfma_f32_16x16x32_bf16 v[116:119], v[236:239], v[36:39], v[116:119]
    v_mfma_f32_16x16x32_bf16 v[120:123], v[236:239], v[40:43], v[120:123]
    v_mfma_f32_16x16x32_bf16 v[124:127], v[236:239], v[44:47], v[124:127]
    s_waitcnt lgkmcnt(0)
    v_mfma_f32_16x16x32_bf16 v[64:67], v[240:243], v[48:51], v[64:67]
    v_mfma_f32_16x16x32_bf16 v[68:71], v[240:243], v[52:55], v[68:71]
    v_mfma_f32_16x16x32_bf16 v[72:75], v[240:243], v[56:59], v[72:75]
    v_mfma_f32_16x16x32_bf16 v[76:79], v[240:243], v[60:63], v[76:79]
    v_mfma_f32_16x16x32_bf16 v[80:83], v[244:247], v[48:51], v[80:83]
    v_mfma_f32_16x16x32_bf16 v[84:87], v[244:247], v[52:55], v[84:87]
    v_mfma_f32_16x16x32_bf16 v[88:91], v[244:247], v[56:59], v[88:91]
    v_mfma_f32_16x16x32_bf16 v[92:95], v[244:247], v[60:63], v[92:95]
    v_mfma_f32_16x16x32_bf16 v[96:99], v[248:251], v[48:51], v[96:99]
    v_mfma_f32_16x16x32_bf16 v[100:103], v[248:251], v[52:55], v[100:103]
    v_mfma_f32_16x16x32_bf16 v[104:107], v[248:251], v[56:59], v[104:107]
    v_mfma_f32_16x16x32_bf16 v[108:111], v[248:251], v[60:63], v[108:111]
    v_mfma_f32_16x16x32_bf16 v[112:115], v[252:255], v[48:51], v[112:115]
    v_mfma_f32_16x16x32_bf16 v[116:119], v[252:255], v[52:55], v[116:119]
    v_mfma_f32_16x16x32_bf16 v[120:123], v[252:255], v[56:59], v[120:123]
    v_mfma_f32_16x16x32_bf16 v[124:127], v[252:255], v[60:63], v[124:127]
    s_nop 7
    s_lshl_b32 s73, s53, 5
    s_add_u32 s73, s73, s52
    s_lshl_b32 s71, s73, 2
    s_add_u32 s71, s71, 36864
    v_mov_b32 v7, s56
    s_waitcnt vmcnt(0)
    s_mov_b64 exec, 1
    buffer_store_dword v7, off, s[40:43], s71 sc1
    s_mov_b64 exec, -1
    v_cvt_pk_bf16_f32 v32, v64, v65
    v_cvt_pk_bf16_f32 v33, v66, v67
    v_cvt_pk_bf16_f32 v34, v80, v81
    v_cvt_pk_bf16_f32 v35, v82, v83
    ds_write_b128 v30, v[32:35] offset:0
    v_cvt_pk_bf16_f32 v36, v68, v69
    v_cvt_pk_bf16_f32 v37, v70, v71
    v_cvt_pk_bf16_f32 v38, v84, v85
    v_cvt_pk_bf16_f32 v39, v86, v87
    ds_write_b128 v30, v[36:39] offset:1024
    v_cvt_pk_bf16_f32 v40, v72, v73
    v_cvt_pk_bf16_f32 v41, v74, v75
    v_cvt_pk_bf16_f32 v42, v88, v89
    v_cvt_pk_bf16_f32 v43, v90, v91
    ds_write_b128 v30, v[40:43] offset:2048
    v_cvt_pk_bf16_f32 v44, v76, v77
    v_cvt_pk_bf16_f32 v45, v78, v79
    v_cvt_pk_bf16_f32 v46, v92, v93
    v_cvt_pk_bf16_f32 v47, v94, v95
    ds_write_b128 v30, v[44:47] offset:3072
    v_cvt_pk_bf16_f32 v48, v96, v97
    v_cvt_pk_bf16_f32 v49, v98, v99
    v_cvt_pk_bf16_f32 v50, v112, v113
    v_cvt_pk_bf16_f32 v51, v114, v115
    ds_write_b128 v30, v[48:51] offset:4096
    v_cvt_pk_bf16_f32 v52, v100, v101
    v_cvt_pk_bf16_f32 v53, v102, v103
    v_cvt_pk_bf16_f32 v54, v116, v117
    v_cvt_pk_bf16_f32 v55, v118, v119
    ds_write_b128 v30, v[52:55] offset:5120
    v_cvt_pk_bf16_f32 v56, v104, v105
    v_cvt_pk_bf16_f32 v57, v106, v107
    v_cvt_pk_bf16_f32 v58, v120, v121
    v_cvt_pk_bf16_f32 v59, v122, v123
    ds_write_b128 v30, v[56:59] offset:6144
    v_cvt_pk_bf16_f32 v60, v108, v109
    v_cvt_pk_bf16_f32 v61, v110, v111
    v_cvt_pk_bf16_f32 v62, v124, v125
    v_cvt_pk_bf16_f32 v63, v126, v127
    ds_write_b128 v30, v[60:63] offset:7168
    s_waitcnt lgkmcnt(0)
    s_barrier
    ds_read_b64_tr_b16 v[32:33], v26 offset:32768
    ds_read_b64_tr_b16 v[34:35], v26 offset:33280
    ds_read_b64_tr_b16 v[36:37], v26 offset:32800
    ds_read_b64_tr_b16 v[38:39], v26 offset:33312
    ds_read_b64_tr_b16 v[40:41], v26 offset:32832
    ds_read_b64_tr_b16 v[42:43], v26 offset:33344
    ds_read_b64_tr_b16 v[44:45], v26 offset:32864
    ds_read_b64_tr_b16 v[46:47], v26 offset:33376
    s_waitcnt lgkmcnt(0)
    ds_read_b64_tr_b16 v[48:49], v26 offset:36864
    ds_read_b64_tr_b16 v[50:51], v26 offset:37376
    ds_read_b64_tr_b16 v[52:53], v26 offset:36896
    ds_read_b64_tr_b16 v[54:55], v26 offset:37408
    ds_read_b64_tr_b16 v[56:57], v26 offset:36928
    ds_read_b64_tr_b16 v[58:59], v26 offset:37440
    ds_read_b64_tr_b16 v[60:61], v26 offset:36960
    ds_read_b64_tr_b16 v[62:63], v26 offset:37472
    v_mfma_f32_16x16x32_bf16 v[64:67], a[0:3], v[32:35], 0
    v_mfma_f32_16x16x32_bf16 v[68:71], a[0:3], v[36:39], 0
    v_mfma_f32_16x16x32_bf16 v[72:75], a[0:3], v[40:43], 0
    v_mfma_f32_16x16x32_bf16 v[76:79], a[0:3], v[44:47], 0
    v_mfma_f32_16x16x32_bf16 v[80:83], a[4:7], v[32:35], 0
    v_mfma_f32_16x16x32_bf16 v[84:87], a[4:7], v[36:39], 0
    v_mfma_f32_16x16x32_bf16 v[88:91], a[4:7], v[40:43], 0
    v_mfma_f32_16x16x32_bf16 v[92:95], a[4:7], v[44:47], 0
    v_mfma_f32_16x16x32_bf16 v[96:99], a[8:11], v[32:35], 0
    v_mfma_f32_16x16x32_bf16 v[100:103], a[8:11], v[36:39], 0
    v_mfma_f32_16x16x32_bf16 v[104:107], a[8:11], v[40:43], 0
    v_mfma_f32_16x16x32_bf16 v[108:111], a[8:11], v[44:47], 0
    v_mfma_f32_16x16x32_bf16 v[112:115], a[12:15], v[32:35], 0
    v_mfma_f32_16x16x32_bf16 v[116:119], a[12:15], v[36:39], 0
    v_mfma_f32_16x16x32_bf16 v[120:123], a[12:15], v[40:43], 0
    v_mfma_f32_16x16x32_bf16 v[124:127], a[12:15], v[44:47], 0
    s_waitcnt lgkmcnt(0)
    ds_read_b64_tr_b16 v[32:33], v26 offset:40960
    ds_read_b64_tr_b16 v[34:35], v26 offset:41472
    ds_read_b64_tr_b16 v[36:37], v26 offset:40992
    ds_read_b64_tr_b16 v[38:39], v26 offset:41504
    ds_read_b64_tr_b16 v[40:41], v26 offset:41024
    ds_read_b64_tr_b16 v[42:43], v26 offset:41536
    ds_read_b64_tr_b16 v[44:45], v26 offset:41056
    ds_read_b64_tr_b16 v[46:47], v26 offset:41568
    v_mfma_f32_16x16x32_bf16 v[64:67], a[16:19], v[48:51], v[64:67]
    v_mfma_f32_16x16x32_bf16 v[68:71], a[16:19], v[52:55], v[68:71]
    v_mfma_f32_16x16x32_bf16 v[72:75], a[16:19], v[56:59], v[72:75]
    v_mfma_f32_16x16x32_bf16 v[76:79], a[16:19], v[60:63], v[76:79]
    v_mfma_f32_16x16x32_bf16 v[80:83], a[20:23], v[48:51], v[80:83]
    v_mfma_f32_16x16x32_bf16 v[84:87], a[20:23], v[52:55], v[84:87]
    v_mfma_f32_16x16x32_bf16 v[88:91], a[20:23], v[56:59], v[88:91]
    v_mfma_f32_16x16x32_bf16 v[92:95], a[20:23], v[60:63], v[92:95]
    v_mfma_f32_16x16x32_bf16 v[96:99], a[24:27], v[48:51], v[96:99]
    v_mfma_f32_16x16x32_bf16 v[100:103], a[24:27], v[52:55], v[100:103]
    v_mfma_f32_16x16x32_bf16 v[104:107], a[24:27], v[56:59], v[104:107]
    v_mfma_f32_16x16x32_bf16 v[108:111], a[24:27], v[60:63], v[108:111]
    v_mfma_f32_16x16x32_bf16 v[112:115], a[28:31], v[48:51], v[112:115]
    v_mfma_f32_16x16x32_bf16 v[116:119], a[28:31], v[52:55], v[116:119]
    v_mfma_f32_16x16x32_bf16 v[120:123], a[28:31], v[56:59], v[120:123]
    v_mfma_f32_16x16x32_bf16 v[124:127], a[28:31], v[60:63], v[124:127]
    s_waitcnt lgkmcnt(0)
    ds_read_b64_tr_b16 v[48:49], v26 offset:45056
    ds_read_b64_tr_b16 v[50:51], v26 offset:45568
    ds_read_b64_tr_b16 v[52:53], v26 offset:45088
    ds_read_b64_tr_b16 v[54:55], v26 offset:45600
    ds_read_b64_tr_b16 v[56:57], v26 offset:45120
    ds_read_b64_tr_b16 v[58:59], v26 offset:45632
    ds_read_b64_tr_b16 v[60:61], v26 offset:45152
    ds_read_b64_tr_b16 v[62:63], v26 offset:45664
    v_mfma_f32_16x16x32_bf16 v[64:67], a[32:35], v[32:35], v[64:67]
    v_mfma_f32_16x16x32_bf16 v[68:71], a[32:35], v[36:39], v[68:71]
    v_mfma_f32_16x16x32_bf16 v[72:75], a[32:35], v[40:43], v[72:75]
    v_mfma_f32_16x16x32_bf16 v[76:79], a[32:35], v[44:47], v[76:79]
    v_mfma_f32_16x16x32_bf16 v[80:83], a[36:39], v[32:35], v[80:83]
    v_mfma_f32_16x16x32_bf16 v[84:87], a[36:39], v[36:39], v[84:87]
    v_mfma_f32_16x16x32_bf16 v[88:91], a[36:39], v[40:43], v[88:91]
    v_mfma_f32_16x16x32_bf16 v[92:95], a[36:39], v[44:47], v[92:95]
    v_mfma_f32_16x16x32_bf16 v[96:99], a[40:43], v[32:35], v[96:99]
    v_mfma_f32_16x16x32_bf16 v[100:103], a[40:43], v[36:39], v[100:103]
    v_mfma_f32_16x16x32_bf16 v[104:107], a[40:43], v[40:43], v[104:107]
    v_mfma_f32_16x16x32_bf16 v[108:111], a[40:43], v[44:47], v[108:111]
    v_mfma_f32_16x16x32_bf16 v[112:115], a[44:47], v[32:35], v[112:115]
    v_mfma_f32_16x16x32_bf16 v[116:119], a[44:47], v[36:39], v[116:119]
    v_mfma_f32_16x16x32_bf16 v[120:123], a[44:47], v[40:43], v[120:123]
    v_mfma_f32_16x16x32_bf16 v[124:127], a[44:47], v[44:47], v[124:127]
    s_waitcnt lgkmcnt(0)
    ds_read_b64_tr_b16 v[32:33], v26 offset:49152
    ds_read_b64_tr_b16 v[34:35], v26 offset:49664
    ds_read_b64_tr_b16 v[36:37], v26 offset:49184
    ds_read_b64_tr_b16 v[38:39], v26 offset:49696
    ds_read_b64_tr_b16 v[40:41], v26 offset:49216
    ds_read_b64_tr_b16 v[42:43], v26 offset:49728
    ds_read_b64_tr_b16 v[44:45], v26 offset:49248
    ds_read_b64_tr_b16 v[46:47], v26 offset:49760
    v_mfma_f32_16x16x32_bf16 v[64:67], a[48:51], v[48:51], v[64:67]
    v_mfma_f32_16x16x32_bf16 v[68:71], a[48:51], v[52:55], v[68:71]
    v_mfma_f32_16x16x32_bf16 v[72:75], a[48:51], v[56:59], v[72:75]
    v_mfma_f32_16x16x32_bf16 v[76:79], a[48:51], v[60:63], v[76:79]
    v_mfma_f32_16x16x32_bf16 v[80:83], a[52:55], v[48:51], v[80:83]
    v_mfma_f32_16x16x32_bf16 v[84:87], a[52:55], v[52:55], v[84:87]
    v_mfma_f32_16x16x32_bf16 v[88:91], a[52:55], v[56:59], v[88:91]
    v_mfma_f32_16x16x32_bf16 v[92:95], a[52:55], v[60:63], v[92:95]
    v_mfma_f32_16x16x32_bf16 v[96:99], a[56:59], v[48:51], v[96:99]
    v_mfma_f32_16x16x32_bf16 v[100:103], a[56:59], v[52:55], v[100:103]
    v_mfma_f32_16x16x32_bf16 v[104:107], a[56:59], v[56:59], v[104:107]
    v_mfma_f32_16x16x32_bf16 v[108:111], a[56:59], v[60:63], v[108:111]
    v_mfma_f32_16x16x32_bf16 v[112:115], a[60:63], v[48:51], v[112:115]
    v_mfma_f32_16x16x32_bf16 v[116:119], a[60:63], v[52:55], v[116:119]
    v_mfma_f32_16x16x32_bf16 v[120:123], a[60:63], v[56:59], v[120:123]
    v_mfma_f32_16x16x32_bf16 v[124:127], a[60:63], v[60:63], v[124:127]
    s_waitcnt lgkmcnt(0)
    ds_read_b64_tr_b16 v[48:49], v26 offset:53248
    ds_read_b64_tr_b16 v[50:51], v26 offset:53760
    ds_read_b64_tr_b16 v[52:53], v26 offset:53280
    ds_read_b64_tr_b16 v[54:55], v26 offset:53792
    ds_read_b64_tr_b16 v[56:57], v26 offset:53312
    ds_read_b64_tr_b16 v[58:59], v26 offset:53824
    ds_read_b64_tr_b16 v[60:61], v26 offset:53344
    ds_read_b64_tr_b16 v[62:63], v26 offset:53856
    v_mfma_f32_16x16x32_bf16 v[64:67], a[64:67], v[32:35], v[64:67]
    v_mfma_f32_16x16x32_bf16 v[68:71], a[64:67], v[36:39], v[68:71]
    v_mfma_f32_16x16x32_bf16 v[72:75], a[64:67], v[40:43], v[72:75]
    v_mfma_f32_16x16x32_bf16 v[76:79], a[64:67], v[44:47], v[76:79]
    v_mfma_f32_16x16x32_bf16 v[80:83], a[68:71], v[32:35], v[80:83]
    v_mfma_f32_16x16x32_bf16 v[84:87], a[68:71], v[36:39], v[84:87]
    v_mfma_f32_16x16x32_bf16 v[88:91], a[68:71], v[40:43], v[88:91]
    v_mfma_f32_16x16x32_bf16 v[92:95], a[68:71], v[44:47], v[92:95]
    v_mfma_f32_16x16x32_bf16 v[96:99], a[72:75], v[32:35], v[96:99]
    v_mfma_f32_16x16x32_bf16 v[100:103], a[72:75], v[36:39], v[100:103]
    v_mfma_f32_16x16x32_bf16 v[104:107], a[72:75], v[40:43], v[104:107]
    v_mfma_f32_16x16x32_bf16 v[108:111], a[72:75], v[44:47], v[108:111]
    v_mfma_f32_16x16x32_bf16 v[112:115], a[76:79], v[32:35], v[112:115]
    v_mfma_f32_16x16x32_bf16 v[116:119], a[76:79], v[36:39], v[116:119]
    v_mfma_f32_16x16x32_bf16 v[120:123], a[76:79], v[40:43], v[120:123]
    v_mfma_f32_16x16x32_bf16 v[124:127], a[76:79], v[44:47], v[124:127]
    s_waitcnt lgkmcnt(0)
    ds_read_b64_tr_b16 v[32:33], v26 offset:57344
    ds_read_b64_tr_b16 v[34:35], v26 offset:57856
    ds_read_b64_tr_b16 v[36:37], v26 offset:57376
    ds_read_b64_tr_b16 v[38:39], v26 offset:57888
    ds_read_b64_tr_b16 v[40:41], v26 offset:57408
    ds_read_b64_tr_b16 v[42:43], v26 offset:57920
    ds_read_b64_tr_b16 v[44:45], v26 offset:57440
    ds_read_b64_tr_b16 v[46:47], v26 offset:57952
    v_mfma_f32_16x16x32_bf16 v[64:67], a[80:83], v[48:51], v[64:67]
    v_mfma_f32_16x16x32_bf16 v[68:71], a[80:83], v[52:55], v[68:71]
    v_mfma_f32_16x16x32_bf16 v[72:75], a[80:83], v[56:59], v[72:75]
    v_mfma_f32_16x16x32_bf16 v[76:79], a[80:83], v[60:63], v[76:79]
    v_mfma_f32_16x16x32_bf16 v[80:83], a[84:87], v[48:51], v[80:83]
    v_mfma_f32_16x16x32_bf16 v[84:87], a[84:87], v[52:55], v[84:87]
    v_mfma_f32_16x16x32_bf16 v[88:91], a[84:87], v[56:59], v[88:91]
    v_mfma_f32_16x16x32_bf16 v[92:95], a[84:87], v[60:63], v[92:95]
    v_mfma_f32_16x16x32_bf16 v[96:99], a[88:91], v[48:51], v[96:99]
    v_mfma_f32_16x16x32_bf16 v[100:103], a[88:91], v[52:55], v[100:103]
    v_mfma_f32_16x16x32_bf16 v[104:107], a[88:91], v[56:59], v[104:107]
    v_mfma_f32_16x16x32_bf16 v[108:111], a[88:91], v[60:63], v[108:111]
    v_mfma_f32_16x16x32_bf16 v[112:115], a[92:95], v[48:51], v[112:115]
    v_mfma_f32_16x16x32_bf16 v[116:119], a[92:95], v[52:55], v[116:119]
    v_mfma_f32_16x16x32_bf16 v[120:123], a[92:95], v[56:59], v[120:123]
    v_mfma_f32_16x16x32_bf16 v[124:127], a[92:95], v[60:63], v[124:127]
    s_waitcnt lgkmcnt(0)
    ds_read_b64_tr_b16 v[48:49], v26 offset:61440
    ds_read_b64_tr_b16 v[50:51], v26 offset:61952
    ds_read_b64_tr_b16 v[52:53], v26 offset:61472
    ds_read_b64_tr_b16 v[54:55], v26 offset:61984
    ds_read_b64_tr_b16 v[56:57], v26 offset:61504
    ds_read_b64_tr_b16 v[58:59], v26 offset:62016
    ds_read_b64_tr_b16 v[60:61], v26 offset:61536
    ds_read_b64_tr_b16 v[62:63], v26 offset:62048
    v_mfma_f32_16x16x32_bf16 v[64:67], a[96:99], v[32:35], v[64:67]
    v_mfma_f32_16x16x32_bf16 v[68:71], a[96:99], v[36:39], v[68:71]
    v_mfma_f32_16x16x32_bf16 v[72:75], a[96:99], v[40:43], v[72:75]
    v_mfma_f32_16x16x32_bf16 v[76:79], a[96:99], v[44:47], v[76:79]
    v_mfma_f32_16x16x32_bf16 v[80:83], a[100:103], v[32:35], v[80:83]
    v_mfma_f32_16x16x32_bf16 v[84:87], a[100:103], v[36:39], v[84:87]
    v_mfma_f32_16x16x32_bf16 v[88:91], a[100:103], v[40:43], v[88:91]
    v_mfma_f32_16x16x32_bf16 v[92:95], a[100:103], v[44:47], v[92:95]
    v_mfma_f32_16x16x32_bf16 v[96:99], a[104:107], v[32:35], v[96:99]
    v_mfma_f32_16x16x32_bf16 v[100:103], a[104:107], v[36:39], v[100:103]
    v_mfma_f32_16x16x32_bf16 v[104:107], a[104:107], v[40:43], v[104:107]
    v_mfma_f32_16x16x32_bf16 v[108:111], a[104:107], v[44:47], v[108:111]
    v_mfma_f32_16x16x32_bf16 v[112:115], a[108:111], v[32:35], v[112:115]
    v_mfma_f32_16x16x32_bf16 v[116:119], a[108:111], v[36:39], v[116:119]
    v_mfma_f32_16x16x32_bf16 v[120:123], a[108:111], v[40:43], v[120:123]
    v_mfma_f32_16x16x32_bf16 v[124:127], a[108:111], v[44:47], v[124:127]
    s_waitcnt lgkmcnt(0)
    v_mfma_f32_16x16x32_bf16 v[64:67], a[112:115], v[48:51], v[64:67]
    v_mfma_f32_16x16x32_bf16 v[68:71], a[112:115], v[52:55], v[68:71]
    v_mfma_f32_16x16x32_bf16 v[72:75], a[112:115], v[56:59], v[72:75]
    v_mfma_f32_16x16x32_bf16 v[76:79], a[112:115], v[60:63], v[76:79]
    v_mfma_f32_16x16x32_bf16 v[80:83], a[116:119], v[48:51], v[80:83]
    v_mfma_f32_16x16x32_bf16 v[84:87], a[116:119], v[52:55], v[84:87]
    v_mfma_f32_16x16x32_bf16 v[88:91], a[116:119], v[56:59], v[88:91]
    v_mfma_f32_16x16x32_bf16 v[92:95], a[116:119], v[60:63], v[92:95]
    v_mfma_f32_16x16x32_bf16 v[96:99], a[120:123], v[48:51], v[96:99]
    v_mfma_f32_16x16x32_bf16 v[100:103], a[120:123], v[52:55], v[100:103]
    v_mfma_f32_16x16x32_bf16 v[104:107], a[120:123], v[56:59], v[104:107]
    v_mfma_f32_16x16x32_bf16 v[108:111], a[120:123], v[60:63], v[108:111]
    v_mfma_f32_16x16x32_bf16 v[112:115], a[124:127], v[48:51], v[112:115]
    v_mfma_f32_16x16x32_bf16 v[116:119], a[124:127], v[52:55], v[116:119]
    v_mfma_f32_16x16x32_bf16 v[120:123], a[124:127], v[56:59], v[120:123]
    v_mfma_f32_16x16x32_bf16 v[124:127], a[124:127], v[60:63], v[124:127]
    s_nop 7
    v_cvt_pk_bf16_f32 v32, v64, v65
    v_cvt_pk_bf16_f32 v33, v66, v67
    v_cvt_pk_bf16_f32 v34, v80, v81
    v_cvt_pk_bf16_f32 v35, v82, v83
    v_cvt_pk_bf16_f32 v36, v68, v69
    v_cvt_pk_bf16_f32 v37, v70, v71
    v_cvt_pk_bf16_f32 v38, v84, v85
    v_cvt_pk_bf16_f32 v39, v86, v87
    v_cvt_pk_bf16_f32 v40, v72, v73
    v_cvt_pk_bf16_f32 v41, v74, v75
    v_cvt_pk_bf16_f32 v42, v88, v89
    v_cvt_pk_bf16_f32 v43, v90, v91
    v_cvt_pk_bf16_f32 v44, v76, v77
    v_cvt_pk_bf16_f32 v45, v78, v79
    v_cvt_pk_bf16_f32 v46, v92, v93
    v_cvt_pk_bf16_f32 v47, v94, v95
    v_cvt_pk_bf16_f32 v48, v96, v97
    v_cvt_pk_bf16_f32 v49, v98, v99
    v_cvt_pk_bf16_f32 v50, v112, v113
    v_cvt_pk_bf16_f32 v51, v114, v115
    v_cvt_pk_bf16_f32 v52, v100, v101
    v_cvt_pk_bf16_f32 v53, v102, v103
    v_cvt_pk_bf16_f32 v54, v116, v117
    v_cvt_pk_bf16_f32 v55, v118, v119
    v_cvt_pk_bf16_f32 v56, v104, v105
    v_cvt_pk_bf16_f32 v57, v106, v107
    v_cvt_pk_bf16_f32 v58, v120, v121
    v_cvt_pk_bf16_f32 v59, v122, v123
    v_cvt_pk_bf16_f32 v60, v108, v109
    v_cvt_pk_bf16_f32 v61, v110, v111
    v_cvt_pk_bf16_f32 v62, v124, v125
    v_cvt_pk_bf16_f32 v63, v126, v127
    ds_write_b128 v25, v[32:35] offset:0
    ds_write_b128 v25, v[36:39] offset:32
    ds_write_b128 v25, v[40:43] offset:64
    ds_write_b128 v25, v[44:47] offset:96
    ds_write_b128 v25, v[48:51] offset:4096
    ds_write_b128 v25, v[52:55] offset:4128
    ds_write_b128 v25, v[56:59] offset:4160
    ds_write_b128 v25, v[60:63] offset:4192
    s_waitcnt lgkmcnt(0)
    v_subrev_u32 v12, 65536, v30
    ds_read_b128 v[128:131], v12 offset:0
    ds_read_b128 v[132:135], v12 offset:1024
    ds_read_b128 v[136:139], v12 offset:2048
    ds_read_b128 v[140:143], v12 offset:3072
    ds_read_b128 v[144:147], v12 offset:4096
    ds_read_b128 v[148:151], v12 offset:5120
    ds_read_b128 v[152:155], v12 offset:6144
    ds_read_b128 v[156:159], v12 offset:7168
    s_add_u32 s70, s82, 6553600
    s_waitcnt lgkmcnt(7)
    buffer_store_dwordx4 v[128:131], v28, s[40:43], s70 offen offset:0 sc1
    s_waitcnt lgkmcnt(6)
    buffer_store_dwordx4 v[132:135], v28, s[40:43], s70 offen offset:1024 sc1
    s_waitcnt lgkmcnt(5)
    buffer_store_dwordx4 v[136:139], v28, s[40:43], s70 offen offset:2048 sc1
    s_waitcnt lgkmcnt(4)
    buffer_store_dwordx4 v[140:143], v28, s[40:43], s70 offen offset:3072 sc1
    s_add_u32 s70, s82, 6557696
    s_waitcnt lgkmcnt(3)
    buffer_store_dwordx4 v[144:147], v28, s[40:43], s70 offen offset:0 sc1
    s_waitcnt lgkmcnt(2)
    buffer_store_dwordx4 v[148:151], v28, s[40:43], s70 offen offset:1024 sc1
    s_waitcnt lgkmcnt(1)
    buffer_store_dwordx4 v[152:155], v28, s[40:43], s70 offen offset:2048 sc1
    s_waitcnt lgkmcnt(0)
    buffer_store_dwordx4 v[156:159], v28, s[40:43], s70 offen offset:3072 sc1
    ds_read_b128 v[32:35], v29 offset:0
    ds_read_b128 v[36:39], v29 offset:1024
    ds_read_b128 v[40:43], v29 offset:2048
    ds_read_b128 v[44:47], v29 offset:3072
    s_waitcnt lgkmcnt(0)
    ds_read_b128 v[48:51], v29 offset:4096
    ds_read_b128 v[52:55], v29 offset:5120
    ds_read_b128 v[56:59], v29 offset:6144
    ds_read_b128 v[60:63], v29 offset:7168
    v_mfma_f32_16x16x32_bf16 v[64:67], a[128:131], v[32:35], 0
    v_mfma_f32_16x16x32_bf16 v[68:71], a[128:131], v[36:39], 0
    v_mfma_f32_16x16x32_bf16 v[72:75], a[128:131], v[40:43], 0
    v_mfma_f32_16x16x32_bf16 v[76:79], a[128:131], v[44:47], 0
    v_mfma_f32_16x16x32_bf16 v[80:83], a[132:135], v[32:35], 0
    v_mfma_f32_16x16x32_bf16 v[84:87], a[132:135], v[36:39], 0
    v_mfma_f32_16x16x32_bf16 v[88:91], a[132:135], v[40:43], 0
    v_mfma_f32_16x16x32_bf16 v[92:95], a[132:135], v[44:47], 0
    v_mfma_f32_16x16x32_bf16 v[96:99], a[136:139], v[32:35], 0
    v_mfma_f32_16x16x32_bf16 v[100:103], a[136:139], v[36:39], 0
    v_mfma_f32_16x16x32_bf16 v[104:107], a[136:139], v[40:43], 0
    v_mfma_f32_16x16x32_bf16 v[108:111], a[136:139], v[44:47], 0
    v_mfma_f32_16x16x32_bf16 v[112:115], a[140:143], v[32:35], 0
    v_mfma_f32_16x16x32_bf16 v[116:119], a[140:143], v[36:39], 0
    v_mfma_f32_16x16x32_bf16 v[120:123], a[140:143], v[40:43], 0
    v_mfma_f32_16x16x32_bf16 v[124:127], a[140:143], v[44:47], 0
    s_waitcnt lgkmcnt(0)
    ds_read_b128 v[32:35], v29 offset:8192
    ds_read_b128 v[36:39], v29 offset:9216
    ds_read_b128 v[40:43], v29 offset:10240
    ds_read_b128 v[44:47], v29 offset:11264
    v_mfma_f32_16x16x32_bf16 v[64:67], a[144:147], v[48:51], v[64:67]
    v_mfma_f32_16x16x32_bf16 v[68:71], a[144:147], v[52:55], v[68:71]
    v_mfma_f32_16x16x32_bf16 v[72:75], a[144:147], v[56:59], v[72:75]
    v_mfma_f32_16x16x32_bf16 v[76:79], a[144:147], v[60:63], v[76:79]
    v_mfma_f32_16x16x32_bf16 v[80:83], a[148:151], v[48:51], v[80:83]
    v_mfma_f32_16x16x32_bf16 v[84:87], a[148:151], v[52:55], v[84:87]
    v_mfma_f32_16x16x32_bf16 v[88:91], a[148:151], v[56:59], v[88:91]
    v_mfma_f32_16x16x32_bf16 v[92:95], a[148:151], v[60:63], v[92:95]
    v_mfma_f32_16x16x32_bf16 v[96:99], a[152:155], v[48:51], v[96:99]
    v_mfma_f32_16x16x32_bf16 v[100:103], a[152:155], v[52:55], v[100:103]
    v_mfma_f32_16x16x32_bf16 v[104:107], a[152:155], v[56:59], v[104:107]
    v_mfma_f32_16x16x32_bf16 v[108:111], a[152:155], v[60:63], v[108:111]
    v_mfma_f32_16x16x32_bf16 v[112:115], a[156:159], v[48:51], v[112:115]
    v_mfma_f32_16x16x32_bf16 v[116:119], a[156:159], v[52:55], v[116:119]
    v_mfma_f32_16x16x32_bf16 v[120:123], a[156:159], v[56:59], v[120:123]
    v_mfma_f32_16x16x32_bf16 v[124:127], a[156:159], v[60:63], v[124:127]
    s_waitcnt lgkmcnt(0)
    ds_read_b128 v[48:51], v29 offset:12288
    ds_read_b128 v[52:55], v29 offset:13312
    ds_read_b128 v[56:59], v29 offset:14336
    ds_read_b128 v[60:63], v29 offset:15360
    v_mfma_f32_16x16x32_bf16 v[64:67], a[160:163], v[32:35], v[64:67]
    v_mfma_f32_16x16x32_bf16 v[68:71], a[160:163], v[36:39], v[68:71]
    v_mfma_f32_16x16x32_bf16 v[72:75], a[160:163], v[40:43], v[72:75]
    v_mfma_f32_16x16x32_bf16 v[76:79], a[160:163], v[44:47], v[76:79]
    v_mfma_f32_16x16x32_bf16 v[80:83], a[164:167], v[32:35], v[80:83]
    v_mfma_f32_16x16x32_bf16 v[84:87], a[164:167], v[36:39], v[84:87]
    v_mfma_f32_16x16x32_bf16 v[88:91], a[164:167], v[40:43], v[88:91]
    v_mfma_f32_16x16x32_bf16 v[92:95], a[164:167], v[44:47], v[92:95]
    v_mfma_f32_16x16x32_bf16 v[96:99], a[168:171], v[32:35], v[96:99]
    v_mfma_f32_16x16x32_bf16 v[100:103], a[168:171], v[36:39], v[100:103]
    v_mfma_f32_16x16x32_bf16 v[104:107], a[168:171], v[40:43], v[104:107]
    v_mfma_f32_16x16x32_bf16 v[108:111], a[168:171], v[44:47], v[108:111]
    v_mfma_f32_16x16x32_bf16 v[112:115], a[172:175], v[32:35], v[112:115]
    v_mfma_f32_16x16x32_bf16 v[116:119], a[172:175], v[36:39], v[116:119]
    v_mfma_f32_16x16x32_bf16 v[120:123], a[172:175], v[40:43], v[120:123]
    v_mfma_f32_16x16x32_bf16 v[124:127], a[172:175], v[44:47], v[124:127]
    s_waitcnt lgkmcnt(0)
    ds_read_b128 v[32:35], v29 offset:16384
    ds_read_b128 v[36:39], v29 offset:17408
    ds_read_b128 v[40:43], v29 offset:18432
    ds_read_b128 v[44:47], v29 offset:19456
    v_mfma_f32_16x16x32_bf16 v[64:67], a[176:179], v[48:51], v[64:67]
    v_mfma_f32_16x16x32_bf16 v[68:71], a[176:179], v[52:55], v[68:71]
    v_mfma_f32_16x16x32_bf16 v[72:75], a[176:179], v[56:59], v[72:75]
    v_mfma_f32_16x16x32_bf16 v[76:79], a[176:179], v[60:63], v[76:79]
    v_mfma_f32_16x16x32_bf16 v[80:83], a[180:183], v[48:51], v[80:83]
    v_mfma_f32_16x16x32_bf16 v[84:87], a[180:183], v[52:55], v[84:87]
    v_mfma_f32_16x16x32_bf16 v[88:91], a[180:183], v[56:59], v[88:91]
    v_mfma_f32_16x16x32_bf16 v[92:95], a[180:183], v[60:63], v[92:95]
    v_mfma_f32_16x16x32_bf16 v[96:99], a[184:187], v[48:51], v[96:99]
    v_mfma_f32_16x16x32_bf16 v[100:103], a[184:187], v[52:55], v[100:103]
    v_mfma_f32_16x16x32_bf16 v[104:107], a[184:187], v[56:59], v[104:107]
    v_mfma_f32_16x16x32_bf16 v[108:111], a[184:187], v[60:63], v[108:111]
    v_mfma_f32_16x16x32_bf16 v[112:115], a[188:191], v[48:51], v[112:115]
    v_mfma_f32_16x16x32_bf16 v[116:119], a[188:191], v[52:55], v[116:119]
    v_mfma_f32_16x16x32_bf16 v[120:123], a[188:191], v[56:59], v[120:123]
    v_mfma_f32_16x16x32_bf16 v[124:127], a[188:191], v[60:63], v[124:127]
    s_waitcnt lgkmcnt(0)
    ds_read_b128 v[48:51], v29 offset:20480
    ds_read_b128 v[52:55], v29 offset:21504
    ds_read_b128 v[56:59], v29 offset:22528
    ds_read_b128 v[60:63], v29 offset:23552
    v_mfma_f32_16x16x32_bf16 v[64:67], a[192:195], v[32:35], v[64:67]
    v_mfma_f32_16x16x32_bf16 v[68:71], a[192:195], v[36:39], v[68:71]
    v_mfma_f32_16x16x32_bf16 v[72:75], a[192:195], v[40:43], v[72:75]
    v_mfma_f32_16x16x32_bf16 v[76:79], a[192:195], v[44:47], v[76:79]
    v_mfma_f32_16x16x32_bf16 v[80:83], a[196:199], v[32:35], v[80:83]
    v_mfma_f32_16x16x32_bf16 v[84:87], a[196:199], v[36:39], v[84:87]
    v_mfma_f32_16x16x32_bf16 v[88:91], a[196:199], v[40:43], v[88:91]
    v_mfma_f32_16x16x32_bf16 v[92:95], a[196:199], v[44:47], v[92:95]
    v_mfma_f32_16x16x32_bf16 v[96:99], a[200:203], v[32:35], v[96:99]
    v_mfma_f32_16x16x32_bf16 v[100:103], a[200:203], v[36:39], v[100:103]
    v_mfma_f32_16x16x32_bf16 v[104:107], a[200:203], v[40:43], v[104:107]
    v_mfma_f32_16x16x32_bf16 v[108:111], a[200:203], v[44:47], v[108:111]
    v_mfma_f32_16x16x32_bf16 v[112:115], a[204:207], v[32:35], v[112:115]
    v_mfma_f32_16x16x32_bf16 v[116:119], a[204:207], v[36:39], v[116:119]
    v_mfma_f32_16x16x32_bf16 v[120:123], a[204:207], v[40:43], v[120:123]
    v_mfma_f32_16x16x32_bf16 v[124:127], a[204:207], v[44:47], v[124:127]
    s_waitcnt lgkmcnt(0)
    ds_read_b128 v[32:35], v29 offset:24576
    ds_read_b128 v[36:39], v29 offset:25600
    ds_read_b128 v[40:43], v29 offset:26624
    ds_read_b128 v[44:47], v29 offset:27648
    v_mfma_f32_16x16x32_bf16 v[64:67], a[208:211], v[48:51], v[64:67]
    v_mfma_f32_16x16x32_bf16 v[68:71], a[208:211], v[52:55], v[68:71]
    v_mfma_f32_16x16x32_bf16 v[72:75], a[208:211], v[56:59], v[72:75]
    v_mfma_f32_16x16x32_bf16 v[76:79], a[208:211], v[60:63], v[76:79]
    v_mfma_f32_16x16x32_bf16 v[80:83], a[212:215], v[48:51], v[80:83]
    v_mfma_f32_16x16x32_bf16 v[84:87], a[212:215], v[52:55], v[84:87]
    v_mfma_f32_16x16x32_bf16 v[88:91], a[212:215], v[56:59], v[88:91]
    v_mfma_f32_16x16x32_bf16 v[92:95], a[212:215], v[60:63], v[92:95]
    v_mfma_f32_16x16x32_bf16 v[96:99], a[216:219], v[48:51], v[96:99]
    v_mfma_f32_16x16x32_bf16 v[100:103], a[216:219], v[52:55], v[100:103]
    v_mfma_f32_16x16x32_bf16 v[104:107], a[216:219], v[56:59], v[104:107]
    v_mfma_f32_16x16x32_bf16 v[108:111], a[216:219], v[60:63], v[108:111]
    v_mfma_f32_16x16x32_bf16 v[112:115], a[220:223], v[48:51], v[112:115]
    v_mfma_f32_16x16x32_bf16 v[116:119], a[220:223], v[52:55], v[116:119]
    v_mfma_f32_16x16x32_bf16 v[120:123], a[220:223], v[56:59], v[120:123]
    v_mfma_f32_16x16x32_bf16 v[124:127], a[220:223], v[60:63], v[124:127]
    s_waitcnt lgkmcnt(0)
    ds_read_b128 v[48:51], v29 offset:28672
    ds_read_b128 v[52:55], v29 offset:29696
    ds_read_b128 v[56:59], v29 offset:30720
    ds_read_b128 v[60:63], v29 offset:31744
    v_mfma_f32_16x16x32_bf16 v[64:67], a[224:227], v[32:35], v[64:67]
    v_mfma_f32_16x16x32_bf16 v[68:71], a[224:227], v[36:39], v[68:71]
    v_mfma_f32_16x16x32_bf16 v[72:75], a[224:227], v[40:43], v[72:75]
    v_mfma_f32_16x16x32_bf16 v[76:79], a[224:227], v[44:47], v[76:79]
    v_mfma_f32_16x16x32_bf16 v[80:83], a[228:231], v[32:35], v[80:83]
    v_mfma_f32_16x16x32_bf16 v[84:87], a[228:231], v[36:39], v[84:87]
    v_mfma_f32_16x16x32_bf16 v[88:91], a[228:231], v[40:43], v[88:91]
    v_mfma_f32_16x16x32_bf16 v[92:95], a[228:231], v[44:47], v[92:95]
    v_mfma_f32_16x16x32_bf16 v[96:99], a[232:235], v[32:35], v[96:99]
    v_mfma_f32_16x16x32_bf16 v[100:103], a[232:235], v[36:39], v[100:103]
    v_mfma_f32_16x16x32_bf16 v[104:107], a[232:235], v[40:43], v[104:107]
    v_mfma_f32_16x16x32_bf16 v[108:111], a[232:235], v[44:47], v[108:111]
    v_mfma_f32_16x16x32_bf16 v[112:115], a[236:239], v[32:35], v[112:115]
    v_mfma_f32_16x16x32_bf16 v[116:119], a[236:239], v[36:39], v[116:119]
    v_mfma_f32_16x16x32_bf16 v[120:123], a[236:239], v[40:43], v[120:123]
    v_mfma_f32_16x16x32_bf16 v[124:127], a[236:239], v[44:47], v[124:127]
    s_waitcnt lgkmcnt(0)
    v_mfma_f32_16x16x32_bf16 v[64:67], a[240:243], v[48:51], v[64:67]
    v_mfma_f32_16x16x32_bf16 v[68:71], a[240:243], v[52:55], v[68:71]
    v_mfma_f32_16x16x32_bf16 v[72:75], a[240:243], v[56:59], v[72:75]
    v_mfma_f32_16x16x32_bf16 v[76:79], a[240:243], v[60:63], v[76:79]
    v_mfma_f32_16x16x32_bf16 v[80:83], a[244:247], v[48:51], v[80:83]
    v_mfma_f32_16x16x32_bf16 v[84:87], a[244:247], v[52:55], v[84:87]
    v_mfma_f32_16x16x32_bf16 v[88:91], a[244:247], v[56:59], v[88:91]
    v_mfma_f32_16x16x32_bf16 v[92:95], a[244:247], v[60:63], v[92:95]
    v_mfma_f32_16x16x32_bf16 v[96:99], a[248:251], v[48:51], v[96:99]
    v_mfma_f32_16x16x32_bf16 v[100:103], a[248:251], v[52:55], v[100:103]
    v_mfma_f32_16x16x32_bf16 v[104:107], a[248:251], v[56:59], v[104:107]
    v_mfma_f32_16x16x32_bf16 v[108:111], a[248:251], v[60:63], v[108:111]
    v_mfma_f32_16x16x32_bf16 v[112:115], a[252:255], v[48:51], v[112:115]
    v_mfma_f32_16x16x32_bf16 v[116:119], a[252:255], v[52:55], v[116:119]
    v_mfma_f32_16x16x32_bf16 v[120:123], a[252:255], v[56:59], v[120:123]
    v_mfma_f32_16x16x32_bf16 v[124:127], a[252:255], v[60:63], v[124:127]
    s_nop 7
    v_cvt_pk_bf16_f32 v32, v64, v65
    v_cvt_pk_bf16_f32 v33, v66, v67
    v_cvt_pk_bf16_f32 v34, v80, v81
    v_cvt_pk_bf16_f32 v35, v82, v83
    v_cvt_pk_bf16_f32 v36, v68, v69
    v_cvt_pk_bf16_f32 v37, v70, v71
    v_cvt_pk_bf16_f32 v38, v84, v85
    v_cvt_pk_bf16_f32 v39, v86, v87
    v_cvt_pk_bf16_f32 v40, v72, v73
    v_cvt_pk_bf16_f32 v41, v74, v75
    v_cvt_pk_bf16_f32 v42, v88, v89
    v_cvt_pk_bf16_f32 v43, v90, v91
    v_cvt_pk_bf16_f32 v44, v76, v77
    v_cvt_pk_bf16_f32 v45, v78, v79
    v_cvt_pk_bf16_f32 v46, v92, v93
    v_cvt_pk_bf16_f32 v47, v94, v95
    v_cvt_pk_bf16_f32 v48, v96, v97
    v_cvt_pk_bf16_f32 v49, v98, v99
    v_cvt_pk_bf16_f32 v50, v112, v113
    v_cvt_pk_bf16_f32 v51, v114, v115
    v_cvt_pk_bf16_f32 v52, v100, v101
    v_cvt_pk_bf16_f32 v53, v102, v103
    v_cvt_pk_bf16_f32 v54, v116, v117
    v_cvt_pk_bf16_f32 v55, v118, v119
    v_cvt_pk_bf16_f32 v56, v104, v105
    v_cvt_pk_bf16_f32 v57, v106, v107
    v_cvt_pk_bf16_f32 v58, v120, v121
    v_cvt_pk_bf16_f32 v59, v122, v123
    v_cvt_pk_bf16_f32 v60, v108, v109
    v_cvt_pk_bf16_f32 v61, v110, v111
    v_cvt_pk_bf16_f32 v62, v124, v125
    v_cvt_pk_bf16_f32 v63, v126, v127
    ds_write_b128 v25, v[32:35] offset:0
    ds_write_b128 v25, v[36:39] offset:32
    ds_write_b128 v25, v[40:43] offset:64
    ds_write_b128 v25, v[44:47] offset:96
    ds_write_b128 v25, v[48:51] offset:4096
    ds_write_b128 v25, v[52:55] offset:4128
    ds_write_b128 v25, v[56:59] offset:4160
    ds_write_b128 v25, v[60:63] offset:4192
    s_waitcnt lgkmcnt(0)
    v_subrev_u32 v12, 65536, v30
    ds_read_b128 v[160:163], v12 offset:0
    ds_read_b128 v[164:167], v12 offset:1024
    ds_read_b128 v[168:171], v12 offset:2048
    ds_read_b128 v[172:175], v12 offset:3072
    ds_read_b128 v[176:179], v12 offset:4096
    ds_read_b128 v[180:183], v12 offset:5120
    ds_read_b128 v[184:187], v12 offset:6144
    ds_read_b128 v[188:191], v12 offset:7168
    s_add_u32 s70, s82, 6684672
    s_waitcnt lgkmcnt(7)
    buffer_store_dwordx4 v[160:163], v28, s[40:43], s70 offen offset:0 sc1
    s_waitcnt lgkmcnt(6)
    buffer_store_dwordx4 v[164:167], v28, s[40:43], s70 offen offset:1024 sc1
    s_waitcnt lgkmcnt(5)
    buffer_store_dwordx4 v[168:171], v28, s[40:43], s70 offen offset:2048 sc1
    s_waitcnt lgkmcnt(4)
    buffer_store_dwordx4 v[172:175], v28, s[40:43], s70 offen offset:3072 sc1
    s_add_u32 s70, s82, 6688768
    s_waitcnt lgkmcnt(3)
    buffer_store_dwordx4 v[176:179], v28, s[40:43], s70 offen offset:0 sc1
    s_waitcnt lgkmcnt(2)
    buffer_store_dwordx4 v[180:183], v28, s[40:43], s70 offen offset:1024 sc1
    s_waitcnt lgkmcnt(1)
    buffer_store_dwordx4 v[184:187], v28, s[40:43], s70 offen offset:2048 sc1
    s_waitcnt lgkmcnt(0)
    buffer_store_dwordx4 v[188:191], v28, s[40:43], s70 offen offset:3072 sc1
    s_waitcnt vmcnt(0)
    s_barrier
    s_cmp_lg_u32 s52, 0
    s_cbranch_scc1 L_end
    s_add_u32 s71, s71, 16
    s_mov_b64 exec, 1
    buffer_store_dword v7, off, s[40:43], s71 sc1
    s_mov_b64 exec, -1
    s_mov_b32 s70, s53
    s_cmp_lg_u32 s70, 0
    s_cbranch_scc1 L_end
    v_lshrrev_b32 v12, 2, v1
    v_min_u32 v13, 13, v12
    v_min_u32 v14, 3, v12
    v_and_b32 v15, 3, v1
    v_lshlrev_b32 v15, 2, v15
    v_lshl_add_u32 v12, v12, 7, v15
    v_lshl_add_u32 v13, v13, 7, v15
    v_lshl_add_u32 v14, v14, 7, v15
    s_mov_b32 s80, 0
L_ep:
    s_sleep 8
    s_mov_b32 s70, 4096
    buffer_load_dword v32, v12, s[40:43], s70 offen sc1
    s_mov_b32 s70, 6144
    buffer_load_dword v33, v12, s[40:43], s70 offen sc1
    s_mov_b32 s70, 8192
    buffer_load_dword v34, v12, s[40:43], s70 offen sc1
    s_mov_b32 s70, 10240
    buffer_load_dword v35, v12, s[40:43], s70 offen sc1
    s_mov_b32 s70, 12288
    buffer_load_dword v36, v12, s[40:43], s70 offen sc1
    s_mov_b32 s70, 14336
    buffer_load_dword v37, v12, s[40:43], s70 offen sc1
    s_mov_b32 s70, 16384
    buffer_load_dword v38, v12, s[40:43], s70 offen sc1
    s_mov_b32 s70, 18432
    buffer_load_dword v39, v13, s[40:43], s70 offen sc1
    s_mov_b32 s70, 20480
    buffer_load_dword v40, v12, s[40:43], s70 offen sc1
    s_mov_b32 s70, 22528
    buffer_load_dword v41, v12, s[40:43], s70 offen sc1
    s_mov_b32 s70, 24576
    buffer_load_dword v42, v12, s[40:43], s70 offen sc1
    s_mov_b32 s70, 26624
    buffer_load_dword v43, v12, s[40:43], s70 offen sc1
    s_mov_b32 s70, 28672
    buffer_load_dword v44, v12, s[40:43], s70 offen sc1
    s_mov_b32 s70, 30720
    buffer_load_dword v45, v12, s[40:43], s70 offen sc1
    s_mov_b32 s70, 32768
    buffer_load_dword v46, v12, s[40:43], s70 offen sc1
    s_mov_b32 s70, 34816
    buffer_load_dword v47, v13, s[40:43], s70 offen sc1
    s_mov_b32 s70, 36864
    buffer_load_dword v48, v14, s[40:43], s70 offen sc1
    s_waitcnt vmcnt(0)
    v_xor_b32 v32, s56, v32
    v_xor_b32 v33, s56, v33
    v_xor_b32 v34, s56, v34
    v_xor_b32 v35, s56, v35
    v_xor_b32 v36, s56, v36
    v_xor_b32 v37, s56, v37
    v_xor_b32 v38, s56, v38
    v_xor_b32 v39, s56, v39
    v_xor_b32 v40, s56, v40
    v_xor_b32 v41, s56, v41
    v_xor_b32 v42, s56, v42
    v_xor_b32 v43, s56, v43
    v_xor_b32 v44, s56, v44
    v_xor_b32 v45, s56, v45
    v_xor_b32 v46, s56, v46
    v_xor_b32 v47, s56, v47
    v_xor_b32 v48, s56, v48
    v_or3_b32 v32, v32, v33, v34
    v_or3_b32 v32, v32, v35, v36
    v_or3_b32 v32, v32, v37, v38
    v_or3_b32 v32, v32, v39, v40
    v_or3_b32 v32, v32, v41, v42
    v_or3_b32 v32, v32, v43, v44
    v_or3_b32 v32, v32, v45, v46
    v_or3_b32 v32, v32, v47, v48
    v_cmp_ne_u32 vcc, 0, v32
    s_add_u32 s80, s80, 1
    s_cmp_gt_u32 s80, 0x8000
    s_cbranch_scc1 L_ep2
    s_cbranch_vccnz L_ep
L_ep2:
    s_mov_b64 exec, 1
    buffer_store_dword v7, off, s[40:43], 0 sc1
    s_endpgm
L_stub_i0:
    s_mov_b32 s74, 0
    s_mov_b32 s75, 8192
    s_mov_b32 s76, 1
    s_call_b64 s[78:79], L_rare0
    s_branch L_back_i0
L_stub_i1:
    s_mov_b32 s74, 16384
    s_mov_b32 s75, 24576
    s_mov_b32 s76, 0
    s_call_b64 s[78:79], L_rare1
    s_branch L_back_i1
L_stub_i2:
    s_mov_b32 s74, 32768
    s_mov_b32 s75, 0
    s_mov_b32 s76, 0
    s_call_b64 s[78:79], L_rare0
    s_branch L_back_i2
L_stub_i3:
    s_mov_b32 s74, 8192
    s_mov_b32 s75, 16384
    s_mov_b32 s76, 0
    s_call_b64 s[78:79], L_rare1
    s_branch L_back_i3
L_stub_i4:
    s_mov_b32 s74, 24576
    s_mov_b32 s75, 32768
    s_mov_b32 s76, 0
    s_call_b64 s[78:79], L_rare0
    s_branch L_back_i4
L_stub_i5:
    s_mov_b32 s74, 0
    s_mov_b32 s75, 8192
    s_mov_b32 s76, 0
    s_call_b64 s[78:79], L_rare1
    s_branch L_back_i5
L_stub_i6:
    s_mov_b32 s74, 16384
    s_mov_b32 s75, 24576
    s_mov_b32 s76, 0
    s_call_b64 s[78:79], L_rare0
    s_branch L_back_i6
L_stub_i7:
    s_mov_b32 s74, 32768
    s_mov_b32 s75, 0
    s_mov_b32 s76, 0
    s_call_b64 s[78:79], L_rare1
    s_branch L_back_i7
L_stub_i8:
    s_mov_b32 s74, 8192
    s_mov_b32 s75, 16384
    s_mov_b32 s76, 0
    s_call_b64 s[78:79], L_rare0
    s_branch L_back_i8
L_stub_i9:
    s_mov_b32 s74, 24576
    s_mov_b32 s75, 32768
    s_mov_b32 s76, 0
    s_call_b64 s[78:79], L_rare1
    s_branch L_back_i9
L_stub_i10:
    s_mov_b32 s74, 0
    s_mov_b32 s75, 8192
    s_mov_b32 s76, 0
    s_call_b64 s[78:79], L_rare0
    s_branch L_back_i10
L_stub_i11:
    s_mov_b32 s74, 16384
    s_mov_b32 s75, 24576
    s_mov_b32 s76, 0
    s_call_b64 s[78:79], L_rare1
    s_branch L_back_i11
L_stub_i12:
    s_mov_b32 s74, 32768
    s_mov_b32 s75, 0
    s_mov_b32 s76, 0
    s_call_b64 s[78:79], L_rare0
    s_branch L_back_i12
L_stub_i13:
    s_mov_b32 s74, 8192
    s_mov_b32 s75, 16384
    s_mov_b32 s76, 0
    s_call_b64 s[78:79], L_rare1
    s_branch L_back_i13
L_stub_i14:
    s_mov_b32 s74, 24576
    s_mov_b32 s75, 32768
    s_mov_b32 s76, 0
    s_call_b64 s[78:79], L_rare0
    s_branch L_back_i14
L_stub_i15:
    s_mov_b32 s74, 0
    s_mov_b32 s75, 8192
    s_mov_b32 s76, 0
    s_call_b64 s[78:79], L_rare1
    s_branch L_back_i15
L_stub_l14:
    s_mov_b32 s74, 24576
    s_mov_b32 s75, 32768
    s_mov_b32 s76, 0
    s_call_b64 s[78:79], L_rare0
    s_branch L_back_l14
L_slowA:
    s_nop 7
    s_nop 7
    v_min3_f32 v26, v9, v11, v13
    v_min_f32 v26, v26, v15
    v_sub_f32 v27, v26, v9
    v_sub_f32 v11, v26, v11
    v_sub_f32 v13, v26, v13
    v_sub_f32 v15, v26, v15
    v_exp_f32 v27, v27
    v_exp_f32 v11, v11
    v_exp_f32 v13, v13
    v_exp_f32 v15, v15
    v_mov_b32 v9, v26
    v_mul_f32 v8, v8, v27
    v_mul_f32 v10, v10, v11
    v_mul_f32 v12, v12, v13
    v_mul_f32 v14, v14, v15
    v_mov_b32 v2, v27
    v_mov_b32 v4, v27
    s_nop 1
    v_permlane32_swap_b32 v2, v4
    s_nop 1
    v_mov_b32 v3, v2
    v_mov_b32 v5, v4
    s_nop 1
    v_permlane16_swap_b32 v2, v3
    v_permlane16_swap_b32 v4, v5
    s_nop 1
    v_mul_f32 v128, v2, v128
    v_mul_f32 v129, v2, v129
    v_mul_f32 v130, v2, v130
    v_mul_f32 v131, v2, v131
    v_mul_f32 v132, v2, v132
    v_mul_f32 v133, v2, v133
    v_mul_f32 v134, v2, v134
    v_mul_f32 v135, v2, v135
    v_mul_f32 v136, v2, v136
    v_mul_f32 v137, v2, v137
    v_mul_f32 v138, v2, v138
    v_mul_f32 v139, v2, v139
    v_mul_f32 v140, v2, v140
    v_mul_f32 v141, v2, v141
    v_mul_f32 v142, v2, v142
    v_mul_f32 v143, v2, v143
    v_mul_f32 v144, v2, v144
    v_mul_f32 v145, v2, v145
    v_mul_f32 v146, v2, v146
    v_mul_f32 v147, v2, v147
    v_mul_f32 v148, v2, v148
    v_mul_f32 v149, v2, v149
    v_mul_f32 v150, v2, v150
    v_mul_f32 v151, v2, v151
    v_mul_f32 v152, v2, v152
    v_mul_f32 v153, v2, v153
    v_mul_f32 v154, v2, v154
    v_mul_f32 v155, v2, v155
    v_mul_f32 v156, v2, v156
    v_mul_f32 v157, v2, v157
    v_mul_f32 v158, v2, v158
    v_mul_f32 v159, v2, v159
    v_mul_f32 v160, v2, v160
    v_mul_f32 v161, v2, v161
    v_mul_f32 v162, v2, v162
    v_mul_f32 v163, v2, v163
    v_mul_f32 v164, v2, v164
    v_mul_f32 v165, v2, v165
    v_mul_f32 v166, v2, v166
    v_mul_f32 v167, v2, v167
    v_mul_f32 v168, v2, v168
    v_mul_f32 v169, v2, v169
    v_mul_f32 v170, v2, v170
    v_mul_f32 v171, v2, v171
    v_mul_f32 v172, v2, v172
    v_mul_f32 v173, v2, v173
    v_mul_f32 v174, v2, v174
    v_mul_f32 v175, v2, v175
    v_mul_f32 v176, v2, v176
    v_mul_f32 v177, v2, v177
    v_mul_f32 v178, v2, v178
    v_mul_f32 v179, v2, v179
    v_mul_f32 v180, v2, v180
    v_mul_f32 v181, v2, v181
    v_mul_f32 v182, v2, v182
    v_mul_f32 v183, v2, v183
    v_mul_f32 v184, v2, v184
    v_mul_f32 v185, v2, v185
    v_mul_f32 v186, v2, v186
    v_mul_f32 v187, v2, v187
    v_mul_f32 v188, v2, v188
    v_mul_f32 v189, v2, v189
    v_mul_f32 v190, v2, v190
    v_mul_f32 v191, v2, v191
    v_mul_f32 v192, v3, v192
    v_mul_f32 v193, v3, v193
    v_mul_f32 v194, v3, v194
    v_mul_f32 v195, v3, v195
    v_mul_f32 v196, v3, v196
    v_mul_f32 v197, v3, v197
    v_mul_f32 v198, v3, v198
    v_mul_f32 v199, v3, v199
    v_mul_f32 v200, v3, v200
    v_mul_f32 v201, v3, v201
    v_mul_f32 v202, v3, v202
    v_mul_f32 v203, v3, v203
    v_mul_f32 v204, v3, v204
    v_mul_f32 v205, v3, v205
    v_mul_f32 v206, v3, v206
    v_mul_f32 v207, v3, v207
    v_mul_f32 v208, v3, v208
    v_mul_f32 v209, v3, v209
    v_mul_f32 v210, v3, v210
    v_mul_f32 v211, v3, v211
    v_mul_f32 v212, v3, v212
    v_mul_f32 v213, v3, v213
    v_mul_f32 v214, v3, v214
    v_mul_f32 v215, v3, v215
    v_mul_f32 v216, v3, v216
    v_mul_f32 v217, v3, v217
    v_mul_f32 v218, v3, v218
    v_mul_f32 v219, v3, v219
    v_mul_f32 v220, v3, v220
    v_mul_f32 v221, v3, v221
    v_mul_f32 v222, v3, v222
    v_mul_f32 v223, v3, v223
    v_mul_f32 v224, v3, v224
    v_mul_f32 v225, v3, v225
    v_mul_f32 v226, v3, v226
    v_mul_f32 v227, v3, v227
    v_mul_f32 v228, v3, v228
    v_mul_f32 v229, v3, v229
    v_mul_f32 v230, v3, v230
    v_mul_f32 v231, v3, v231
    v_mul_f32 v232, v3, v232
    v_mul_f32 v233, v3, v233
    v_mul_f32 v234, v3, v234
    v_mul_f32 v235, v3, v235
    v_mul_f32 v236, v3, v236
    v_mul_f32 v237, v3, v237
    v_mul_f32 v238, v3, v238
    v_mul_f32 v239, v3, v239
    v_mul_f32 v240, v3, v240
    v_mul_f32 v241, v3, v241
    v_mul_f32 v242, v3, v242
    v_mul_f32 v243, v3, v243
    v_mul_f32 v244, v3, v244
    v_mul_f32 v245, v3, v245
    v_mul_f32 v246, v3, v246
    v_mul_f32 v247, v3, v247
    v_mul_f32 v248, v3, v248
    v_mul_f32 v249, v3, v249
    v_mul_f32 v250, v3, v250
    v_mul_f32 v251, v3, v251
    v_mul_f32 v252, v3, v252
    v_mul_f32 v253, v3, v253
    v_mul_f32 v254, v3, v254
    v_mul_f32 v255, v3, v255
    v_accvgpr_read_b32 v48, a128
    v_accvgpr_read_b32 v49, a129
    v_accvgpr_read_b32 v50, a130
    v_accvgpr_read_b32 v51, a131
    v_mul_f32 v48, v4, v48
    v_mul_f32 v49, v4, v49
    v_mul_f32 v50, v4, v50
    v_mul_f32 v51, v4, v51
    v_accvgpr_write_b32 a128, v48
    v_accvgpr_write_b32 a129, v49
    v_accvgpr_write_b32 a130, v50
    v_accvgpr_write_b32 a131, v51
    v_accvgpr_read_b32 v48, a132
    v_accvgpr_read_b32 v49, a133
    v_accvgpr_read_b32 v50, a134
    v_accvgpr_read_b32 v51, a135
    v_mul_f32 v48, v4, v48
    v_mul_f32 v49, v4, v49
    v_mul_f32 v50, v4, v50
    v_mul_f32 v51, v4, v51
    v_accvgpr_write_b32 a132, v48
    v_accvgpr_write_b32 a133, v49
    v_accvgpr_write_b32 a134, v50
    v_accvgpr_write_b32 a135, v51
    v_accvgpr_read_b32 v48, a136
    v_accvgpr_read_b32 v49, a137
    v_accvgpr_read_b32 v50, a138
    v_accvgpr_read_b32 v51, a139
    v_mul_f32 v48, v4, v48
    v_mul_f32 v49, v4, v49
    v_mul_f32 v50, v4, v50
    v_mul_f32 v51, v4, v51
    v_accvgpr_write_b32 a136, v48
    v_accvgpr_write_b32 a137, v49
    v_accvgpr_write_b32 a138, v50
    v_accvgpr_write_b32 a139, v51
    v_accvgpr_read_b32 v48, a140
    v_accvgpr_read_b32 v49, a141
    v_accvgpr_read_b32 v50, a142
    v_accvgpr_read_b32 v51, a143
    v_mul_f32 v48, v4, v48
    v_mul_f32 v49, v4, v49
    v_mul_f32 v50, v4, v50
    v_mul_f32 v51, v4, v51
    v_accvgpr_write_b32 a140, v48
    v_accvgpr_write_b32 a141, v49
    v_accvgpr_write_b32 a142, v50
    v_accvgpr_write_b32 a143, v51
    v_accvgpr_read_b32 v48, a144
    v_accvgpr_read_b32 v49, a145
    v_accvgpr_read_b32 v50, a146
    v_accvgpr_read_b32 v51, a147
    v_mul_f32 v48, v4, v48
    v_mul_f32 v49, v4, v49
    v_mul_f32 v50, v4, v50
    v_mul_f32 v51, v4, v51
    v_accvgpr_write_b32 a144, v48
    v_accvgpr_write_b32 a145, v49
    v_accvgpr_write_b32 a146, v50
    v_accvgpr_write_b32 a147, v51
    v_accvgpr_read_b32 v48, a148
    v_accvgpr_read_b32 v49, a149
    v_accvgpr_read_b32 v50, a150
    v_accvgpr_read_b32 v51, a151
    v_mul_f32 v48, v4, v48
    v_mul_f32 v49, v4, v49
    v_mul_f32 v50, v4, v50
    v_mul_f32 v51, v4, v51
    v_accvgpr_write_b32 a148, v48
    v_accvgpr_write_b32 a149, v49
    v_accvgpr_write_b32 a150, v50
    v_accvgpr_write_b32 a151, v51
    v_accvgpr_read_b32 v48, a152
    v_accvgpr_read_b32 v49, a153
    v_accvgpr_read_b32 v50, a154
    v_accvgpr_read_b32 v51, a155
    v_mul_f32 v48, v4, v48
    v_mul_f32 v49, v4, v49
    v_mul_f32 v50, v4, v50
    v_mul_f32 v51, v4, v51
    v_accvgpr_write_b32 a152, v48
    v_accvgpr_write_b32 a153, v49
    v_accvgpr_write_b32 a154, v50
    v_accvgpr_write_b32 a155, v51
    v_accvgpr_read_b32 v48, a156
    v_accvgpr_read_b32 v49, a157
    v_accvgpr_read_b32 v50, a158
    v_accvgpr_read_b32 v51, a159
    v_mul_f32 v48, v4, v48
    v_mul_f32 v49, v4, v49
    v_mul_f32 v50, v4, v50
    v_mul_f32 v51, v4, v51
    v_accvgpr_write_b32 a156, v48
    v_accvgpr_write_b32 a157, v49
    v_accvgpr_write_b32 a158, v50
    v_accvgpr_write_b32 a159, v51
    v_accvgpr_read_b32 v48, a160
    v_accvgpr_read_b32 v49, a161
    v_accvgpr_read_b32 v50, a162
    v_accvgpr_read_b32 v51, a163
    v_mul_f32 v48, v4, v48
    v_mul_f32 v49, v4, v49
    v_mul_f32 v50, v4, v50
    v_mul_f32 v51, v4, v51
    v_accvgpr_write_b32 a160, v48
    v_accvgpr_write_b32 a161, v49
    v_accvgpr_write_b32 a162, v50
    v_accvgpr_write_b32 a163, v51
    v_accvgpr_read_b32 v48, a164
    v_accvgpr_read_b32 v49, a165
    v_accvgpr_read_b32 v50, a166
    v_accvgpr_read_b32 v51, a167
    v_mul_f32 v48, v4, v48
    v_mul_f32 v49, v4, v49
    v_mul_f32 v50, v4, v50
    v_mul_f32 v51, v4, v51
    v_accvgpr_write_b32 a164, v48
    v_accvgpr_write_b32 a165, v49
    v_accvgpr_write_b32 a166, v50
    v_accvgpr_write_b32 a167, v51
    v_accvgpr_read_b32 v48, a168
    v_accvgpr_read_b32 v49, a169
    v_accvgpr_read_b32 v50, a170
    v_accvgpr_read_b32 v51, a171
    v_mul_f32 v48, v4, v48
    v_mul_f32 v49, v4, v49
    v_mul_f32 v50, v4, v50
    v_mul_f32 v51, v4, v51
    v_accvgpr_write_b32 a168, v48
    v_accvgpr_write_b32 a169, v49
    v_accvgpr_write_b32 a170, v50
    v_accvgpr_write_b32 a171, v51
    v_accvgpr_read_b32 v48, a172
    v_accvgpr_read_b32 v49, a173
    v_accvgpr_read_b32 v50, a174
    v_accvgpr_read_b32 v51, a175
    v_mul_f32 v48, v4, v48
    v_mul_f32 v49, v4, v49
    v_mul_f32 v50, v4, v50
    v_mul_f32 v51, v4, v51
    v_accvgpr_write_b32 a172, v48
    v_accvgpr_write_b32 a173, v49
    v_accvgpr_write_b32 a174, v50
    v_accvgpr_write_b32 a175, v51
    v_accvgpr_read_b32 v48, a176
    v_accvgpr_read_b32 v49, a177
    v_accvgpr_read_b32 v50, a178
    v_accvgpr_read_b32 v51, a179
    v_mul_f32 v48, v4, v48
    v_mul_f32 v49, v4, v49
    v_mul_f32 v50, v4, v50
    v_mul_f32 v51, v4, v51
    v_accvgpr_write_b32 a176, v48
    v_accvgpr_write_b32 a177, v49
    v_accvgpr_write_b32 a178, v50
    v_accvgpr_write_b32 a179, v51
    v_accvgpr_read_b32 v48, a180
    v_accvgpr_read_b32 v49, a181
    v_accvgpr_read_b32 v50, a182
    v_accvgpr_read_b32 v51, a183
    v_mul_f32 v48, v4, v48
    v_mul_f32 v49, v4, v49
    v_mul_f32 v50, v4, v50
    v_mul_f32 v51, v4, v51
    v_accvgpr_write_b32 a180, v48
    v_accvgpr_write_b32 a181, v49
    v_accvgpr_write_b32 a182, v50
    v_accvgpr_write_b32 a183, v51
    v_accvgpr_read_b32 v48, a184
    v_accvgpr_read_b32 v49, a185
    v_accvgpr_read_b32 v50, a186
    v_accvgpr_read_b32 v51, a187
    v_mul_f32 v48, v4, v48
    v_mul_f32 v49, v4, v49
    v_mul_f32 v50, v4, v50
    v_mul_f32 v51, v4, v51
    v_accvgpr_write_b32 a184, v48
    v_accvgpr_write_b32 a185, v49
    v_accvgpr_write_b32 a186, v50
    v_accvgpr_write_b32 a187, v51
    v_accvgpr_read_b32 v48, a188
    v_accvgpr_read_b32 v49, a189
    v_accvgpr_read_b32 v50, a190
    v_accvgpr_read_b32 v51, a191
    v_mul_f32 v48, v4, v48
    v_mul_f32 v49, v4, v49
    v_mul_f32 v50, v4, v50
    v_mul_f32 v51, v4, v51
    v_accvgpr_write_b32 a188, v48
    v_accvgpr_write_b32 a189, v49
    v_accvgpr_write_b32 a190, v50
    v_accvgpr_write_b32 a191, v51
    v_accvgpr_read_b32 v48, a192
    v_accvgpr_read_b32 v49, a193
    v_accvgpr_read_b32 v50, a194
    v_accvgpr_read_b32 v51, a195
    v_mul_f32 v48, v5, v48
    v_mul_f32 v49, v5, v49
    v_mul_f32 v50, v5, v50
    v_mul_f32 v51, v5, v51
    v_accvgpr_write_b32 a192, v48
    v_accvgpr_write_b32 a193, v49
    v_accvgpr_write_b32 a194, v50
    v_accvgpr_write_b32 a195, v51
    v_accvgpr_read_b32 v48, a196
    v_accvgpr_read_b32 v49, a197
    v_accvgpr_read_b32 v50, a198
    v_accvgpr_read_b32 v51, a199
    v_mul_f32 v48, v5, v48
    v_mul_f32 v49, v5, v49
    v_mul_f32 v50, v5, v50
    v_mul_f32 v51, v5, v51
    v_accvgpr_write_b32 a196, v48
    v_accvgpr_write_b32 a197, v49
    v_accvgpr_write_b32 a198, v50
    v_accvgpr_write_b32 a199, v51
    v_accvgpr_read_b32 v48, a200
    v_accvgpr_read_b32 v49, a201
    v_accvgpr_read_b32 v50, a202
    v_accvgpr_read_b32 v51, a203
    v_mul_f32 v48, v5, v48
    v_mul_f32 v49, v5, v49
    v_mul_f32 v50, v5, v50
    v_mul_f32 v51, v5, v51
    v_accvgpr_write_b32 a200, v48
    v_accvgpr_write_b32 a201, v49
    v_accvgpr_write_b32 a202, v50
    v_accvgpr_write_b32 a203, v51
    v_accvgpr_read_b32 v48, a204
    v_accvgpr_read_b32 v49, a205
    v_accvgpr_read_b32 v50, a206
    v_accvgpr_read_b32 v51, a207
    v_mul_f32 v48, v5, v48
    v_mul_f32 v49, v5, v49
    v_mul_f32 v50, v5, v50
    v_mul_f32 v51, v5, v51
    v_accvgpr_write_b32 a204, v48
    v_accvgpr_write_b32 a205, v49
    v_accvgpr_write_b32 a206, v50
    v_accvgpr_write_b32 a207, v51
    v_accvgpr_read_b32 v48, a208
    v_accvgpr_read_b32 v49, a209
    v_accvgpr_read_b32 v50, a210
    v_accvgpr_read_b32 v51, a211
    v_mul_f32 v48, v5, v48
    v_mul_f32 v49, v5, v49
    v_mul_f32 v50, v5, v50
    v_mul_f32 v51, v5, v51
    v_accvgpr_write_b32 a208, v48
    v_accvgpr_write_b32 a209, v49
    v_accvgpr_write_b32 a210, v50
    v_accvgpr_write_b32 a211, v51
    v_accvgpr_read_b32 v48, a212
    v_accvgpr_read_b32 v49, a213
    v_accvgpr_read_b32 v50, a214
    v_accvgpr_read_b32 v51, a215
    v_mul_f32 v48, v5, v48
    v_mul_f32 v49, v5, v49
    v_mul_f32 v50, v5, v50
    v_mul_f32 v51, v5, v51
    v_accvgpr_write_b32 a212, v48
    v_accvgpr_write_b32 a213, v49
    v_accvgpr_write_b32 a214, v50
    v_accvgpr_write_b32 a215, v51
    v_accvgpr_read_b32 v48, a216
    v_accvgpr_read_b32 v49, a217
    v_accvgpr_read_b32 v50, a218
    v_accvgpr_read_b32 v51, a219
    v_mul_f32 v48, v5, v48
    v_mul_f32 v49, v5, v49
    v_mul_f32 v50, v5, v50
    v_mul_f32 v51, v5, v51
    v_accvgpr_write_b32 a216, v48
    v_accvgpr_write_b32 a217, v49
    v_accvgpr_write_b32 a218, v50
    v_accvgpr_write_b32 a219, v51
    v_accvgpr_read_b32 v48, a220
    v_accvgpr_read_b32 v49, a221
    v_accvgpr_read_b32 v50, a222
    v_accvgpr_read_b32 v51, a223
    v_mul_f32 v48, v5, v48
    v_mul_f32 v49, v5, v49
    v_mul_f32 v50, v5, v50
    v_mul_f32 v51, v5, v51
    v_accvgpr_write_b32 a220, v48
    v_accvgpr_write_b32 a221, v49
    v_accvgpr_write_b32 a222, v50
    v_accvgpr_write_b32 a223, v51
    v_accvgpr_read_b32 v48, a224
    v_accvgpr_read_b32 v49, a225
    v_accvgpr_read_b32 v50, a226
    v_accvgpr_read_b32 v51, a227
    v_mul_f32 v48, v5, v48
    v_mul_f32 v49, v5, v49
    v_mul_f32 v50, v5, v50
    v_mul_f32 v51, v5, v51
    v_accvgpr_write_b32 a224, v48
    v_accvgpr_write_b32 a225, v49
    v_accvgpr_write_b32 a226, v50
    v_accvgpr_write_b32 a227, v51
    v_accvgpr_read_b32 v48, a228
    v_accvgpr_read_b32 v49, a229
    v_accvgpr_read_b32 v50, a230
    v_accvgpr_read_b32 v51, a231
    v_mul_f32 v48, v5, v48
    v_mul_f32 v49, v5, v49
    v_mul_f32 v50, v5, v50
    v_mul_f32 v51, v5, v51
    v_accvgpr_write_b32 a228, v48
    v_accvgpr_write_b32 a229, v49
    v_accvgpr_write_b32 a230, v50
    v_accvgpr_write_b32 a231, v51
    v_accvgpr_read_b32 v48, a232
    v_accvgpr_read_b32 v49, a233
    v_accvgpr_read_b32 v50, a234
    v_accvgpr_read_b32 v51, a235
    v_mul_f32 v48, v5, v48
    v_mul_f32 v49, v5, v49
    v_mul_f32 v50, v5, v50
    v_mul_f32 v51, v5, v51
    v_accvgpr_write_b32 a232, v48
    v_accvgpr_write_b32 a233, v49
    v_accvgpr_write_b32 a234, v50
    v_accvgpr_write_b32 a235, v51
    v_accvgpr_read_b32 v48, a236
    v_accvgpr_read_b32 v49, a237
    v_accvgpr_read_b32 v50, a238
    v_accvgpr_read_b32 v51, a239
    v_mul_f32 v48, v5, v48
    v_mul_f32 v49, v5, v49
    v_mul_f32 v50, v5, v50
    v_mul_f32 v51, v5, v51
    v_accvgpr_write_b32 a236, v48
    v_accvgpr_write_b32 a237, v49
    v_accvgpr_write_b32 a238, v50
    v_accvgpr_write_b32 a239, v51
    v_accvgpr_read_b32 v48, a240
    v_accvgpr_read_b32 v49, a241
    v_accvgpr_read_b32 v50, a242
    v_accvgpr_read_b32 v51, a243
    v_mul_f32 v48, v5, v48
    v_mul_f32 v49, v5, v49
    v_mul_f32 v50, v5, v50
    v_mul_f32 v51, v5, v51
    v_accvgpr_write_b32 a240, v48
    v_accvgpr_write_b32 a241, v49
    v_accvgpr_write_b32 a242, v50
    v_accvgpr_write_b32 a243, v51
    v_accvgpr_read_b32 v48, a244
    v_accvgpr_read_b32 v49, a245
    v_accvgpr_read_b32 v50, a246
    v_accvgpr_read_b32 v51, a247
    v_mul_f32 v48, v5, v48
    v_mul_f32 v49, v5, v49
    v_mul_f32 v50, v5, v50
    v_mul_f32 v51, v5, v51
    v_accvgpr_write_b32 a244, v48
    v_accvgpr_write_b32 a245, v49
    v_accvgpr_write_b32 a246, v50
    v_accvgpr_write_b32 a247, v51
    v_accvgpr_read_b32 v48, a248
    v_accvgpr_read_b32 v49, a249
    v_accvgpr_read_b32 v50, a250
    v_accvgpr_read_b32 v51, a251
    v_mul_f32 v48, v5, v48
    v_mul_f32 v49, v5, v49
    v_mul_f32 v50, v5, v50
    v_mul_f32 v51, v5, v51
    v_accvgpr_write_b32 a248, v48
    v_accvgpr_write_b32 a249, v49
    v_accvgpr_write_b32 a250, v50
    v_accvgpr_write_b32 a251, v51
    v_accvgpr_read_b32 v48, a252
    v_accvgpr_read_b32 v49, a253
    v_accvgpr_read_b32 v50, a254
    v_accvgpr_read_b32 v51, a255
    v_mul_f32 v48, v5, v48
    v_mul_f32 v49, v5, v49
    v_mul_f32 v50, v5, v50
    v_mul_f32 v51, v5, v51
    v_accvgpr_write_b32 a252, v48
    v_accvgpr_write_b32 a253, v49
    v_accvgpr_write_b32 a254, v50
    v_accvgpr_write_b32 a255, v51
    s_nop 1
    s_branch L_back_slowA
L_slowB:
    s_waitcnt vmcnt(0) lgkmcnt(0)
    v_min_f32 v10, v9, v89
    v_sub_f32 v9, v10, v9
    v_sub_f32 v89, v10, v89
    v_exp_f32 v9, v9
    v_exp_f32 v89, v89
    s_nop 0
    v_mul_f32 v8, v8, v9
    v_mul_f32 v88, v88, v89
    v_mov_b32 v10, v9
    v_mov_b32 v11, v89
    s_nop 1
    v_permlane16_swap_b32 v9, v10
    v_permlane16_swap_b32 v89, v11
    s_nop 1
    v_accvgpr_read_b32 v2, a128
    v_mul_f32 v2, v9, v2
    v_accvgpr_write_b32 a128, v2
    v_accvgpr_read_b32 v2, a129
    v_mul_f32 v2, v9, v2
    v_accvgpr_write_b32 a129, v2
    v_accvgpr_read_b32 v2, a130
    v_mul_f32 v2, v9, v2
    v_accvgpr_write_b32 a130, v2
    v_accvgpr_read_b32 v2, a131
    v_mul_f32 v2, v9, v2
    v_accvgpr_write_b32 a131, v2
    v_accvgpr_read_b32 v2, a132
    v_mul_f32 v2, v9, v2
    v_accvgpr_write_b32 a132, v2
    v_accvgpr_read_b32 v2, a133
    v_mul_f32 v2, v9, v2
    v_accvgpr_write_b32 a133, v2
    v_accvgpr_read_b32 v2, a134
    v_mul_f32 v2, v9, v2
    v_accvgpr_write_b32 a134, v2
    v_accvgpr_read_b32 v2, a135
    v_mul_f32 v2, v9, v2
    v_accvgpr_write_b32 a135, v2
    v_accvgpr_read_b32 v2, a136
    v_mul_f32 v2, v9, v2
    v_accvgpr_write_b32 a136, v2
    v_accvgpr_read_b32 v2, a137
    v_mul_f32 v2, v9, v2
    v_accvgpr_write_b32 a137, v2
    v_accvgpr_read_b32 v2, a138
    v_mul_f32 v2, v9, v2
    v_accvgpr_write_b32 a138, v2
    v_accvgpr_read_b32 v2, a139
    v_mul_f32 v2, v9, v2
    v_accvgpr_write_b32 a139, v2
    v_accvgpr_read_b32 v2, a140
    v_mul_f32 v2, v9, v2
    v_accvgpr_write_b32 a140, v2
    v_accvgpr_read_b32 v2, a141
    v_mul_f32 v2, v9, v2
    v_accvgpr_write_b32 a141, v2
    v_accvgpr_read_b32 v2, a142
    v_mul_f32 v2, v9, v2
    v_accvgpr_write_b32 a142, v2
    v_accvgpr_read_b32 v2, a143
    v_mul_f32 v2, v9, v2
    v_accvgpr_write_b32 a143, v2
    v_lshlrev_b32 v2, 16, v192
    v_and_b32 v3, s67, v192
    v_mul_f32 v2, v89, v2
    v_mul_f32 v3, v89, v3
    v_cvt_pk_bf16_f32 v192, v2, v3
    v_lshlrev_b32 v2, 16, v193
    v_and_b32 v3, s67, v193
    v_mul_f32 v2, v89, v2
    v_mul_f32 v3, v89, v3
    v_cvt_pk_bf16_f32 v193, v2, v3
    v_lshlrev_b32 v2, 16, v194
    v_and_b32 v3, s67, v194
    v_mul_f32 v2, v89, v2
    v_mul_f32 v3, v89, v3
    v_cvt_pk_bf16_f32 v194, v2, v3
    v_lshlrev_b32 v2, 16, v195
    v_and_b32 v3, s67, v195
    v_mul_f32 v2, v89, v2
    v_mul_f32 v3, v89, v3
    v_cvt_pk_bf16_f32 v195, v2, v3
    v_lshlrev_b32 v2, 16, v196
    v_and_b32 v3, s67, v196
    v_mul_f32 v2, v89, v2
    v_mul_f32 v3, v89, v3
    v_cvt_pk_bf16_f32 v196, v2, v3
    v_lshlrev_b32 v2, 16, v197
    v_and_b32 v3, s67, v197
    v_mul_f32 v2, v89, v2
    v_mul_f32 v3, v89, v3
    v_cvt_pk_bf16_f32 v197, v2, v3
    v_lshlrev_b32 v2, 16, v198
    v_and_b32 v3, s67, v198
    v_mul_f32 v2, v89, v2
    v_mul_f32 v3, v89, v3
    v_cvt_pk_bf16_f32 v198, v2, v3
    v_lshlrev_b32 v2, 16, v199
    v_and_b32 v3, s67, v199
    v_mul_f32 v2, v89, v2
    v_mul_f32 v3, v89, v3
    v_cvt_pk_bf16_f32 v199, v2, v3
    v_lshlrev_b32 v2, 16, v144
    v_and_b32 v3, s67, v144
    v_mul_f32 v2, v9, v2
    v_mul_f32 v3, v9, v3
    v_cvt_pk_bf16_f32 v144, v2, v3
    v_lshlrev_b32 v2, 16, v145
    v_and_b32 v3, s67, v145
    v_mul_f32 v2, v9, v2
    v_mul_f32 v3, v9, v3
    v_cvt_pk_bf16_f32 v145, v2, v3
    v_lshlrev_b32 v2, 16, v146
    v_and_b32 v3, s67, v146
    v_mul_f32 v2, v9, v2
    v_mul_f32 v3, v9, v3
    v_cvt_pk_bf16_f32 v146, v2, v3
    v_lshlrev_b32 v2, 16, v147
    v_and_b32 v3, s67, v147
    v_mul_f32 v2, v9, v2
    v_mul_f32 v3, v9, v3
    v_cvt_pk_bf16_f32 v147, v2, v3
    v_lshlrev_b32 v2, 16, v148
    v_and_b32 v3, s67, v148
    v_mul_f32 v2, v9, v2
    v_mul_f32 v3, v9, v3
    v_cvt_pk_bf16_f32 v148, v2, v3
    v_lshlrev_b32 v2, 16, v149
    v_and_b32 v3, s67, v149
    v_mul_f32 v2, v9, v2
    v_mul_f32 v3, v9, v3
    v_cvt_pk_bf16_f32 v149, v2, v3
    v_lshlrev_b32 v2, 16, v150
    v_and_b32 v3, s67, v150
    v_mul_f32 v2, v9, v2
    v_mul_f32 v3, v9, v3
    v_cvt_pk_bf16_f32 v150, v2, v3
    v_lshlrev_b32 v2, 16, v151
    v_and_b32 v3, s67, v151
    v_mul_f32 v2, v9, v2
    v_mul_f32 v3, v9, v3
    v_cvt_pk_bf16_f32 v151, v2, v3
    v_lshlrev_b32 v2, 16, v160
    v_and_b32 v3, s67, v160
    v_mul_f32 v2, v9, v2
    v_mul_f32 v3, v9, v3
    v_cvt_pk_bf16_f32 v160, v2, v3
    v_lshlrev_b32 v2, 16, v161
    v_and_b32 v3, s67, v161
    v_mul_f32 v2, v9, v2
    v_mul_f32 v3, v9, v3
    v_cvt_pk_bf16_f32 v161, v2, v3
    v_lshlrev_b32 v2, 16, v162
    v_and_b32 v3, s67, v162
    v_mul_f32 v2, v9, v2
    v_mul_f32 v3, v9, v3
    v_cvt_pk_bf16_f32 v162, v2, v3
    v_lshlrev_b32 v2, 16, v163
    v_and_b32 v3, s67, v163
    v_mul_f32 v2, v9, v2
    v_mul_f32 v3, v9, v3
    v_cvt_pk_bf16_f32 v163, v2, v3
    v_lshlrev_b32 v2, 16, v164
    v_and_b32 v3, s67, v164
    v_mul_f32 v2, v9, v2
    v_mul_f32 v3, v9, v3
    v_cvt_pk_bf16_f32 v164, v2, v3
    v_lshlrev_b32 v2, 16, v165
    v_and_b32 v3, s67, v165
    v_mul_f32 v2, v9, v2
    v_mul_f32 v3, v9, v3
    v_cvt_pk_bf16_f32 v165, v2, v3
    v_lshlrev_b32 v2, 16, v166
    v_and_b32 v3, s67, v166
    v_mul_f32 v2, v9, v2
    v_mul_f32 v3, v9, v3
    v_cvt_pk_bf16_f32 v166, v2, v3
    v_lshlrev_b32 v2, 16, v167
    v_and_b32 v3, s67, v167
    v_mul_f32 v2, v9, v2
    v_mul_f32 v3, v9, v3
    v_cvt_pk_bf16_f32 v167, v2, v3
    v_lshlrev_b32 v2, 16, v176
    v_and_b32 v3, s67, v176
    v_mul_f32 v2, v9, v2
    v_mul_f32 v3, v9, v3
    v_cvt_pk_bf16_f32 v176, v2, v3
    v_lshlrev_b32 v2, 16, v177
    v_and_b32 v3, s67, v177
    v_mul_f32 v2, v9, v2
    v_mul_f32 v3, v9, v3
    v_cvt_pk_bf16_f32 v177, v2, v3
    v_lshlrev_b32 v2, 16, v178
    v_and_b32 v3, s67, v178
    v_mul_f32 v2, v9, v2
    v_mul_f32 v3, v9, v3
    v_cvt_pk_bf16_f32 v178, v2, v3
    v_lshlrev_b32 v2, 16, v179
    v_and_b32 v3, s67, v179
    v_mul_f32 v2, v9, v2
    v_mul_f32 v3, v9, v3
    v_cvt_pk_bf16_f32 v179, v2, v3
    v_lshlrev_b32 v2, 16, v180
    v_and_b32 v3, s67, v180
    v_mul_f32 v2, v9, v2
    v_mul_f32 v3, v9, v3
    v_cvt_pk_bf16_f32 v180, v2, v3
    v_lshlrev_b32 v2, 16, v181
    v_and_b32 v3, s67, v181
    v_mul_f32 v2, v9, v2
    v_mul_f32 v3, v9, v3
    v_cvt_pk_bf16_f32 v181, v2, v3
    v_lshlrev_b32 v2, 16, v182
    v_and_b32 v3, s67, v182
    v_mul_f32 v2, v9, v2
    v_mul_f32 v3, v9, v3
    v_cvt_pk_bf16_f32 v182, v2, v3
    v_lshlrev_b32 v2, 16, v183
    v_and_b32 v3, s67, v183
    v_mul_f32 v2, v9, v2
    v_mul_f32 v3, v9, v3
    v_cvt_pk_bf16_f32 v183, v2, v3
    v_accvgpr_read_b32 v2, a192
    v_mul_f32 v2, v10, v2
    v_accvgpr_write_b32 a192, v2
    v_accvgpr_read_b32 v2, a193
    v_mul_f32 v2, v10, v2
    v_accvgpr_write_b32 a193, v2
    v_accvgpr_read_b32 v2, a194
    v_mul_f32 v2, v10, v2
    v_accvgpr_write_b32 a194, v2
    v_accvgpr_read_b32 v2, a195
    v_mul_f32 v2, v10, v2
    v_accvgpr_write_b32 a195, v2
    v_accvgpr_read_b32 v2, a196
    v_mul_f32 v2, v10, v2
    v_accvgpr_write_b32 a196, v2
    v_accvgpr_read_b32 v2, a197
    v_mul_f32 v2, v10, v2
    v_accvgpr_write_b32 a197, v2
    v_accvgpr_read_b32 v2, a198
    v_mul_f32 v2, v10, v2
    v_accvgpr_write_b32 a198, v2
    v_accvgpr_read_b32 v2, a199
    v_mul_f32 v2, v10, v2
    v_accvgpr_write_b32 a199, v2
    v_accvgpr_read_b32 v2, a200
    v_mul_f32 v2, v10, v2
    v_accvgpr_write_b32 a200, v2
    v_accvgpr_read_b32 v2, a201
    v_mul_f32 v2, v10, v2
    v_accvgpr_write_b32 a201, v2
    v_accvgpr_read_b32 v2, a202
    v_mul_f32 v2, v10, v2
    v_accvgpr_write_b32 a202, v2
    v_accvgpr_read_b32 v2, a203
    v_mul_f32 v2, v10, v2
    v_accvgpr_write_b32 a203, v2
    v_accvgpr_read_b32 v2, a204
    v_mul_f32 v2, v10, v2
    v_accvgpr_write_b32 a204, v2
    v_accvgpr_read_b32 v2, a205
    v_mul_f32 v2, v10, v2
    v_accvgpr_write_b32 a205, v2
    v_accvgpr_read_b32 v2, a206
    v_mul_f32 v2, v10, v2
    v_accvgpr_write_b32 a206, v2
    v_accvgpr_read_b32 v2, a207
    v_mul_f32 v2, v10, v2
    v_accvgpr_write_b32 a207, v2
    v_lshlrev_b32 v2, 16, v200
    v_and_b32 v3, s67, v200
    v_mul_f32 v2, v11, v2
    v_mul_f32 v3, v11, v3
    v_cvt_pk_bf16_f32 v200, v2, v3
    v_lshlrev_b32 v2, 16, v201
    v_and_b32 v3, s67, v201
    v_mul_f32 v2, v11, v2
    v_mul_f32 v3, v11, v3
    v_cvt_pk_bf16_f32 v201, v2, v3
    v_lshlrev_b32 v2, 16, v202
    v_and_b32 v3, s67, v202
    v_mul_f32 v2, v11, v2
    v_mul_f32 v3, v11, v3
    v_cvt_pk_bf16_f32 v202, v2, v3
    v_lshlrev_b32 v2, 16, v203
    v_and_b32 v3, s67, v203
    v_mul_f32 v2, v11, v2
    v_mul_f32 v3, v11, v3
    v_cvt_pk_bf16_f32 v203, v2, v3
    v_lshlrev_b32 v2, 16, v204
    v_and_b32 v3, s67, v204
    v_mul_f32 v2, v11, v2
    v_mul_f32 v3, v11, v3
    v_cvt_pk_bf16_f32 v204, v2, v3
    v_lshlrev_b32 v2, 16, v205
    v_and_b32 v3, s67, v205
    v_mul_f32 v2, v11, v2
    v_mul_f32 v3, v11, v3
    v_cvt_pk_bf16_f32 v205, v2, v3
    v_lshlrev_b32 v2, 16, v206
    v_and_b32 v3, s67, v206
    v_mul_f32 v2, v11, v2
    v_mul_f32 v3, v11, v3
    v_cvt_pk_bf16_f32 v206, v2, v3
    v_lshlrev_b32 v2, 16, v207
    v_and_b32 v3, s67, v207
    v_mul_f32 v2, v11, v2
    v_mul_f32 v3, v11, v3
    v_cvt_pk_bf16_f32 v207, v2, v3
    v_lshlrev_b32 v2, 16, v152
    v_and_b32 v3, s67, v152
    v_mul_f32 v2, v10, v2
    v_mul_f32 v3, v10, v3
    v_cvt_pk_bf16_f32 v152, v2, v3
    v_lshlrev_b32 v2, 16, v153
    v_and_b32 v3, s67, v153
    v_mul_f32 v2, v10, v2
    v_mul_f32 v3, v10, v3
    v_cvt_pk_bf16_f32 v153, v2, v3
    v_lshlrev_b32 v2, 16, v154
    v_and_b32 v3, s67, v154
    v_mul_f32 v2, v10, v2
    v_mul_f32 v3, v10, v3
    v_cvt_pk_bf16_f32 v154, v2, v3
    v_lshlrev_b32 v2, 16, v155
    v_and_b32 v3, s67, v155
    v_mul_f32 v2, v10, v2
    v_mul_f32 v3, v10, v3
    v_cvt_pk_bf16_f32 v155, v2, v3
    v_lshlrev_b32 v2, 16, v156
    v_and_b32 v3, s67, v156
    v_mul_f32 v2, v10, v2
    v_mul_f32 v3, v10, v3
    v_cvt_pk_bf16_f32 v156, v2, v3
    v_lshlrev_b32 v2, 16, v157
    v_and_b32 v3, s67, v157
    v_mul_f32 v2, v10, v2
    v_mul_f32 v3, v10, v3
    v_cvt_pk_bf16_f32 v157, v2, v3
    v_lshlrev_b32 v2, 16, v158
    v_and_b32 v3, s67, v158
    v_mul_f32 v2, v10, v2
    v_mul_f32 v3, v10, v3
    v_cvt_pk_bf16_f32 v158, v2, v3
    v_lshlrev_b32 v2, 16, v159
    v_and_b32 v3, s67, v159
    v_mul_f32 v2, v10, v2
    v_mul_f32 v3, v10, v3
    v_cvt_pk_bf16_f32 v159, v2, v3
    v_lshlrev_b32 v2, 16, v168
    v_and_b32 v3, s67, v168
    v_mul_f32 v2, v10, v2
    v_mul_f32 v3, v10, v3
    v_cvt_pk_bf16_f32 v168, v2, v3
    v_lshlrev_b32 v2, 16, v169
    v_and_b32 v3, s67, v169
    v_mul_f32 v2, v10, v2
    v_mul_f32 v3, v10, v3
    v_cvt_pk_bf16_f32 v169, v2, v3
    v_lshlrev_b32 v2, 16, v170
    v_and_b32 v3, s67, v170
    v_mul_f32 v2, v10, v2
    v_mul_f32 v3, v10, v3
    v_cvt_pk_bf16_f32 v170, v2, v3
    v_lshlrev_b32 v2, 16, v171
    v_and_b32 v3, s67, v171
    v_mul_f32 v2, v10, v2
    v_mul_f32 v3, v10, v3
    v_cvt_pk_bf16_f32 v171, v2, v3
    v_lshlrev_b32 v2, 16, v172
    v_and_b32 v3, s67, v172
    v_mul_f32 v2, v10, v2
    v_mul_f32 v3, v10, v3
    v_cvt_pk_bf16_f32 v172, v2, v3
    v_lshlrev_b32 v2, 16, v173
    v_and_b32 v3, s67, v173
    v_mul_f32 v2, v10, v2
    v_mul_f32 v3, v10, v3
    v_cvt_pk_bf16_f32 v173, v2, v3
    v_lshlrev_b32 v2, 16, v174
    v_and_b32 v3, s67, v174
    v_mul_f32 v2, v10, v2
    v_mul_f32 v3, v10, v3
    v_cvt_pk_bf16_f32 v174, v2, v3
    v_lshlrev_b32 v2, 16, v175
    v_and_b32 v3, s67, v175
    v_mul_f32 v2, v10, v2
    v_mul_f32 v3, v10, v3
    v_cvt_pk_bf16_f32 v175, v2, v3
    v_lshlrev_b32 v2, 16, v184
    v_and_b32 v3, s67, v184
    v_mul_f32 v2, v10, v2
    v_mul_f32 v3, v10, v3
    v_cvt_pk_bf16_f32 v184, v2, v3
    v_lshlrev_b32 v2, 16, v185
    v_and_b32 v3, s67, v185
    v_mul_f32 v2, v10, v2
    v_mul_f32 v3, v10, v3
    v_cvt_pk_bf16_f32 v185, v2, v3
    v_lshlrev_b32 v2, 16, v186
    v_and_b32 v3, s67, v186
    v_mul_f32 v2, v10, v2
    v_mul_f32 v3, v10, v3
    v_cvt_pk_bf16_f32 v186, v2, v3
    v_lshlrev_b32 v2, 16, v187
    v_and_b32 v3, s67, v187
    v_mul_f32 v2, v10, v2
    v_mul_f32 v3, v10, v3
    v_cvt_pk_bf16_f32 v187, v2, v3
    v_lshlrev_b32 v2, 16, v188
    v_and_b32 v3, s67, v188
    v_mul_f32 v2, v10, v2
    v_mul_f32 v3, v10, v3
    v_cvt_pk_bf16_f32 v188, v2, v3
    v_lshlrev_b32 v2, 16, v189
    v_and_b32 v3, s67, v189
    v_mul_f32 v2, v10, v2
    v_mul_f32 v3, v10, v3
    v_cvt_pk_bf16_f32 v189, v2, v3
    v_lshlrev_b32 v2, 16, v190
    v_and_b32 v3, s67, v190
    v_mul_f32 v2, v10, v2
    v_mul_f32 v3, v10, v3
    v_cvt_pk_bf16_f32 v190, v2, v3
    v_lshlrev_b32 v2, 16, v191
    v_and_b32 v3, s67, v191
    v_mul_f32 v2, v10, v2
    v_mul_f32 v3, v10, v3
    v_cvt_pk_bf16_f32 v191, v2, v3
    s_nop 1
    s_branch L_back_slowB
L_rare0:
    s_waitcnt lgkmcnt(0)
    s_nop 7
    s_nop 7
    v_add_u32 v7, s74, v2
    ds_read_b128 v[48:51], v7 offset:0
    ds_read_b128 v[52:55], v7 offset:256
    ds_read_b128 v[56:59], v7 offset:2048
    ds_read_b128 v[60:63], v7 offset:2304
    s_waitcnt lgkmcnt(0)
    v_mfma_f32_16x16x32_bf16 v[64:67], v[48:51], a[0:3], 0
    v_mfma_f32_16x16x32_bf16 v[72:75], v[48:51], a[32:35], 0
    v_mfma_f32_16x16x32_bf16 v[80:83], v[48:51], a[64:67], 0
    v_mfma_f32_16x16x32_bf16 v[88:91], v[48:51], a[96:99], 0
    v_mfma_f32_16x16x32_bf16 v[68:71], v[52:55], a[0:3], 0
    v_mfma_f32_16x16x32_bf16 v[76:79], v[52:55], a[32:35], 0
    v_mfma_f32_16x16x32_bf16 v[84:87], v[52:55], a[64:67], 0
    v_mfma_f32_16x16x32_bf16 v[92:95], v[52:55], a[96:99], 0
    v_mfma_f32_16x16x32_bf16 v[64:67], v[56:59], a[4:7], v[64:67]
    v_mfma_f32_16x16x32_bf16 v[72:75], v[56:59], a[36:39], v[72:75]
    v_mfma_f32_16x16x32_bf16 v[80:83], v[56:59], a[68:71], v[80:83]
    v_mfma_f32_16x16x32_bf16 v[88:91], v[56:59], a[100:103], v[88:91]
    v_mfma_f32_16x16x32_bf16 v[68:71], v[60:63], a[4:7], v[68:71]
    v_mfma_f32_16x16x32_bf16 v[76:79], v[60:63], a[36:39], v[76:79]
    v_mfma_f32_16x16x32_bf16 v[84:87], v[60:63], a[68:71], v[84:87]
    v_mfma_f32_16x16x32_bf16 v[92:95], v[60:63], a[100:103], v[92:95]
    ds_read_b128 v[48:51], v7 offset:4096
    ds_read_b128 v[52:55], v7 offset:4352
    ds_read_b128 v[56:59], v7 offset:6144
    ds_read_b128 v[60:63], v7 offset:6400
    s_waitcnt lgkmcnt(0)
    v_mfma_f32_16x16x32_bf16 v[64:67], v[48:51], a[8:11], v[64:67]
    v_mfma_f32_16x16x32_bf16 v[72:75], v[48:51], a[40:43], v[72:75]
    v_mfma_f32_16x16x32_bf16 v[80:83], v[48:51], a[72:75], v[80:83]
    v_mfma_f32_16x16x32_bf16 v[88:91], v[48:51], a[104:107], v[88:91]
    v_mfma_f32_16x16x32_bf16 v[68:71], v[52:55], a[8:11], v[68:71]
    v_mfma_f32_16x16x32_bf16 v[76:79], v[52:55], a[40:43], v[76:79]
    v_mfma_f32_16x16x32_bf16 v[84:87], v[52:55], a[72:75], v[84:87]
    v_mfma_f32_16x16x32_bf16 v[92:95], v[52:55], a[104:107], v[92:95]
    v_mfma_f32_16x16x32_bf16 v[64:67], v[56:59], a[12:15], v[64:67]
    v_mfma_f32_16x16x32_bf16 v[72:75], v[56:59], a[44:47], v[72:75]
    v_mfma_f32_16x16x32_bf16 v[80:83], v[56:59], a[76:79], v[80:83]
    v_mfma_f32_16x16x32_bf16 v[88:91], v[56:59], a[108:111], v[88:91]
    v_mfma_f32_16x16x32_bf16 v[68:71], v[60:63], a[12:15], v[68:71]
    v_mfma_f32_16x16x32_bf16 v[76:79], v[60:63], a[44:47], v[76:79]
    v_mfma_f32_16x16x32_bf16 v[84:87], v[60:63], a[76:79], v[84:87]
    v_mfma_f32_16x16x32_bf16 v[92:95], v[60:63], a[108:111], v[92:95]
    v_add_u32 v7, s75, v2
    ds_read_b128 v[48:51], v7 offset:0
    ds_read_b128 v[52:55], v7 offset:256
    ds_read_b128 v[56:59], v7 offset:2048
    ds_read_b128 v[60:63], v7 offset:2304
    s_waitcnt lgkmcnt(0)
    v_mfma_f32_16x16x32_bf16 v[64:67], v[48:51], a[16:19], v[64:67]
    v_mfma_f32_16x16x32_bf16 v[72:75], v[48:51], a[48:51], v[72:75]
    v_mfma_f32_16x16x32_bf16 v[80:83], v[48:51], a[80:83], v[80:83]
    v_mfma_f32_16x16x32_bf16 v[88:91], v[48:51], a[112:115], v[88:91]
    v_mfma_f32_16x16x32_bf16 v[68:71], v[52:55], a[16:19], v[68:71]
    v_mfma_f32_16x16x32_bf16 v[76:79], v[52:55], a[48:51], v[76:79]
    v_mfma_f32_16x16x32_bf16 v[84:87], v[52:55], a[80:83], v[84:87]
    v_mfma_f32_16x16x32_bf16 v[92:95], v[52:55], a[112:115], v[92:95]
    v_mfma_f32_16x16x32_bf16 v[64:67], v[56:59], a[20:23], v[64:67]
    v_mfma_f32_16x16x32_bf16 v[72:75], v[56:59], a[52:55], v[72:75]
    v_mfma_f32_16x16x32_bf16 v[80:83], v[56:59], a[84:87], v[80:83]
    v_mfma_f32_16x16x32_bf16 v[88:91], v[56:59], a[116:119], v[88:91]
    v_mfma_f32_16x16x32_bf16 v[68:71], v[60:63], a[20:23], v[68:71]
    v_mfma_f32_16x16x32_bf16 v[76:79], v[60:63], a[52:55], v[76:79]
    v_mfma_f32_16x16x32_bf16 v[84:87], v[60:63], a[84:87], v[84:87]
    v_mfma_f32_16x16x32_bf16 v[92:95], v[60:63], a[116:119], v[92:95]
    ds_read_b128 v[48:51], v7 offset:4096
    ds_read_b128 v[52:55], v7 offset:4352
    ds_read_b128 v[56:59], v7 offset:6144
    ds_read_b128 v[60:63], v7 offset:6400
    s_waitcnt lgkmcnt(0)
    v_mfma_f32_16x16x32_bf16 v[64:67], v[48:51], a[24:27], v[64:67]
    v_mfma_f32_16x16x32_bf16 v[72:75], v[48:51], a[56:59], v[72:75]
    v_mfma_f32_16x16x32_bf16 v[80:83], v[48:51], a[88:91], v[80:83]
    v_mfma_f32_16x16x32_bf16 v[88:91], v[48:51], a[120:123], v[88:91]
    v_mfma_f32_16x16x32_bf16 v[68:71], v[52:55], a[24:27], v[68:71]
    v_mfma_f32_16x16x32_bf16 v[76:79], v[52:55], a[56:59], v[76:79]
    v_mfma_f32_16x16x32_bf16 v[84:87], v[52:55], a[88:91], v[84:87]
    v_mfma_f32_16x16x32_bf16 v[92:95], v[52:55], a[120:123], v[92:95]
    v_mfma_f32_16x16x32_bf16 v[64:67], v[56:59], a[28:31], v[64:67]
    v_mfma_f32_16x16x32_bf16 v[72:75], v[56:59], a[60:63], v[72:75]
    v_mfma_f32_16x16x32_bf16 v[80:83], v[56:59], a[92:95], v[80:83]
    v_mfma_f32_16x16x32_bf16 v[88:91], v[56:59], a[124:127], v[88:91]
    v_mfma_f32_16x16x32_bf16 v[68:71], v[60:63], a[28:31], v[68:71]
    v_mfma_f32_16x16x32_bf16 v[76:79], v[60:63], a[60:63], v[76:79]
    v_mfma_f32_16x16x32_bf16 v[84:87], v[60:63], a[92:95], v[84:87]
    v_mfma_f32_16x16x32_bf16 v[92:95], v[60:63], a[124:127], v[92:95]
    s_nop 7
    s_nop 7
    v_max3_f32 v12, v64, v65, v66
    v_max3_f32 v12, v12, v67, v68
    v_max3_f32 v12, v12, v69, v70
    v_max_f32 v12, v12, v71
    v_mov_b32 v7, v12
    s_nop 1
    v_permlane32_swap_b32 v7, v12
    s_nop 1
    v_max_f32 v12, v12, v7
    v_mov_b32 v7, v12
    s_nop 1
    v_permlane16_swap_b32 v7, v12
    s_nop 1
    v_max_f32 v12, v12, v7
    v_sub_f32 v12, 0, v12
    v_max3_f32 v13, v72, v73, v74
    v_max3_f32 v13, v13, v75, v76
    v_max3_f32 v13, v13, v77, v78
    v_max_f32 v13, v13, v79
    v_mov_b32 v7, v13
    s_nop 1
    v_permlane32_swap_b32 v7, v13
    s_nop 1
    v_max_f32 v13, v13, v7
    v_mov_b32 v7, v13
    s_nop 1
    v_permlane16_swap_b32 v7, v13
    s_nop 1
    v_max_f32 v13, v13, v7
    v_sub_f32 v13, 0, v13
    v_max3_f32 v14, v80, v81, v82
    v_max3_f32 v14, v14, v83, v84
    v_max3_f32 v14, v14, v85, v86
    v_max_f32 v14, v14, v87
    v_mov_b32 v7, v14
    s_nop 1
    v_permlane32_swap_b32 v7, v14
    s_nop 1
    v_max_f32 v14, v14, v7
    v_mov_b32 v7, v14
    s_nop 1
    v_permlane16_swap_b32 v7, v14
    s_nop 1
    v_max_f32 v14, v14, v7
    v_sub_f32 v14, 0, v14
    v_max3_f32 v15, v88, v89, v90
    v_max3_f32 v15, v15, v91, v92
    v_max3_f32 v15, v15, v93, v94
    v_max_f32 v15, v15, v95
    v_mov_b32 v7, v15
    s_nop 1
    v_permlane32_swap_b32 v7, v15
    s_nop 1
    v_max_f32 v15, v15, v7
    v_mov_b32 v7, v15
    s_nop 1
    v_permlane16_swap_b32 v7, v15
    s_nop 1
    v_max_f32 v15, v15, v7
    v_sub_f32 v15, 0, v15
    s_cmp_lg_u32 s76, 0
    s_cbranch_scc1 L_rare0_a
    v_min_f32 v12, v12, v16
    v_min_f32 v13, v13, v20
    v_min_f32 v14, v14, v24
    v_min_f32 v15, v15, v28
    v_sub_f32 v7, v12, v16
    v_exp_f32 v7, v7
    s_nop 0
    v_mul_f32 v8, v7, v8
    v_mul_f32 v128, v7, v128
    v_mul_f32 v129, v7, v129
    v_mul_f32 v130, v7, v130
    v_mul_f32 v131, v7, v131
    v_mul_f32 v132, v7, v132
    v_mul_f32 v133, v7, v133
    v_mul_f32 v134, v7, v134
    v_mul_f32 v135, v7, v135
    v_mul_f32 v136, v7, v136
    v_mul_f32 v137, v7, v137
    v_mul_f32 v138, v7, v138
    v_mul_f32 v139, v7, v139
    v_mul_f32 v140, v7, v140
    v_mul_f32 v141, v7, v141
    v_mul_f32 v142, v7, v142
    v_mul_f32 v143, v7, v143
    v_mul_f32 v144, v7, v144
    v_mul_f32 v145, v7, v145
    v_mul_f32 v146, v7, v146
    v_mul_f32 v147, v7, v147
    v_mul_f32 v148, v7, v148
    v_mul_f32 v149, v7, v149
    v_mul_f32 v150, v7, v150
    v_mul_f32 v151, v7, v151
    v_mul_f32 v152, v7, v152
    v_mul_f32 v153, v7, v153
    v_mul_f32 v154, v7, v154
    v_mul_f32 v155, v7, v155
    v_mul_f32 v156, v7, v156
    v_mul_f32 v157, v7, v157
    v_mul_f32 v158, v7, v158
    v_mul_f32 v159, v7, v159
    v_mul_f32 v160, v7, v160
    v_mul_f32 v161, v7, v161
    v_mul_f32 v162, v7, v162
    v_mul_f32 v163, v7, v163
    v_mul_f32 v164, v7, v164
    v_mul_f32 v165, v7, v165
    v_mul_f32 v166, v7, v166
    v_mul_f32 v167, v7, v167
    v_mul_f32 v168, v7, v168
    v_mul_f32 v169, v7, v169
    v_mul_f32 v170, v7, v170
    v_mul_f32 v171, v7, v171
    v_mul_f32 v172, v7, v172
    v_mul_f32 v173, v7, v173
    v_mul_f32 v174, v7, v174
    v_mul_f32 v175, v7, v175
    v_mul_f32 v176, v7, v176
    v_mul_f32 v177, v7, v177
    v_mul_f32 v178, v7, v178
    v_mul_f32 v179, v7, v179
    v_mul_f32 v180, v7, v180
    v_mul_f32 v181, v7, v181
    v_mul_f32 v182, v7, v182
    v_mul_f32 v183, v7, v183
    v_mul_f32 v184, v7, v184
    v_mul_f32 v185, v7, v185
    v_mul_f32 v186, v7, v186
    v_mul_f32 v187, v7, v187
    v_mul_f32 v188, v7, v188
    v_mul_f32 v189, v7, v189
    v_mul_f32 v190, v7, v190
    v_mul_f32 v191, v7, v191
    v_sub_f32 v7, v13, v20
    v_exp_f32 v7, v7
    s_nop 0
    v_mul_f32 v9, v7, v9
    v_mul_f32 v192, v7, v192
    v_mul_f32 v193, v7, v193
    v_mul_f32 v194, v7, v194
    v_mul_f32 v195, v7, v195
    v_mul_f32 v196, v7, v196
    v_mul_f32 v197, v7, v197
    v_mul_f32 v198, v7, v198
    v_mul_f32 v199, v7, v199
    v_mul_f32 v200, v7, v200
    v_mul_f32 v201, v7, v201
    v_mul_f32 v202, v7, v202
    v_mul_f32 v203, v7, v203
    v_mul_f32 v204, v7, v204
    v_mul_f32 v205, v7, v205
    v_mul_f32 v206, v7, v206
    v_mul_f32 v207, v7, v207
    v_mul_f32 v208, v7, v208
    v_mul_f32 v209, v7, v209
    v_mul_f32 v210, v7, v210
    v_mul_f32 v211, v7, v211
    v_mul_f32 v212, v7, v212
    v_mul_f32 v213, v7, v213
    v_mul_f32 v214, v7, v214
    v_mul_f32 v215, v7, v215
    v_mul_f32 v216, v7, v216
    v_mul_f32 v217, v7, v217
    v_mul_f32 v218, v7, v218
    v_mul_f32 v219, v7, v219
    v_mul_f32 v220, v7, v220
    v_mul_f32 v221, v7, v221
    v_mul_f32 v222, v7, v222
    v_mul_f32 v223, v7, v223
    v_mul_f32 v224, v7, v224
    v_mul_f32 v225, v7, v225
    v_mul_f32 v226, v7, v226
    v_mul_f32 v227, v7, v227
    v_mul_f32 v228, v7, v228
    v_mul_f32 v229, v7, v229
    v_mul_f32 v230, v7, v230
    v_mul_f32 v231, v7, v231
    v_mul_f32 v232, v7, v232
    v_mul_f32 v233, v7, v233
    v_mul_f32 v234, v7, v234
    v_mul_f32 v235, v7, v235
    v_mul_f32 v236, v7, v236
    v_mul_f32 v237, v7, v237
    v_mul_f32 v238, v7, v238
    v_mul_f32 v239, v7, v239
    v_mul_f32 v240, v7, v240
    v_mul_f32 v241, v7, v241
    v_mul_f32 v242, v7, v242
    v_mul_f32 v243, v7, v243
    v_mul_f32 v244, v7, v244
    v_mul_f32 v245, v7, v245
    v_mul_f32 v246, v7, v246
    v_mul_f32 v247, v7, v247
    v_mul_f32 v248, v7, v248
    v_mul_f32 v249, v7, v249
    v_mul_f32 v250, v7, v250
    v_mul_f32 v251, v7, v251
    v_mul_f32 v252, v7, v252
    v_mul_f32 v253, v7, v253
    v_mul_f32 v254, v7, v254
    v_mul_f32 v255, v7, v255
    v_sub_f32 v7, v14, v24
    v_exp_f32 v7, v7
    s_nop 0
    v_mul_f32 v10, v7, v10
    v_accvgpr_read_b32 v48, a128
    v_accvgpr_read_b32 v49, a129
    v_accvgpr_read_b32 v50, a130
    v_accvgpr_read_b32 v51, a131
    v_mul_f32 v48, v7, v48
    v_mul_f32 v49, v7, v49
    v_mul_f32 v50, v7, v50
    v_mul_f32 v51, v7, v51
    v_accvgpr_write_b32 a128, v48
    v_accvgpr_write_b32 a129, v49
    v_accvgpr_write_b32 a130, v50
    v_accvgpr_write_b32 a131, v51
    v_accvgpr_read_b32 v48, a132
    v_accvgpr_read_b32 v49, a133
    v_accvgpr_read_b32 v50, a134
    v_accvgpr_read_b32 v51, a135
    v_mul_f32 v48, v7, v48
    v_mul_f32 v49, v7, v49
    v_mul_f32 v50, v7, v50
    v_mul_f32 v51, v7, v51
    v_accvgpr_write_b32 a132, v48
    v_accvgpr_write_b32 a133, v49
    v_accvgpr_write_b32 a134, v50
    v_accvgpr_write_b32 a135, v51
    v_accvgpr_read_b32 v48, a136
    v_accvgpr_read_b32 v49, a137
    v_accvgpr_read_b32 v50, a138
    v_accvgpr_read_b32 v51, a139
    v_mul_f32 v48, v7, v48
    v_mul_f32 v49, v7, v49
    v_mul_f32 v50, v7, v50
    v_mul_f32 v51, v7, v51
    v_accvgpr_write_b32 a136, v48
    v_accvgpr_write_b32 a137, v49
    v_accvgpr_write_b32 a138, v50
    v_accvgpr_write_b32 a139, v51
    v_accvgpr_read_b32 v48, a140
    v_accvgpr_read_b32 v49, a141
    v_accvgpr_read_b32 v50, a142
    v_accvgpr_read_b32 v51, a143
    v_mul_f32 v48, v7, v48
    v_mul_f32 v49, v7, v49
    v_mul_f32 v50, v7, v50
    v_mul_f32 v51, v7, v51
    v_accvgpr_write_b32 a140, v48
    v_accvgpr_write_b32 a141, v49
    v_accvgpr_write_b32 a142, v50
    v_accvgpr_write_b32 a143, v51
    v_accvgpr_read_b32 v48, a144
    v_accvgpr_read_b32 v49, a145
    v_accvgpr_read_b32 v50, a146
    v_accvgpr_read_b32 v51, a147
    v_mul_f32 v48, v7, v48
    v_mul_f32 v49, v7, v49
    v_mul_f32 v50, v7, v50
    v_mul_f32 v51, v7, v51
    v_accvgpr_write_b32 a144, v48
    v_accvgpr_write_b32 a145, v49
    v_accvgpr_write_b32 a146, v50
    v_accvgpr_write_b32 a147, v51
    v_accvgpr_read_b32 v48, a148
    v_accvgpr_read_b32 v49, a149
    v_accvgpr_read_b32 v50, a150
    v_accvgpr_read_b32 v51, a151
    v_mul_f32 v48, v7, v48
    v_mul_f32 v49, v7, v49
    v_mul_f32 v50, v7, v50
    v_mul_f32 v51, v7, v51
    v_accvgpr_write_b32 a148, v48
    v_accvgpr_write_b32 a149, v49
    v_accvgpr_write_b32 a150, v50
    v_accvgpr_write_b32 a151, v51
    v_accvgpr_read_b32 v48, a152
    v_accvgpr_read_b32 v49, a153
    v_accvgpr_read_b32 v50, a154
    v_accvgpr_read_b32 v51, a155
    v_mul_f32 v48, v7, v48
    v_mul_f32 v49, v7, v49
    v_mul_f32 v50, v7, v50
    v_mul_f32 v51, v7, v51
    v_accvgpr_write_b32 a152, v48
    v_accvgpr_write_b32 a153, v49
    v_accvgpr_write_b32 a154, v50
    v_accvgpr_write_b32 a155, v51
    v_accvgpr_read_b32 v48, a156
    v_accvgpr_read_b32 v49, a157
    v_accvgpr_read_b32 v50, a158
    v_accvgpr_read_b32 v51, a159
    v_mul_f32 v48, v7, v48
    v_mul_f32 v49, v7, v49
    v_mul_f32 v50, v7, v50
    v_mul_f32 v51, v7, v51
    v_accvgpr_write_b32 a156, v48
    v_accvgpr_write_b32 a157, v49
    v_accvgpr_write_b32 a158, v50
    v_accvgpr_write_b32 a159, v51
    v_accvgpr_read_b32 v48, a160
    v_accvgpr_read_b32 v49, a161
    v_accvgpr_read_b32 v50, a162
    v_accvgpr_read_b32 v51, a163
    v_mul_f32 v48, v7, v48
    v_mul_f32 v49, v7, v49
    v_mul_f32 v50, v7, v50
    v_mul_f32 v51, v7, v51
    v_accvgpr_write_b32 a160, v48
    v_accvgpr_write_b32 a161, v49
    v_accvgpr_write_b32 a162, v50
    v_accvgpr_write_b32 a163, v51
    v_accvgpr_read_b32 v48, a164
    v_accvgpr_read_b32 v49, a165
    v_accvgpr_read_b32 v50, a166
    v_accvgpr_read_b32 v51, a167
    v_mul_f32 v48, v7, v48
    v_mul_f32 v49, v7, v49
    v_mul_f32 v50, v7, v50
    v_mul_f32 v51, v7, v51
    v_accvgpr_write_b32 a164, v48
    v_accvgpr_write_b32 a165, v49
    v_accvgpr_write_b32 a166, v50
    v_accvgpr_write_b32 a167, v51
    v_accvgpr_read_b32 v48, a168
    v_accvgpr_read_b32 v49, a169
    v_accvgpr_read_b32 v50, a170
    v_accvgpr_read_b32 v51, a171
    v_mul_f32 v48, v7, v48
    v_mul_f32 v49, v7, v49
    v_mul_f32 v50, v7, v50
    v_mul_f32 v51, v7, v51
    v_accvgpr_write_b32 a168, v48
    v_accvgpr_write_b32 a169, v49
    v_accvgpr_write_b32 a170, v50
    v_accvgpr_write_b32 a171, v51
    v_accvgpr_read_b32 v48, a172
    v_accvgpr_read_b32 v49, a173
    v_accvgpr_read_b32 v50, a174
    v_accvgpr_read_b32 v51, a175
    v_mul_f32 v48, v7, v48
    v_mul_f32 v49, v7, v49
    v_mul_f32 v50, v7, v50
    v_mul_f32 v51, v7, v51
    v_accvgpr_write_b32 a172, v48
    v_accvgpr_write_b32 a173, v49
    v_accvgpr_write_b32 a174, v50
    v_accvgpr_write_b32 a175, v51
    v_accvgpr_read_b32 v48, a176
    v_accvgpr_read_b32 v49, a177
    v_accvgpr_read_b32 v50, a178
    v_accvgpr_read_b32 v51, a179
    v_mul_f32 v48, v7, v48
    v_mul_f32 v49, v7, v49
    v_mul_f32 v50, v7, v50
    v_mul_f32 v51, v7, v51
    v_accvgpr_write_b32 a176, v48
    v_accvgpr_write_b32 a177, v49
    v_accvgpr_write_b32 a178, v50
    v_accvgpr_write_b32 a179, v51
    v_accvgpr_read_b32 v48, a180
    v_accvgpr_read_b32 v49, a181
    v_accvgpr_read_b32 v50, a182
    v_accvgpr_read_b32 v51, a183
    v_mul_f32 v48, v7, v48
    v_mul_f32 v49, v7, v49
    v_mul_f32 v50, v7, v50
    v_mul_f32 v51, v7, v51
    v_accvgpr_write_b32 a180, v48
    v_accvgpr_write_b32 a181, v49
    v_accvgpr_write_b32 a182, v50
    v_accvgpr_write_b32 a183, v51
    v_accvgpr_read_b32 v48, a184
    v_accvgpr_read_b32 v49, a185
    v_accvgpr_read_b32 v50, a186
    v_accvgpr_read_b32 v51, a187
    v_mul_f32 v48, v7, v48
    v_mul_f32 v49, v7, v49
    v_mul_f32 v50, v7, v50
    v_mul_f32 v51, v7, v51
    v_accvgpr_write_b32 a184, v48
    v_accvgpr_write_b32 a185, v49
    v_accvgpr_write_b32 a186, v50
    v_accvgpr_write_b32 a187, v51
    v_accvgpr_read_b32 v48, a188
    v_accvgpr_read_b32 v49, a189
    v_accvgpr_read_b32 v50, a190
    v_accvgpr_read_b32 v51, a191
    v_mul_f32 v48, v7, v48
    v_mul_f32 v49, v7, v49
    v_mul_f32 v50, v7, v50
    v_mul_f32 v51, v7, v51
    v_accvgpr_write_b32 a188, v48
    v_accvgpr_write_b32 a189, v49
    v_accvgpr_write_b32 a190, v50
    v_accvgpr_write_b32 a191, v51
    v_sub_f32 v7, v15, v28
    v_exp_f32 v7, v7
    s_nop 0
    v_mul_f32 v11, v7, v11
    v_accvgpr_read_b32 v48, a192
    v_accvgpr_read_b32 v49, a193
    v_accvgpr_read_b32 v50, a194
    v_accvgpr_read_b32 v51, a195
    v_mul_f32 v48, v7, v48
    v_mul_f32 v49, v7, v49
    v_mul_f32 v50, v7, v50
    v_mul_f32 v51, v7, v51
    v_accvgpr_write_b32 a192, v48
    v_accvgpr_write_b32 a193, v49
    v_accvgpr_write_b32 a194, v50
    v_accvgpr_write_b32 a195, v51
    v_accvgpr_read_b32 v48, a196
    v_accvgpr_read_b32 v49, a197
    v_accvgpr_read_b32 v50, a198
    v_accvgpr_read_b32 v51, a199
    v_mul_f32 v48, v7, v48
    v_mul_f32 v49, v7, v49
    v_mul_f32 v50, v7, v50
    v_mul_f32 v51, v7, v51
    v_accvgpr_write_b32 a196, v48
    v_accvgpr_write_b32 a197, v49
    v_accvgpr_write_b32 a198, v50
    v_accvgpr_write_b32 a199, v51
    v_accvgpr_read_b32 v48, a200
    v_accvgpr_read_b32 v49, a201
    v_accvgpr_read_b32 v50, a202
    v_accvgpr_read_b32 v51, a203
    v_mul_f32 v48, v7, v48
    v_mul_f32 v49, v7, v49
    v_mul_f32 v50, v7, v50
    v_mul_f32 v51, v7, v51
    v_accvgpr_write_b32 a200, v48
    v_accvgpr_write_b32 a201, v49
    v_accvgpr_write_b32 a202, v50
    v_accvgpr_write_b32 a203, v51
    v_accvgpr_read_b32 v48, a204
    v_accvgpr_read_b32 v49, a205
    v_accvgpr_read_b32 v50, a206
    v_accvgpr_read_b32 v51, a207
    v_mul_f32 v48, v7, v48
    v_mul_f32 v49, v7, v49
    v_mul_f32 v50, v7, v50
    v_mul_f32 v51, v7, v51
    v_accvgpr_write_b32 a204, v48
    v_accvgpr_write_b32 a205, v49
    v_accvgpr_write_b32 a206, v50
    v_accvgpr_write_b32 a207, v51
    v_accvgpr_read_b32 v48, a208
    v_accvgpr_read_b32 v49, a209
    v_accvgpr_read_b32 v50, a210
    v_accvgpr_read_b32 v51, a211
    v_mul_f32 v48, v7, v48
    v_mul_f32 v49, v7, v49
    v_mul_f32 v50, v7, v50
    v_mul_f32 v51, v7, v51
    v_accvgpr_write_b32 a208, v48
    v_accvgpr_write_b32 a209, v49
    v_accvgpr_write_b32 a210, v50
    v_accvgpr_write_b32 a211, v51
    v_accvgpr_read_b32 v48, a212
    v_accvgpr_read_b32 v49, a213
    v_accvgpr_read_b32 v50, a214
    v_accvgpr_read_b32 v51, a215
    v_mul_f32 v48, v7, v48
    v_mul_f32 v49, v7, v49
    v_mul_f32 v50, v7, v50
    v_mul_f32 v51, v7, v51
    v_accvgpr_write_b32 a212, v48
    v_accvgpr_write_b32 a213, v49
    v_accvgpr_write_b32 a214, v50
    v_accvgpr_write_b32 a215, v51
    v_accvgpr_read_b32 v48, a216
    v_accvgpr_read_b32 v49, a217
    v_accvgpr_read_b32 v50, a218
    v_accvgpr_read_b32 v51, a219
    v_mul_f32 v48, v7, v48
    v_mul_f32 v49, v7, v49
    v_mul_f32 v50, v7, v50
    v_mul_f32 v51, v7, v51
    v_accvgpr_write_b32 a216, v48
    v_accvgpr_write_b32 a217, v49
    v_accvgpr_write_b32 a218, v50
    v_accvgpr_write_b32 a219, v51
    v_accvgpr_read_b32 v48, a220
    v_accvgpr_read_b32 v49, a221
    v_accvgpr_read_b32 v50, a222
    v_accvgpr_read_b32 v51, a223
    v_mul_f32 v48, v7, v48
    v_mul_f32 v49, v7, v49
    v_mul_f32 v50, v7, v50
    v_mul_f32 v51, v7, v51
    v_accvgpr_write_b32 a220, v48
    v_accvgpr_write_b32 a221, v49
    v_accvgpr_write_b32 a222, v50
    v_accvgpr_write_b32 a223, v51
    v_accvgpr_read_b32 v48, a224
    v_accvgpr_read_b32 v49, a225
    v_accvgpr_read_b32 v50, a226
    v_accvgpr_read_b32 v51, a227
    v_mul_f32 v48, v7, v48
    v_mul_f32 v49, v7, v49
    v_mul_f32 v50, v7, v50
    v_mul_f32 v51, v7, v51
    v_accvgpr_write_b32 a224, v48
    v_accvgpr_write_b32 a225, v49
    v_accvgpr_write_b32 a226, v50
    v_accvgpr_write_b32 a227, v51
    v_accvgpr_read_b32 v48, a228
    v_accvgpr_read_b32 v49, a229
    v_accvgpr_read_b32 v50, a230
    v_accvgpr_read_b32 v51, a231
    v_mul_f32 v48, v7, v48
    v_mul_f32 v49, v7, v49
    v_mul_f32 v50, v7, v50
    v_mul_f32 v51, v7, v51
    v_accvgpr_write_b32 a228, v48
    v_accvgpr_write_b32 a229, v49
    v_accvgpr_write_b32 a230, v50
    v_accvgpr_write_b32 a231, v51
    v_accvgpr_read_b32 v48, a232
    v_accvgpr_read_b32 v49, a233
    v_accvgpr_read_b32 v50, a234
    v_accvgpr_read_b32 v51, a235
    v_mul_f32 v48, v7, v48
    v_mul_f32 v49, v7, v49
    v_mul_f32 v50, v7, v50
    v_mul_f32 v51, v7, v51
    v_accvgpr_write_b32 a232, v48
    v_accvgpr_write_b32 a233, v49
    v_accvgpr_write_b32 a234, v50
    v_accvgpr_write_b32 a235, v51
    v_accvgpr_read_b32 v48, a236
    v_accvgpr_read_b32 v49, a237
    v_accvgpr_read_b32 v50, a238
    v_accvgpr_read_b32 v51, a239
    v_mul_f32 v48, v7, v48
    v_mul_f32 v49, v7, v49
    v_mul_f32 v50, v7, v50
    v_mul_f32 v51, v7, v51
    v_accvgpr_write_b32 a236, v48
    v_accvgpr_write_b32 a237, v49
    v_accvgpr_write_b32 a238, v50
    v_accvgpr_write_b32 a239, v51
    v_accvgpr_read_b32 v48, a240
    v_accvgpr_read_b32 v49, a241
    v_accvgpr_read_b32 v50, a242
    v_accvgpr_read_b32 v51, a243
    v_mul_f32 v48, v7, v48
    v_mul_f32 v49, v7, v49
    v_mul_f32 v50, v7, v50
    v_mul_f32 v51, v7, v51
    v_accvgpr_write_b32 a240, v48
    v_accvgpr_write_b32 a241, v49
    v_accvgpr_write_b32 a242, v50
    v_accvgpr_write_b32 a243, v51
    v_accvgpr_read_b32 v48, a244
    v_accvgpr_read_b32 v49, a245
    v_accvgpr_read_b32 v50, a246
    v_accvgpr_read_b32 v51, a247
    v_mul_f32 v48, v7, v48
    v_mul_f32 v49, v7, v49
    v_mul_f32 v50, v7, v50
    v_mul_f32 v51, v7, v51
    v_accvgpr_write_b32 a244, v48
    v_accvgpr_write_b32 a245, v49
    v_accvgpr_write_b32 a246, v50
    v_accvgpr_write_b32 a247, v51
    v_accvgpr_read_b32 v48, a248
    v_accvgpr_read_b32 v49, a249
    v_accvgpr_read_b32 v50, a250
    v_accvgpr_read_b32 v51, a251
    v_mul_f32 v48, v7, v48
    v_mul_f32 v49, v7, v49
    v_mul_f32 v50, v7, v50
    v_mul_f32 v51, v7, v51
    v_accvgpr_write_b32 a248, v48
    v_accvgpr_write_b32 a249, v49
    v_accvgpr_write_b32 a250, v50
    v_accvgpr_write_b32 a251, v51
    v_accvgpr_read_b32 v48, a252
    v_accvgpr_read_b32 v49, a253
    v_accvgpr_read_b32 v50, a254
    v_accvgpr_read_b32 v51, a255
    v_mul_f32 v48, v7, v48
    v_mul_f32 v49, v7, v49
    v_mul_f32 v50, v7, v50
    v_mul_f32 v51, v7, v51
    v_accvgpr_write_b32 a252, v48
    v_accvgpr_write_b32 a253, v49
    v_accvgpr_write_b32 a254, v50
    v_accvgpr_write_b32 a255, v51
L_rare0_a:
    v_sub_f32 v7, v12, v16
    v_add_f32 v96, v96, v7
    v_add_f32 v64, v64, v12
    v_add_f32 v97, v97, v7
    v_add_f32 v65, v65, v12
    v_add_f32 v98, v98, v7
    v_add_f32 v66, v66, v12
    v_add_f32 v99, v99, v7
    v_add_f32 v67, v67, v12
    v_add_f32 v100, v100, v7
    v_add_f32 v68, v68, v12
    v_add_f32 v101, v101, v7
    v_add_f32 v69, v69, v12
    v_add_f32 v102, v102, v7
    v_add_f32 v70, v70, v12
    v_add_f32 v103, v103, v7
    v_add_f32 v71, v71, v12
    v_mov_b32 v16, v12
    v_mov_b32 v17, v12
    v_mov_b32 v18, v12
    v_mov_b32 v19, v12
    v_sub_f32 v7, v13, v20
    v_add_f32 v104, v104, v7
    v_add_f32 v72, v72, v13
    v_add_f32 v105, v105, v7
    v_add_f32 v73, v73, v13
    v_add_f32 v106, v106, v7
    v_add_f32 v74, v74, v13
    v_add_f32 v107, v107, v7
    v_add_f32 v75, v75, v13
    v_add_f32 v108, v108, v7
    v_add_f32 v76, v76, v13
    v_add_f32 v109, v109, v7
    v_add_f32 v77, v77, v13
    v_add_f32 v110, v110, v7
    v_add_f32 v78, v78, v13
    v_add_f32 v111, v111, v7
    v_add_f32 v79, v79, v13
    v_mov_b32 v20, v13
    v_mov_b32 v21, v13
    v_mov_b32 v22, v13
    v_mov_b32 v23, v13
    v_sub_f32 v7, v14, v24
    v_add_f32 v112, v112, v7
    v_add_f32 v80, v80, v14
    v_add_f32 v113, v113, v7
    v_add_f32 v81, v81, v14
    v_add_f32 v114, v114, v7
    v_add_f32 v82, v82, v14
    v_add_f32 v115, v115, v7
    v_add_f32 v83, v83, v14
    v_add_f32 v116, v116, v7
    v_add_f32 v84, v84, v14
    v_add_f32 v117, v117, v7
    v_add_f32 v85, v85, v14
    v_add_f32 v118, v118, v7
    v_add_f32 v86, v86, v14
    v_add_f32 v119, v119, v7
    v_add_f32 v87, v87, v14
    v_mov_b32 v24, v14
    v_mov_b32 v25, v14
    v_mov_b32 v26, v14
    v_mov_b32 v27, v14
    v_sub_f32 v7, v15, v28
    v_add_f32 v120, v120, v7
    v_add_f32 v88, v88, v15
    v_add_f32 v121, v121, v7
    v_add_f32 v89, v89, v15
    v_add_f32 v122, v122, v7
    v_add_f32 v90, v90, v15
    v_add_f32 v123, v123, v7
    v_add_f32 v91, v91, v15
    v_add_f32 v124, v124, v7
    v_add_f32 v92, v92, v15
    v_add_f32 v125, v125, v7
    v_add_f32 v93, v93, v15
    v_add_f32 v126, v126, v7
    v_add_f32 v94, v94, v15
    v_add_f32 v127, v127, v7
    v_add_f32 v95, v95, v15
    v_mov_b32 v28, v15
    v_mov_b32 v29, v15
    v_mov_b32 v30, v15
    v_mov_b32 v31, v15
    v_exp_f32 v64, v64
    v_exp_f32 v65, v65
    v_exp_f32 v66, v66
    v_add_f32 v12, v64, v65
    v_cvt_pk_bf16_f32 v64, v64, v65
    v_exp_f32 v67, v67
    v_add_f32 v12, v12, v66
    v_exp_f32 v68, v68
    v_add_f32 v12, v12, v67
    v_cvt_pk_bf16_f32 v65, v66, v67
    v_exp_f32 v69, v69
    v_add_f32 v12, v12, v68
    v_exp_f32 v70, v70
    v_add_f32 v12, v12, v69
    v_cvt_pk_bf16_f32 v66, v68, v69
    v_exp_f32 v71, v71
    v_add_f32 v12, v12, v70
    v_exp_f32 v72, v72
    v_add_f32 v12, v12, v71
    v_cvt_pk_bf16_f32 v67, v70, v71
    v_exp_f32 v73, v73
    v_exp_f32 v74, v74
    v_add_f32 v13, v72, v73
    v_cvt_pk_bf16_f32 v72, v72, v73
    v_exp_f32 v75, v75
    v_add_f32 v13, v13, v74
    v_exp_f32 v76, v76
    v_add_f32 v13, v13, v75
    v_cvt_pk_bf16_f32 v73, v74, v75
    v_exp_f32 v77, v77
    v_add_f32 v13, v13, v76
    v_exp_f32 v78, v78
    v_add_f32 v13, v13, v77
    v_cvt_pk_bf16_f32 v74, v76, v77
    v_exp_f32 v79, v79
    v_add_f32 v13, v13, v78
    v_exp_f32 v80, v80
    v_add_f32 v13, v13, v79
    v_cvt_pk_bf16_f32 v75, v78, v79
    v_exp_f32 v81, v81
    v_exp_f32 v82, v82
    v_add_f32 v14, v80, v81
    v_cvt_pk_bf16_f32 v80, v80, v81
    v_exp_f32 v83, v83
    v_add_f32 v14, v14, v82
    v_exp_f32 v84, v84
    v_add_f32 v14, v14, v83
    v_cvt_pk_bf16_f32 v81, v82, v83
    v_exp_f32 v85, v85
    v_add_f32 v14, v14, v84
    v_exp_f32 v86, v86
    v_add_f32 v14, v14, v85
    v_cvt_pk_bf16_f32 v82, v84, v85
    v_exp_f32 v87, v87
    v_add_f32 v14, v14, v86
    v_exp_f32 v88, v88
    v_add_f32 v14, v14, v87
    v_cvt_pk_bf16_f32 v83, v86, v87
    v_exp_f32 v89, v89
    v_exp_f32 v90, v90
    v_add_f32 v15, v88, v89
    v_cvt_pk_bf16_f32 v88, v88, v89
    v_exp_f32 v91, v91
    v_add_f32 v15, v15, v90
    v_exp_f32 v92, v92
    v_add_f32 v15, v15, v91
    v_cvt_pk_bf16_f32 v89, v90, v91
    v_exp_f32 v93, v93
    v_add_f32 v15, v15, v92
    v_exp_f32 v94, v94
    v_add_f32 v15, v15, v93
    v_cvt_pk_bf16_f32 v90, v92, v93
    v_exp_f32 v95, v95
    v_add_f32 v15, v15, v94
    v_max3_f32 v7, v12, v13, v14
    v_add_f32 v15, v15, v95
    v_cvt_pk_bf16_f32 v91, v94, v95
    v_add_f32 v7, v7, v15
    s_nop 1
    s_setpc_b64 s[78:79]
L_rare1:
    s_waitcnt lgkmcnt(0)
    s_nop 7
    s_nop 7
    v_add_u32 v7, s74, v2
    ds_read_b128 v[48:51], v7 offset:0
    ds_read_b128 v[52:55], v7 offset:256
    ds_read_b128 v[56:59], v7 offset:2048
    ds_read_b128 v[60:63], v7 offset:2304
    s_waitcnt lgkmcnt(0)
    v_mfma_f32_16x16x32_bf16 v[96:99], v[48:51], a[0:3], 0
    v_mfma_f32_16x16x32_bf16 v[104:107], v[48:51], a[32:35], 0
    v_mfma_f32_16x16x32_bf16 v[112:115], v[48:51], a[64:67], 0
    v_mfma_f32_16x16x32_bf16 v[120:123], v[48:51], a[96:99], 0
    v_mfma_f32_16x16x32_bf16 v[100:103], v[52:55], a[0:3], 0
    v_mfma_f32_16x16x32_bf16 v[108:111], v[52:55], a[32:35], 0
    v_mfma_f32_16x16x32_bf16 v[116:119], v[52:55], a[64:67], 0
    v_mfma_f32_16x16x32_bf16 v[124:127], v[52:55], a[96:99], 0
    v_mfma_f32_16x16x32_bf16 v[96:99], v[56:59], a[4:7], v[96:99]
    v_mfma_f32_16x16x32_bf16 v[104:107], v[56:59], a[36:39], v[104:107]
    v_mfma_f32_16x16x32_bf16 v[112:115], v[56:59], a[68:71], v[112:115]
    v_mfma_f32_16x16x32_bf16 v[120:123], v[56:59], a[100:103], v[120:123]
    v_mfma_f32_16x16x32_bf16 v[100:103], v[60:63], a[4:7], v[100:103]
    v_mfma_f32_16x16x32_bf16 v[108:111], v[60:63], a[36:39], v[108:111]
    v_mfma_f32_16x16x32_bf16 v[116:119], v[60:63], a[68:71], v[116:119]
    v_mfma_f32_16x16x32_bf16 v[124:127], v[60:63], a[100:103], v[124:127]
    ds_read_b128 v[48:51], v7 offset:4096
    ds_read_b128 v[52:55], v7 offset:4352
    ds_read_b128 v[56:59], v7 offset:6144
    ds_read_b128 v[60:63], v7 offset:6400
    s_waitcnt lgkmcnt(0)
    v_mfma_f32_16x16x32_bf16 v[96:99], v[48:51], a[8:11], v[96:99]
    v_mfma_f32_16x16x32_bf16 v[104:107], v[48:51], a[40:43], v[104:107]
    v_mfma_f32_16x16x32_bf16 v[112:115], v[48:51], a[72:75], v[112:115]
    v_mfma_f32_16x16x32_bf16 v[120:123], v[48:51], a[104:107], v[120:123]
    v_mfma_f32_16x16x32_bf16 v[100:103], v[52:55], a[8:11], v[100:103]
    v_mfma_f32_16x16x32_bf16 v[108:111], v[52:55], a[40:43], v[108:111]
    v_mfma_f32_16x16x32_bf16 v[116:119], v[52:55], a[72:75], v[116:119]
    v_mfma_f32_16x16x32_bf16 v[124:127], v[52:55], a[104:107], v[124:127]
    v_mfma_f32_16x16x32_bf16 v[96:99], v[56:59], a[12:15], v[96:99]
    v_mfma_f32_16x16x32_bf16 v[104:107], v[56:59], a[44:47], v[104:107]
    v_mfma_f32_16x16x32_bf16 v[112:115], v[56:59], a[76:79], v[112:115]
    v_mfma_f32_16x16x32_bf16 v[120:123], v[56:59], a[108:111], v[120:123]
    v_mfma_f32_16x16x32_bf16 v[100:103], v[60:63], a[12:15], v[100:103]
    v_mfma_f32_16x16x32_bf16 v[108:111], v[60:63], a[44:47], v[108:111]
    v_mfma_f32_16x16x32_bf16 v[116:119], v[60:63], a[76:79], v[116:119]
    v_mfma_f32_16x16x32_bf16 v[124:127], v[60:63], a[108:111], v[124:127]
    v_add_u32 v7, s75, v2
    ds_read_b128 v[48:51], v7 offset:0
    ds_read_b128 v[52:55], v7 offset:256
    ds_read_b128 v[56:59], v7 offset:2048
    ds_read_b128 v[60:63], v7 offset:2304
    s_waitcnt lgkmcnt(0)
    v_mfma_f32_16x16x32_bf16 v[96:99], v[48:51], a[16:19], v[96:99]
    v_mfma_f32_16x16x32_bf16 v[104:107], v[48:51], a[48:51], v[104:107]
    v_mfma_f32_16x16x32_bf16 v[112:115], v[48:51], a[80:83], v[112:115]
    v_mfma_f32_16x16x32_bf16 v[120:123], v[48:51], a[112:115], v[120:123]
    v_mfma_f32_16x16x32_bf16 v[100:103], v[52:55], a[16:19], v[100:103]
    v_mfma_f32_16x16x32_bf16 v[108:111], v[52:55], a[48:51], v[108:111]
    v_mfma_f32_16x16x32_bf16 v[116:119], v[52:55], a[80:83], v[116:119]
    v_mfma_f32_16x16x32_bf16 v[124:127], v[52:55], a[112:115], v[124:127]
    v_mfma_f32_16x16x32_bf16 v[96:99], v[56:59], a[20:23], v[96:99]
    v_mfma_f32_16x16x32_bf16 v[104:107], v[56:59], a[52:55], v[104:107]
    v_mfma_f32_16x16x32_bf16 v[112:115], v[56:59], a[84:87], v[112:115]
    v_mfma_f32_16x16x32_bf16 v[120:123], v[56:59], a[116:119], v[120:123]
    v_mfma_f32_16x16x32_bf16 v[100:103], v[60:63], a[20:23], v[100:103]
    v_mfma_f32_16x16x32_bf16 v[108:111], v[60:63], a[52:55], v[108:111]
    v_mfma_f32_16x16x32_bf16 v[116:119], v[60:63], a[84:87], v[116:119]
    v_mfma_f32_16x16x32_bf16 v[124:127], v[60:63], a[116:119], v[124:127]
    ds_read_b128 v[48:51], v7 offset:4096
    ds_read_b128 v[52:55], v7 offset:4352
    ds_read_b128 v[56:59], v7 offset:6144
    ds_read_b128 v[60:63], v7 offset:6400
    s_waitcnt lgkmcnt(0)
    v_mfma_f32_16x16x32_bf16 v[96:99], v[48:51], a[24:27], v[96:99]
    v_mfma_f32_16x16x32_bf16 v[104:107], v[48:51], a[56:59], v[104:107]
    v_mfma_f32_16x16x32_bf16 v[112:115], v[48:51], a[88:91], v[112:115]
    v_mfma_f32_16x16x32_bf16 v[120:123], v[48:51], a[120:123], v[120:123]
    v_mfma_f32_16x16x32_bf16 v[100:103], v[52:55], a[24:27], v[100:103]
    v_mfma_f32_16x16x32_bf16 v[108:111], v[52:55], a[56:59], v[108:111]
    v_mfma_f32_16x16x32_bf16 v[116:119], v[52:55], a[88:91], v[116:119]
    v_mfma_f32_16x16x32_bf16 v[124:127], v[52:55], a[120:123], v[124:127]
    v_mfma_f32_16x16x32_bf16 v[96:99], v[56:59], a[28:31], v[96:99]
    v_mfma_f32_16x16x32_bf16 v[104:107], v[56:59], a[60:63], v[104:107]
    v_mfma_f32_16x16x32_bf16 v[112:115], v[56:59], a[92:95], v[112:115]
    v_mfma_f32_16x16x32_bf16 v[120:123], v[56:59], a[124:127], v[120:123]
    v_mfma_f32_16x16x32_bf16 v[100:103], v[60:63], a[28:31], v[100:103]
    v_mfma_f32_16x16x32_bf16 v[108:111], v[60:63], a[60:63], v[108:111]
    v_mfma_f32_16x16x32_bf16 v[116:119], v[60:63], a[92:95], v[116:119]
    v_mfma_f32_16x16x32_bf16 v[124:127], v[60:63], a[124:127], v[124:127]
    s_nop 7
    s_nop 7
    v_max3_f32 v12, v96, v97, v98
    v_max3_f32 v12, v12, v99, v100
    v_max3_f32 v12, v12, v101, v102
    v_max_f32 v12, v12, v103
    v_mov_b32 v7, v12
    s_nop 1
    v_permlane32_swap_b32 v7, v12
    s_nop 1
    v_max_f32 v12, v12, v7
    v_mov_b32 v7, v12
    s_nop 1
    v_permlane16_swap_b32 v7, v12
    s_nop 1
    v_max_f32 v12, v12, v7
    v_sub_f32 v12, 0, v12
    v_max3_f32 v13, v104, v105, v106
    v_max3_f32 v13, v13, v107, v108
    v_max3_f32 v13, v13, v109, v110
    v_max_f32 v13, v13, v111
    v_mov_b32 v7, v13
    s_nop 1
    v_permlane32_swap_b32 v7, v13
    s_nop 1
    v_max_f32 v13, v13, v7
    v_mov_b32 v7, v13
    s_nop 1
    v_permlane16_swap_b32 v7, v13
    s_nop 1
    v_max_f32 v13, v13, v7
    v_sub_f32 v13, 0, v13
    v_max3_f32 v14, v112, v113, v114
    v_max3_f32 v14, v14, v115, v116
    v_max3_f32 v14, v14, v117, v118
    v_max_f32 v14, v14, v119
    v_mov_b32 v7, v14
    s_nop 1
    v_permlane32_swap_b32 v7, v14
    s_nop 1
    v_max_f32 v14, v14, v7
    v_mov_b32 v7, v14
    s_nop 1
    v_permlane16_swap_b32 v7, v14
    s_nop 1
    v_max_f32 v14, v14, v7
    v_sub_f32 v14, 0, v14
    v_max3_f32 v15, v120, v121, v122
    v_max3_f32 v15, v15, v123, v124
    v_max3_f32 v15, v15, v125, v126
    v_max_f32 v15, v15, v127
    v_mov_b32 v7, v15
    s_nop 1
    v_permlane32_swap_b32 v7, v15
    s_nop 1
    v_max_f32 v15, v15, v7
    v_mov_b32 v7, v15
    s_nop 1
    v_permlane16_swap_b32 v7, v15
    s_nop 1
    v_max_f32 v15, v15, v7
    v_sub_f32 v15, 0, v15
    s_cmp_lg_u32 s76, 0
    s_cbranch_scc1 L_rare1_a
    v_min_f32 v12, v12, v16
    v_min_f32 v13, v13, v20
    v_min_f32 v14, v14, v24
    v_min_f32 v15, v15, v28
    v_sub_f32 v7, v12, v16
    v_exp_f32 v7, v7
    s_nop 0
    v_mul_f32 v8, v7, v8
    v_mul_f32 v128, v7, v128
    v_mul_f32 v129, v7, v129
    v_mul_f32 v130, v7, v130
    v_mul_f32 v131, v7, v131
    v_mul_f32 v132, v7, v132
    v_mul_f32 v133, v7, v133
    v_mul_f32 v134, v7, v134
    v_mul_f32 v135, v7, v135
    v_mul_f32 v136, v7, v136
    v_mul_f32 v137, v7, v137
    v_mul_f32 v138, v7, v138
    v_mul_f32 v139, v7, v139
    v_mul_f32 v140, v7, v140
    v_mul_f32 v141, v7, v141
    v_mul_f32 v142, v7, v142
    v_mul_f32 v143, v7, v143
    v_mul_f32 v144, v7, v144
    v_mul_f32 v145, v7, v145
    v_mul_f32 v146, v7, v146
    v_mul_f32 v147, v7, v147
    v_mul_f32 v148, v7, v148
    v_mul_f32 v149, v7, v149
    v_mul_f32 v150, v7, v150
    v_mul_f32 v151, v7, v151
    v_mul_f32 v152, v7, v152
    v_mul_f32 v153, v7, v153
    v_mul_f32 v154, v7, v154
    v_mul_f32 v155, v7, v155
    v_mul_f32 v156, v7, v156
    v_mul_f32 v157, v7, v157
    v_mul_f32 v158, v7, v158
    v_mul_f32 v159, v7, v159
    v_mul_f32 v160, v7, v160
    v_mul_f32 v161, v7, v161
    v_mul_f32 v162, v7, v162
    v_mul_f32 v163, v7, v163
    v_mul_f32 v164, v7, v164
    v_mul_f32 v165, v7, v165
    v_mul_f32 v166, v7, v166
    v_mul_f32 v167, v7, v167
    v_mul_f32 v168, v7, v168
    v_mul_f32 v169, v7, v169
    v_mul_f32 v170, v7, v170
    v_mul_f32 v171, v7, v171
    v_mul_f32 v172, v7, v172
    v_mul_f32 v173, v7, v173
    v_mul_f32 v174, v7, v174
    v_mul_f32 v175, v7, v175
    v_mul_f32 v176, v7, v176
    v_mul_f32 v177, v7, v177
    v_mul_f32 v178, v7, v178
    v_mul_f32 v179, v7, v179
    v_mul_f32 v180, v7, v180
    v_mul_f32 v181, v7, v181
    v_mul_f32 v182, v7, v182
    v_mul_f32 v183, v7, v183
    v_mul_f32 v184, v7, v184
    v_mul_f32 v185, v7, v185
    v_mul_f32 v186, v7, v186
    v_mul_f32 v187, v7, v187
    v_mul_f32 v188, v7, v188
    v_mul_f32 v189, v7, v189
    v_mul_f32 v190, v7, v190
    v_mul_f32 v191, v7, v191
    v_sub_f32 v7, v13, v20
    v_exp_f32 v7, v7
    s_nop 0
    v_mul_f32 v9, v7, v9
    v_mul_f32 v192, v7, v192
    v_mul_f32 v193, v7, v193
    v_mul_f32 v194, v7, v194
    v_mul_f32 v195, v7, v195
    v_mul_f32 v196, v7, v196
    v_mul_f32 v197, v7, v197
    v_mul_f32 v198, v7, v198
    v_mul_f32 v199, v7, v199
    v_mul_f32 v200, v7, v200
    v_mul_f32 v201, v7, v201
    v_mul_f32 v202, v7, v202
    v_mul_f32 v203, v7, v203
    v_mul_f32 v204, v7, v204
    v_mul_f32 v205, v7, v205
    v_mul_f32 v206, v7, v206
    v_mul_f32 v207, v7, v207
    v_mul_f32 v208, v7, v208
    v_mul_f32 v209, v7, v209
    v_mul_f32 v210, v7, v210
    v_mul_f32 v211, v7, v211
    v_mul_f32 v212, v7, v212
    v_mul_f32 v213, v7, v213
    v_mul_f32 v214, v7, v214
    v_mul_f32 v215, v7, v215
    v_mul_f32 v216, v7, v216
    v_mul_f32 v217, v7, v217
    v_mul_f32 v218, v7, v218
    v_mul_f32 v219, v7, v219
    v_mul_f32 v220, v7, v220
    v_mul_f32 v221, v7, v221
    v_mul_f32 v222, v7, v222
    v_mul_f32 v223, v7, v223
    v_mul_f32 v224, v7, v224
    v_mul_f32 v225, v7, v225
    v_mul_f32 v226, v7, v226
    v_mul_f32 v227, v7, v227
    v_mul_f32 v228, v7, v228
    v_mul_f32 v229, v7, v229
    v_mul_f32 v230, v7, v230
    v_mul_f32 v231, v7, v231
    v_mul_f32 v232, v7, v232
    v_mul_f32 v233, v7, v233
    v_mul_f32 v234, v7, v234
    v_mul_f32 v235, v7, v235
    v_mul_f32 v236, v7, v236
    v_mul_f32 v237, v7, v237
    v_mul_f32 v238, v7, v238
    v_mul_f32 v239, v7, v239
    v_mul_f32 v240, v7, v240
    v_mul_f32 v241, v7, v241
    v_mul_f32 v242, v7, v242
    v_mul_f32 v243, v7, v243
    v_mul_f32 v244, v7, v244
    v_mul_f32 v245, v7, v245
    v_mul_f32 v246, v7, v246
    v_mul_f32 v247, v7, v247
    v_mul_f32 v248, v7, v248
    v_mul_f32 v249, v7, v249
    v_mul_f32 v250, v7, v250
    v_mul_f32 v251, v7, v251
    v_mul_f32 v252, v7, v252
    v_mul_f32 v253, v7, v253
    v_mul_f32 v254, v7, v254
    v_mul_f32 v255, v7, v255
    v_sub_f32 v7, v14, v24
    v_exp_f32 v7, v7
    s_nop 0
    v_mul_f32 v10, v7, v10
    v_accvgpr_read_b32 v48, a128
    v_accvgpr_read_b32 v49, a129
    v_accvgpr_read_b32 v50, a130
    v_accvgpr_read_b32 v51, a131
    v_mul_f32 v48, v7, v48
    v_mul_f32 v49, v7, v49
    v_mul_f32 v50, v7, v50
    v_mul_f32 v51, v7, v51
    v_accvgpr_write_b32 a128, v48
    v_accvgpr_write_b32 a129, v49
    v_accvgpr_write_b32 a130, v50
    v_accvgpr_write_b32 a131, v51
    v_accvgpr_read_b32 v48, a132
    v_accvgpr_read_b32 v49, a133
    v_accvgpr_read_b32 v50, a134
    v_accvgpr_read_b32 v51, a135
    v_mul_f32 v48, v7, v48
    v_mul_f32 v49, v7, v49
    v_mul_f32 v50, v7, v50
    v_mul_f32 v51, v7, v51
    v_accvgpr_write_b32 a132, v48
    v_accvgpr_write_b32 a133, v49
    v_accvgpr_write_b32 a134, v50
    v_accvgpr_write_b32 a135, v51
    v_accvgpr_read_b32 v48, a136
    v_accvgpr_read_b32 v49, a137
    v_accvgpr_read_b32 v50, a138
    v_accvgpr_read_b32 v51, a139
    v_mul_f32 v48, v7, v48
    v_mul_f32 v49, v7, v49
    v_mul_f32 v50, v7, v50
    v_mul_f32 v51, v7, v51
    v_accvgpr_write_b32 a136, v48
    v_accvgpr_write_b32 a137, v49
    v_accvgpr_write_b32 a138, v50
    v_accvgpr_write_b32 a139, v51
    v_accvgpr_read_b32 v48, a140
    v_accvgpr_read_b32 v49, a141
    v_accvgpr_read_b32 v50, a142
    v_accvgpr_read_b32 v51, a143
    v_mul_f32 v48, v7, v48
    v_mul_f32 v49, v7, v49
    v_mul_f32 v50, v7, v50
    v_mul_f32 v51, v7, v51
    v_accvgpr_write_b32 a140, v48
    v_accvgpr_write_b32 a141, v49
    v_accvgpr_write_b32 a142, v50
    v_accvgpr_write_b32 a143, v51
    v_accvgpr_read_b32 v48, a144
    v_accvgpr_read_b32 v49, a145
    v_accvgpr_read_b32 v50, a146
    v_accvgpr_read_b32 v51, a147
    v_mul_f32 v48, v7, v48
    v_mul_f32 v49, v7, v49
    v_mul_f32 v50, v7, v50
    v_mul_f32 v51, v7, v51
    v_accvgpr_write_b32 a144, v48
    v_accvgpr_write_b32 a145, v49
    v_accvgpr_write_b32 a146, v50
    v_accvgpr_write_b32 a147, v51
    v_accvgpr_read_b32 v48, a148
    v_accvgpr_read_b32 v49, a149
    v_accvgpr_read_b32 v50, a150
    v_accvgpr_read_b32 v51, a151
    v_mul_f32 v48, v7, v48
    v_mul_f32 v49, v7, v49
    v_mul_f32 v50, v7, v50
    v_mul_f32 v51, v7, v51
    v_accvgpr_write_b32 a148, v48
    v_accvgpr_write_b32 a149, v49
    v_accvgpr_write_b32 a150, v50
    v_accvgpr_write_b32 a151, v51
    v_accvgpr_read_b32 v48, a152
    v_accvgpr_read_b32 v49, a153
    v_accvgpr_read_b32 v50, a154
    v_accvgpr_read_b32 v51, a155
    v_mul_f32 v48, v7, v48
    v_mul_f32 v49, v7, v49
    v_mul_f32 v50, v7, v50
    v_mul_f32 v51, v7, v51
    v_accvgpr_write_b32 a152, v48
    v_accvgpr_write_b32 a153, v49
    v_accvgpr_write_b32 a154, v50
    v_accvgpr_write_b32 a155, v51
    v_accvgpr_read_b32 v48, a156
    v_accvgpr_read_b32 v49, a157
    v_accvgpr_read_b32 v50, a158
    v_accvgpr_read_b32 v51, a159
    v_mul_f32 v48, v7, v48
    v_mul_f32 v49, v7, v49
    v_mul_f32 v50, v7, v50
    v_mul_f32 v51, v7, v51
    v_accvgpr_write_b32 a156, v48
    v_accvgpr_write_b32 a157, v49
    v_accvgpr_write_b32 a158, v50
    v_accvgpr_write_b32 a159, v51
    v_accvgpr_read_b32 v48, a160
    v_accvgpr_read_b32 v49, a161
    v_accvgpr_read_b32 v50, a162
    v_accvgpr_read_b32 v51, a163
    v_mul_f32 v48, v7, v48
    v_mul_f32 v49, v7, v49
    v_mul_f32 v50, v7, v50
    v_mul_f32 v51, v7, v51
    v_accvgpr_write_b32 a160, v48
    v_accvgpr_write_b32 a161, v49
    v_accvgpr_write_b32 a162, v50
    v_accvgpr_write_b32 a163, v51
    v_accvgpr_read_b32 v48, a164
    v_accvgpr_read_b32 v49, a165
    v_accvgpr_read_b32 v50, a166
    v_accvgpr_read_b32 v51, a167
    v_mul_f32 v48, v7, v48
    v_mul_f32 v49, v7, v49
    v_mul_f32 v50, v7, v50
    v_mul_f32 v51, v7, v51
    v_accvgpr_write_b32 a164, v48
    v_accvgpr_write_b32 a165, v49
    v_accvgpr_write_b32 a166, v50
    v_accvgpr_write_b32 a167, v51
    v_accvgpr_read_b32 v48, a168
    v_accvgpr_read_b32 v49, a169
    v_accvgpr_read_b32 v50, a170
    v_accvgpr_read_b32 v51, a171
    v_mul_f32 v48, v7, v48
    v_mul_f32 v49, v7, v49
    v_mul_f32 v50, v7, v50
    v_mul_f32 v51, v7, v51
    v_accvgpr_write_b32 a168, v48
    v_accvgpr_write_b32 a169, v49
    v_accvgpr_write_b32 a170, v50
    v_accvgpr_write_b32 a171, v51
    v_accvgpr_read_b32 v48, a172
    v_accvgpr_read_b32 v49, a173
    v_accvgpr_read_b32 v50, a174
    v_accvgpr_read_b32 v51, a175
    v_mul_f32 v48, v7, v48
    v_mul_f32 v49, v7, v49
    v_mul_f32 v50, v7, v50
    v_mul_f32 v51, v7, v51
    v_accvgpr_write_b32 a172, v48
    v_accvgpr_write_b32 a173, v49
    v_accvgpr_write_b32 a174, v50
    v_accvgpr_write_b32 a175, v51
    v_accvgpr_read_b32 v48, a176
    v_accvgpr_read_b32 v49, a177
    v_accvgpr_read_b32 v50, a178
    v_accvgpr_read_b32 v51, a179
    v_mul_f32 v48, v7, v48
    v_mul_f32 v49, v7, v49
    v_mul_f32 v50, v7, v50
    v_mul_f32 v51, v7, v51
    v_accvgpr_write_b32 a176, v48
    v_accvgpr_write_b32 a177, v49
    v_accvgpr_write_b32 a178, v50
    v_accvgpr_write_b32 a179, v51
    v_accvgpr_read_b32 v48, a180
    v_accvgpr_read_b32 v49, a181
    v_accvgpr_read_b32 v50, a182
    v_accvgpr_read_b32 v51, a183
    v_mul_f32 v48, v7, v48
    v_mul_f32 v49, v7, v49
    v_mul_f32 v50, v7, v50
    v_mul_f32 v51, v7, v51
    v_accvgpr_write_b32 a180, v48
    v_accvgpr_write_b32 a181, v49
    v_accvgpr_write_b32 a182, v50
    v_accvgpr_write_b32 a183, v51
    v_accvgpr_read_b32 v48, a184
    v_accvgpr_read_b32 v49, a185
    v_accvgpr_read_b32 v50, a186
    v_accvgpr_read_b32 v51, a187
    v_mul_f32 v48, v7, v48
    v_mul_f32 v49, v7, v49
    v_mul_f32 v50, v7, v50
    v_mul_f32 v51, v7, v51
    v_accvgpr_write_b32 a184, v48
    v_accvgpr_write_b32 a185, v49
    v_accvgpr_write_b32 a186, v50
    v_accvgpr_write_b32 a187, v51
    v_accvgpr_read_b32 v48, a188
    v_accvgpr_read_b32 v49, a189
    v_accvgpr_read_b32 v50, a190
    v_accvgpr_read_b32 v51, a191
    v_mul_f32 v48, v7, v48
    v_mul_f32 v49, v7, v49
    v_mul_f32 v50, v7, v50
    v_mul_f32 v51, v7, v51
    v_accvgpr_write_b32 a188, v48
    v_accvgpr_write_b32 a189, v49
    v_accvgpr_write_b32 a190, v50
    v_accvgpr_write_b32 a191, v51
    v_sub_f32 v7, v15, v28
    v_exp_f32 v7, v7
    s_nop 0
    v_mul_f32 v11, v7, v11
    v_accvgpr_read_b32 v48, a192
    v_accvgpr_read_b32 v49, a193
    v_accvgpr_read_b32 v50, a194
    v_accvgpr_read_b32 v51, a195
    v_mul_f32 v48, v7, v48
    v_mul_f32 v49, v7, v49
    v_mul_f32 v50, v7, v50
    v_mul_f32 v51, v7, v51
    v_accvgpr_write_b32 a192, v48
    v_accvgpr_write_b32 a193, v49
    v_accvgpr_write_b32 a194, v50
    v_accvgpr_write_b32 a195, v51
    v_accvgpr_read_b32 v48, a196
    v_accvgpr_read_b32 v49, a197
    v_accvgpr_read_b32 v50, a198
    v_accvgpr_read_b32 v51, a199
    v_mul_f32 v48, v7, v48
    v_mul_f32 v49, v7, v49
    v_mul_f32 v50, v7, v50
    v_mul_f32 v51, v7, v51
    v_accvgpr_write_b32 a196, v48
    v_accvgpr_write_b32 a197, v49
    v_accvgpr_write_b32 a198, v50
    v_accvgpr_write_b32 a199, v51
    v_accvgpr_read_b32 v48, a200
    v_accvgpr_read_b32 v49, a201
    v_accvgpr_read_b32 v50, a202
    v_accvgpr_read_b32 v51, a203
    v_mul_f32 v48, v7, v48
    v_mul_f32 v49, v7, v49
    v_mul_f32 v50, v7, v50
    v_mul_f32 v51, v7, v51
    v_accvgpr_write_b32 a200, v48
    v_accvgpr_write_b32 a201, v49
    v_accvgpr_write_b32 a202, v50
    v_accvgpr_write_b32 a203, v51
    v_accvgpr_read_b32 v48, a204
    v_accvgpr_read_b32 v49, a205
    v_accvgpr_read_b32 v50, a206
    v_accvgpr_read_b32 v51, a207
    v_mul_f32 v48, v7, v48
    v_mul_f32 v49, v7, v49
    v_mul_f32 v50, v7, v50
    v_mul_f32 v51, v7, v51
    v_accvgpr_write_b32 a204, v48
    v_accvgpr_write_b32 a205, v49
    v_accvgpr_write_b32 a206, v50
    v_accvgpr_write_b32 a207, v51
    v_accvgpr_read_b32 v48, a208
    v_accvgpr_read_b32 v49, a209
    v_accvgpr_read_b32 v50, a210
    v_accvgpr_read_b32 v51, a211
    v_mul_f32 v48, v7, v48
    v_mul_f32 v49, v7, v49
    v_mul_f32 v50, v7, v50
    v_mul_f32 v51, v7, v51
    v_accvgpr_write_b32 a208, v48
    v_accvgpr_write_b32 a209, v49
    v_accvgpr_write_b32 a210, v50
    v_accvgpr_write_b32 a211, v51
    v_accvgpr_read_b32 v48, a212
    v_accvgpr_read_b32 v49, a213
    v_accvgpr_read_b32 v50, a214
    v_accvgpr_read_b32 v51, a215
    v_mul_f32 v48, v7, v48
    v_mul_f32 v49, v7, v49
    v_mul_f32 v50, v7, v50
    v_mul_f32 v51, v7, v51
    v_accvgpr_write_b32 a212, v48
    v_accvgpr_write_b32 a213, v49
    v_accvgpr_write_b32 a214, v50
    v_accvgpr_write_b32 a215, v51
    v_accvgpr_read_b32 v48, a216
    v_accvgpr_read_b32 v49, a217
    v_accvgpr_read_b32 v50, a218
    v_accvgpr_read_b32 v51, a219
    v_mul_f32 v48, v7, v48
    v_mul_f32 v49, v7, v49
    v_mul_f32 v50, v7, v50
    v_mul_f32 v51, v7, v51
    v_accvgpr_write_b32 a216, v48
    v_accvgpr_write_b32 a217, v49
    v_accvgpr_write_b32 a218, v50
    v_accvgpr_write_b32 a219, v51
    v_accvgpr_read_b32 v48, a220
    v_accvgpr_read_b32 v49, a221
    v_accvgpr_read_b32 v50, a222
    v_accvgpr_read_b32 v51, a223
    v_mul_f32 v48, v7, v48
    v_mul_f32 v49, v7, v49
    v_mul_f32 v50, v7, v50
    v_mul_f32 v51, v7, v51
    v_accvgpr_write_b32 a220, v48
    v_accvgpr_write_b32 a221, v49
    v_accvgpr_write_b32 a222, v50
    v_accvgpr_write_b32 a223, v51
    v_accvgpr_read_b32 v48, a224
    v_accvgpr_read_b32 v49, a225
    v_accvgpr_read_b32 v50, a226
    v_accvgpr_read_b32 v51, a227
    v_mul_f32 v48, v7, v48
    v_mul_f32 v49, v7, v49
    v_mul_f32 v50, v7, v50
    v_mul_f32 v51, v7, v51
    v_accvgpr_write_b32 a224, v48
    v_accvgpr_write_b32 a225, v49
    v_accvgpr_write_b32 a226, v50
    v_accvgpr_write_b32 a227, v51
    v_accvgpr_read_b32 v48, a228
    v_accvgpr_read_b32 v49, a229
    v_accvgpr_read_b32 v50, a230
    v_accvgpr_read_b32 v51, a231
    v_mul_f32 v48, v7, v48
    v_mul_f32 v49, v7, v49
    v_mul_f32 v50, v7, v50
    v_mul_f32 v51, v7, v51
    v_accvgpr_write_b32 a228, v48
    v_accvgpr_write_b32 a229, v49
    v_accvgpr_write_b32 a230, v50
    v_accvgpr_write_b32 a231, v51
    v_accvgpr_read_b32 v48, a232
    v_accvgpr_read_b32 v49, a233
    v_accvgpr_read_b32 v50, a234
    v_accvgpr_read_b32 v51, a235
    v_mul_f32 v48, v7, v48
    v_mul_f32 v49, v7, v49
    v_mul_f32 v50, v7, v50
    v_mul_f32 v51, v7, v51
    v_accvgpr_write_b32 a232, v48
    v_accvgpr_write_b32 a233, v49
    v_accvgpr_write_b32 a234, v50
    v_accvgpr_write_b32 a235, v51
    v_accvgpr_read_b32 v48, a236
    v_accvgpr_read_b32 v49, a237
    v_accvgpr_read_b32 v50, a238
    v_accvgpr_read_b32 v51, a239
    v_mul_f32 v48, v7, v48
    v_mul_f32 v49, v7, v49
    v_mul_f32 v50, v7, v50
    v_mul_f32 v51, v7, v51
    v_accvgpr_write_b32 a236, v48
    v_accvgpr_write_b32 a237, v49
    v_accvgpr_write_b32 a238, v50
    v_accvgpr_write_b32 a239, v51
    v_accvgpr_read_b32 v48, a240
    v_accvgpr_read_b32 v49, a241
    v_accvgpr_read_b32 v50, a242
    v_accvgpr_read_b32 v51, a243
    v_mul_f32 v48, v7, v48
    v_mul_f32 v49, v7, v49
    v_mul_f32 v50, v7, v50
    v_mul_f32 v51, v7, v51
    v_accvgpr_write_b32 a240, v48
    v_accvgpr_write_b32 a241, v49
    v_accvgpr_write_b32 a242, v50
    v_accvgpr_write_b32 a243, v51
    v_accvgpr_read_b32 v48, a244
    v_accvgpr_read_b32 v49, a245
    v_accvgpr_read_b32 v50, a246
    v_accvgpr_read_b32 v51, a247
    v_mul_f32 v48, v7, v48
    v_mul_f32 v49, v7, v49
    v_mul_f32 v50, v7, v50
    v_mul_f32 v51, v7, v51
    v_accvgpr_write_b32 a244, v48
    v_accvgpr_write_b32 a245, v49
    v_accvgpr_write_b32 a246, v50
    v_accvgpr_write_b32 a247, v51
    v_accvgpr_read_b32 v48, a248
    v_accvgpr_read_b32 v49, a249
    v_accvgpr_read_b32 v50, a250
    v_accvgpr_read_b32 v51, a251
    v_mul_f32 v48, v7, v48
    v_mul_f32 v49, v7, v49
    v_mul_f32 v50, v7, v50
    v_mul_f32 v51, v7, v51
    v_accvgpr_write_b32 a248, v48
    v_accvgpr_write_b32 a249, v49
    v_accvgpr_write_b32 a250, v50
    v_accvgpr_write_b32 a251, v51
    v_accvgpr_read_b32 v48, a252
    v_accvgpr_read_b32 v49, a253
    v_accvgpr_read_b32 v50, a254
    v_accvgpr_read_b32 v51, a255
    v_mul_f32 v48, v7, v48
    v_mul_f32 v49, v7, v49
    v_mul_f32 v50, v7, v50
    v_mul_f32 v51, v7, v51
    v_accvgpr_write_b32 a252, v48
    v_accvgpr_write_b32 a253, v49
    v_accvgpr_write_b32 a254, v50
    v_accvgpr_write_b32 a255, v51
L_rare1_a:
    v_sub_f32 v7, v12, v16
    v_add_f32 v64, v64, v7
    v_add_f32 v96, v96, v12
    v_add_f32 v65, v65, v7
    v_add_f32 v97, v97, v12
    v_add_f32 v66, v66, v7
    v_add_f32 v98, v98, v12
    v_add_f32 v67, v67, v7
    v_add_f32 v99, v99, v12
    v_add_f32 v68, v68, v7
    v_add_f32 v100, v100, v12
    v_add_f32 v69, v69, v7
    v_add_f32 v101, v101, v12
    v_add_f32 v70, v70, v7
    v_add_f32 v102, v102, v12
    v_add_f32 v71, v71, v7
    v_add_f32 v103, v103, v12
    v_mov_b32 v16, v12
    v_mov_b32 v17, v12
    v_mov_b32 v18, v12
    v_mov_b32 v19, v12
    v_sub_f32 v7, v13, v20
    v_add_f32 v72, v72, v7
    v_add_f32 v104, v104, v13
    v_add_f32 v73, v73, v7
    v_add_f32 v105, v105, v13
    v_add_f32 v74, v74, v7
    v_add_f32 v106, v106, v13
    v_add_f32 v75, v75, v7
    v_add_f32 v107, v107, v13
    v_add_f32 v76, v76, v7
    v_add_f32 v108, v108, v13
    v_add_f32 v77, v77, v7
    v_add_f32 v109, v109, v13
    v_add_f32 v78, v78, v7
    v_add_f32 v110, v110, v13
    v_add_f32 v79, v79, v7
    v_add_f32 v111, v111, v13
    v_mov_b32 v20, v13
    v_mov_b32 v21, v13
    v_mov_b32 v22, v13
    v_mov_b32 v23, v13
    v_sub_f32 v7, v14, v24
    v_add_f32 v80, v80, v7
    v_add_f32 v112, v112, v14
    v_add_f32 v81, v81, v7
    v_add_f32 v113, v113, v14
    v_add_f32 v82, v82, v7
    v_add_f32 v114, v114, v14
    v_add_f32 v83, v83, v7
    v_add_f32 v115, v115, v14
    v_add_f32 v84, v84, v7
    v_add_f32 v116, v116, v14
    v_add_f32 v85, v85, v7
    v_add_f32 v117, v117, v14
    v_add_f32 v86, v86, v7
    v_add_f32 v118, v118, v14
    v_add_f32 v87, v87, v7
    v_add_f32 v119, v119, v14
    v_mov_b32 v24, v14
    v_mov_b32 v25, v14
    v_mov_b32 v26, v14
    v_mov_b32 v27, v14
    v_sub_f32 v7, v15, v28
    v_add_f32 v88, v88, v7
    v_add_f32 v120, v120, v15
    v_add_f32 v89, v89, v7
    v_add_f32 v121, v121, v15
    v_add_f32 v90, v90, v7
    v_add_f32 v122, v122, v15
    v_add_f32 v91, v91, v7
    v_add_f32 v123, v123, v15
    v_add_f32 v92, v92, v7
    v_add_f32 v124, v124, v15
    v_add_f32 v93, v93, v7
    v_add_f32 v125, v125, v15
    v_add_f32 v94, v94, v7
    v_add_f32 v126, v126, v15
    v_add_f32 v95, v95, v7
    v_add_f32 v127, v127, v15
    v_mov_b32 v28, v15
    v_mov_b32 v29, v15
    v_mov_b32 v30, v15
    v_mov_b32 v31, v15
    v_exp_f32 v96, v96
    v_exp_f32 v97, v97
    v_exp_f32 v98, v98
    v_add_f32 v12, v96, v97
    v_cvt_pk_bf16_f32 v96, v96, v97
    v_exp_f32 v99, v99
    v_add_f32 v12, v12, v98
    v_exp_f32 v100, v100
    v_add_f32 v12, v12, v99
    v_cvt_pk_bf16_f32 v97, v98, v99
    v_exp_f32 v101, v101
    v_add_f32 v12, v12, v100
    v_exp_f32 v102, v102
    v_add_f32 v12, v12, v101
    v_cvt_pk_bf16_f32 v98, v100, v101
    v_exp_f32 v103, v103
    v_add_f32 v12, v12, v102
    v_exp_f32 v104, v104
    v_add_f32 v12, v12, v103
    v_cvt_pk_bf16_f32 v99, v102, v103
    v_exp_f32 v105, v105
    v_exp_f32 v106, v106
    v_add_f32 v13, v104, v105
    v_cvt_pk_bf16_f32 v104, v104, v105
    v_exp_f32 v107, v107
    v_add_f32 v13, v13, v106
    v_exp_f32 v108, v108
    v_add_f32 v13, v13, v107
    v_cvt_pk_bf16_f32 v105, v106, v107
    v_exp_f32 v109, v109
    v_add_f32 v13, v13, v108
    v_exp_f32 v110, v110
    v_add_f32 v13, v13, v109
    v_cvt_pk_bf16_f32 v106, v108, v109
    v_exp_f32 v111, v111
    v_add_f32 v13, v13, v110
    v_exp_f32 v112, v112
    v_add_f32 v13, v13, v111
    v_cvt_pk_bf16_f32 v107, v110, v111
    v_exp_f32 v113, v113
    v_exp_f32 v114, v114
    v_add_f32 v14, v112, v113
    v_cvt_pk_bf16_f32 v112, v112, v113
    v_exp_f32 v115, v115
    v_add_f32 v14, v14, v114
    v_exp_f32 v116, v116
    v_add_f32 v14, v14, v115
    v_cvt_pk_bf16_f32 v113, v114, v115
    v_exp_f32 v117, v117
    v_add_f32 v14, v14, v116
    v_exp_f32 v118, v118
    v_add_f32 v14, v14, v117
    v_cvt_pk_bf16_f32 v114, v116, v117
    v_exp_f32 v119, v119
    v_add_f32 v14, v14, v118
    v_exp_f32 v120, v120
    v_add_f32 v14, v14, v119
    v_cvt_pk_bf16_f32 v115, v118, v119
    v_exp_f32 v121, v121
    v_exp_f32 v122, v122
    v_add_f32 v15, v120, v121
    v_cvt_pk_bf16_f32 v120, v120, v121
    v_exp_f32 v123, v123
    v_add_f32 v15, v15, v122
    v_exp_f32 v124, v124
    v_add_f32 v15, v15, v123
    v_cvt_pk_bf16_f32 v121, v122, v123
    v_exp_f32 v125, v125
    v_add_f32 v15, v15, v124
    v_exp_f32 v126, v126
    v_add_f32 v15, v15, v125
    v_cvt_pk_bf16_f32 v122, v124, v125
    v_exp_f32 v127, v127
    v_add_f32 v15, v15, v126
    v_max3_f32 v7, v12, v13, v14
    v_add_f32 v15, v15, v127
    v_cvt_pk_bf16_f32 v123, v126, v127
    v_add_f32 v7, v7, v15
    s_nop 1
    s_setpc_b64 s[78:79]
L_end:
    s_endpgm
.section .rodata,"a"
.p2align 6
.amdhsa_kernel standalone__conformer_family_branchformer__speech_kernel
.amdhsa_next_free_vgpr 512
.amdhsa_next_free_sgpr 102
.amdhsa_accum_offset 256
.amdhsa_group_segment_fixed_size 0
.amdhsa_kernarg_size 96
.amdhsa_user_sgpr_count 2
.amdhsa_user_sgpr_kernarg_segment_ptr 1
.amdhsa_system_sgpr_workgroup_id_x 1
.end_amdhsa_kernel
```
